```python
import torch

def _softmax(x, axis=-1):
    return torch.softmax(x, dim=axis)
def _gelu(x):
    return torch.nn.functional.gelu(x, approximate="tanh")
def _silu(x):
    return torch.nn.functional.silu(x)
def _sigmoid(x):
    return torch.sigmoid(x)
def _layernorm(x, axis=-1, eps=1e-5):
    m = x.mean(dim=axis, keepdim=True)
    v = x.var(dim=axis, keepdim=True, unbiased=False)
    return (x - m) / torch.sqrt(v + eps)
def _scatter_add(tgt, idx, src, axis=0):
    return tgt.clone().index_add_(axis, idx, src)
def _segment_sum(src, seg, n):
    out = torch.zeros((n,) + src.shape[1:], dtype=src.dtype)
    return out.index_add_(0, seg, src)
def _pad(x, pw):
    flat = tuple(v for pair in reversed(pw) for v in pair)
    return torch.nn.functional.pad(x, flat)

kernel_name = 'standalone__gqa_block_cached__near_ridge'

def setup_inputs():

    _w = (lambda a: (lambda t: t.to(torch.bfloat16) if t.is_floating_point() else t)(torch.as_tensor(a)))
    B, Sq, D = 16, 112, 448
    Hq, Hkv, Sk, Dh = 16, 8, 512, 256
    assert Hq % Hkv == 0, (Hq, Hkv)
    return {
        "x": _w((lambda *s: torch.randn(*s, dtype=torch.bfloat16) * 0.8)(B, Sq, D)),
        "k_cache": _w((lambda *s: torch.randn(*s, dtype=torch.bfloat16) * 0.8)(B, Hkv, Sk, Dh)),
        "v_cache": _w((lambda *s: torch.randn(*s, dtype=torch.bfloat16) * 0.05)(B, Hkv, Sk, Dh)),
        "wq": _w((lambda *s: torch.randn(*s, dtype=torch.bfloat16) * 0.8)(D, Hq * Dh) * (D ** -0.5)),
        "wo": _w((lambda *s: torch.randn(*s, dtype=torch.bfloat16) * 0.05)(Hq * Dh, D) * ((Hq * Dh) ** -0.5)),
    }

def reference(x, k_cache, v_cache, wq, wo):
    B, Sq, D = x.shape
    Hq, Dh = 16, 256
    Hkv = k_cache.shape[1]
    rep = Hq // Hkv
    q = (lambda x, *d: x.permute(*d))((x @ wq).reshape(B, Sq, Hq, Dh), 0, 2, 1, 3)
    k = (lambda x, n, axis: torch.repeat_interleave(x, n, dim=axis))(k_cache, rep, axis=1)
    v = (lambda x, n, axis: torch.repeat_interleave(x, n, dim=axis))(v_cache, rep, axis=1)
    scores = torch.einsum("bhqd,bhkd->bhqk", q, k) * (Dh ** -0.5)
    p = _softmax(scores, axis=-1)
    o = torch.einsum("bhqk,bhkd->bhqd", p, v)
    return (lambda x, *d: x.permute(*d))(o, 0, 2, 1, 3).reshape(B, Sq, Hq * Dh) @ wo
```

```asm
; @launch grid=(256,1,1) block=(256,1,1) lds=163840
.amdgcn_target "amdgcn-amd-amdhsa--gfx950"
.text
.globl standalone__gqa_block_cached__near_ridge_kernel
.p2align 8
.type standalone__gqa_block_cached__near_ridge_kernel,@function
standalone__gqa_block_cached__near_ridge_kernel:
    s_cmp_ge_u32 s2, 256
    s_cbranch_scc1 L_exit
    s_load_dwordx8 s[8:15], s[0:1], 0
    s_load_dwordx2 s[4:5], s[0:1], 32
    s_load_dwordx2 s[64:65], s[0:1], 40
    s_load_dwordx2 s[6:7], s[0:1], 56
    s_getpc_b64 s[24:25]
L_pc:
    s_mov_b32 s26, L_end-L_pc
    s_mov_b32 s27, 0x20000
    v_lshlrev_b32 v54, 7, v0
    v_lshrrev_b32 v55, 4, v0
    s_lshr_b32 s40, s2, 3
    s_lshl_b32 s40, s40, 11
    v_lshl_add_u32 v54, v55, 24, v54
    buffer_load_dword v56, v54, s[24:27], s40 offen
    v_lshrrev_b32 v50, 6, v0
    v_and_b32 v53, 63, v0
    v_readfirstlane_b32 s3, v50
    v_lshrrev_b32 v46, 3, v53
    v_and_b32 v47, 7, v53
    v_lshrrev_b32 v48, 4, v53
    v_and_b32 v49, 15, v53
    s_bfe_u32 s46, s2, 0x10003
    s_and_b32 s55, s2, 7
    s_lshr_b32 s58, s2, 4
    s_mov_b32 s47, s58
    s_mov_b32 s41, s46
    s_lshl_b32 s56, s55, 1
    s_add_u32 s56, s56, s46
    s_lshl_b32 s40, s41, 2
    s_add_u32 s40, s40, s47
    s_mul_i32 s43, s40, 37
    s_lshr_b32 s43, s43, 8
    s_mul_i32 s43, s43, 7
    s_sub_u32 s40, s40, s43
    s_lshl_b32 s48, s40, 7
    s_mul_i32 s42, s3, 24576
    s_lshl_b32 s45, s3, 12
    s_add_u32 s45, s45, 98304
    v_lshl_add_u32 v40, v50, 5, v46
    v_mul_u32_u24 v41, 896, v40
    v_xor_b32 v42, v47, v48
    v_lshlrev_b32 v42, 4, v42
    v_xor_b32 v43, 64, v42
    v_add_u32 v116, v41, v42
    v_add_u32 v117, v41, v43
    v_add_u32 v118, 12288, v116
    v_add_u32 v119, 18432, v117
    v_add_u32 v117, 6144, v117
    v_and_b32 v42, 1, v48
    v_lshlrev_b32 v42, 1, v42
    v_xor_b32 v42, v47, v42
    v_lshlrev_b32 v42, 4, v42
    v_lshl_add_u32 v42, v50, 7, v42
    v_lshl_add_u32 v120, v46, 13, v42
    v_xor_b32 v121, 64, v120
    v_add_u32 v122, 129024, v120
    v_add_u32 v123, 193536, v121
    v_add_u32 v121, 64512, v121
    s_mov_b32 s18, 100352
    s_mov_b32 s19, 0x20000
    s_mul_i32 s16, s58, 100352
    s_lshl_b32 s20, s56, 9
    s_sub_u32 s22, 3670016, s20
    s_mov_b32 s23, 0x20000
    s_waitcnt lgkmcnt(0)
    s_add_u32 s16, s8, s16
    s_addc_u32 s17, s9, 0
    s_add_u32 s20, s14, s20
    s_addc_u32 s21, s15, 0
    s_add_u32 m0, s45, 0
    s_mov_b32 s43, s48
    buffer_load_dwordx4 v116, s[16:19], s43 offen offset:0 lds
    buffer_load_dwordx4 v117, s[16:19], s43 offen offset:1024 lds
    buffer_load_dwordx4 v118, s[16:19], s43 offen offset:2048 lds
    buffer_load_dwordx4 v119, s[16:19], s43 offen offset:3072 lds
    s_add_u32 m0, s42, 0
    s_lshl_b32 s43, s48, 12
    buffer_load_dwordx4 v120, s[20:23], s43 offen offset:0 lds
    buffer_load_dwordx4 v121, s[20:23], s43 offen offset:1024 lds
    buffer_load_dwordx4 v122, s[20:23], s43 offen offset:2048 lds
    buffer_load_dwordx4 v123, s[20:23], s43 offen offset:3072 lds
    s_add_u32 m0, s42, 4096
    s_lshl_b32 s43, s48, 12
    s_bitset1_b32 s43, 18
    buffer_load_dwordx4 v120, s[20:23], s43 offen offset:0 lds
    buffer_load_dwordx4 v121, s[20:23], s43 offen offset:1024 lds
    buffer_load_dwordx4 v122, s[20:23], s43 offen offset:2048 lds
    buffer_load_dwordx4 v123, s[20:23], s43 offen offset:3072 lds
    s_add_u32 s49, s48, 128
    s_cmp_eq_u32 s49, 896
    s_cselect_b32 s49, 0, s49
    s_add_u32 s50, s49, 128
    s_cmp_eq_u32 s50, 896
    s_cselect_b32 s50, 0, s50
    s_add_u32 s51, s50, 128
    s_cmp_eq_u32 s51, 896
    s_cselect_b32 s51, 0, s51
    s_add_u32 s52, s51, 128
    s_cmp_eq_u32 s52, 896
    s_cselect_b32 s52, 0, s52
    s_add_u32 s53, s52, 128
    s_cmp_eq_u32 s53, 896
    s_cselect_b32 s53, 0, s53
    s_add_u32 s54, s53, 128
    s_cmp_eq_u32 s54, 896
    s_cselect_b32 s54, 0, s54
    s_mov_b32 s44, 0x3db8aa3b
    s_lshl_b32 s59, s3, 11
    s_mul_i32 s40, s47, 16
    v_add_u32 v58, s40, v46
    v_mul_u32_u24 v59, 4, v50
    v_add_u32 v58, v58, v59
    v_mul_u32_u24 v58, 896, v58
    v_lshl_add_u32 v11, v47, 7, v58
    v_cmp_gt_u32 vcc, 32, v53
    v_mov_b32 v59, 0x7ffffff0
    v_bfe_u32 v51, v53, 2, 2
    v_cndmask_b32 v11, v59, v11, vcc
    v_and_b32 v52, 3, v53
    v_lshlrev_b32 v10, 4, v53
    v_bfe_u32 v42, v53, 1, 3
    v_xor_b32 v42, v42, v48
    v_lshlrev_b32 v42, 4, v42
    v_lshl_add_u32 v42, v49, 7, v42
    v_add_u32 v124, 98304, v42
    v_xor_b32 v125, 64, v124
    v_lshrrev_b32 v44, 1, v51
    v_and_b32 v42, 1, v48
    v_lshl_add_u32 v45, v42, 1, v44
    v_lshlrev_b32 v43, 3, v52
    v_lshl_add_u32 v43, v45, 5, v43
    v_add_u32 v44, s42, v43
    v_lshl_add_u32 v42, v48, 3, v51
    v_lshl_add_u32 v126, v42, 7, v44
    v_xor_b32 v127, 32, v126
    v_xor_b32 v128, 64, v126
    v_xor_b32 v129, 96, v126
    v_lshlrev_b32 v128, 1, v45
    v_xor_b32 v128, v128, v52
    v_lshlrev_b32 v128, 4, v128
    v_lshl_add_u32 v128, v42, 7, v128
    v_add_u32 v126, s42, v128
    v_xor_b32 v127, 64, v126
    v_lshl_add_u32 v42, v48, 2, v51
    v_lshl_add_u32 v16, v42, 7, v44
    v_xor_b32 v17, 32, v16
    v_xor_b32 v18, 64, v16
    v_xor_b32 v19, 96, v16
    v_lshl_add_u32 v20, v42, 7, v43
    v_lshlrev_b32 v42, 5, v50
    v_xor_b32 v20, v20, v42
    v_add_u32 v21, 49152, v20
    v_xor_b32 v43, v48, v49
    v_lshlrev_b32 v43, 4, v43
    v_lshl_add_u32 v42, v49, 8, v43
    v_add_u32 v12, s42, v42
    v_xor_b32 v13, 64, v12
    v_xor_b32 v14, 128, v12
    v_xor_b32 v15, 192, v12
    v_lshl_add_u32 v42, v50, 5, v48
    v_lshl_add_u32 v1, v42, 9, v43
    v_xor_b32 v2, 64, v1
    v_add_u32 v2, 1024, v2
    v_xor_b32 v3, 128, v1
    v_add_u32 v3, 2048, v3
    v_xor_b32 v4, 192, v1
    v_add_u32 v4, 3072, v4
    v_lshlrev_b32 v42, 1, v48
    v_xor_b32 v42, v47, v42
    v_lshlrev_b32 v42, 4, v42
    v_add_u32 v9, v41, v42
    v_lshl_add_u32 v42, v50, 7, v42
    v_lshl_add_u32 v5, v46, 9, v42
    v_add_u32 v6, 3072, v5
    v_add_u32 v7, 6144, v5
    v_add_u32 v8, 9216, v5
    v_add_u32 v22, 98304, v10
    v_mul_u32_u24 v42, 7168, v50
    v_add_u32 v23, v22, v42
    v_add_u32 v24, v23, v42
    v_lshrrev_b32 v43, 1, v48
    v_lshl_add_u32 v43, v43, 4, v49
    v_and_b32 v44, 1, v48
    v_lshlrev_b32 v44, 3, v44
    v_lshl_add_u32 v43, v43, 4, v44
    v_lshl_add_u32 v43, v42, 1, v43
    v_add_u32 v130, 98304, v43
    s_mov_b32 s26, 262144
    s_mov_b32 s27, 0x20000
    s_mov_b32 s30, 262144
    s_mov_b32 s31, 0x20000
    s_mov_b32 s34, 229376
    s_mov_b32 s35, 0x20000
    s_mov_b32 s38, 25088
    s_mov_b32 s39, 0x20000
    s_mov_b32 s66, 100352
    s_mov_b32 s67, 0x20000
    s_mov_b32 s62, 1605632
    s_mov_b32 s63, 0x20000
    s_lshl_b32 s40, s58, 3
    s_add_u32 s40, s40, s55
    s_lshl_b32 s28, s40, 18
    s_mul_i32 s32, s56, 229376
    s_lshl_b32 s40, s58, 4
    s_add_u32 s40, s40, s56
    s_lshl_b32 s40, s40, 2
    s_add_u32 s40, s40, s3
    s_mul_i32 s36, s40, 25088
    s_mul_i32 s60, s58, 1605632
    s_lshl_b32 s40, s58, 1
    s_add_u32 s40, s40, s56
    s_and_b32 s55, s40, 15
    s_and_b32 s40, s55, 1
    s_mul_i32 s57, s40, 50176
    s_lshr_b32 s40, s55, 2
    s_lshl_b32 s40, s40, 10
    s_add_u32 s57, s57, s40
    s_bfe_u32 s40, s55, 0x10001
    s_lshl_b32 s40, s40, 7
    s_add_u32 s57, s57, s40
    s_cmp_ge_u32 s55, 12
    s_cselect_b32 s40, 7, 8
    s_lshl_b32 s40, s3, s40
    s_add_u32 s57, s57, s40
    s_cmp_ge_u32 s55, 14
    s_cselect_b32 s62, 0, s62
    s_cselect_b32 s66, 0, s66
    s_lshl_b32 s46, s58, 2
    s_and_b32 s40, s55, 1
    s_lshl_b32 s40, s40, 1
    s_add_u32 s40, s40, s46
    s_lshl_b32 s40, s40, 11
    s_add_u32 s41, s40, 33554432
    s_add_u32 s40, s46, s3
    s_lshl_b32 s40, s40, 4
    s_add_u32 s40, s40, s56
    s_lshl_b32 s40, s40, 7
    s_add_u32 s46, s40, 33554432
    s_mul_i32 s40, s58, 100352
    s_add_u32 s24, s10, s28
    s_addc_u32 s25, s11, 0
    s_add_u32 s28, s12, s28
    s_addc_u32 s29, s13, 0
    s_add_u32 s32, s4, s32
    s_addc_u32 s33, s5, 0
    s_add_u32 s36, s6, s36
    s_addc_u32 s37, s7, 0
    s_add_u32 s64, s64, s40
    s_addc_u32 s65, s65, 0
    s_add_u32 s60, s6, s60
    s_addc_u32 s61, s7, 0
    s_add_u32 s8, s6, s41
    s_addc_u32 s9, s7, 0
    s_mov_b32 s10, 4096
    s_mov_b32 s11, 0x20000
    s_add_u32 s12, s6, s46
    s_addc_u32 s13, s7, 0
    s_mov_b32 s14, 128
    s_mov_b32 s15, 0x20000
    s_add_u32 m0, s45, 16384
    s_mov_b32 s43, s49
    buffer_load_dwordx4 v116, s[16:19], s43 offen offset:0 lds
    buffer_load_dwordx4 v117, s[16:19], s43 offen offset:1024 lds
    buffer_load_dwordx4 v118, s[16:19], s43 offen offset:2048 lds
    buffer_load_dwordx4 v119, s[16:19], s43 offen offset:3072 lds
    s_add_u32 m0, s42, 8192
    s_lshl_b32 s43, s49, 12
    buffer_load_dwordx4 v120, s[20:23], s43 offen offset:0 lds
    buffer_load_dwordx4 v121, s[20:23], s43 offen offset:1024 lds
    buffer_load_dwordx4 v122, s[20:23], s43 offen offset:2048 lds
    buffer_load_dwordx4 v123, s[20:23], s43 offen offset:3072 lds
    s_add_u32 m0, s42, 12288
    s_lshl_b32 s43, s49, 12
    s_bitset1_b32 s43, 18
    buffer_load_dwordx4 v120, s[20:23], s43 offen offset:0 lds
    buffer_load_dwordx4 v121, s[20:23], s43 offen offset:1024 lds
    buffer_load_dwordx4 v122, s[20:23], s43 offen offset:2048 lds
    buffer_load_dwordx4 v123, s[20:23], s43 offen offset:3072 lds
    s_waitcnt vmcnt(20)
    s_barrier
    s_waitcnt vmcnt(16)
    s_waitcnt vmcnt(12)
    ds_read_b64_tr_b16 a[0:1], v126 offset:0
    ds_read_b64_tr_b16 a[2:3], v126 offset:512
    ds_read_b64_tr_b16 a[4:5], v126 offset:8
    ds_read_b64_tr_b16 a[6:7], v126 offset:520
    ds_read_b64_tr_b16 a[8:9], v127 offset:0
    ds_read_b64_tr_b16 a[10:11], v127 offset:512
    ds_read_b64_tr_b16 a[12:13], v127 offset:8
    ds_read_b64_tr_b16 a[14:15], v127 offset:520
    ds_read_b64_tr_b16 a[16:17], v126 offset:4096
    ds_read_b64_tr_b16 a[18:19], v126 offset:4608
    ds_read_b64_tr_b16 a[20:21], v126 offset:4104
    ds_read_b64_tr_b16 a[22:23], v126 offset:4616
    ds_read_b64_tr_b16 a[24:25], v127 offset:4096
    s_waitcnt lgkmcnt(9)
    ds_read_b64_tr_b16 a[26:27], v127 offset:4608
    ds_read_b64_tr_b16 a[28:29], v127 offset:4104
    ds_read_b64_tr_b16 a[30:31], v127 offset:4616
    ds_read_b128 a[64:67], v124 offset:0
    s_waitcnt lgkmcnt(9)
    ds_read_b128 a[92:95], v125 offset:0
    ds_read_b128 a[68:71], v124 offset:2048
    s_waitcnt lgkmcnt(2)
    v_mfma_f32_16x16x32_bf16 v[144:147], a[0:3], a[64:67], 0
    ds_read_b128 a[96:99], v125 offset:2048
    s_add_u32 m0, s45, 32768
    s_waitcnt lgkmcnt(2)
    v_mfma_f32_16x16x32_bf16 v[144:147], a[16:19], a[92:95], v[144:147]
    s_mov_b32 s43, s50
    v_mfma_f32_16x16x32_bf16 v[148:151], a[4:7], a[64:67], 0
    buffer_load_dwordx4 v116, s[16:19], s43 offen offset:0 lds
    v_mfma_f32_16x16x32_bf16 v[148:151], a[20:23], a[92:95], v[148:151]
    ds_read_b128 a[72:75], v124 offset:4096
    v_mfma_f32_16x16x32_bf16 v[152:155], a[8:11], a[64:67], 0
    v_mfma_f32_16x16x32_bf16 v[152:155], a[24:27], a[92:95], v[152:155]
    ds_read_b128 a[100:103], v125 offset:4096
    v_mfma_f32_16x16x32_bf16 v[156:159], a[12:15], a[64:67], 0
    s_waitcnt vmcnt(5)
    buffer_load_dwordx4 v117, s[16:19], s43 offen offset:1024 lds
    v_mfma_f32_16x16x32_bf16 v[156:159], a[28:31], a[92:95], v[156:159]
    ds_read_b128 a[76:79], v124 offset:6144
    s_waitcnt lgkmcnt(4)
    v_mfma_f32_16x16x32_bf16 v[160:163], a[0:3], a[68:71], 0
    ds_read_b64_tr_b16 a[32:33], v126 offset:8192
    s_waitcnt lgkmcnt(4)
    v_mfma_f32_16x16x32_bf16 v[160:163], a[16:19], a[96:99], v[160:163]
    ds_read_b128 a[104:107], v125 offset:6144
    v_mfma_f32_16x16x32_bf16 v[164:167], a[4:7], a[68:71], 0
    buffer_load_dwordx4 v118, s[16:19], s43 offen offset:2048 lds
    v_mfma_f32_16x16x32_bf16 v[164:167], a[20:23], a[96:99], v[164:167]
    ds_read_b128 a[80:83], v124 offset:8192
    v_mfma_f32_16x16x32_bf16 v[168:171], a[8:11], a[68:71], 0
    ds_read_b64_tr_b16 a[34:35], v126 offset:8704
    v_mfma_f32_16x16x32_bf16 v[168:171], a[24:27], a[96:99], v[168:171]
    ds_read_b128 a[108:111], v125 offset:8192
    v_mfma_f32_16x16x32_bf16 v[172:175], a[12:15], a[68:71], 0
    buffer_load_dwordx4 v119, s[16:19], s43 offen offset:3072 lds
    v_mfma_f32_16x16x32_bf16 v[172:175], a[28:31], a[96:99], v[172:175]
    ds_read_b128 a[84:87], v124 offset:10240
    s_add_u32 m0, s42, 16384
    s_waitcnt lgkmcnt(8)
    v_mfma_f32_16x16x32_bf16 v[176:179], a[0:3], a[72:75], 0
    ds_read_b64_tr_b16 a[36:37], v126 offset:8200
    s_lshl_b32 s43, s50, 12
    s_waitcnt lgkmcnt(8)
    v_mfma_f32_16x16x32_bf16 v[176:179], a[16:19], a[100:103], v[176:179]
    ds_read_b128 a[112:115], v125 offset:10240
    v_mfma_f32_16x16x32_bf16 v[180:183], a[4:7], a[72:75], 0
    buffer_load_dwordx4 v120, s[20:23], s43 offen offset:0 lds
    v_mfma_f32_16x16x32_bf16 v[180:183], a[20:23], a[100:103], v[180:183]
    ds_read_b128 a[88:91], v124 offset:12288
    v_mfma_f32_16x16x32_bf16 v[184:187], a[8:11], a[72:75], 0
    ds_read_b64_tr_b16 a[38:39], v126 offset:8712
    v_mfma_f32_16x16x32_bf16 v[184:187], a[24:27], a[100:103], v[184:187]
    ds_read_b128 a[116:119], v125 offset:12288
    v_mfma_f32_16x16x32_bf16 v[188:191], a[12:15], a[72:75], 0
    buffer_load_dwordx4 v121, s[20:23], s43 offen offset:1024 lds
    v_mfma_f32_16x16x32_bf16 v[188:191], a[28:31], a[100:103], v[188:191]
    ds_read_b64_tr_b16 a[40:41], v127 offset:8192
    s_waitcnt lgkmcnt(12)
    v_mfma_f32_16x16x32_bf16 v[192:195], a[0:3], a[76:79], 0
    ds_read_b64_tr_b16 a[42:43], v127 offset:8704
    s_waitcnt lgkmcnt(11)
    v_mfma_f32_16x16x32_bf16 v[192:195], a[16:19], a[104:107], v[192:195]
    ds_read_b64_tr_b16 a[44:45], v127 offset:8200
    v_mfma_f32_16x16x32_bf16 v[196:199], a[4:7], a[76:79], 0
    buffer_load_dwordx4 v122, s[20:23], s43 offen offset:2048 lds
    v_mfma_f32_16x16x32_bf16 v[196:199], a[20:23], a[104:107], v[196:199]
    ds_read_b64_tr_b16 a[46:47], v127 offset:8712
    v_mfma_f32_16x16x32_bf16 v[200:203], a[8:11], a[76:79], 0
    v_mfma_f32_16x16x32_bf16 v[200:203], a[24:27], a[104:107], v[200:203]
    v_mfma_f32_16x16x32_bf16 v[204:207], a[12:15], a[76:79], 0
    s_waitcnt vmcnt(7)
    buffer_load_dwordx4 v123, s[20:23], s43 offen offset:3072 lds
    v_mfma_f32_16x16x32_bf16 v[204:207], a[28:31], a[104:107], v[204:207]
    s_waitcnt lgkmcnt(9)
    ds_read_b64_tr_b16 a[48:49], v126 offset:12288
    s_add_u32 m0, s42, 20480
    v_mfma_f32_16x16x32_bf16 v[208:211], a[0:3], a[80:83], 0
    ds_read_b64_tr_b16 a[50:51], v126 offset:12800
    s_lshl_b32 s43, s50, 12
    v_mfma_f32_16x16x32_bf16 v[208:211], a[16:19], a[108:111], v[208:211]
    ds_read_b64_tr_b16 a[52:53], v126 offset:12296
    s_bitset1_b32 s43, 18
    v_mfma_f32_16x16x32_bf16 v[212:215], a[4:7], a[80:83], 0
    buffer_load_dwordx4 v120, s[20:23], s43 offen offset:0 lds
    v_mfma_f32_16x16x32_bf16 v[212:215], a[20:23], a[108:111], v[212:215]
    ds_read_b64_tr_b16 a[54:55], v126 offset:12808
    v_mfma_f32_16x16x32_bf16 v[216:219], a[8:11], a[80:83], 0
    s_waitcnt lgkmcnt(9)
    ds_read_b64_tr_b16 a[56:57], v127 offset:12288
    v_mfma_f32_16x16x32_bf16 v[216:219], a[24:27], a[108:111], v[216:219]
    ds_read_b64_tr_b16 a[58:59], v127 offset:12800
    v_mfma_f32_16x16x32_bf16 v[220:223], a[12:15], a[80:83], 0
    buffer_load_dwordx4 v121, s[20:23], s43 offen offset:1024 lds
    v_mfma_f32_16x16x32_bf16 v[220:223], a[28:31], a[108:111], v[220:223]
    ds_read_b64_tr_b16 a[60:61], v127 offset:12296
    v_mfma_f32_16x16x32_bf16 v[224:227], a[0:3], a[84:87], 0
    s_waitcnt lgkmcnt(11)
    s_barrier
    ds_read_b128 a[120:123], v124 offset:16384
    v_mfma_f32_16x16x32_bf16 v[224:227], a[16:19], a[112:115], v[224:227]
    ds_read_b64_tr_b16 a[62:63], v127 offset:12808
    v_mfma_f32_16x16x32_bf16 v[228:231], a[4:7], a[84:87], 0
    buffer_load_dwordx4 v122, s[20:23], s43 offen offset:2048 lds
    v_mfma_f32_16x16x32_bf16 v[228:231], a[20:23], a[112:115], v[228:231]
    s_waitcnt lgkmcnt(9)
    ds_read_b128 a[148:151], v125 offset:16384
    v_mfma_f32_16x16x32_bf16 v[232:235], a[8:11], a[84:87], 0
    v_mfma_f32_16x16x32_bf16 v[232:235], a[24:27], a[112:115], v[232:235]
    ds_read_b128 a[124:127], v124 offset:18432
    v_mfma_f32_16x16x32_bf16 v[236:239], a[12:15], a[84:87], 0
    buffer_load_dwordx4 v123, s[20:23], s43 offen offset:3072 lds
    v_mfma_f32_16x16x32_bf16 v[236:239], a[28:31], a[112:115], v[236:239]
    ds_read_b128 a[152:155], v125 offset:18432
    s_add_u32 m0, s45, 49152
    v_mfma_f32_16x16x32_bf16 v[240:243], a[0:3], a[88:91], 0
    s_mov_b32 s43, s51
    v_mfma_f32_16x16x32_bf16 v[240:243], a[16:19], a[116:119], v[240:243]
    ds_read_b128 a[128:131], v124 offset:20480
    v_mfma_f32_16x16x32_bf16 v[244:247], a[4:7], a[88:91], 0
    buffer_load_dwordx4 v116, s[16:19], s43 offen offset:0 lds
    v_mfma_f32_16x16x32_bf16 v[244:247], a[20:23], a[116:119], v[244:247]
    s_waitcnt lgkmcnt(9)
    ds_read_b128 a[156:159], v125 offset:20480
    v_mfma_f32_16x16x32_bf16 v[248:251], a[8:11], a[88:91], 0
    v_mfma_f32_16x16x32_bf16 v[248:251], a[24:27], a[116:119], v[248:251]
    ds_read_b128 a[132:135], v124 offset:22528
    v_mfma_f32_16x16x32_bf16 v[252:255], a[12:15], a[88:91], 0
    buffer_load_dwordx4 v117, s[16:19], s43 offen offset:1024 lds
    v_mfma_f32_16x16x32_bf16 v[252:255], a[28:31], a[116:119], v[252:255]
    ds_read_b128 a[160:163], v125 offset:22528
    s_waitcnt lgkmcnt(8)
    v_mfma_f32_16x16x32_bf16 v[144:147], a[32:35], a[120:123], v[144:147]
    s_waitcnt lgkmcnt(6)
    v_mfma_f32_16x16x32_bf16 v[144:147], a[48:51], a[148:151], v[144:147]
    ds_read_b128 a[136:139], v124 offset:24576
    v_mfma_f32_16x16x32_bf16 v[148:151], a[36:39], a[120:123], v[148:151]
    buffer_load_dwordx4 v118, s[16:19], s43 offen offset:2048 lds
    v_mfma_f32_16x16x32_bf16 v[148:151], a[52:55], a[148:151], v[148:151]
    ds_read_b128 a[164:167], v125 offset:24576
    v_mfma_f32_16x16x32_bf16 v[152:155], a[40:43], a[120:123], v[152:155]
    v_mfma_f32_16x16x32_bf16 v[152:155], a[56:59], a[148:151], v[152:155]
    ds_read_b128 a[140:143], v124 offset:26624
    v_mfma_f32_16x16x32_bf16 v[156:159], a[44:47], a[120:123], v[156:159]
    s_waitcnt vmcnt(7)
    buffer_load_dwordx4 v119, s[16:19], s43 offen offset:3072 lds
    v_mfma_f32_16x16x32_bf16 v[156:159], a[60:63], a[148:151], v[156:159]
    ds_read_b128 a[168:171], v125 offset:26624
    s_add_u32 m0, s42, 0
    s_waitcnt lgkmcnt(9)
    v_mfma_f32_16x16x32_bf16 v[160:163], a[32:35], a[124:127], v[160:163]
    ds_read_b64_tr_b16 a[0:1], v126 offset:16384
    s_lshl_b32 s43, s51, 12
    s_waitcnt lgkmcnt(9)
    v_mfma_f32_16x16x32_bf16 v[160:163], a[48:51], a[152:155], v[160:163]
    ds_read_b128 a[144:147], v124 offset:28672
    v_mfma_f32_16x16x32_bf16 v[164:167], a[36:39], a[124:127], v[164:167]
    buffer_load_dwordx4 v120, s[20:23], s43 offen offset:0 lds
    v_mfma_f32_16x16x32_bf16 v[164:167], a[52:55], a[152:155], v[164:167]
    ds_read_b128 a[172:175], v125 offset:28672
    v_mfma_f32_16x16x32_bf16 v[168:171], a[40:43], a[124:127], v[168:171]
    ds_read_b64_tr_b16 a[2:3], v126 offset:16896
    v_mfma_f32_16x16x32_bf16 v[168:171], a[56:59], a[152:155], v[168:171]
    ds_read_b64_tr_b16 a[4:5], v126 offset:16392
    v_mfma_f32_16x16x32_bf16 v[172:175], a[44:47], a[124:127], v[172:175]
    buffer_load_dwordx4 v121, s[20:23], s43 offen offset:1024 lds
    v_mfma_f32_16x16x32_bf16 v[172:175], a[60:63], a[152:155], v[172:175]
    s_waitcnt lgkmcnt(9)
    ds_read_b64_tr_b16 a[6:7], v126 offset:16904
    v_mfma_f32_16x16x32_bf16 v[176:179], a[32:35], a[128:131], v[176:179]
    ds_read_b64_tr_b16 a[8:9], v127 offset:16384
    v_mfma_f32_16x16x32_bf16 v[176:179], a[48:51], a[156:159], v[176:179]
    ds_read_b64_tr_b16 a[10:11], v127 offset:16896
    v_mfma_f32_16x16x32_bf16 v[180:183], a[36:39], a[128:131], v[180:183]
    buffer_load_dwordx4 v122, s[20:23], s43 offen offset:2048 lds
    v_mfma_f32_16x16x32_bf16 v[180:183], a[52:55], a[156:159], v[180:183]
    ds_read_b64_tr_b16 a[12:13], v127 offset:16392
    v_mfma_f32_16x16x32_bf16 v[184:187], a[40:43], a[128:131], v[184:187]
    s_waitcnt lgkmcnt(9)
    ds_read_b64_tr_b16 a[14:15], v127 offset:16904
    v_mfma_f32_16x16x32_bf16 v[184:187], a[56:59], a[156:159], v[184:187]
    v_mfma_f32_16x16x32_bf16 v[188:191], a[44:47], a[128:131], v[188:191]
    buffer_load_dwordx4 v123, s[20:23], s43 offen offset:3072 lds
    v_mfma_f32_16x16x32_bf16 v[188:191], a[60:63], a[156:159], v[188:191]
    s_add_u32 m0, s42, 4096
    s_lshl_b32 s43, s51, 12
    v_mfma_f32_16x16x32_bf16 v[192:195], a[32:35], a[132:135], v[192:195]
    s_bitset1_b32 s43, 18
    v_mfma_f32_16x16x32_bf16 v[192:195], a[48:51], a[160:163], v[192:195]
    v_mfma_f32_16x16x32_bf16 v[196:199], a[36:39], a[132:135], v[196:199]
    buffer_load_dwordx4 v120, s[20:23], s43 offen offset:0 lds
    v_mfma_f32_16x16x32_bf16 v[196:199], a[52:55], a[160:163], v[196:199]
    v_mfma_f32_16x16x32_bf16 v[200:203], a[40:43], a[132:135], v[200:203]
    v_mfma_f32_16x16x32_bf16 v[200:203], a[56:59], a[160:163], v[200:203]
    v_mfma_f32_16x16x32_bf16 v[204:207], a[44:47], a[132:135], v[204:207]
    s_waitcnt vmcnt(9)
    buffer_load_dwordx4 v121, s[20:23], s43 offen offset:1024 lds
    v_mfma_f32_16x16x32_bf16 v[204:207], a[60:63], a[160:163], v[204:207]
    ds_read_b64_tr_b16 a[16:17], v126 offset:20480
    v_mfma_f32_16x16x32_bf16 v[208:211], a[32:35], a[136:139], v[208:211]
    ds_read_b64_tr_b16 a[18:19], v126 offset:20992
    v_mfma_f32_16x16x32_bf16 v[208:211], a[48:51], a[164:167], v[208:211]
    ds_read_b64_tr_b16 a[20:21], v126 offset:20488
    v_mfma_f32_16x16x32_bf16 v[212:215], a[36:39], a[136:139], v[212:215]
    buffer_load_dwordx4 v122, s[20:23], s43 offen offset:2048 lds
    v_mfma_f32_16x16x32_bf16 v[212:215], a[52:55], a[164:167], v[212:215]
    s_waitcnt lgkmcnt(9)
    ds_read_b64_tr_b16 a[22:23], v126 offset:21000
    v_mfma_f32_16x16x32_bf16 v[216:219], a[40:43], a[136:139], v[216:219]
    ds_read_b64_tr_b16 a[24:25], v127 offset:20480
    v_mfma_f32_16x16x32_bf16 v[216:219], a[56:59], a[164:167], v[216:219]
    ds_read_b64_tr_b16 a[26:27], v127 offset:20992
    v_mfma_f32_16x16x32_bf16 v[220:223], a[44:47], a[136:139], v[220:223]
    buffer_load_dwordx4 v123, s[20:23], s43 offen offset:3072 lds
    v_mfma_f32_16x16x32_bf16 v[220:223], a[60:63], a[164:167], v[220:223]
    ds_read_b64_tr_b16 a[28:29], v127 offset:20488
    s_add_u32 m0, s45, 0
    v_mfma_f32_16x16x32_bf16 v[224:227], a[32:35], a[140:143], v[224:227]
    s_barrier
    s_waitcnt lgkmcnt(9)
    ds_read_b128 a[64:67], v124 offset:32768
    s_mov_b32 s43, s52
    v_mfma_f32_16x16x32_bf16 v[224:227], a[48:51], a[168:171], v[224:227]
    ds_read_b64_tr_b16 a[30:31], v127 offset:21000
    v_mfma_f32_16x16x32_bf16 v[228:231], a[36:39], a[140:143], v[228:231]
    buffer_load_dwordx4 v116, s[16:19], s43 offen offset:0 lds
    v_mfma_f32_16x16x32_bf16 v[228:231], a[52:55], a[168:171], v[228:231]
    ds_read_b128 a[92:95], v125 offset:32768
    v_mfma_f32_16x16x32_bf16 v[232:235], a[40:43], a[140:143], v[232:235]
    v_mfma_f32_16x16x32_bf16 v[232:235], a[56:59], a[168:171], v[232:235]
    ds_read_b128 a[68:71], v124 offset:34816
    v_mfma_f32_16x16x32_bf16 v[236:239], a[44:47], a[140:143], v[236:239]
    buffer_load_dwordx4 v117, s[16:19], s43 offen offset:1024 lds
    v_mfma_f32_16x16x32_bf16 v[236:239], a[60:63], a[168:171], v[236:239]
    s_waitcnt lgkmcnt(9)
    ds_read_b128 a[96:99], v125 offset:34816
    v_mfma_f32_16x16x32_bf16 v[240:243], a[32:35], a[144:147], v[240:243]
    v_mfma_f32_16x16x32_bf16 v[240:243], a[48:51], a[172:175], v[240:243]
    ds_read_b128 a[72:75], v124 offset:36864
    v_mfma_f32_16x16x32_bf16 v[244:247], a[36:39], a[144:147], v[244:247]
    buffer_load_dwordx4 v118, s[16:19], s43 offen offset:2048 lds
    v_mfma_f32_16x16x32_bf16 v[244:247], a[52:55], a[172:175], v[244:247]
    ds_read_b128 a[100:103], v125 offset:36864
    v_mfma_f32_16x16x32_bf16 v[248:251], a[40:43], a[144:147], v[248:251]
    v_mfma_f32_16x16x32_bf16 v[248:251], a[56:59], a[172:175], v[248:251]
    ds_read_b128 a[76:79], v124 offset:38912
    v_mfma_f32_16x16x32_bf16 v[252:255], a[44:47], a[144:147], v[252:255]
    buffer_load_dwordx4 v119, s[16:19], s43 offen offset:3072 lds
    v_mfma_f32_16x16x32_bf16 v[252:255], a[60:63], a[172:175], v[252:255]
    s_waitcnt lgkmcnt(9)
    ds_read_b128 a[104:107], v125 offset:38912
    s_add_u32 m0, s42, 8192
    s_waitcnt lgkmcnt(8)
    v_mfma_f32_16x16x32_bf16 v[144:147], a[0:3], a[64:67], v[144:147]
    s_lshl_b32 s43, s52, 12
    s_waitcnt lgkmcnt(6)
    v_mfma_f32_16x16x32_bf16 v[144:147], a[16:19], a[92:95], v[144:147]
    ds_read_b128 a[80:83], v124 offset:40960
    v_mfma_f32_16x16x32_bf16 v[148:151], a[4:7], a[64:67], v[148:151]
    buffer_load_dwordx4 v120, s[20:23], s43 offen offset:0 lds
    v_mfma_f32_16x16x32_bf16 v[148:151], a[20:23], a[92:95], v[148:151]
    ds_read_b128 a[108:111], v125 offset:40960
    v_mfma_f32_16x16x32_bf16 v[152:155], a[8:11], a[64:67], v[152:155]
    v_mfma_f32_16x16x32_bf16 v[152:155], a[24:27], a[92:95], v[152:155]
    ds_read_b128 a[84:87], v124 offset:43008
    v_mfma_f32_16x16x32_bf16 v[156:159], a[12:15], a[64:67], v[156:159]
    s_waitcnt vmcnt(9)
    buffer_load_dwordx4 v121, s[20:23], s43 offen offset:1024 lds
    v_mfma_f32_16x16x32_bf16 v[156:159], a[28:31], a[92:95], v[156:159]
    ds_read_b128 a[112:115], v125 offset:43008
    s_waitcnt lgkmcnt(9)
    v_mfma_f32_16x16x32_bf16 v[160:163], a[0:3], a[68:71], v[160:163]
    ds_read_b64_tr_b16 a[32:33], v126 offset:0
    s_waitcnt lgkmcnt(9)
    v_mfma_f32_16x16x32_bf16 v[160:163], a[16:19], a[96:99], v[160:163]
    ds_read_b128 a[88:91], v124 offset:45056
    v_mfma_f32_16x16x32_bf16 v[164:167], a[4:7], a[68:71], v[164:167]
    buffer_load_dwordx4 v122, s[20:23], s43 offen offset:2048 lds
    v_mfma_f32_16x16x32_bf16 v[164:167], a[20:23], a[96:99], v[164:167]
    ds_read_b128 a[116:119], v125 offset:45056
    v_mfma_f32_16x16x32_bf16 v[168:171], a[8:11], a[68:71], v[168:171]
    ds_read_b64_tr_b16 a[34:35], v126 offset:512
    v_mfma_f32_16x16x32_bf16 v[168:171], a[24:27], a[96:99], v[168:171]
    ds_read_b64_tr_b16 a[36:37], v126 offset:8
    v_mfma_f32_16x16x32_bf16 v[172:175], a[12:15], a[68:71], v[172:175]
    buffer_load_dwordx4 v123, s[20:23], s43 offen offset:3072 lds
    v_mfma_f32_16x16x32_bf16 v[172:175], a[28:31], a[96:99], v[172:175]
    s_waitcnt lgkmcnt(9)
    ds_read_b64_tr_b16 a[38:39], v126 offset:520
    s_add_u32 m0, s42, 12288
    v_mfma_f32_16x16x32_bf16 v[176:179], a[0:3], a[72:75], v[176:179]
    ds_read_b64_tr_b16 a[40:41], v127 offset:0
    s_lshl_b32 s43, s52, 12
    v_mfma_f32_16x16x32_bf16 v[176:179], a[16:19], a[100:103], v[176:179]
    ds_read_b64_tr_b16 a[42:43], v127 offset:512
    s_bitset1_b32 s43, 18
    v_mfma_f32_16x16x32_bf16 v[180:183], a[4:7], a[72:75], v[180:183]
    buffer_load_dwordx4 v120, s[20:23], s43 offen offset:0 lds
    v_mfma_f32_16x16x32_bf16 v[180:183], a[20:23], a[100:103], v[180:183]
    ds_read_b64_tr_b16 a[44:45], v127 offset:8
    v_mfma_f32_16x16x32_bf16 v[184:187], a[8:11], a[72:75], v[184:187]
    s_waitcnt lgkmcnt(9)
    ds_read_b64_tr_b16 a[46:47], v127 offset:520
    v_mfma_f32_16x16x32_bf16 v[184:187], a[24:27], a[100:103], v[184:187]
    v_mfma_f32_16x16x32_bf16 v[188:191], a[12:15], a[72:75], v[188:191]
    buffer_load_dwordx4 v121, s[20:23], s43 offen offset:1024 lds
    v_mfma_f32_16x16x32_bf16 v[188:191], a[28:31], a[100:103], v[188:191]
    v_mfma_f32_16x16x32_bf16 v[192:195], a[0:3], a[76:79], v[192:195]
    v_mfma_f32_16x16x32_bf16 v[192:195], a[16:19], a[104:107], v[192:195]
    v_mfma_f32_16x16x32_bf16 v[196:199], a[4:7], a[76:79], v[196:199]
    buffer_load_dwordx4 v122, s[20:23], s43 offen offset:2048 lds
    v_mfma_f32_16x16x32_bf16 v[196:199], a[20:23], a[104:107], v[196:199]
    v_mfma_f32_16x16x32_bf16 v[200:203], a[8:11], a[76:79], v[200:203]
    v_mfma_f32_16x16x32_bf16 v[200:203], a[24:27], a[104:107], v[200:203]
    v_mfma_f32_16x16x32_bf16 v[204:207], a[12:15], a[76:79], v[204:207]
    s_waitcnt vmcnt(11)
    buffer_load_dwordx4 v123, s[20:23], s43 offen offset:3072 lds
    v_mfma_f32_16x16x32_bf16 v[204:207], a[28:31], a[104:107], v[204:207]
    ds_read_b64_tr_b16 a[48:49], v126 offset:4096
    s_add_u32 m0, s45, 16384
    v_mfma_f32_16x16x32_bf16 v[208:211], a[0:3], a[80:83], v[208:211]
    ds_read_b64_tr_b16 a[50:51], v126 offset:4608
    s_mov_b32 s43, s53
    v_mfma_f32_16x16x32_bf16 v[208:211], a[16:19], a[108:111], v[208:211]
    ds_read_b64_tr_b16 a[52:53], v126 offset:4104
    v_mfma_f32_16x16x32_bf16 v[212:215], a[4:7], a[80:83], v[212:215]
    buffer_load_dwordx4 v116, s[16:19], s43 offen offset:0 lds
    v_mfma_f32_16x16x32_bf16 v[212:215], a[20:23], a[108:111], v[212:215]
    s_waitcnt lgkmcnt(9)
    ds_read_b64_tr_b16 a[54:55], v126 offset:4616
    v_mfma_f32_16x16x32_bf16 v[216:219], a[8:11], a[80:83], v[216:219]
    ds_read_b64_tr_b16 a[56:57], v127 offset:4096
    v_mfma_f32_16x16x32_bf16 v[216:219], a[24:27], a[108:111], v[216:219]
    ds_read_b64_tr_b16 a[58:59], v127 offset:4608
    v_mfma_f32_16x16x32_bf16 v[220:223], a[12:15], a[80:83], v[220:223]
    buffer_load_dwordx4 v117, s[16:19], s43 offen offset:1024 lds
    v_mfma_f32_16x16x32_bf16 v[220:223], a[28:31], a[108:111], v[220:223]
    ds_read_b64_tr_b16 a[60:61], v127 offset:4104
    v_mfma_f32_16x16x32_bf16 v[224:227], a[0:3], a[84:87], v[224:227]
    s_barrier
    s_waitcnt lgkmcnt(9)
    ds_read_b128 a[120:123], v124 offset:49152
    v_mfma_f32_16x16x32_bf16 v[224:227], a[16:19], a[112:115], v[224:227]
    ds_read_b64_tr_b16 a[62:63], v127 offset:4616
    v_mfma_f32_16x16x32_bf16 v[228:231], a[4:7], a[84:87], v[228:231]
    buffer_load_dwordx4 v118, s[16:19], s43 offen offset:2048 lds
    v_mfma_f32_16x16x32_bf16 v[228:231], a[20:23], a[112:115], v[228:231]
    ds_read_b128 a[148:151], v125 offset:49152
    v_mfma_f32_16x16x32_bf16 v[232:235], a[8:11], a[84:87], v[232:235]
    v_mfma_f32_16x16x32_bf16 v[232:235], a[24:27], a[112:115], v[232:235]
    ds_read_b128 a[124:127], v124 offset:51200
    v_mfma_f32_16x16x32_bf16 v[236:239], a[12:15], a[84:87], v[236:239]
    buffer_load_dwordx4 v119, s[16:19], s43 offen offset:3072 lds
    v_mfma_f32_16x16x32_bf16 v[236:239], a[28:31], a[112:115], v[236:239]
    s_waitcnt lgkmcnt(9)
    ds_read_b128 a[152:155], v125 offset:51200
    s_add_u32 m0, s42, 16384
    v_mfma_f32_16x16x32_bf16 v[240:243], a[0:3], a[88:91], v[240:243]
    s_lshl_b32 s43, s53, 12
    v_mfma_f32_16x16x32_bf16 v[240:243], a[16:19], a[116:119], v[240:243]
    ds_read_b128 a[128:131], v124 offset:53248
    v_mfma_f32_16x16x32_bf16 v[244:247], a[4:7], a[88:91], v[244:247]
    buffer_load_dwordx4 v120, s[20:23], s43 offen offset:0 lds
    v_mfma_f32_16x16x32_bf16 v[244:247], a[20:23], a[116:119], v[244:247]
    ds_read_b128 a[156:159], v125 offset:53248
    v_mfma_f32_16x16x32_bf16 v[248:251], a[8:11], a[88:91], v[248:251]
    v_mfma_f32_16x16x32_bf16 v[248:251], a[24:27], a[116:119], v[248:251]
    ds_read_b128 a[132:135], v124 offset:55296
    v_mfma_f32_16x16x32_bf16 v[252:255], a[12:15], a[88:91], v[252:255]
    buffer_load_dwordx4 v121, s[20:23], s43 offen offset:1024 lds
    v_mfma_f32_16x16x32_bf16 v[252:255], a[28:31], a[116:119], v[252:255]
    s_waitcnt lgkmcnt(9)
    ds_read_b128 a[160:163], v125 offset:55296
    s_waitcnt lgkmcnt(8)
    v_mfma_f32_16x16x32_bf16 v[144:147], a[32:35], a[120:123], v[144:147]
    s_waitcnt lgkmcnt(6)
    v_mfma_f32_16x16x32_bf16 v[144:147], a[48:51], a[148:151], v[144:147]
    ds_read_b128 a[136:139], v124 offset:57344
    v_mfma_f32_16x16x32_bf16 v[148:151], a[36:39], a[120:123], v[148:151]
    buffer_load_dwordx4 v122, s[20:23], s43 offen offset:2048 lds
    v_mfma_f32_16x16x32_bf16 v[148:151], a[52:55], a[148:151], v[148:151]
    ds_read_b128 a[164:167], v125 offset:57344
    v_mfma_f32_16x16x32_bf16 v[152:155], a[40:43], a[120:123], v[152:155]
    v_mfma_f32_16x16x32_bf16 v[152:155], a[56:59], a[148:151], v[152:155]
    ds_read_b128 a[140:143], v124 offset:59392
    v_mfma_f32_16x16x32_bf16 v[156:159], a[44:47], a[120:123], v[156:159]
    s_waitcnt vmcnt(11)
    buffer_load_dwordx4 v123, s[20:23], s43 offen offset:3072 lds
    v_mfma_f32_16x16x32_bf16 v[156:159], a[60:63], a[148:151], v[156:159]
    ds_read_b128 a[168:171], v125 offset:59392
    s_add_u32 m0, s42, 20480
    s_waitcnt lgkmcnt(9)
    v_mfma_f32_16x16x32_bf16 v[160:163], a[32:35], a[124:127], v[160:163]
    ds_read_b64_tr_b16 a[0:1], v126 offset:8192
    s_lshl_b32 s43, s53, 12
    s_waitcnt lgkmcnt(9)
    v_mfma_f32_16x16x32_bf16 v[160:163], a[48:51], a[152:155], v[160:163]
    ds_read_b128 a[144:147], v124 offset:61440
    s_bitset1_b32 s43, 18
    v_mfma_f32_16x16x32_bf16 v[164:167], a[36:39], a[124:127], v[164:167]
    buffer_load_dwordx4 v120, s[20:23], s43 offen offset:0 lds
    v_mfma_f32_16x16x32_bf16 v[164:167], a[52:55], a[152:155], v[164:167]
    ds_read_b128 a[172:175], v125 offset:61440
    v_mfma_f32_16x16x32_bf16 v[168:171], a[40:43], a[124:127], v[168:171]
    ds_read_b64_tr_b16 a[2:3], v126 offset:8704
    v_mfma_f32_16x16x32_bf16 v[168:171], a[56:59], a[152:155], v[168:171]
    ds_read_b64_tr_b16 a[4:5], v126 offset:8200
    v_mfma_f32_16x16x32_bf16 v[172:175], a[44:47], a[124:127], v[172:175]
    buffer_load_dwordx4 v121, s[20:23], s43 offen offset:1024 lds
    v_mfma_f32_16x16x32_bf16 v[172:175], a[60:63], a[152:155], v[172:175]
    s_waitcnt lgkmcnt(9)
    ds_read_b64_tr_b16 a[6:7], v126 offset:8712
    v_mfma_f32_16x16x32_bf16 v[176:179], a[32:35], a[128:131], v[176:179]
    ds_read_b64_tr_b16 a[8:9], v127 offset:8192
    v_mfma_f32_16x16x32_bf16 v[176:179], a[48:51], a[156:159], v[176:179]
    ds_read_b64_tr_b16 a[10:11], v127 offset:8704
    v_mfma_f32_16x16x32_bf16 v[180:183], a[36:39], a[128:131], v[180:183]
    buffer_load_dwordx4 v122, s[20:23], s43 offen offset:2048 lds
    v_mfma_f32_16x16x32_bf16 v[180:183], a[52:55], a[156:159], v[180:183]
    ds_read_b64_tr_b16 a[12:13], v127 offset:8200
    v_mfma_f32_16x16x32_bf16 v[184:187], a[40:43], a[128:131], v[184:187]
    s_waitcnt lgkmcnt(9)
    ds_read_b64_tr_b16 a[14:15], v127 offset:8712
    v_mfma_f32_16x16x32_bf16 v[184:187], a[56:59], a[156:159], v[184:187]
    v_mfma_f32_16x16x32_bf16 v[188:191], a[44:47], a[128:131], v[188:191]
    buffer_load_dwordx4 v123, s[20:23], s43 offen offset:3072 lds
    v_mfma_f32_16x16x32_bf16 v[188:191], a[60:63], a[156:159], v[188:191]
    s_add_u32 m0, s45, 32768
    s_mov_b32 s43, s54
    v_mfma_f32_16x16x32_bf16 v[192:195], a[32:35], a[132:135], v[192:195]
    v_mfma_f32_16x16x32_bf16 v[192:195], a[48:51], a[160:163], v[192:195]
    v_mfma_f32_16x16x32_bf16 v[196:199], a[36:39], a[132:135], v[196:199]
    buffer_load_dwordx4 v116, s[16:19], s43 offen offset:0 lds
    v_mfma_f32_16x16x32_bf16 v[196:199], a[52:55], a[160:163], v[196:199]
    v_mfma_f32_16x16x32_bf16 v[200:203], a[40:43], a[132:135], v[200:203]
    v_mfma_f32_16x16x32_bf16 v[200:203], a[56:59], a[160:163], v[200:203]
    v_mfma_f32_16x16x32_bf16 v[204:207], a[44:47], a[132:135], v[204:207]
    s_waitcnt vmcnt(13)
    buffer_load_dwordx4 v117, s[16:19], s43 offen offset:1024 lds
    v_mfma_f32_16x16x32_bf16 v[204:207], a[60:63], a[160:163], v[204:207]
    ds_read_b64_tr_b16 a[16:17], v126 offset:12288
    v_mfma_f32_16x16x32_bf16 v[208:211], a[32:35], a[136:139], v[208:211]
    ds_read_b64_tr_b16 a[18:19], v126 offset:12800
    v_mfma_f32_16x16x32_bf16 v[208:211], a[48:51], a[164:167], v[208:211]
    ds_read_b64_tr_b16 a[20:21], v126 offset:12296
    v_mfma_f32_16x16x32_bf16 v[212:215], a[36:39], a[136:139], v[212:215]
    buffer_load_dwordx4 v118, s[16:19], s43 offen offset:2048 lds
    v_mfma_f32_16x16x32_bf16 v[212:215], a[52:55], a[164:167], v[212:215]
    s_waitcnt lgkmcnt(9)
    ds_read_b64_tr_b16 a[22:23], v126 offset:12808
    v_mfma_f32_16x16x32_bf16 v[216:219], a[40:43], a[136:139], v[216:219]
    ds_read_b64_tr_b16 a[24:25], v127 offset:12288
    v_mfma_f32_16x16x32_bf16 v[216:219], a[56:59], a[164:167], v[216:219]
    ds_read_b64_tr_b16 a[26:27], v127 offset:12800
    v_mfma_f32_16x16x32_bf16 v[220:223], a[44:47], a[136:139], v[220:223]
    buffer_load_dwordx4 v119, s[16:19], s43 offen offset:3072 lds
    v_mfma_f32_16x16x32_bf16 v[220:223], a[60:63], a[164:167], v[220:223]
    ds_read_b64_tr_b16 a[28:29], v127 offset:12296
    s_add_u32 m0, s42, 0
    v_mfma_f32_16x16x32_bf16 v[224:227], a[32:35], a[140:143], v[224:227]
    s_barrier
    s_waitcnt lgkmcnt(9)
    ds_read_b128 a[64:67], v124 offset:0
    s_lshl_b32 s43, s54, 12
    v_mfma_f32_16x16x32_bf16 v[224:227], a[48:51], a[168:171], v[224:227]
    ds_read_b64_tr_b16 a[30:31], v127 offset:12808
    v_mfma_f32_16x16x32_bf16 v[228:231], a[36:39], a[140:143], v[228:231]
    buffer_load_dwordx4 v120, s[20:23], s43 offen offset:0 lds
    v_mfma_f32_16x16x32_bf16 v[228:231], a[52:55], a[168:171], v[228:231]
    ds_read_b128 a[92:95], v125 offset:0
    v_mfma_f32_16x16x32_bf16 v[232:235], a[40:43], a[140:143], v[232:235]
    v_mfma_f32_16x16x32_bf16 v[232:235], a[56:59], a[168:171], v[232:235]
    ds_read_b128 a[68:71], v124 offset:2048
    v_mfma_f32_16x16x32_bf16 v[236:239], a[44:47], a[140:143], v[236:239]
    buffer_load_dwordx4 v121, s[20:23], s43 offen offset:1024 lds
    v_mfma_f32_16x16x32_bf16 v[236:239], a[60:63], a[168:171], v[236:239]
    s_waitcnt lgkmcnt(9)
    ds_read_b128 a[96:99], v125 offset:2048
    v_mfma_f32_16x16x32_bf16 v[240:243], a[32:35], a[144:147], v[240:243]
    v_mfma_f32_16x16x32_bf16 v[240:243], a[48:51], a[172:175], v[240:243]
    ds_read_b128 a[72:75], v124 offset:4096
    v_mfma_f32_16x16x32_bf16 v[244:247], a[36:39], a[144:147], v[244:247]
    buffer_load_dwordx4 v122, s[20:23], s43 offen offset:2048 lds
    v_mfma_f32_16x16x32_bf16 v[244:247], a[52:55], a[172:175], v[244:247]
    ds_read_b128 a[100:103], v125 offset:4096
    v_mfma_f32_16x16x32_bf16 v[248:251], a[40:43], a[144:147], v[248:251]
    v_mfma_f32_16x16x32_bf16 v[248:251], a[56:59], a[172:175], v[248:251]
    ds_read_b128 a[76:79], v124 offset:6144
    v_mfma_f32_16x16x32_bf16 v[252:255], a[44:47], a[144:147], v[252:255]
    buffer_load_dwordx4 v123, s[20:23], s43 offen offset:3072 lds
    v_mfma_f32_16x16x32_bf16 v[252:255], a[60:63], a[172:175], v[252:255]
    s_waitcnt lgkmcnt(9)
    ds_read_b128 a[104:107], v125 offset:6144
    s_add_u32 m0, s42, 4096
    s_waitcnt lgkmcnt(8)
    v_mfma_f32_16x16x32_bf16 v[144:147], a[0:3], a[64:67], v[144:147]
    s_waitcnt vmcnt(12)
    ds_read_b64_tr_b16 a[32:33], v126 offset:16384
    s_lshl_b32 s43, s54, 12
    s_waitcnt lgkmcnt(7)
    v_mfma_f32_16x16x32_bf16 v[144:147], a[16:19], a[92:95], v[144:147]
    ds_read_b128 a[80:83], v124 offset:8192
    s_bitset1_b32 s43, 18
    v_mfma_f32_16x16x32_bf16 v[148:151], a[4:7], a[64:67], v[148:151]
    buffer_load_dwordx4 v120, s[20:23], s43 offen offset:0 lds
    v_mfma_f32_16x16x32_bf16 v[148:151], a[20:23], a[92:95], v[148:151]
    ds_read_b128 a[108:111], v125 offset:8192
    v_mfma_f32_16x16x32_bf16 v[152:155], a[8:11], a[64:67], v[152:155]
    ds_read_b64_tr_b16 a[34:35], v126 offset:16896
    v_mfma_f32_16x16x32_bf16 v[152:155], a[24:27], a[92:95], v[152:155]
    ds_read_b128 a[84:87], v124 offset:10240
    v_mfma_f32_16x16x32_bf16 v[156:159], a[12:15], a[64:67], v[156:159]
    s_barrier
    buffer_load_dwordx4 v121, s[20:23], s43 offen offset:1024 lds
    v_mfma_f32_16x16x32_bf16 v[156:159], a[28:31], a[92:95], v[156:159]
    ds_read_b128 a[112:115], v125 offset:10240
    s_waitcnt lgkmcnt(11)
    v_mfma_f32_16x16x32_bf16 v[160:163], a[0:3], a[68:71], v[160:163]
    ds_read_b64_tr_b16 a[36:37], v126 offset:16392
    s_waitcnt lgkmcnt(11)
    v_mfma_f32_16x16x32_bf16 v[160:163], a[16:19], a[96:99], v[160:163]
    ds_read_b128 a[88:91], v124 offset:12288
    v_mfma_f32_16x16x32_bf16 v[164:167], a[4:7], a[68:71], v[164:167]
    s_waitcnt vmcnt(10)
    buffer_load_dwordx4 v122, s[20:23], s43 offen offset:2048 lds
    v_mfma_f32_16x16x32_bf16 v[164:167], a[20:23], a[96:99], v[164:167]
    ds_read_b128 a[116:119], v125 offset:12288
    v_mfma_f32_16x16x32_bf16 v[168:171], a[8:11], a[68:71], v[168:171]
    s_waitcnt lgkmcnt(9)
    ds_read_b64_tr_b16 a[38:39], v126 offset:16904
    v_mfma_f32_16x16x32_bf16 v[168:171], a[24:27], a[96:99], v[168:171]
    ds_read_b128 a[120:123], v124 offset:16384
    v_mfma_f32_16x16x32_bf16 v[172:175], a[12:15], a[68:71], v[172:175]
    buffer_load_dwordx4 v123, s[20:23], s43 offen offset:3072 lds
    v_mfma_f32_16x16x32_bf16 v[172:175], a[28:31], a[96:99], v[172:175]
    ds_read_b128 a[148:151], v125 offset:16384
    s_add_u32 m0, s42, 8192
    v_mfma_f32_16x16x32_bf16 v[176:179], a[0:3], a[72:75], v[176:179]
    ds_read_b64_tr_b16 a[40:41], v127 offset:16384
    s_mov_b32 s43, 0
    v_mfma_f32_16x16x32_bf16 v[176:179], a[16:19], a[100:103], v[176:179]
    s_waitcnt lgkmcnt(9)
    ds_read_b64_tr_b16 a[42:43], v127 offset:16896
    v_mfma_f32_16x16x32_bf16 v[180:183], a[4:7], a[72:75], v[180:183]
    buffer_load_dwordx4 v1, s[24:27], s43 offen offset:0 nt lds
    v_mfma_f32_16x16x32_bf16 v[180:183], a[20:23], a[100:103], v[180:183]
    ds_read_b64_tr_b16 a[44:45], v127 offset:16392
    v_mfma_f32_16x16x32_bf16 v[184:187], a[8:11], a[72:75], v[184:187]
    ds_read_b64_tr_b16 a[46:47], v127 offset:16904
    v_mfma_f32_16x16x32_bf16 v[184:187], a[24:27], a[100:103], v[184:187]
    ds_read_b64_tr_b16 a[48:49], v126 offset:20480
    v_mfma_f32_16x16x32_bf16 v[188:191], a[12:15], a[72:75], v[188:191]
    s_waitcnt vmcnt(5)
    buffer_load_dwordx4 v2, s[24:27], s43 offen offset:1024 nt lds
    v_mfma_f32_16x16x32_bf16 v[188:191], a[28:31], a[100:103], v[188:191]
    s_waitcnt lgkmcnt(9)
    ds_read_b64_tr_b16 a[50:51], v126 offset:20992
    v_mfma_f32_16x16x32_bf16 v[192:195], a[0:3], a[76:79], v[192:195]
    ds_read_b64_tr_b16 a[52:53], v126 offset:20488
    v_mfma_f32_16x16x32_bf16 v[192:195], a[16:19], a[104:107], v[192:195]
    ds_read_b64_tr_b16 a[54:55], v126 offset:21000
    v_mfma_f32_16x16x32_bf16 v[196:199], a[4:7], a[76:79], v[196:199]
    buffer_load_dwordx4 v3, s[24:27], s43 offen offset:2048 nt lds
    v_mfma_f32_16x16x32_bf16 v[196:199], a[20:23], a[104:107], v[196:199]
    ds_read_b64_tr_b16 a[56:57], v127 offset:20480
    v_mfma_f32_16x16x32_bf16 v[200:203], a[8:11], a[76:79], v[200:203]
    s_waitcnt lgkmcnt(9)
    ds_read_b64_tr_b16 a[58:59], v127 offset:20992
    v_mfma_f32_16x16x32_bf16 v[200:203], a[24:27], a[104:107], v[200:203]
    ds_read_b64_tr_b16 a[60:61], v127 offset:20488
    v_mfma_f32_16x16x32_bf16 v[204:207], a[12:15], a[76:79], v[204:207]
    buffer_load_dwordx4 v4, s[24:27], s43 offen offset:3072 nt lds
    v_mfma_f32_16x16x32_bf16 v[204:207], a[28:31], a[104:107], v[204:207]
    ds_read_b64_tr_b16 a[62:63], v127 offset:21000
    s_add_u32 m0, s42, 12288
    v_mfma_f32_16x16x32_bf16 v[208:211], a[0:3], a[80:83], v[208:211]
    ds_read_b64_tr_b16 a[176:177], v126 offset:0
    s_mov_b32 s43, 256
    v_mfma_f32_16x16x32_bf16 v[208:211], a[16:19], a[108:111], v[208:211]
    s_waitcnt lgkmcnt(9)
    ds_read_b64_tr_b16 a[178:179], v126 offset:512
    v_mfma_f32_16x16x32_bf16 v[212:215], a[4:7], a[80:83], v[212:215]
    s_waitcnt vmcnt(4)
    buffer_load_dwordx4 v1, s[24:27], s43 offen offset:0 nt lds
    v_mfma_f32_16x16x32_bf16 v[212:215], a[20:23], a[108:111], v[212:215]
    ds_read_b64_tr_b16 a[180:181], v126 offset:8
    v_mfma_f32_16x16x32_bf16 v[216:219], a[8:11], a[80:83], v[216:219]
    ds_read_b64_tr_b16 a[182:183], v126 offset:520
    v_mfma_f32_16x16x32_bf16 v[216:219], a[24:27], a[108:111], v[216:219]
    ds_read_b64_tr_b16 a[184:185], v127 offset:0
    v_mfma_f32_16x16x32_bf16 v[220:223], a[12:15], a[80:83], v[220:223]
    buffer_load_dwordx4 v2, s[24:27], s43 offen offset:1024 nt lds
    v_mfma_f32_16x16x32_bf16 v[220:223], a[28:31], a[108:111], v[220:223]
    s_waitcnt lgkmcnt(9)
    ds_read_b64_tr_b16 a[186:187], v127 offset:512
    v_mfma_f32_16x16x32_bf16 v[224:227], a[0:3], a[84:87], v[224:227]
    ds_read_b64_tr_b16 a[188:189], v127 offset:8
    v_mfma_f32_16x16x32_bf16 v[224:227], a[16:19], a[112:115], v[224:227]
    ds_read_b64_tr_b16 a[190:191], v127 offset:520
    v_mfma_f32_16x16x32_bf16 v[228:231], a[4:7], a[84:87], v[228:231]
    ds_read_b64_tr_b16 a[192:193], v126 offset:4096
    v_mfma_f32_16x16x32_bf16 v[228:231], a[20:23], a[112:115], v[228:231]
    s_waitcnt lgkmcnt(9)
    ds_read_b64_tr_b16 a[194:195], v126 offset:4608
    v_mfma_f32_16x16x32_bf16 v[232:235], a[8:11], a[84:87], v[232:235]
    s_barrier
    ds_read_b64_tr_b16 a[196:197], v126 offset:4104
    v_mfma_f32_16x16x32_bf16 v[232:235], a[24:27], a[112:115], v[232:235]
    buffer_load_dwordx4 v3, s[24:27], s43 offen offset:2048 nt lds
    v_mfma_f32_16x16x32_bf16 v[236:239], a[12:15], a[84:87], v[236:239]
    ds_read_b64_tr_b16 a[198:199], v126 offset:4616
    v_mfma_f32_16x16x32_bf16 v[236:239], a[28:31], a[112:115], v[236:239]
    ds_read_b64_tr_b16 a[200:201], v127 offset:4096
    v_mfma_f32_16x16x32_bf16 v[240:243], a[0:3], a[88:91], v[240:243]
    s_waitcnt lgkmcnt(9)
    ds_read_b64_tr_b16 a[202:203], v127 offset:4608
    v_mfma_f32_16x16x32_bf16 v[240:243], a[16:19], a[116:119], v[240:243]
    ds_read_b64_tr_b16 a[204:205], v127 offset:4104
    v_mfma_f32_16x16x32_bf16 v[244:247], a[4:7], a[88:91], v[244:247]
    ds_read_b64_tr_b16 a[206:207], v127 offset:4616
    v_mfma_f32_16x16x32_bf16 v[244:247], a[20:23], a[116:119], v[244:247]
    ds_read_b128 a[124:127], v124 offset:18432
    v_mfma_f32_16x16x32_bf16 v[248:251], a[8:11], a[88:91], v[248:251]
    buffer_load_dwordx4 v4, s[24:27], s43 offen offset:3072 nt lds
    v_mfma_f32_16x16x32_bf16 v[248:251], a[24:27], a[116:119], v[248:251]
    s_waitcnt lgkmcnt(9)
    ds_read_b128 a[152:155], v125 offset:18432
    ds_read_b128 a[128:131], v124 offset:20480
    ds_read_b128 a[156:159], v125 offset:20480
    ds_read_b128 a[132:135], v124 offset:22528
    s_waitcnt lgkmcnt(9)
    ds_read_b128 a[160:163], v125 offset:22528
    ds_read_b128 a[136:139], v124 offset:24576
    ds_read_b128 a[164:167], v125 offset:24576
    ds_read_b128 a[140:143], v124 offset:26624
    s_waitcnt lgkmcnt(9)
    ds_read_b128 a[168:171], v125 offset:26624
    ds_read_b128 a[144:147], v124 offset:28672
    ds_read_b128 a[172:175], v125 offset:28672
    ds_read_b128 a[64:67], v124 offset:32768
    v_mfma_f32_16x16x32_bf16 v[252:255], a[12:15], a[88:91], v[252:255]
    s_waitcnt lgkmcnt(9)
    ds_read_b128 a[92:95], v125 offset:32768
    v_mfma_f32_16x16x32_bf16 v[252:255], a[28:31], a[116:119], v[252:255]
    v_mfma_f32_16x16x32_bf16 v[144:147], a[32:35], a[120:123], v[144:147]
    ds_read_b128 a[68:71], v124 offset:34816
    s_add_u32 m0, s42, 16384
    v_mfma_f32_16x16x32_bf16 v[144:147], a[48:51], a[148:151], v[144:147]
    s_mov_b32 s43, 8192
    s_waitcnt lgkmcnt(2)
    v_mfma_f32_16x16x32_bf16 v[144:147], a[176:179], a[64:67], v[144:147]
    ds_read_b128 a[96:99], v125 offset:34816
    s_waitcnt lgkmcnt(2)
    v_mfma_f32_16x16x32_bf16 v[144:147], a[192:195], a[92:95], v[144:147]
    v_mfma_f32_16x16x32_bf16 v[148:151], a[36:39], a[120:123], v[148:151]
    buffer_load_dwordx4 v1, s[24:27], s43 offen offset:0 nt lds
    v_mfma_f32_16x16x32_bf16 v[148:151], a[52:55], a[148:151], v[148:151]
    ds_read_b128 a[72:75], v124 offset:36864
    v_mfma_f32_16x16x32_bf16 v[148:151], a[180:183], a[64:67], v[148:151]
    v_mfma_f32_16x16x32_bf16 v[148:151], a[196:199], a[92:95], v[148:151]
    ds_read_b128 a[100:103], v125 offset:36864
    v_mfma_f32_16x16x32_bf16 v[152:155], a[40:43], a[120:123], v[152:155]
    ds_read_b128 a[76:79], v124 offset:38912
    v_mul_f32 v144, s44, v144
    v_mfma_f32_16x16x32_bf16 v[152:155], a[56:59], a[148:151], v[152:155]
    ds_read_b128 a[104:107], v125 offset:38912
    v_mul_f32 v145, s44, v145
    v_mfma_f32_16x16x32_bf16 v[152:155], a[184:187], a[64:67], v[152:155]
    ds_read_b128 a[80:83], v124 offset:40960
    v_mul_f32 v146, s44, v146
    v_mfma_f32_16x16x32_bf16 v[152:155], a[200:203], a[92:95], v[152:155]
    ds_read_b128 a[108:111], v125 offset:40960
    v_mul_f32 v147, s44, v147
    v_mfma_f32_16x16x32_bf16 v[156:159], a[44:47], a[120:123], v[156:159]
    ds_read_b128 a[84:87], v124 offset:43008
    v_mul_f32 v148, s44, v148
    v_mfma_f32_16x16x32_bf16 v[156:159], a[60:63], a[148:151], v[156:159]
    ds_read_b128 a[112:115], v125 offset:43008
    buffer_load_dwordx4 v2, s[24:27], s43 offen offset:1024 nt lds
    v_mfma_f32_16x16x32_bf16 v[156:159], a[188:191], a[64:67], v[156:159]
    ds_read_b128 a[88:91], v124 offset:45056
    v_mul_f32 v149, s44, v149
    v_mfma_f32_16x16x32_bf16 v[156:159], a[204:207], a[92:95], v[156:159]
    ds_read_b128 a[116:119], v125 offset:45056
    v_mul_f32 v150, s44, v150
    v_mfma_f32_16x16x32_bf16 v[160:163], a[32:35], a[124:127], v[160:163]
    v_mul_f32 v151, s44, v151
    v_cvt_pk_bf16_f32 v144, v144, v145
    v_mfma_f32_16x16x32_bf16 v[160:163], a[48:51], a[152:155], v[160:163]
    v_cvt_pk_bf16_f32 v145, v146, v147
    v_cvt_pk_bf16_f32 v146, v148, v149
    s_waitcnt lgkmcnt(11)
    v_mfma_f32_16x16x32_bf16 v[160:163], a[176:179], a[68:71], v[160:163]
    s_waitcnt lgkmcnt(0)
    s_barrier
    v_cvt_pk_bf16_f32 v147, v150, v151
    v_mul_f32 v152, s44, v152
    v_mfma_f32_16x16x32_bf16 v[160:163], a[192:195], a[96:99], v[160:163]
    buffer_load_dwordx4 v3, s[24:27], s43 offen offset:2048 nt lds
    v_mfma_f32_16x16x32_bf16 v[164:167], a[36:39], a[124:127], v[164:167]
    ds_write_b128 v24, v[144:147] offset:0
    v_mfma_f32_16x16x32_bf16 v[164:167], a[52:55], a[152:155], v[164:167]
    v_mul_f32 v153, s44, v153
    v_mul_f32 v154, s44, v154
    v_mfma_f32_16x16x32_bf16 v[164:167], a[180:183], a[68:71], v[164:167]
    v_mul_f32 v155, s44, v155
    v_mul_f32 v156, s44, v156
    v_mfma_f32_16x16x32_bf16 v[164:167], a[196:199], a[96:99], v[164:167]
    v_mul_f32 v157, s44, v157
    v_mul_f32 v158, s44, v158
    v_mfma_f32_16x16x32_bf16 v[168:171], a[40:43], a[124:127], v[168:171]
    v_mul_f32 v159, s44, v159
    v_cvt_pk_bf16_f32 v152, v152, v153
    v_mfma_f32_16x16x32_bf16 v[168:171], a[56:59], a[152:155], v[168:171]
    v_cvt_pk_bf16_f32 v153, v154, v155
    v_cvt_pk_bf16_f32 v154, v156, v157
    v_mfma_f32_16x16x32_bf16 v[168:171], a[184:187], a[68:71], v[168:171]
    buffer_load_dwordx4 v4, s[24:27], s43 offen offset:3072 nt lds
    v_mfma_f32_16x16x32_bf16 v[168:171], a[200:203], a[96:99], v[168:171]
    v_cvt_pk_bf16_f32 v155, v158, v159
    v_mul_f32 v160, s44, v160
    v_mfma_f32_16x16x32_bf16 v[172:175], a[44:47], a[124:127], v[172:175]
    ds_write_b128 v24, v[152:155] offset:7168
    v_mfma_f32_16x16x32_bf16 v[172:175], a[60:63], a[152:155], v[172:175]
    v_mul_f32 v161, s44, v161
    v_mul_f32 v162, s44, v162
    v_mfma_f32_16x16x32_bf16 v[172:175], a[188:191], a[68:71], v[172:175]
    s_add_u32 m0, s42, 20480
    s_mov_b32 s43, 8448
    v_mfma_f32_16x16x32_bf16 v[172:175], a[204:207], a[96:99], v[172:175]
    v_mul_f32 v163, s44, v163
    v_mul_f32 v164, s44, v164
    v_mfma_f32_16x16x32_bf16 v[176:179], a[32:35], a[128:131], v[176:179]
    v_mul_f32 v165, s44, v165
    v_mul_f32 v166, s44, v166
    v_mfma_f32_16x16x32_bf16 v[176:179], a[48:51], a[156:159], v[176:179]
    v_mul_f32 v167, s44, v167
    v_cvt_pk_bf16_f32 v160, v160, v161
    v_mfma_f32_16x16x32_bf16 v[176:179], a[176:179], a[72:75], v[176:179]
    buffer_load_dwordx4 v1, s[24:27], s43 offen offset:0 nt lds
    v_mfma_f32_16x16x32_bf16 v[176:179], a[192:195], a[100:103], v[176:179]
    v_cvt_pk_bf16_f32 v161, v162, v163
    v_cvt_pk_bf16_f32 v162, v164, v165
    v_mfma_f32_16x16x32_bf16 v[180:183], a[36:39], a[128:131], v[180:183]
    v_cvt_pk_bf16_f32 v163, v166, v167
    v_mul_f32 v168, s44, v168
    v_mfma_f32_16x16x32_bf16 v[180:183], a[52:55], a[156:159], v[180:183]
    ds_write_b128 v24, v[160:163] offset:1024
    v_mfma_f32_16x16x32_bf16 v[180:183], a[180:183], a[72:75], v[180:183]
    v_mul_f32 v169, s44, v169
    v_mul_f32 v170, s44, v170
    v_mfma_f32_16x16x32_bf16 v[180:183], a[196:199], a[100:103], v[180:183]
    v_mul_f32 v171, s44, v171
    v_mul_f32 v172, s44, v172
    v_mfma_f32_16x16x32_bf16 v[184:187], a[40:43], a[128:131], v[184:187]
    v_mul_f32 v173, s44, v173
    v_mul_f32 v174, s44, v174
    v_mfma_f32_16x16x32_bf16 v[184:187], a[56:59], a[156:159], v[184:187]
    buffer_load_dwordx4 v2, s[24:27], s43 offen offset:1024 nt lds
    v_mfma_f32_16x16x32_bf16 v[184:187], a[184:187], a[72:75], v[184:187]
    v_mul_f32 v175, s44, v175
    v_cvt_pk_bf16_f32 v168, v168, v169
    v_mfma_f32_16x16x32_bf16 v[184:187], a[200:203], a[100:103], v[184:187]
    v_cvt_pk_bf16_f32 v169, v170, v171
    v_cvt_pk_bf16_f32 v170, v172, v173
    v_mfma_f32_16x16x32_bf16 v[188:191], a[44:47], a[128:131], v[188:191]
    v_cvt_pk_bf16_f32 v171, v174, v175
    v_mul_f32 v176, s44, v176
    v_mfma_f32_16x16x32_bf16 v[188:191], a[60:63], a[156:159], v[188:191]
    ds_write_b128 v24, v[168:171] offset:8192
    v_mfma_f32_16x16x32_bf16 v[188:191], a[188:191], a[72:75], v[188:191]
    v_mul_f32 v177, s44, v177
    v_mul_f32 v178, s44, v178
    v_mfma_f32_16x16x32_bf16 v[188:191], a[204:207], a[100:103], v[188:191]
    v_mul_f32 v179, s44, v179
    v_mul_f32 v180, s44, v180
    v_mfma_f32_16x16x32_bf16 v[192:195], a[32:35], a[132:135], v[192:195]
    v_mul_f32 v181, s44, v181
    v_mul_f32 v182, s44, v182
    v_mfma_f32_16x16x32_bf16 v[192:195], a[48:51], a[160:163], v[192:195]
    buffer_load_dwordx4 v3, s[24:27], s43 offen offset:2048 nt lds
    v_mfma_f32_16x16x32_bf16 v[192:195], a[176:179], a[76:79], v[192:195]
    v_mul_f32 v183, s44, v183
    v_cvt_pk_bf16_f32 v176, v176, v177
    v_mfma_f32_16x16x32_bf16 v[192:195], a[192:195], a[104:107], v[192:195]
    v_cvt_pk_bf16_f32 v177, v178, v179
    v_cvt_pk_bf16_f32 v178, v180, v181
    v_mfma_f32_16x16x32_bf16 v[196:199], a[36:39], a[132:135], v[196:199]
    v_cvt_pk_bf16_f32 v179, v182, v183
    v_mul_f32 v184, s44, v184
    v_mfma_f32_16x16x32_bf16 v[196:199], a[52:55], a[160:163], v[196:199]
    ds_write_b128 v24, v[176:179] offset:2048
    v_mfma_f32_16x16x32_bf16 v[196:199], a[180:183], a[76:79], v[196:199]
    v_mul_f32 v185, s44, v185
    v_mul_f32 v186, s44, v186
    v_mfma_f32_16x16x32_bf16 v[196:199], a[196:199], a[104:107], v[196:199]
    v_mul_f32 v187, s44, v187
    v_mul_f32 v188, s44, v188
    v_mfma_f32_16x16x32_bf16 v[200:203], a[40:43], a[132:135], v[200:203]
    buffer_load_dwordx4 v4, s[24:27], s43 offen offset:3072 nt lds
    v_mfma_f32_16x16x32_bf16 v[200:203], a[56:59], a[160:163], v[200:203]
    v_mul_f32 v189, s44, v189
    v_mul_f32 v190, s44, v190
    v_mfma_f32_16x16x32_bf16 v[200:203], a[184:187], a[76:79], v[200:203]
    v_mul_f32 v191, s44, v191
    v_cvt_pk_bf16_f32 v184, v184, v185
    v_mfma_f32_16x16x32_bf16 v[200:203], a[200:203], a[104:107], v[200:203]
    v_cvt_pk_bf16_f32 v185, v186, v187
    v_cvt_pk_bf16_f32 v186, v188, v189
    v_mfma_f32_16x16x32_bf16 v[204:207], a[44:47], a[132:135], v[204:207]
    s_add_u32 m0, s42, 0
    s_mov_b32 s43, 65536
    v_mfma_f32_16x16x32_bf16 v[204:207], a[60:63], a[160:163], v[204:207]
    v_cvt_pk_bf16_f32 v187, v190, v191
    v_mul_f32 v192, s44, v192
    v_mfma_f32_16x16x32_bf16 v[204:207], a[188:191], a[76:79], v[204:207]
    ds_write_b128 v24, v[184:187] offset:9216
    v_mfma_f32_16x16x32_bf16 v[204:207], a[204:207], a[104:107], v[204:207]
    v_mul_f32 v193, s44, v193
    v_mul_f32 v194, s44, v194
    v_mfma_f32_16x16x32_bf16 v[208:211], a[32:35], a[136:139], v[208:211]
    buffer_load_dwordx4 v1, s[24:27], s43 offen offset:0 nt lds
    v_mfma_f32_16x16x32_bf16 v[208:211], a[48:51], a[164:167], v[208:211]
    v_mul_f32 v195, s44, v195
    v_mul_f32 v196, s44, v196
    v_mfma_f32_16x16x32_bf16 v[208:211], a[176:179], a[80:83], v[208:211]
    v_mul_f32 v197, s44, v197
    v_mul_f32 v198, s44, v198
    v_mfma_f32_16x16x32_bf16 v[208:211], a[192:195], a[108:111], v[208:211]
    v_mul_f32 v199, s44, v199
    v_cvt_pk_bf16_f32 v192, v192, v193
    v_mfma_f32_16x16x32_bf16 v[212:215], a[36:39], a[136:139], v[212:215]
    v_cvt_pk_bf16_f32 v193, v194, v195
    v_cvt_pk_bf16_f32 v194, v196, v197
    v_mfma_f32_16x16x32_bf16 v[212:215], a[52:55], a[164:167], v[212:215]
    v_cvt_pk_bf16_f32 v195, v198, v199
    v_mul_f32 v200, s44, v200
    v_mfma_f32_16x16x32_bf16 v[212:215], a[180:183], a[80:83], v[212:215]
    ds_write_b128 v24, v[192:195] offset:3072
    v_mfma_f32_16x16x32_bf16 v[212:215], a[196:199], a[108:111], v[212:215]
    buffer_load_dwordx4 v2, s[24:27], s43 offen offset:1024 nt lds
    v_mfma_f32_16x16x32_bf16 v[216:219], a[40:43], a[136:139], v[216:219]
    v_mul_f32 v201, s44, v201
    v_mul_f32 v202, s44, v202
    v_mfma_f32_16x16x32_bf16 v[216:219], a[56:59], a[164:167], v[216:219]
    v_mul_f32 v203, s44, v203
    v_mul_f32 v204, s44, v204
    v_mfma_f32_16x16x32_bf16 v[216:219], a[184:187], a[80:83], v[216:219]
    v_mul_f32 v205, s44, v205
    v_mul_f32 v206, s44, v206
    v_mfma_f32_16x16x32_bf16 v[216:219], a[200:203], a[108:111], v[216:219]
    v_mul_f32 v207, s44, v207
    v_cvt_pk_bf16_f32 v200, v200, v201
    v_mfma_f32_16x16x32_bf16 v[220:223], a[44:47], a[136:139], v[220:223]
    v_cvt_pk_bf16_f32 v201, v202, v203
    v_cvt_pk_bf16_f32 v202, v204, v205
    v_mfma_f32_16x16x32_bf16 v[220:223], a[60:63], a[164:167], v[220:223]
    v_cvt_pk_bf16_f32 v203, v206, v207
    v_mul_f32 v208, s44, v208
    v_mfma_f32_16x16x32_bf16 v[220:223], a[188:191], a[80:83], v[220:223]
    ds_write_b128 v24, v[200:203] offset:10240
    v_mfma_f32_16x16x32_bf16 v[220:223], a[204:207], a[108:111], v[220:223]
    buffer_load_dwordx4 v3, s[24:27], s43 offen offset:2048 nt lds
    v_mfma_f32_16x16x32_bf16 v[224:227], a[32:35], a[140:143], v[224:227]
    v_mul_f32 v209, s44, v209
    v_mul_f32 v210, s44, v210
    v_mfma_f32_16x16x32_bf16 v[224:227], a[48:51], a[168:171], v[224:227]
    v_mul_f32 v211, s44, v211
    v_mul_f32 v212, s44, v212
    v_mfma_f32_16x16x32_bf16 v[224:227], a[176:179], a[84:87], v[224:227]
    v_mul_f32 v213, s44, v213
    v_mul_f32 v214, s44, v214
    v_mfma_f32_16x16x32_bf16 v[224:227], a[192:195], a[112:115], v[224:227]
    v_mul_f32 v215, s44, v215
    v_cvt_pk_bf16_f32 v208, v208, v209
    v_mfma_f32_16x16x32_bf16 v[228:231], a[36:39], a[140:143], v[228:231]
    v_cvt_pk_bf16_f32 v209, v210, v211
    v_cvt_pk_bf16_f32 v210, v212, v213
    v_mfma_f32_16x16x32_bf16 v[228:231], a[52:55], a[168:171], v[228:231]
    v_cvt_pk_bf16_f32 v211, v214, v215
    v_mul_f32 v216, s44, v216
    v_mfma_f32_16x16x32_bf16 v[228:231], a[180:183], a[84:87], v[228:231]
    buffer_load_dwordx4 v4, s[24:27], s43 offen offset:3072 nt lds
    v_mfma_f32_16x16x32_bf16 v[228:231], a[196:199], a[112:115], v[228:231]
    ds_write_b128 v24, v[208:211] offset:4096
    v_mfma_f32_16x16x32_bf16 v[232:235], a[40:43], a[140:143], v[232:235]
    v_mul_f32 v217, s44, v217
    v_mul_f32 v218, s44, v218
    v_mfma_f32_16x16x32_bf16 v[232:235], a[56:59], a[168:171], v[232:235]
    v_mul_f32 v219, s44, v219
    v_mul_f32 v220, s44, v220
    v_mfma_f32_16x16x32_bf16 v[232:235], a[184:187], a[84:87], v[232:235]
    s_add_u32 m0, s42, 4096
    s_mov_b32 s43, 65792
    v_mfma_f32_16x16x32_bf16 v[232:235], a[200:203], a[112:115], v[232:235]
    v_mul_f32 v221, s44, v221
    v_mul_f32 v222, s44, v222
    v_mfma_f32_16x16x32_bf16 v[236:239], a[44:47], a[140:143], v[236:239]
    v_mul_f32 v223, s44, v223
    v_cvt_pk_bf16_f32 v216, v216, v217
    v_mfma_f32_16x16x32_bf16 v[236:239], a[60:63], a[168:171], v[236:239]
    v_cvt_pk_bf16_f32 v217, v218, v219
    v_cvt_pk_bf16_f32 v218, v220, v221
    v_mfma_f32_16x16x32_bf16 v[236:239], a[188:191], a[84:87], v[236:239]
    buffer_load_dwordx4 v1, s[24:27], s43 offen offset:0 nt lds
    v_mfma_f32_16x16x32_bf16 v[236:239], a[204:207], a[112:115], v[236:239]
    v_cvt_pk_bf16_f32 v219, v222, v223
    v_mul_f32 v224, s44, v224
    v_mfma_f32_16x16x32_bf16 v[240:243], a[32:35], a[144:147], v[240:243]
    ds_write_b128 v24, v[216:219] offset:11264
    v_mfma_f32_16x16x32_bf16 v[240:243], a[48:51], a[172:175], v[240:243]
    v_mul_f32 v225, s44, v225
    v_mul_f32 v226, s44, v226
    v_mfma_f32_16x16x32_bf16 v[240:243], a[176:179], a[88:91], v[240:243]
    v_mul_f32 v227, s44, v227
    v_mul_f32 v228, s44, v228
    v_mfma_f32_16x16x32_bf16 v[240:243], a[192:195], a[116:119], v[240:243]
    v_mul_f32 v229, s44, v229
    v_mul_f32 v230, s44, v230
    v_mfma_f32_16x16x32_bf16 v[244:247], a[36:39], a[144:147], v[244:247]
    s_waitcnt vmcnt(17)
    ds_read_b128 a[224:227], v12 offset:8192
    v_mul_f32 v231, s44, v231
    v_mfma_f32_16x16x32_bf16 v[244:247], a[52:55], a[172:175], v[244:247]
    ds_read_b128 a[228:231], v13 offset:8192
    v_cvt_pk_bf16_f32 v224, v224, v225
    v_mfma_f32_16x16x32_bf16 v[244:247], a[180:183], a[88:91], v[244:247]
    buffer_load_dwordx4 v2, s[24:27], s43 offen offset:1024 nt lds
    v_mfma_f32_16x16x32_bf16 v[244:247], a[196:199], a[116:119], v[244:247]
    ds_read_b128 a[232:235], v14 offset:8192
    v_cvt_pk_bf16_f32 v225, v226, v227
    v_mfma_f32_16x16x32_bf16 v[248:251], a[40:43], a[144:147], v[248:251]
    v_cvt_pk_bf16_f32 v226, v228, v229
    v_cvt_pk_bf16_f32 v227, v230, v231
    v_mfma_f32_16x16x32_bf16 v[248:251], a[56:59], a[172:175], v[248:251]
    s_waitcnt lgkmcnt(9)
    ds_read_b128 a[236:239], v15 offset:8192
    v_mul_f32 v232, s44, v232
    v_mfma_f32_16x16x32_bf16 v[248:251], a[184:187], a[88:91], v[248:251]
    ds_write_b128 v24, v[224:227] offset:5120
    v_mfma_f32_16x16x32_bf16 v[248:251], a[200:203], a[116:119], v[248:251]
    v_mul_f32 v233, s44, v233
    v_mul_f32 v234, s44, v234
    v_mfma_f32_16x16x32_bf16 v[252:255], a[44:47], a[144:147], v[252:255]
    v_mul_f32 v235, s44, v235
    v_mul_f32 v236, s44, v236
    v_mfma_f32_16x16x32_bf16 v[252:255], a[60:63], a[172:175], v[252:255]
    buffer_load_dwordx4 v3, s[24:27], s43 offen offset:2048 nt lds
    v_mfma_f32_16x16x32_bf16 v[252:255], a[188:191], a[88:91], v[252:255]
    v_mul_f32 v237, s44, v237
    v_mul_f32 v238, s44, v238
    v_mfma_f32_16x16x32_bf16 v[252:255], a[204:207], a[116:119], v[252:255]
    v_mul_f32 v239, s44, v239
    v_cvt_pk_bf16_f32 v232, v232, v233
    v_cvt_pk_bf16_f32 v233, v234, v235
    v_cvt_pk_bf16_f32 v234, v236, v237
    v_cvt_pk_bf16_f32 v235, v238, v239
    ds_write_b128 v24, v[232:235] offset:12288
    v_mul_f32 v240, s44, v240
    v_mul_f32 v241, s44, v241
    v_mul_f32 v242, s44, v242
    v_mul_f32 v243, s44, v243
    v_mul_f32 v244, s44, v244
    v_mul_f32 v245, s44, v245
    v_mul_f32 v246, s44, v246
    v_mul_f32 v247, s44, v247
    v_cvt_pk_bf16_f32 v240, v240, v241
    v_cvt_pk_bf16_f32 v241, v242, v243
    v_cvt_pk_bf16_f32 v242, v244, v245
    v_cvt_pk_bf16_f32 v243, v246, v247
    ds_write_b128 v24, v[240:243] offset:6144
    buffer_load_dwordx4 v4, s[24:27], s43 offen offset:3072 nt lds
    v_mul_f32 v248, s44, v248
    v_mul_f32 v249, s44, v249
    v_mul_f32 v250, s44, v250
    v_mul_f32 v251, s44, v251
    v_mul_f32 v252, s44, v252
    v_mul_f32 v253, s44, v253
    v_mul_f32 v254, s44, v254
    v_mul_f32 v255, s44, v255
    v_cvt_pk_bf16_f32 v248, v248, v249
    v_cvt_pk_bf16_f32 v249, v250, v251
    v_cvt_pk_bf16_f32 v250, v252, v253
    v_cvt_pk_bf16_f32 v251, v254, v255
    s_waitcnt lgkmcnt(9)
    ds_write_b128 v24, v[248:251] offset:13312
    s_waitcnt lgkmcnt(0)
    s_barrier
    ds_read_b128 a[0:3], v22 offset:0
    ds_read_b128 a[28:31], v22 offset:7168
    ds_read_b128 a[56:59], v22 offset:14336
    ds_read_b128 a[84:87], v22 offset:21504
    ds_read_b128 a[4:7], v22 offset:1024
    ds_read_b128 a[32:35], v22 offset:8192
    ds_read_b128 a[60:63], v22 offset:15360
    ds_read_b128 a[88:91], v22 offset:22528
    ds_read_b128 a[8:11], v22 offset:2048
    s_waitcnt lgkmcnt(8)
    v_mfma_f32_16x16x32_bf16 v[32:35], a[224:227], a[0:3], 0
    ds_read_b128 a[36:39], v22 offset:9216
    s_add_u32 m0, s42, 8192
    s_waitcnt lgkmcnt(8)
    v_mfma_f32_16x16x32_bf16 v[32:35], a[228:231], a[28:31], v[32:35]
    ds_read_b128 a[64:67], v22 offset:16384
    s_mov_b32 s43, 73728
    s_waitcnt lgkmcnt(8)
    v_mfma_f32_16x16x32_bf16 v[32:35], a[232:235], a[56:59], v[32:35]
    ds_read_b128 a[92:95], v22 offset:23552
    s_waitcnt lgkmcnt(8)
    v_mfma_f32_16x16x32_bf16 v[32:35], a[236:239], a[84:87], v[32:35]
    ds_read_b128 a[12:15], v22 offset:3072
    buffer_load_dwordx4 v1, s[24:27], s43 offen offset:0 nt lds
    s_waitcnt lgkmcnt(8)
    v_mfma_f32_16x16x32_bf16 v[36:39], a[224:227], a[4:7], 0
    ds_read_b128 a[40:43], v22 offset:10240
    s_waitcnt lgkmcnt(8)
    v_mfma_f32_16x16x32_bf16 v[36:39], a[228:231], a[32:35], v[36:39]
    ds_read_b128 a[68:71], v22 offset:17408
    s_waitcnt lgkmcnt(8)
    v_mfma_f32_16x16x32_bf16 v[36:39], a[232:235], a[60:63], v[36:39]
    ds_read_b128 a[96:99], v22 offset:24576
    s_waitcnt lgkmcnt(8)
    v_mfma_f32_16x16x32_bf16 v[36:39], a[236:239], a[88:91], v[36:39]
    ds_read_b128 a[16:19], v22 offset:4096
    s_waitcnt lgkmcnt(8)
    v_mfma_f32_16x16x32_bf16 v[40:43], a[224:227], a[8:11], 0
    ds_read_b128 a[44:47], v22 offset:11264
    s_waitcnt lgkmcnt(8)
    v_mfma_f32_16x16x32_bf16 v[40:43], a[228:231], a[36:39], v[40:43]
    ds_read_b128 a[72:75], v22 offset:18432
    buffer_load_dwordx4 v2, s[24:27], s43 offen offset:1024 nt lds
    s_waitcnt lgkmcnt(8)
    v_mfma_f32_16x16x32_bf16 v[40:43], a[232:235], a[64:67], v[40:43]
    ds_read_b128 a[100:103], v22 offset:25600
    s_waitcnt lgkmcnt(8)
    v_mfma_f32_16x16x32_bf16 v[40:43], a[236:239], a[92:95], v[40:43]
    ds_read_b128 a[20:23], v22 offset:5120
    s_waitcnt lgkmcnt(8)
    v_mfma_f32_16x16x32_bf16 v[44:47], a[224:227], a[12:15], 0
    ds_read_b128 a[48:51], v22 offset:12288
    s_waitcnt lgkmcnt(8)
    v_mfma_f32_16x16x32_bf16 v[44:47], a[228:231], a[40:43], v[44:47]
    ds_read_b128 a[76:79], v22 offset:19456
    s_waitcnt lgkmcnt(8)
    v_mfma_f32_16x16x32_bf16 v[44:47], a[232:235], a[68:71], v[44:47]
    ds_read_b128 a[104:107], v22 offset:26624
    s_waitcnt lgkmcnt(8)
    v_mfma_f32_16x16x32_bf16 v[44:47], a[236:239], a[96:99], v[44:47]
    ds_read_b128 a[24:27], v22 offset:6144
    buffer_load_dwordx4 v3, s[24:27], s43 offen offset:2048 nt lds
    s_waitcnt lgkmcnt(8)
    v_mfma_f32_16x16x32_bf16 v[48:51], a[224:227], a[16:19], 0
    s_waitcnt vmcnt(19)
    ds_read_b128 a[52:55], v22 offset:13312
    s_waitcnt lgkmcnt(8)
    v_mfma_f32_16x16x32_bf16 v[48:51], a[228:231], a[44:47], v[48:51]
    ds_read_b128 a[80:83], v22 offset:20480
    s_waitcnt lgkmcnt(8)
    v_mfma_f32_16x16x32_bf16 v[48:51], a[232:235], a[72:75], v[48:51]
    ds_read_b128 a[108:111], v22 offset:27648
    s_waitcnt lgkmcnt(8)
    v_mfma_f32_16x16x32_bf16 v[48:51], a[236:239], a[100:103], v[48:51]
    ds_read_b128 a[240:243], v12 offset:12288
    s_waitcnt lgkmcnt(8)
    v_mfma_f32_16x16x32_bf16 v[52:55], a[224:227], a[20:23], 0
    ds_read_b128 a[112:115], v22 offset:28672
    s_waitcnt lgkmcnt(8)
    v_mfma_f32_16x16x32_bf16 v[52:55], a[228:231], a[48:51], v[52:55]
    ds_read_b128 a[244:247], v13 offset:12288
    s_waitcnt lgkmcnt(8)
    v_mfma_f32_16x16x32_bf16 v[52:55], a[232:235], a[76:79], v[52:55]
    ds_read_b128 a[140:143], v22 offset:35840
    buffer_load_dwordx4 v4, s[24:27], s43 offen offset:3072 nt lds
    s_waitcnt lgkmcnt(8)
    v_mfma_f32_16x16x32_bf16 v[52:55], a[236:239], a[104:107], v[52:55]
    ds_read_b128 a[248:251], v14 offset:12288
    s_waitcnt lgkmcnt(8)
    v_mfma_f32_16x16x32_bf16 v[56:59], a[224:227], a[24:27], 0
    ds_read_b128 a[168:171], v22 offset:43008
    s_waitcnt lgkmcnt(8)
    v_mfma_f32_16x16x32_bf16 v[56:59], a[228:231], a[52:55], v[56:59]
    ds_read_b128 a[252:255], v15 offset:12288
    s_waitcnt lgkmcnt(8)
    v_mfma_f32_16x16x32_bf16 v[56:59], a[232:235], a[80:83], v[56:59]
    ds_read_b128 a[196:199], v22 offset:50176
    s_waitcnt lgkmcnt(8)
    v_mfma_f32_16x16x32_bf16 v[56:59], a[236:239], a[108:111], v[56:59]
    ds_read_b128 a[116:119], v22 offset:29696
    s_waitcnt lgkmcnt(7)
    v_mfma_f32_16x16x32_bf16 v[32:35], a[240:243], a[112:115], v[32:35]
    ds_read_b128 a[144:147], v22 offset:36864
    s_waitcnt lgkmcnt(6)
    v_mfma_f32_16x16x32_bf16 v[32:35], a[244:247], a[140:143], v[32:35]
    ds_read_b128 a[172:175], v22 offset:44032
    s_waitcnt lgkmcnt(5)
    v_mfma_f32_16x16x32_bf16 v[32:35], a[248:251], a[168:171], v[32:35]
    ds_read_b128 a[200:203], v22 offset:51200
    s_waitcnt lgkmcnt(4)
    v_mfma_f32_16x16x32_bf16 v[32:35], a[252:255], a[196:199], v[32:35]
    ds_read_b128 a[120:123], v22 offset:30720
    s_waitcnt lgkmcnt(4)
    v_mfma_f32_16x16x32_bf16 v[36:39], a[240:243], a[116:119], v[36:39]
    ds_read_b128 a[148:151], v22 offset:37888
    s_add_u32 m0, s42, 12288
    s_waitcnt lgkmcnt(4)
    v_mfma_f32_16x16x32_bf16 v[36:39], a[244:247], a[144:147], v[36:39]
    ds_read_b128 a[176:179], v22 offset:45056
    s_mov_b32 s43, 73984
    s_waitcnt lgkmcnt(4)
    v_mfma_f32_16x16x32_bf16 v[36:39], a[248:251], a[172:175], v[36:39]
    ds_read_b128 a[204:207], v22 offset:52224
    buffer_load_dwordx4 v1, s[24:27], s43 offen offset:0 nt lds
    s_waitcnt lgkmcnt(4)
    v_mfma_f32_16x16x32_bf16 v[36:39], a[252:255], a[200:203], v[36:39]
    ds_read_b128 a[124:127], v22 offset:31744
    s_waitcnt lgkmcnt(4)
    v_mfma_f32_16x16x32_bf16 v[40:43], a[240:243], a[120:123], v[40:43]
    ds_read_b128 a[152:155], v22 offset:38912
    s_waitcnt lgkmcnt(4)
    v_mfma_f32_16x16x32_bf16 v[40:43], a[244:247], a[148:151], v[40:43]
    ds_read_b128 a[180:183], v22 offset:46080
    s_waitcnt lgkmcnt(4)
    v_mfma_f32_16x16x32_bf16 v[40:43], a[248:251], a[176:179], v[40:43]
    ds_read_b128 a[208:211], v22 offset:53248
    s_waitcnt lgkmcnt(4)
    v_mfma_f32_16x16x32_bf16 v[40:43], a[252:255], a[204:207], v[40:43]
    ds_read_b128 a[128:131], v22 offset:32768
    s_waitcnt lgkmcnt(4)
    v_mfma_f32_16x16x32_bf16 v[44:47], a[240:243], a[124:127], v[44:47]
    ds_read_b128 a[156:159], v22 offset:39936
    buffer_load_dwordx4 v2, s[24:27], s43 offen offset:1024 nt lds
    s_waitcnt lgkmcnt(4)
    v_mfma_f32_16x16x32_bf16 v[44:47], a[244:247], a[152:155], v[44:47]
    ds_read_b128 a[184:187], v22 offset:47104
    s_waitcnt lgkmcnt(4)
    v_mfma_f32_16x16x32_bf16 v[44:47], a[248:251], a[180:183], v[44:47]
    ds_read_b128 a[212:215], v22 offset:54272
    s_waitcnt lgkmcnt(4)
    v_mfma_f32_16x16x32_bf16 v[44:47], a[252:255], a[208:211], v[44:47]
    ds_read_b128 a[132:135], v22 offset:33792
    s_waitcnt lgkmcnt(4)
    v_mfma_f32_16x16x32_bf16 v[48:51], a[240:243], a[128:131], v[48:51]
    s_waitcnt vmcnt(18)
    ds_read_b128 a[160:163], v22 offset:40960
    s_waitcnt lgkmcnt(4)
    v_mfma_f32_16x16x32_bf16 v[48:51], a[244:247], a[156:159], v[48:51]
    ds_read_b128 a[188:191], v22 offset:48128
    s_waitcnt lgkmcnt(4)
    v_mfma_f32_16x16x32_bf16 v[48:51], a[248:251], a[184:187], v[48:51]
    ds_read_b128 a[216:219], v22 offset:55296
    buffer_load_dwordx4 v3, s[24:27], s43 offen offset:2048 nt lds
    s_waitcnt lgkmcnt(4)
    v_mfma_f32_16x16x32_bf16 v[48:51], a[252:255], a[212:215], v[48:51]
    ds_read_b128 a[136:139], v22 offset:34816
    s_waitcnt lgkmcnt(4)
    v_mfma_f32_16x16x32_bf16 v[52:55], a[240:243], a[132:135], v[52:55]
    ds_read_b128 a[164:167], v22 offset:41984
    s_waitcnt lgkmcnt(4)
    v_mfma_f32_16x16x32_bf16 v[52:55], a[244:247], a[160:163], v[52:55]
    ds_read_b128 a[192:195], v22 offset:49152
    s_waitcnt lgkmcnt(4)
    v_mfma_f32_16x16x32_bf16 v[52:55], a[248:251], a[188:191], v[52:55]
    ds_read_b128 a[220:223], v22 offset:56320
    s_waitcnt lgkmcnt(4)
    v_mfma_f32_16x16x32_bf16 v[52:55], a[252:255], a[216:219], v[52:55]
    ds_read_b128 a[224:227], v12 offset:16384
    s_waitcnt lgkmcnt(4)
    v_mfma_f32_16x16x32_bf16 v[56:59], a[240:243], a[136:139], v[56:59]
    ds_read_b128 a[228:231], v13 offset:16384
    buffer_load_dwordx4 v4, s[24:27], s43 offen offset:3072 nt lds
    s_waitcnt lgkmcnt(4)
    v_mfma_f32_16x16x32_bf16 v[56:59], a[244:247], a[164:167], v[56:59]
    ds_read_b128 a[232:235], v14 offset:16384
    s_waitcnt lgkmcnt(4)
    v_mfma_f32_16x16x32_bf16 v[56:59], a[248:251], a[192:195], v[56:59]
    ds_read_b128 a[236:239], v15 offset:16384
    s_waitcnt lgkmcnt(4)
    v_mfma_f32_16x16x32_bf16 v[56:59], a[252:255], a[220:223], v[56:59]
    v_exp_f32 v32, v32
    s_waitcnt lgkmcnt(3)
    v_mfma_f32_16x16x32_bf16 v[60:63], a[224:227], a[0:3], 0
    v_exp_f32 v33, v33
    s_waitcnt lgkmcnt(2)
    v_mfma_f32_16x16x32_bf16 v[60:63], a[228:231], a[28:31], v[60:63]
    v_exp_f32 v34, v34
    s_waitcnt lgkmcnt(1)
    v_mfma_f32_16x16x32_bf16 v[60:63], a[232:235], a[56:59], v[60:63]
    v_exp_f32 v35, v35
    s_waitcnt lgkmcnt(0)
    v_mfma_f32_16x16x32_bf16 v[60:63], a[236:239], a[84:87], v[60:63]
    v_exp_f32 v36, v36
    v_mfma_f32_16x16x32_bf16 v[64:67], a[224:227], a[4:7], 0
    s_barrier
    v_exp_f32 v37, v37
    v_mfma_f32_16x16x32_bf16 v[64:67], a[228:231], a[32:35], v[64:67]
    s_add_u32 m0, s42, 16384
    s_mov_b32 s43, 131072
    v_mfma_f32_16x16x32_bf16 v[64:67], a[232:235], a[60:63], v[64:67]
    buffer_load_dwordx4 v1, s[24:27], s43 offen offset:0 nt lds
    v_mfma_f32_16x16x32_bf16 v[64:67], a[236:239], a[88:91], v[64:67]
    v_exp_f32 v38, v38
    v_mfma_f32_16x16x32_bf16 v[68:71], a[224:227], a[8:11], 0
    v_exp_f32 v39, v39
    v_mfma_f32_16x16x32_bf16 v[68:71], a[228:231], a[36:39], v[68:71]
    v_exp_f32 v40, v40
    v_mfma_f32_16x16x32_bf16 v[68:71], a[232:235], a[64:67], v[68:71]
    buffer_load_dwordx4 v2, s[24:27], s43 offen offset:1024 nt lds
    v_mfma_f32_16x16x32_bf16 v[68:71], a[236:239], a[92:95], v[68:71]
    v_exp_f32 v41, v41
    v_mfma_f32_16x16x32_bf16 v[72:75], a[224:227], a[12:15], 0
    v_exp_f32 v42, v42
    v_mfma_f32_16x16x32_bf16 v[72:75], a[228:231], a[40:43], v[72:75]
    v_exp_f32 v43, v43
    v_mfma_f32_16x16x32_bf16 v[72:75], a[232:235], a[68:71], v[72:75]
    v_exp_f32 v44, v44
    v_mfma_f32_16x16x32_bf16 v[72:75], a[236:239], a[96:99], v[72:75]
    v_exp_f32 v45, v45
    v_mfma_f32_16x16x32_bf16 v[76:79], a[224:227], a[16:19], 0
    s_waitcnt vmcnt(18)
    ds_read_b128 a[240:243], v12 offset:20480
    v_cvt_pk_bf16_f32 v88, v32, v33
    v_mfma_f32_16x16x32_bf16 v[76:79], a[228:231], a[44:47], v[76:79]
    ds_read_b128 a[244:247], v13 offset:20480
    v_add_f32 v25, v32, v33
    v_mfma_f32_16x16x32_bf16 v[76:79], a[232:235], a[72:75], v[76:79]
    buffer_load_dwordx4 v3, s[24:27], s43 offen offset:2048 nt lds
    v_mfma_f32_16x16x32_bf16 v[76:79], a[236:239], a[100:103], v[76:79]
    ds_read_b128 a[248:251], v14 offset:20480
    v_cvt_pk_bf16_f32 v89, v34, v35
    v_mfma_f32_16x16x32_bf16 v[80:83], a[224:227], a[20:23], 0
    ds_write_b64 v23, v[88:89] offset:0
    v_mfma_f32_16x16x32_bf16 v[80:83], a[228:231], a[48:51], v[80:83]
    ds_read_b128 a[252:255], v15 offset:20480
    v_add_f32 v25, v25, v34
    v_mfma_f32_16x16x32_bf16 v[80:83], a[232:235], a[76:79], v[80:83]
    v_exp_f32 v46, v46
    v_mfma_f32_16x16x32_bf16 v[80:83], a[236:239], a[104:107], v[80:83]
    v_exp_f32 v47, v47
    v_mfma_f32_16x16x32_bf16 v[84:87], a[224:227], a[24:27], 0
    buffer_load_dwordx4 v4, s[24:27], s43 offen offset:3072 nt lds
    v_mfma_f32_16x16x32_bf16 v[84:87], a[228:231], a[52:55], v[84:87]
    v_exp_f32 v48, v48
    v_mfma_f32_16x16x32_bf16 v[84:87], a[232:235], a[80:83], v[84:87]
    v_exp_f32 v49, v49
    v_mfma_f32_16x16x32_bf16 v[84:87], a[236:239], a[108:111], v[84:87]
    v_exp_f32 v50, v50
    s_waitcnt lgkmcnt(4)
    v_mfma_f32_16x16x32_bf16 v[60:63], a[240:243], a[112:115], v[60:63]
    s_waitcnt lgkmcnt(0)
    s_add_u32 m0, s42, 20480
    s_mov_b32 s43, 131328
    v_mfma_f32_16x16x32_bf16 v[60:63], a[244:247], a[140:143], v[60:63]
    v_exp_f32 v51, v51
    v_mfma_f32_16x16x32_bf16 v[60:63], a[248:251], a[168:171], v[60:63]
    v_exp_f32 v52, v52
    v_mfma_f32_16x16x32_bf16 v[60:63], a[252:255], a[196:199], v[60:63]
    v_exp_f32 v53, v53
    v_mfma_f32_16x16x32_bf16 v[64:67], a[240:243], a[116:119], v[64:67]
    buffer_load_dwordx4 v1, s[24:27], s43 offen offset:0 nt lds
    v_mfma_f32_16x16x32_bf16 v[64:67], a[244:247], a[144:147], v[64:67]
    v_exp_f32 v54, v54
    v_mfma_f32_16x16x32_bf16 v[64:67], a[248:251], a[172:175], v[64:67]
    v_exp_f32 v55, v55
    v_mfma_f32_16x16x32_bf16 v[64:67], a[252:255], a[200:203], v[64:67]
    v_exp_f32 v56, v56
    v_mfma_f32_16x16x32_bf16 v[68:71], a[240:243], a[120:123], v[68:71]
    v_exp_f32 v57, v57
    v_mfma_f32_16x16x32_bf16 v[68:71], a[244:247], a[148:151], v[68:71]
    v_exp_f32 v58, v58
    v_mfma_f32_16x16x32_bf16 v[68:71], a[248:251], a[176:179], v[68:71]
    v_exp_f32 v59, v59
    v_mfma_f32_16x16x32_bf16 v[68:71], a[252:255], a[204:207], v[68:71]
    buffer_load_dwordx4 v2, s[24:27], s43 offen offset:1024 nt lds
    v_mfma_f32_16x16x32_bf16 v[72:75], a[240:243], a[124:127], v[72:75]
    v_exp_f32 v60, v60
    v_mfma_f32_16x16x32_bf16 v[72:75], a[244:247], a[152:155], v[72:75]
    v_exp_f32 v61, v61
    v_mfma_f32_16x16x32_bf16 v[72:75], a[248:251], a[180:183], v[72:75]
    v_exp_f32 v62, v62
    v_mfma_f32_16x16x32_bf16 v[72:75], a[252:255], a[208:211], v[72:75]
    v_exp_f32 v63, v63
    v_mfma_f32_16x16x32_bf16 v[76:79], a[240:243], a[128:131], v[76:79]
    s_waitcnt vmcnt(18)
    ds_read_b128 a[224:227], v12 offset:0
    v_add_f32 v25, v25, v35
    v_mfma_f32_16x16x32_bf16 v[76:79], a[244:247], a[156:159], v[76:79]
    ds_read_b128 a[228:231], v13 offset:0
    v_cvt_pk_bf16_f32 v92, v36, v37
    v_mfma_f32_16x16x32_bf16 v[76:79], a[248:251], a[184:187], v[76:79]
    v_exp_f32 v64, v64
    v_mfma_f32_16x16x32_bf16 v[76:79], a[252:255], a[212:215], v[76:79]
    ds_read_b128 a[232:235], v14 offset:0
    v_add_f32 v26, v36, v37
    v_mfma_f32_16x16x32_bf16 v[80:83], a[240:243], a[132:135], v[80:83]
    buffer_load_dwordx4 v3, s[24:27], s43 offen offset:2048 nt lds
    v_mfma_f32_16x16x32_bf16 v[80:83], a[244:247], a[160:163], v[80:83]
    ds_read_b128 a[236:239], v15 offset:0
    v_cvt_pk_bf16_f32 v93, v38, v39
    v_mfma_f32_16x16x32_bf16 v[80:83], a[248:251], a[188:191], v[80:83]
    ds_write_b64 v23, v[92:93] offset:1024
    v_mfma_f32_16x16x32_bf16 v[80:83], a[252:255], a[216:219], v[80:83]
    v_exp_f32 v65, v65
    v_mfma_f32_16x16x32_bf16 v[84:87], a[240:243], a[136:139], v[84:87]
    v_exp_f32 v66, v66
    v_mfma_f32_16x16x32_bf16 v[84:87], a[244:247], a[164:167], v[84:87]
    v_exp_f32 v67, v67
    v_mfma_f32_16x16x32_bf16 v[84:87], a[248:251], a[192:195], v[84:87]
    buffer_load_dwordx4 v4, s[24:27], s43 offen offset:3072 nt lds
    v_mfma_f32_16x16x32_bf16 v[84:87], a[252:255], a[220:223], v[84:87]
    v_exp_f32 v68, v68
    s_waitcnt lgkmcnt(4)
    v_mfma_f32_16x16x32_bf16 v[228:231], a[224:227], a[0:3], 0
    v_exp_f32 v69, v69
    s_waitcnt lgkmcnt(3)
    v_mfma_f32_16x16x32_bf16 v[228:231], a[228:231], a[28:31], v[228:231]
    v_exp_f32 v70, v70
    s_waitcnt lgkmcnt(2)
    v_mfma_f32_16x16x32_bf16 v[228:231], a[232:235], a[56:59], v[228:231]
    s_waitcnt lgkmcnt(1)
    s_add_u32 m0, s42, 0
    s_mov_b32 s43, 139264
    v_mfma_f32_16x16x32_bf16 v[228:231], a[236:239], a[84:87], v[228:231]
    v_exp_f32 v71, v71
    v_mfma_f32_16x16x32_bf16 v[232:235], a[224:227], a[4:7], 0
    v_exp_f32 v72, v72
    v_mfma_f32_16x16x32_bf16 v[232:235], a[228:231], a[32:35], v[232:235]
    v_exp_f32 v73, v73
    v_mfma_f32_16x16x32_bf16 v[232:235], a[232:235], a[60:63], v[232:235]
    buffer_load_dwordx4 v1, s[24:27], s43 offen offset:0 nt lds
    v_mfma_f32_16x16x32_bf16 v[232:235], a[236:239], a[88:91], v[232:235]
    v_exp_f32 v74, v74
    v_mfma_f32_16x16x32_bf16 v[236:239], a[224:227], a[8:11], 0
    v_exp_f32 v75, v75
    v_mfma_f32_16x16x32_bf16 v[236:239], a[228:231], a[36:39], v[236:239]
    v_exp_f32 v76, v76
    v_mfma_f32_16x16x32_bf16 v[236:239], a[232:235], a[64:67], v[236:239]
    v_exp_f32 v77, v77
    v_mfma_f32_16x16x32_bf16 v[236:239], a[236:239], a[92:95], v[236:239]
    v_exp_f32 v78, v78
    v_mfma_f32_16x16x32_bf16 v[240:243], a[224:227], a[12:15], 0
    v_exp_f32 v79, v79
    v_mfma_f32_16x16x32_bf16 v[240:243], a[228:231], a[40:43], v[240:243]
    buffer_load_dwordx4 v2, s[24:27], s43 offen offset:1024 nt lds
    v_mfma_f32_16x16x32_bf16 v[240:243], a[232:235], a[68:71], v[240:243]
    v_exp_f32 v80, v80
    v_mfma_f32_16x16x32_bf16 v[240:243], a[236:239], a[96:99], v[240:243]
    v_exp_f32 v81, v81
    v_mfma_f32_16x16x32_bf16 v[244:247], a[224:227], a[16:19], 0
    s_waitcnt vmcnt(18)
    ds_read_b128 a[240:243], v12 offset:4096
    v_add_f32 v26, v26, v38
    v_mfma_f32_16x16x32_bf16 v[244:247], a[228:231], a[44:47], v[244:247]
    ds_read_b128 a[244:247], v13 offset:4096
    v_add_f32 v26, v26, v39
    v_mfma_f32_16x16x32_bf16 v[244:247], a[232:235], a[72:75], v[244:247]
    v_exp_f32 v82, v82
    v_mfma_f32_16x16x32_bf16 v[244:247], a[236:239], a[100:103], v[244:247]
    ds_read_b128 a[248:251], v14 offset:4096
    v_cvt_pk_bf16_f32 v96, v40, v41
    v_mfma_f32_16x16x32_bf16 v[248:251], a[224:227], a[20:23], 0
    v_exp_f32 v83, v83
    v_mfma_f32_16x16x32_bf16 v[248:251], a[228:231], a[48:51], v[248:251]
    ds_read_b128 a[252:255], v15 offset:4096
    v_add_f32 v27, v40, v41
    v_mfma_f32_16x16x32_bf16 v[248:251], a[232:235], a[76:79], v[248:251]
    buffer_load_dwordx4 v3, s[24:27], s43 offen offset:2048 nt lds
    v_mfma_f32_16x16x32_bf16 v[248:251], a[236:239], a[104:107], v[248:251]
    v_exp_f32 v84, v84
    v_mfma_f32_16x16x32_bf16 v[252:255], a[224:227], a[24:27], 0
    v_exp_f32 v85, v85
    v_mfma_f32_16x16x32_bf16 v[252:255], a[228:231], a[52:55], v[252:255]
    v_exp_f32 v86, v86
    v_mfma_f32_16x16x32_bf16 v[252:255], a[232:235], a[80:83], v[252:255]
    v_exp_f32 v87, v87
    v_mfma_f32_16x16x32_bf16 v[252:255], a[236:239], a[108:111], v[252:255]
    v_cvt_pk_bf16_f32 v97, v42, v43
    v_add_f32 v27, v27, v42
    s_waitcnt lgkmcnt(3)
    v_mfma_f32_16x16x32_bf16 v[228:231], a[240:243], a[112:115], v[228:231]
    buffer_load_dwordx4 v4, s[24:27], s43 offen offset:3072 nt lds
    s_waitcnt lgkmcnt(2)
    v_mfma_f32_16x16x32_bf16 v[228:231], a[244:247], a[140:143], v[228:231]
    ds_write_b64 v23, v[96:97] offset:2048
    s_waitcnt lgkmcnt(2)
    v_mfma_f32_16x16x32_bf16 v[228:231], a[248:251], a[168:171], v[228:231]
    v_add_f32 v27, v27, v43
    v_cvt_pk_bf16_f32 v100, v44, v45
    s_waitcnt lgkmcnt(1)
    v_mfma_f32_16x16x32_bf16 v[228:231], a[252:255], a[196:199], v[228:231]
    v_add_f32 v28, v44, v45
    v_cvt_pk_bf16_f32 v101, v46, v47
    v_mfma_f32_16x16x32_bf16 v[232:235], a[240:243], a[116:119], v[232:235]
    s_add_u32 m0, s42, 4096
    s_mov_b32 s43, 139520
    v_mfma_f32_16x16x32_bf16 v[232:235], a[244:247], a[144:147], v[232:235]
    ds_write_b64 v23, v[100:101] offset:3072
    v_mfma_f32_16x16x32_bf16 v[232:235], a[248:251], a[172:175], v[232:235]
    v_exp_f32 v228, v228
    v_mfma_f32_16x16x32_bf16 v[232:235], a[252:255], a[200:203], v[232:235]
    v_exp_f32 v229, v229
    v_mfma_f32_16x16x32_bf16 v[236:239], a[240:243], a[120:123], v[236:239]
    buffer_load_dwordx4 v1, s[24:27], s43 offen offset:0 nt lds
    v_mfma_f32_16x16x32_bf16 v[236:239], a[244:247], a[148:151], v[236:239]
    v_exp_f32 v230, v230
    v_mfma_f32_16x16x32_bf16 v[236:239], a[248:251], a[176:179], v[236:239]
    v_exp_f32 v231, v231
    v_mfma_f32_16x16x32_bf16 v[236:239], a[252:255], a[204:207], v[236:239]
    v_exp_f32 v232, v232
    v_mfma_f32_16x16x32_bf16 v[240:243], a[240:243], a[124:127], v[240:243]
    v_exp_f32 v233, v233
    v_mfma_f32_16x16x32_bf16 v[240:243], a[244:247], a[152:155], v[240:243]
    v_exp_f32 v234, v234
    v_mfma_f32_16x16x32_bf16 v[240:243], a[248:251], a[180:183], v[240:243]
    v_exp_f32 v235, v235
    v_mfma_f32_16x16x32_bf16 v[240:243], a[252:255], a[208:211], v[240:243]
    buffer_load_dwordx4 v2, s[24:27], s43 offen offset:1024 nt lds
    v_mfma_f32_16x16x32_bf16 v[244:247], a[240:243], a[128:131], v[244:247]
    s_waitcnt vmcnt(18)
    ds_read_b128 a[224:227], v12 offset:8192
    v_add_f32 v28, v28, v46
    v_mfma_f32_16x16x32_bf16 v[244:247], a[244:247], a[156:159], v[244:247]
    ds_read_b128 a[228:231], v13 offset:8192
    v_add_f32 v28, v28, v47
    v_mfma_f32_16x16x32_bf16 v[244:247], a[248:251], a[184:187], v[244:247]
    v_exp_f32 v236, v236
    v_mfma_f32_16x16x32_bf16 v[244:247], a[252:255], a[212:215], v[244:247]
    ds_read_b128 a[232:235], v14 offset:8192
    v_cvt_pk_bf16_f32 v104, v48, v49
    v_mfma_f32_16x16x32_bf16 v[248:251], a[240:243], a[132:135], v[248:251]
    v_exp_f32 v237, v237
    v_mfma_f32_16x16x32_bf16 v[248:251], a[244:247], a[160:163], v[248:251]
    ds_read_b128 a[236:239], v15 offset:8192
    v_add_f32 v29, v48, v49
    v_mfma_f32_16x16x32_bf16 v[248:251], a[248:251], a[188:191], v[248:251]
    v_exp_f32 v238, v238
    v_mfma_f32_16x16x32_bf16 v[248:251], a[252:255], a[216:219], v[248:251]
    buffer_load_dwordx4 v3, s[24:27], s43 offen offset:2048 nt lds
    v_mfma_f32_16x16x32_bf16 v[252:255], a[240:243], a[136:139], v[252:255]
    v_exp_f32 v239, v239
    v_mfma_f32_16x16x32_bf16 v[252:255], a[244:247], a[164:167], v[252:255]
    v_exp_f32 v240, v240
    v_mfma_f32_16x16x32_bf16 v[252:255], a[248:251], a[192:195], v[252:255]
    v_exp_f32 v241, v241
    v_mfma_f32_16x16x32_bf16 v[252:255], a[252:255], a[220:223], v[252:255]
    v_exp_f32 v242, v242
    s_waitcnt lgkmcnt(3)
    v_mfma_f32_16x16x32_bf16 v[32:35], a[224:227], a[0:3], 0
    v_exp_f32 v243, v243
    s_waitcnt lgkmcnt(2)
    v_mfma_f32_16x16x32_bf16 v[32:35], a[228:231], a[28:31], v[32:35]
    v_exp_f32 v244, v244
    s_waitcnt lgkmcnt(1)
    v_mfma_f32_16x16x32_bf16 v[32:35], a[232:235], a[56:59], v[32:35]
    buffer_load_dwordx4 v4, s[24:27], s43 offen offset:3072 nt lds
    s_waitcnt lgkmcnt(0)
    v_mfma_f32_16x16x32_bf16 v[32:35], a[236:239], a[84:87], v[32:35]
    v_exp_f32 v245, v245
    v_mfma_f32_16x16x32_bf16 v[36:39], a[224:227], a[4:7], 0
    v_exp_f32 v246, v246
    v_mfma_f32_16x16x32_bf16 v[36:39], a[228:231], a[32:35], v[36:39]
    v_exp_f32 v247, v247
    v_mfma_f32_16x16x32_bf16 v[36:39], a[232:235], a[60:63], v[36:39]
    s_add_u32 m0, s42, 8192
    s_mov_b32 s43, 196608
    v_mfma_f32_16x16x32_bf16 v[36:39], a[236:239], a[88:91], v[36:39]
    v_exp_f32 v248, v248
    v_mfma_f32_16x16x32_bf16 v[40:43], a[224:227], a[8:11], 0
    v_exp_f32 v249, v249
    v_mfma_f32_16x16x32_bf16 v[40:43], a[228:231], a[36:39], v[40:43]
    v_exp_f32 v250, v250
    v_mfma_f32_16x16x32_bf16 v[40:43], a[232:235], a[64:67], v[40:43]
    buffer_load_dwordx4 v1, s[24:27], s43 offen offset:0 nt lds
    v_mfma_f32_16x16x32_bf16 v[40:43], a[236:239], a[92:95], v[40:43]
    v_exp_f32 v251, v251
    v_mfma_f32_16x16x32_bf16 v[44:47], a[224:227], a[12:15], 0
    v_exp_f32 v252, v252
    v_mfma_f32_16x16x32_bf16 v[44:47], a[228:231], a[40:43], v[44:47]
    v_exp_f32 v253, v253
    v_mfma_f32_16x16x32_bf16 v[44:47], a[232:235], a[68:71], v[44:47]
    v_exp_f32 v254, v254
    v_mfma_f32_16x16x32_bf16 v[44:47], a[236:239], a[96:99], v[44:47]
    v_cvt_pk_bf16_f32 v105, v50, v51
    v_add_f32 v29, v29, v50
    v_add_f32 v29, v29, v51
    v_mfma_f32_16x16x32_bf16 v[48:51], a[224:227], a[16:19], 0
    s_waitcnt vmcnt(17)
    ds_read_b128 a[240:243], v12 offset:12288
    v_cvt_pk_bf16_f32 v108, v52, v53
    v_mfma_f32_16x16x32_bf16 v[48:51], a[228:231], a[44:47], v[48:51]
    ds_read_b128 a[244:247], v13 offset:12288
    v_add_f32 v30, v52, v53
    v_mfma_f32_16x16x32_bf16 v[48:51], a[232:235], a[72:75], v[48:51]
    buffer_load_dwordx4 v2, s[24:27], s43 offen offset:1024 nt lds
    v_mfma_f32_16x16x32_bf16 v[48:51], a[236:239], a[100:103], v[48:51]
    v_cvt_pk_bf16_f32 v109, v54, v55
    v_add_f32 v30, v30, v54
    v_add_f32 v30, v30, v55
    v_mfma_f32_16x16x32_bf16 v[52:55], a[224:227], a[20:23], 0
    ds_read_b128 a[248:251], v14 offset:12288
    v_cvt_pk_bf16_f32 v112, v56, v57
    v_mfma_f32_16x16x32_bf16 v[52:55], a[228:231], a[48:51], v[52:55]
    ds_read_b128 a[252:255], v15 offset:12288
    v_add_f32 v31, v56, v57
    v_mfma_f32_16x16x32_bf16 v[52:55], a[232:235], a[76:79], v[52:55]
    ds_write_b64 v23, v[104:105] offset:4096
    v_mfma_f32_16x16x32_bf16 v[52:55], a[236:239], a[104:107], v[52:55]
    v_cvt_pk_bf16_f32 v113, v58, v59
    v_add_f32 v31, v31, v58
    v_add_f32 v31, v31, v59
    v_mfma_f32_16x16x32_bf16 v[56:59], a[224:227], a[24:27], 0
    v_exp_f32 v255, v255
    v_mfma_f32_16x16x32_bf16 v[56:59], a[228:231], a[52:55], v[56:59]
    buffer_load_dwordx4 v3, s[24:27], s43 offen offset:2048 nt lds
    v_mfma_f32_16x16x32_bf16 v[56:59], a[232:235], a[80:83], v[56:59]
    ds_write_b64 v23, v[108:109] offset:5120
    v_mfma_f32_16x16x32_bf16 v[56:59], a[236:239], a[108:111], v[56:59]
    v_add_f32 v25, v25, v60
    v_cvt_pk_bf16_f32 v90, v60, v61
    s_waitcnt lgkmcnt(5)
    v_mfma_f32_16x16x32_bf16 v[32:35], a[240:243], a[112:115], v[32:35]
    v_add_f32 v25, v25, v61
    v_cvt_pk_bf16_f32 v91, v62, v63
    s_waitcnt lgkmcnt(4)
    v_mfma_f32_16x16x32_bf16 v[32:35], a[244:247], a[140:143], v[32:35]
    ds_write_b64 v23, v[112:113] offset:6144
    s_waitcnt lgkmcnt(4)
    v_mfma_f32_16x16x32_bf16 v[32:35], a[248:251], a[168:171], v[32:35]
    v_add_f32 v25, v25, v62
    v_add_f32 v25, v25, v63
    s_waitcnt lgkmcnt(3)
    v_mfma_f32_16x16x32_bf16 v[32:35], a[252:255], a[196:199], v[32:35]
    v_add_f32 v26, v26, v64
    v_cvt_pk_bf16_f32 v94, v64, v65
    v_mfma_f32_16x16x32_bf16 v[36:39], a[240:243], a[116:119], v[36:39]
    buffer_load_dwordx4 v4, s[24:27], s43 offen offset:3072 nt lds
    v_mfma_f32_16x16x32_bf16 v[36:39], a[244:247], a[144:147], v[36:39]
    ds_write_b64 v23, v[90:91] offset:8
    v_mfma_f32_16x16x32_bf16 v[36:39], a[248:251], a[172:175], v[36:39]
    v_add_f32 v26, v26, v65
    v_cvt_pk_bf16_f32 v95, v66, v67
    v_mfma_f32_16x16x32_bf16 v[36:39], a[252:255], a[200:203], v[36:39]
    v_exp_f32 v32, v32
    v_mfma_f32_16x16x32_bf16 v[40:43], a[240:243], a[120:123], v[40:43]
    s_add_u32 m0, s42, 12288
    s_mov_b32 s43, 196864
    v_mfma_f32_16x16x32_bf16 v[40:43], a[244:247], a[148:151], v[40:43]
    ds_write_b64 v23, v[94:95] offset:1032
    v_mfma_f32_16x16x32_bf16 v[40:43], a[248:251], a[176:179], v[40:43]
    v_exp_f32 v33, v33
    v_mfma_f32_16x16x32_bf16 v[40:43], a[252:255], a[204:207], v[40:43]
    v_exp_f32 v34, v34
    v_mfma_f32_16x16x32_bf16 v[44:47], a[240:243], a[124:127], v[44:47]
    buffer_load_dwordx4 v1, s[24:27], s43 offen offset:0 nt lds
    v_mfma_f32_16x16x32_bf16 v[44:47], a[244:247], a[152:155], v[44:47]
    v_exp_f32 v35, v35
    v_mfma_f32_16x16x32_bf16 v[44:47], a[248:251], a[180:183], v[44:47]
    v_exp_f32 v36, v36
    v_mfma_f32_16x16x32_bf16 v[44:47], a[252:255], a[208:211], v[44:47]
    v_exp_f32 v37, v37
    v_mfma_f32_16x16x32_bf16 v[48:51], a[240:243], a[128:131], v[48:51]
    s_waitcnt vmcnt(17)
    ds_read_b128 a[224:227], v12 offset:16384
    v_add_f32 v26, v26, v66
    v_mfma_f32_16x16x32_bf16 v[48:51], a[244:247], a[156:159], v[48:51]
    ds_read_b128 a[228:231], v13 offset:16384
    v_add_f32 v26, v26, v67
    v_mfma_f32_16x16x32_bf16 v[48:51], a[248:251], a[184:187], v[48:51]
    v_exp_f32 v38, v38
    v_mfma_f32_16x16x32_bf16 v[48:51], a[252:255], a[212:215], v[48:51]
    ds_read_b128 a[232:235], v14 offset:16384
    v_add_f32 v27, v27, v68
    v_mfma_f32_16x16x32_bf16 v[52:55], a[240:243], a[132:135], v[52:55]
    buffer_load_dwordx4 v2, s[24:27], s43 offen offset:1024 nt lds
    v_mfma_f32_16x16x32_bf16 v[52:55], a[244:247], a[160:163], v[52:55]
    ds_read_b128 a[236:239], v15 offset:16384
    v_cvt_pk_bf16_f32 v98, v68, v69
    v_mfma_f32_16x16x32_bf16 v[52:55], a[248:251], a[188:191], v[52:55]
    v_exp_f32 v39, v39
    v_mfma_f32_16x16x32_bf16 v[52:55], a[252:255], a[216:219], v[52:55]
    v_exp_f32 v40, v40
    v_mfma_f32_16x16x32_bf16 v[56:59], a[240:243], a[136:139], v[56:59]
    v_exp_f32 v41, v41
    v_mfma_f32_16x16x32_bf16 v[56:59], a[244:247], a[164:167], v[56:59]
    v_exp_f32 v42, v42
    v_mfma_f32_16x16x32_bf16 v[56:59], a[248:251], a[192:195], v[56:59]
    v_exp_f32 v43, v43
    v_mfma_f32_16x16x32_bf16 v[56:59], a[252:255], a[220:223], v[56:59]
    buffer_load_dwordx4 v3, s[24:27], s43 offen offset:2048 nt lds
    s_waitcnt lgkmcnt(3)
    v_mfma_f32_16x16x32_bf16 v[60:63], a[224:227], a[0:3], 0
    v_exp_f32 v44, v44
    s_waitcnt lgkmcnt(2)
    v_mfma_f32_16x16x32_bf16 v[60:63], a[228:231], a[28:31], v[60:63]
    v_exp_f32 v45, v45
    s_waitcnt lgkmcnt(1)
    v_mfma_f32_16x16x32_bf16 v[60:63], a[232:235], a[56:59], v[60:63]
    v_exp_f32 v46, v46
    s_waitcnt lgkmcnt(0)
    v_mfma_f32_16x16x32_bf16 v[60:63], a[236:239], a[84:87], v[60:63]
    v_exp_f32 v47, v47
    v_mfma_f32_16x16x32_bf16 v[64:67], a[224:227], a[4:7], 0
    v_exp_f32 v48, v48
    v_mfma_f32_16x16x32_bf16 v[64:67], a[228:231], a[32:35], v[64:67]
    v_exp_f32 v49, v49
    v_mfma_f32_16x16x32_bf16 v[64:67], a[232:235], a[60:63], v[64:67]
    buffer_load_dwordx4 v4, s[24:27], s43 offen offset:3072 nt lds
    v_mfma_f32_16x16x32_bf16 v[64:67], a[236:239], a[88:91], v[64:67]
    v_add_f32 v27, v27, v69
    v_cvt_pk_bf16_f32 v99, v70, v71
    v_add_f32 v27, v27, v70
    v_add_f32 v27, v27, v71
    v_mfma_f32_16x16x32_bf16 v[68:71], a[224:227], a[8:11], 0
    ds_write_b64 v23, v[98:99] offset:2056
    v_mfma_f32_16x16x32_bf16 v[68:71], a[228:231], a[36:39], v[68:71]
    v_add_f32 v28, v28, v72
    v_cvt_pk_bf16_f32 v102, v72, v73
    v_mfma_f32_16x16x32_bf16 v[68:71], a[232:235], a[64:67], v[68:71]
    s_add_u32 m0, s42, 16384
    s_mov_b32 s43, 204800
    v_mfma_f32_16x16x32_bf16 v[68:71], a[236:239], a[92:95], v[68:71]
    v_add_f32 v28, v28, v73
    v_cvt_pk_bf16_f32 v103, v74, v75
    v_add_f32 v28, v28, v74
    v_add_f32 v28, v28, v75
    v_mfma_f32_16x16x32_bf16 v[72:75], a[224:227], a[12:15], 0
    ds_write_b64 v23, v[102:103] offset:3080
    v_mfma_f32_16x16x32_bf16 v[72:75], a[228:231], a[40:43], v[72:75]
    v_add_f32 v29, v29, v76
    v_cvt_pk_bf16_f32 v106, v76, v77
    v_mfma_f32_16x16x32_bf16 v[72:75], a[232:235], a[68:71], v[72:75]
    buffer_load_dwordx4 v1, s[24:27], s43 offen offset:0 nt lds
    v_mfma_f32_16x16x32_bf16 v[72:75], a[236:239], a[96:99], v[72:75]
    v_add_f32 v29, v29, v77
    v_cvt_pk_bf16_f32 v107, v78, v79
    v_add_f32 v29, v29, v78
    v_add_f32 v29, v29, v79
    v_mfma_f32_16x16x32_bf16 v[76:79], a[224:227], a[16:19], 0
    s_waitcnt vmcnt(17)
    ds_read_b128 a[240:243], v12 offset:20480
    v_add_f32 v30, v30, v80
    v_mfma_f32_16x16x32_bf16 v[76:79], a[228:231], a[44:47], v[76:79]
    ds_read_b128 a[244:247], v13 offset:20480
    v_cvt_pk_bf16_f32 v110, v80, v81
    v_mfma_f32_16x16x32_bf16 v[76:79], a[232:235], a[72:75], v[76:79]
    ds_write_b64 v23, v[106:107] offset:4104
    v_mfma_f32_16x16x32_bf16 v[76:79], a[236:239], a[100:103], v[76:79]
    v_add_f32 v30, v30, v81
    v_cvt_pk_bf16_f32 v111, v82, v83
    v_add_f32 v30, v30, v82
    v_add_f32 v30, v30, v83
    v_mfma_f32_16x16x32_bf16 v[80:83], a[224:227], a[20:23], 0
    ds_read_b128 a[248:251], v14 offset:20480
    v_add_f32 v31, v31, v84
    v_mfma_f32_16x16x32_bf16 v[80:83], a[228:231], a[48:51], v[80:83]
    ds_read_b128 a[252:255], v15 offset:20480
    v_cvt_pk_bf16_f32 v114, v84, v85
    v_mfma_f32_16x16x32_bf16 v[80:83], a[232:235], a[76:79], v[80:83]
    buffer_load_dwordx4 v2, s[24:27], s43 offen offset:1024 nt lds
    v_mfma_f32_16x16x32_bf16 v[80:83], a[236:239], a[104:107], v[80:83]
    v_add_f32 v31, v31, v85
    v_cvt_pk_bf16_f32 v115, v86, v87
    v_add_f32 v31, v31, v86
    v_add_f32 v31, v31, v87
    v_mfma_f32_16x16x32_bf16 v[84:87], a[224:227], a[24:27], 0
    ds_write_b64 v23, v[110:111] offset:5128
    v_mfma_f32_16x16x32_bf16 v[84:87], a[228:231], a[52:55], v[84:87]
    v_exp_f32 v50, v50
    v_mfma_f32_16x16x32_bf16 v[84:87], a[232:235], a[80:83], v[84:87]
    v_exp_f32 v51, v51
    v_mfma_f32_16x16x32_bf16 v[84:87], a[236:239], a[108:111], v[84:87]
    ds_write_b64 v23, v[114:115] offset:6152
    s_waitcnt lgkmcnt(6)
    v_mfma_f32_16x16x32_bf16 v[60:63], a[240:243], a[112:115], v[60:63]
    v_exp_f32 v52, v52
    s_waitcnt lgkmcnt(5)
    v_mfma_f32_16x16x32_bf16 v[60:63], a[244:247], a[140:143], v[60:63]
    buffer_load_dwordx4 v3, s[24:27], s43 offen offset:2048 nt lds
    s_waitcnt lgkmcnt(3)
    v_mfma_f32_16x16x32_bf16 v[60:63], a[248:251], a[168:171], v[60:63]
    v_exp_f32 v53, v53
    s_waitcnt lgkmcnt(2)
    v_mfma_f32_16x16x32_bf16 v[60:63], a[252:255], a[196:199], v[60:63]
    v_exp_f32 v54, v54
    v_mfma_f32_16x16x32_bf16 v[64:67], a[240:243], a[116:119], v[64:67]
    v_exp_f32 v55, v55
    v_mfma_f32_16x16x32_bf16 v[64:67], a[244:247], a[144:147], v[64:67]
    v_exp_f32 v56, v56
    v_mfma_f32_16x16x32_bf16 v[64:67], a[248:251], a[172:175], v[64:67]
    v_exp_f32 v57, v57
    v_mfma_f32_16x16x32_bf16 v[64:67], a[252:255], a[200:203], v[64:67]
    v_exp_f32 v58, v58
    v_mfma_f32_16x16x32_bf16 v[68:71], a[240:243], a[120:123], v[68:71]
    buffer_load_dwordx4 v4, s[24:27], s43 offen offset:3072 nt lds
    v_mfma_f32_16x16x32_bf16 v[68:71], a[244:247], a[148:151], v[68:71]
    v_exp_f32 v59, v59
    v_mfma_f32_16x16x32_bf16 v[68:71], a[248:251], a[176:179], v[68:71]
    v_exp_f32 v60, v60
    v_mfma_f32_16x16x32_bf16 v[68:71], a[252:255], a[204:207], v[68:71]
    v_exp_f32 v61, v61
    v_mfma_f32_16x16x32_bf16 v[72:75], a[240:243], a[124:127], v[72:75]
    s_add_u32 m0, s42, 20480
    s_mov_b32 s43, 205056
    v_mfma_f32_16x16x32_bf16 v[72:75], a[244:247], a[152:155], v[72:75]
    v_exp_f32 v62, v62
    v_mfma_f32_16x16x32_bf16 v[72:75], a[248:251], a[180:183], v[72:75]
    v_exp_f32 v63, v63
    v_mfma_f32_16x16x32_bf16 v[72:75], a[252:255], a[208:211], v[72:75]
    v_exp_f32 v64, v64
    v_mfma_f32_16x16x32_bf16 v[76:79], a[240:243], a[128:131], v[76:79]
    s_waitcnt vmcnt(16)
    ds_read_b128 a[224:227], v12 offset:0
    v_add_f32 v25, v25, v228
    v_mfma_f32_16x16x32_bf16 v[76:79], a[244:247], a[156:159], v[76:79]
    ds_read_b128 a[228:231], v13 offset:0
    v_cvt_pk_bf16_f32 v116, v228, v229
    v_mfma_f32_16x16x32_bf16 v[76:79], a[248:251], a[184:187], v[76:79]
    buffer_load_dwordx4 v1, s[24:27], s43 offen offset:0 nt lds
    v_mfma_f32_16x16x32_bf16 v[76:79], a[252:255], a[212:215], v[76:79]
    ds_read_b128 a[232:235], v14 offset:0
    v_add_f32 v25, v25, v229
    v_mfma_f32_16x16x32_bf16 v[80:83], a[240:243], a[132:135], v[80:83]
    v_exp_f32 v65, v65
    v_mfma_f32_16x16x32_bf16 v[80:83], a[244:247], a[160:163], v[80:83]
    ds_read_b128 a[236:239], v15 offset:0
    v_cvt_pk_bf16_f32 v117, v230, v231
    v_mfma_f32_16x16x32_bf16 v[80:83], a[248:251], a[188:191], v[80:83]
    ds_write_b64 v23, v[116:117] offset:28672
    v_mfma_f32_16x16x32_bf16 v[80:83], a[252:255], a[216:219], v[80:83]
    buffer_load_dwordx4 v2, s[24:27], s43 offen offset:1024 nt lds
    v_mfma_f32_16x16x32_bf16 v[84:87], a[240:243], a[136:139], v[84:87]
    v_exp_f32 v66, v66
    v_mfma_f32_16x16x32_bf16 v[84:87], a[244:247], a[164:167], v[84:87]
    v_exp_f32 v67, v67
    v_mfma_f32_16x16x32_bf16 v[84:87], a[248:251], a[192:195], v[84:87]
    v_exp_f32 v68, v68
    v_mfma_f32_16x16x32_bf16 v[84:87], a[252:255], a[220:223], v[84:87]
    v_add_f32 v25, v25, v230
    v_add_f32 v25, v25, v231
    s_waitcnt lgkmcnt(4)
    v_mfma_f32_16x16x32_bf16 v[228:231], a[224:227], a[0:3], 0
    v_exp_f32 v69, v69
    s_waitcnt lgkmcnt(3)
    v_mfma_f32_16x16x32_bf16 v[228:231], a[228:231], a[28:31], v[228:231]
    v_add_f32 v26, v26, v232
    v_cvt_pk_bf16_f32 v120, v232, v233
    s_waitcnt lgkmcnt(2)
    v_mfma_f32_16x16x32_bf16 v[228:231], a[232:235], a[56:59], v[228:231]
    v_add_f32 v26, v26, v233
    v_cvt_pk_bf16_f32 v121, v234, v235
    s_waitcnt lgkmcnt(1)
    v_mfma_f32_16x16x32_bf16 v[228:231], a[236:239], a[84:87], v[228:231]
    v_add_f32 v26, v26, v234
    v_add_f32 v26, v26, v235
    v_mfma_f32_16x16x32_bf16 v[232:235], a[224:227], a[4:7], 0
    buffer_load_dwordx4 v3, s[24:27], s43 offen offset:2048 nt lds
    v_mfma_f32_16x16x32_bf16 v[232:235], a[228:231], a[32:35], v[232:235]
    ds_write_b64 v23, v[120:121] offset:29696
    v_mfma_f32_16x16x32_bf16 v[232:235], a[232:235], a[60:63], v[232:235]
    v_add_f32 v27, v27, v236
    v_cvt_pk_bf16_f32 v124, v236, v237
    v_mfma_f32_16x16x32_bf16 v[232:235], a[236:239], a[88:91], v[232:235]
    v_add_f32 v27, v27, v237
    v_cvt_pk_bf16_f32 v125, v238, v239
    v_add_f32 v27, v27, v238
    v_add_f32 v27, v27, v239
    v_mfma_f32_16x16x32_bf16 v[236:239], a[224:227], a[8:11], 0
    ds_write_b64 v23, v[124:125] offset:30720
    v_mfma_f32_16x16x32_bf16 v[236:239], a[228:231], a[36:39], v[236:239]
    v_add_f32 v28, v28, v240
    v_cvt_pk_bf16_f32 v128, v240, v241
    v_mfma_f32_16x16x32_bf16 v[236:239], a[232:235], a[64:67], v[236:239]
    buffer_load_dwordx4 v4, s[24:27], s43 offen offset:3072 nt lds
    v_mfma_f32_16x16x32_bf16 v[236:239], a[236:239], a[92:95], v[236:239]
    v_add_f32 v28, v28, v241
    v_cvt_pk_bf16_f32 v129, v242, v243
    v_add_f32 v28, v28, v242
    v_add_f32 v28, v28, v243
    v_mfma_f32_16x16x32_bf16 v[240:243], a[224:227], a[12:15], 0
    ds_write_b64 v23, v[128:129] offset:31744
    v_mfma_f32_16x16x32_bf16 v[240:243], a[228:231], a[40:43], v[240:243]
    v_add_f32 v29, v29, v244
    v_cvt_pk_bf16_f32 v132, v244, v245
    v_mfma_f32_16x16x32_bf16 v[240:243], a[232:235], a[68:71], v[240:243]
    s_add_u32 m0, s42, 0
    s_mov_b32 s43, 0
    v_mfma_f32_16x16x32_bf16 v[240:243], a[236:239], a[96:99], v[240:243]
    v_add_f32 v29, v29, v245
    v_cvt_pk_bf16_f32 v133, v246, v247
    v_add_f32 v29, v29, v246
    v_add_f32 v29, v29, v247
    v_mfma_f32_16x16x32_bf16 v[244:247], a[224:227], a[16:19], 0
    s_waitcnt vmcnt(16)
    ds_read_b128 a[240:243], v12 offset:4096
    v_add_f32 v30, v30, v248
    v_mfma_f32_16x16x32_bf16 v[244:247], a[228:231], a[44:47], v[244:247]
    ds_read_b128 a[244:247], v13 offset:4096
    v_cvt_pk_bf16_f32 v136, v248, v249
    v_mfma_f32_16x16x32_bf16 v[244:247], a[232:235], a[72:75], v[244:247]
    buffer_load_dwordx4 v5, s[28:31], s43 offen offset:0 nt lds
    v_mfma_f32_16x16x32_bf16 v[244:247], a[236:239], a[100:103], v[244:247]
    v_add_f32 v30, v30, v249
    v_cvt_pk_bf16_f32 v137, v250, v251
    v_add_f32 v30, v30, v250
    v_add_f32 v30, v30, v251
    v_mfma_f32_16x16x32_bf16 v[248:251], a[224:227], a[20:23], 0
    ds_read_b128 a[248:251], v14 offset:4096
    v_add_f32 v31, v31, v252
    v_mfma_f32_16x16x32_bf16 v[248:251], a[228:231], a[48:51], v[248:251]
    ds_read_b128 a[252:255], v15 offset:4096
    v_cvt_pk_bf16_f32 v140, v252, v253
    v_mfma_f32_16x16x32_bf16 v[248:251], a[232:235], a[76:79], v[248:251]
    ds_write_b64 v23, v[132:133] offset:32768
    v_mfma_f32_16x16x32_bf16 v[248:251], a[236:239], a[104:107], v[248:251]
    v_add_f32 v31, v31, v253
    v_cvt_pk_bf16_f32 v141, v254, v255
    v_add_f32 v31, v31, v254
    v_add_f32 v31, v31, v255
    v_mfma_f32_16x16x32_bf16 v[252:255], a[224:227], a[24:27], 0
    v_exp_f32 v70, v70
    v_mfma_f32_16x16x32_bf16 v[252:255], a[228:231], a[52:55], v[252:255]
    buffer_load_dwordx4 v6, s[28:31], s43 offen offset:1024 nt lds
    v_mfma_f32_16x16x32_bf16 v[252:255], a[232:235], a[80:83], v[252:255]
    ds_write_b64 v23, v[136:137] offset:33792
    v_mfma_f32_16x16x32_bf16 v[252:255], a[236:239], a[108:111], v[252:255]
    v_exp_f32 v71, v71
    s_waitcnt lgkmcnt(5)
    v_mfma_f32_16x16x32_bf16 v[228:231], a[240:243], a[112:115], v[228:231]
    v_exp_f32 v72, v72
    s_waitcnt lgkmcnt(4)
    v_mfma_f32_16x16x32_bf16 v[228:231], a[244:247], a[140:143], v[228:231]
    ds_write_b64 v23, v[140:141] offset:34816
    s_waitcnt lgkmcnt(4)
    v_mfma_f32_16x16x32_bf16 v[228:231], a[248:251], a[168:171], v[228:231]
    v_exp_f32 v73, v73
    s_waitcnt lgkmcnt(3)
    v_mfma_f32_16x16x32_bf16 v[228:231], a[252:255], a[196:199], v[228:231]
    v_exp_f32 v74, v74
    v_mfma_f32_16x16x32_bf16 v[232:235], a[240:243], a[116:119], v[232:235]
    v_exp_f32 v75, v75
    v_mfma_f32_16x16x32_bf16 v[232:235], a[244:247], a[144:147], v[232:235]
    buffer_load_dwordx4 v7, s[28:31], s43 offen offset:2048 nt lds
    v_mfma_f32_16x16x32_bf16 v[232:235], a[248:251], a[172:175], v[232:235]
    v_exp_f32 v76, v76
    v_mfma_f32_16x16x32_bf16 v[232:235], a[252:255], a[200:203], v[232:235]
    v_exp_f32 v77, v77
    v_mfma_f32_16x16x32_bf16 v[236:239], a[240:243], a[120:123], v[236:239]
    v_exp_f32 v78, v78
    v_mfma_f32_16x16x32_bf16 v[236:239], a[244:247], a[148:151], v[236:239]
    v_exp_f32 v79, v79
    v_mfma_f32_16x16x32_bf16 v[236:239], a[248:251], a[176:179], v[236:239]
    v_exp_f32 v80, v80
    v_mfma_f32_16x16x32_bf16 v[236:239], a[252:255], a[204:207], v[236:239]
    v_exp_f32 v81, v81
    v_mfma_f32_16x16x32_bf16 v[240:243], a[240:243], a[124:127], v[240:243]
    buffer_load_dwordx4 v8, s[28:31], s43 offen offset:3072 nt lds
    v_mfma_f32_16x16x32_bf16 v[240:243], a[244:247], a[152:155], v[240:243]
    v_exp_f32 v82, v82
    v_mfma_f32_16x16x32_bf16 v[240:243], a[248:251], a[180:183], v[240:243]
    v_exp_f32 v83, v83
    v_mfma_f32_16x16x32_bf16 v[240:243], a[252:255], a[208:211], v[240:243]
    v_exp_f32 v84, v84
    v_mfma_f32_16x16x32_bf16 v[244:247], a[240:243], a[128:131], v[244:247]
    s_waitcnt vmcnt(16)
    ds_read_b128 a[224:227], v12 offset:8192
    s_add_u32 m0, s42, 4096
    v_mfma_f32_16x16x32_bf16 v[244:247], a[244:247], a[156:159], v[244:247]
    ds_read_b128 a[228:231], v13 offset:8192
    s_mov_b32 s43, 16384
    v_mfma_f32_16x16x32_bf16 v[244:247], a[248:251], a[184:187], v[244:247]
    v_exp_f32 v85, v85
    v_mfma_f32_16x16x32_bf16 v[244:247], a[252:255], a[212:215], v[244:247]
    ds_read_b128 a[232:235], v14 offset:8192
    v_add_f32 v25, v25, v32
    v_mfma_f32_16x16x32_bf16 v[248:251], a[240:243], a[132:135], v[248:251]
    buffer_load_dwordx4 v5, s[28:31], s43 offen offset:0 nt lds
    v_mfma_f32_16x16x32_bf16 v[248:251], a[244:247], a[160:163], v[248:251]
    ds_read_b128 a[236:239], v15 offset:8192
    v_cvt_pk_bf16_f32 v118, v32, v33
    v_mfma_f32_16x16x32_bf16 v[248:251], a[248:251], a[188:191], v[248:251]
    v_exp_f32 v86, v86
    v_mfma_f32_16x16x32_bf16 v[248:251], a[252:255], a[216:219], v[248:251]
    v_exp_f32 v87, v87
    v_mfma_f32_16x16x32_bf16 v[252:255], a[240:243], a[136:139], v[252:255]
    v_exp_f32 v228, v228
    v_mfma_f32_16x16x32_bf16 v[252:255], a[244:247], a[164:167], v[252:255]
    v_exp_f32 v229, v229
    v_mfma_f32_16x16x32_bf16 v[252:255], a[248:251], a[192:195], v[252:255]
    v_add_f32 v25, v25, v33
    v_cvt_pk_bf16_f32 v119, v34, v35
    v_mfma_f32_16x16x32_bf16 v[252:255], a[252:255], a[220:223], v[252:255]
    v_add_f32 v25, v25, v34
    v_add_f32 v25, v25, v35
    s_waitcnt lgkmcnt(3)
    v_mfma_f32_16x16x32_bf16 v[32:35], a[224:227], a[0:3], 0
    buffer_load_dwordx4 v6, s[28:31], s43 offen offset:1024 nt lds
    s_waitcnt lgkmcnt(2)
    v_mfma_f32_16x16x32_bf16 v[32:35], a[228:231], a[28:31], v[32:35]
    ds_write_b64 v23, v[118:119] offset:28680
    s_waitcnt lgkmcnt(2)
    v_mfma_f32_16x16x32_bf16 v[32:35], a[232:235], a[56:59], v[32:35]
    v_add_f32 v26, v26, v36
    v_cvt_pk_bf16_f32 v122, v36, v37
    s_waitcnt lgkmcnt(1)
    v_mfma_f32_16x16x32_bf16 v[32:35], a[236:239], a[84:87], v[32:35]
    v_add_f32 v26, v26, v37
    v_cvt_pk_bf16_f32 v123, v38, v39
    v_add_f32 v26, v26, v38
    v_add_f32 v26, v26, v39
    v_mfma_f32_16x16x32_bf16 v[36:39], a[224:227], a[4:7], 0
    ds_write_b64 v23, v[122:123] offset:29704
    v_mfma_f32_16x16x32_bf16 v[36:39], a[228:231], a[32:35], v[36:39]
    v_add_f32 v27, v27, v40
    v_cvt_pk_bf16_f32 v126, v40, v41
    v_mfma_f32_16x16x32_bf16 v[36:39], a[232:235], a[60:63], v[36:39]
    v_add_f32 v27, v27, v41
    v_cvt_pk_bf16_f32 v127, v42, v43
    v_mfma_f32_16x16x32_bf16 v[36:39], a[236:239], a[88:91], v[36:39]
    v_add_f32 v27, v27, v42
    v_add_f32 v27, v27, v43
    v_mfma_f32_16x16x32_bf16 v[40:43], a[224:227], a[8:11], 0
    buffer_load_dwordx4 v7, s[28:31], s43 offen offset:2048 nt lds
    v_mfma_f32_16x16x32_bf16 v[40:43], a[228:231], a[36:39], v[40:43]
    ds_write_b64 v23, v[126:127] offset:30728
    v_mfma_f32_16x16x32_bf16 v[40:43], a[232:235], a[64:67], v[40:43]
    v_add_f32 v28, v28, v44
    v_cvt_pk_bf16_f32 v130, v44, v45
    v_mfma_f32_16x16x32_bf16 v[40:43], a[236:239], a[92:95], v[40:43]
    v_add_f32 v28, v28, v45
    v_cvt_pk_bf16_f32 v131, v46, v47
    v_add_f32 v28, v28, v46
    v_add_f32 v28, v28, v47
    v_mfma_f32_16x16x32_bf16 v[44:47], a[224:227], a[12:15], 0
    ds_write_b64 v23, v[130:131] offset:31752
    v_mfma_f32_16x16x32_bf16 v[44:47], a[228:231], a[40:43], v[44:47]
    v_add_f32 v29, v29, v48
    v_cvt_pk_bf16_f32 v134, v48, v49
    v_mfma_f32_16x16x32_bf16 v[44:47], a[232:235], a[68:71], v[44:47]
    buffer_load_dwordx4 v8, s[28:31], s43 offen offset:3072 nt lds
    v_mfma_f32_16x16x32_bf16 v[44:47], a[236:239], a[96:99], v[44:47]
    v_add_f32 v29, v29, v49
    v_cvt_pk_bf16_f32 v135, v50, v51
    v_add_f32 v29, v29, v50
    v_add_f32 v29, v29, v51
    v_mfma_f32_16x16x32_bf16 v[48:51], a[224:227], a[16:19], 0
    s_waitcnt vmcnt(16)
    ds_read_b128 a[240:243], v12 offset:12288
    v_add_f32 v30, v30, v52
    v_mfma_f32_16x16x32_bf16 v[48:51], a[228:231], a[44:47], v[48:51]
    ds_read_b128 a[244:247], v13 offset:12288
    v_cvt_pk_bf16_f32 v138, v52, v53
    v_mfma_f32_16x16x32_bf16 v[48:51], a[232:235], a[72:75], v[48:51]
    s_add_u32 m0, s42, 8192
    s_mov_b32 s43, 32768
    v_mfma_f32_16x16x32_bf16 v[48:51], a[236:239], a[100:103], v[48:51]
    v_add_f32 v30, v30, v53
    v_cvt_pk_bf16_f32 v139, v54, v55
    v_add_f32 v30, v30, v54
    v_add_f32 v30, v30, v55
    v_mfma_f32_16x16x32_bf16 v[52:55], a[224:227], a[20:23], 0
    ds_read_b128 a[248:251], v14 offset:12288
    v_add_f32 v31, v31, v56
    v_mfma_f32_16x16x32_bf16 v[52:55], a[228:231], a[48:51], v[52:55]
    ds_read_b128 a[252:255], v15 offset:12288
    v_cvt_pk_bf16_f32 v142, v56, v57
    v_mfma_f32_16x16x32_bf16 v[52:55], a[232:235], a[76:79], v[52:55]
    buffer_load_dwordx4 v5, s[28:31], s43 offen offset:0 nt lds
    v_mfma_f32_16x16x32_bf16 v[52:55], a[236:239], a[104:107], v[52:55]
    v_add_f32 v31, v31, v57
    v_cvt_pk_bf16_f32 v143, v58, v59
    v_add_f32 v31, v31, v58
    v_add_f32 v31, v31, v59
    v_mfma_f32_16x16x32_bf16 v[56:59], a[224:227], a[24:27], 0
    ds_write_b64 v23, v[134:135] offset:32776
    v_mfma_f32_16x16x32_bf16 v[56:59], a[228:231], a[52:55], v[56:59]
    v_exp_f32 v230, v230
    v_mfma_f32_16x16x32_bf16 v[56:59], a[232:235], a[80:83], v[56:59]
    v_exp_f32 v231, v231
    v_mfma_f32_16x16x32_bf16 v[56:59], a[236:239], a[108:111], v[56:59]
    ds_write_b64 v23, v[138:139] offset:33800
    s_waitcnt lgkmcnt(5)
    v_mfma_f32_16x16x32_bf16 v[32:35], a[240:243], a[112:115], v[32:35]
    v_exp_f32 v232, v232
    s_waitcnt lgkmcnt(4)
    v_mfma_f32_16x16x32_bf16 v[32:35], a[244:247], a[140:143], v[32:35]
    buffer_load_dwordx4 v6, s[28:31], s43 offen offset:1024 nt lds
    s_waitcnt lgkmcnt(3)
    v_mfma_f32_16x16x32_bf16 v[32:35], a[248:251], a[168:171], v[32:35]
    ds_write_b64 v23, v[142:143] offset:34824
    s_waitcnt lgkmcnt(3)
    v_mfma_f32_16x16x32_bf16 v[32:35], a[252:255], a[196:199], v[32:35]
    v_exp_f32 v233, v233
    v_mfma_f32_16x16x32_bf16 v[36:39], a[240:243], a[116:119], v[36:39]
    v_exp_f32 v234, v234
    v_mfma_f32_16x16x32_bf16 v[36:39], a[244:247], a[144:147], v[36:39]
    v_exp_f32 v235, v235
    v_mfma_f32_16x16x32_bf16 v[36:39], a[248:251], a[172:175], v[36:39]
    v_exp_f32 v236, v236
    v_mfma_f32_16x16x32_bf16 v[36:39], a[252:255], a[200:203], v[36:39]
    v_exp_f32 v237, v237
    v_mfma_f32_16x16x32_bf16 v[40:43], a[240:243], a[120:123], v[40:43]
    v_exp_f32 v238, v238
    v_mfma_f32_16x16x32_bf16 v[40:43], a[244:247], a[148:151], v[40:43]
    buffer_load_dwordx4 v7, s[28:31], s43 offen offset:2048 nt lds
    v_mfma_f32_16x16x32_bf16 v[40:43], a[248:251], a[176:179], v[40:43]
    v_exp_f32 v239, v239
    v_mfma_f32_16x16x32_bf16 v[40:43], a[252:255], a[204:207], v[40:43]
    v_exp_f32 v240, v240
    v_mfma_f32_16x16x32_bf16 v[44:47], a[240:243], a[124:127], v[44:47]
    v_exp_f32 v241, v241
    v_mfma_f32_16x16x32_bf16 v[44:47], a[244:247], a[152:155], v[44:47]
    v_exp_f32 v242, v242
    v_mfma_f32_16x16x32_bf16 v[44:47], a[248:251], a[180:183], v[44:47]
    v_exp_f32 v243, v243
    v_mfma_f32_16x16x32_bf16 v[44:47], a[252:255], a[208:211], v[44:47]
    v_exp_f32 v244, v244
    v_mfma_f32_16x16x32_bf16 v[48:51], a[240:243], a[128:131], v[48:51]
    s_waitcnt vmcnt(15)
    ds_read_b128 a[224:227], v12 offset:16384
    v_add_f32 v25, v25, v60
    v_mfma_f32_16x16x32_bf16 v[48:51], a[244:247], a[156:159], v[48:51]
    ds_read_b128 a[228:231], v13 offset:16384
    v_cvt_pk_bf16_f32 v88, v60, v61
    v_mfma_f32_16x16x32_bf16 v[48:51], a[248:251], a[184:187], v[48:51]
    buffer_load_dwordx4 v8, s[28:31], s43 offen offset:3072 nt lds
    v_mfma_f32_16x16x32_bf16 v[48:51], a[252:255], a[212:215], v[48:51]
    ds_read_b128 a[232:235], v14 offset:16384
    v_add_f32 v25, v25, v61
    v_mfma_f32_16x16x32_bf16 v[52:55], a[240:243], a[132:135], v[52:55]
    s_add_u32 m0, s42, 12288
    s_mov_b32 s43, 49152
    v_mfma_f32_16x16x32_bf16 v[52:55], a[244:247], a[160:163], v[52:55]
    ds_read_b128 a[236:239], v15 offset:16384
    v_cvt_pk_bf16_f32 v89, v62, v63
    v_mfma_f32_16x16x32_bf16 v[52:55], a[248:251], a[188:191], v[52:55]
    v_exp_f32 v245, v245
    v_mfma_f32_16x16x32_bf16 v[52:55], a[252:255], a[216:219], v[52:55]
    v_exp_f32 v246, v246
    v_mfma_f32_16x16x32_bf16 v[56:59], a[240:243], a[136:139], v[56:59]
    buffer_load_dwordx4 v5, s[28:31], s43 offen offset:0 nt lds
    v_mfma_f32_16x16x32_bf16 v[56:59], a[244:247], a[164:167], v[56:59]
    v_exp_f32 v247, v247
    v_mfma_f32_16x16x32_bf16 v[56:59], a[248:251], a[192:195], v[56:59]
    v_exp_f32 v248, v248
    v_mfma_f32_16x16x32_bf16 v[56:59], a[252:255], a[220:223], v[56:59]
    v_add_f32 v25, v25, v62
    v_add_f32 v25, v25, v63
    s_waitcnt lgkmcnt(3)
    v_mfma_f32_16x16x32_bf16 v[60:63], a[224:227], a[0:3], 0
    v_exp_f32 v249, v249
    s_waitcnt lgkmcnt(2)
    v_mfma_f32_16x16x32_bf16 v[60:63], a[228:231], a[28:31], v[60:63]
    v_add_f32 v26, v26, v64
    v_cvt_pk_bf16_f32 v92, v64, v65
    s_waitcnt lgkmcnt(1)
    v_mfma_f32_16x16x32_bf16 v[60:63], a[232:235], a[56:59], v[60:63]
    v_add_f32 v26, v26, v65
    v_cvt_pk_bf16_f32 v93, v66, v67
    s_waitcnt lgkmcnt(0)
    v_mfma_f32_16x16x32_bf16 v[60:63], a[236:239], a[84:87], v[60:63]
    v_add_f32 v26, v26, v66
    v_add_f32 v26, v26, v67
    v_mfma_f32_16x16x32_bf16 v[64:67], a[224:227], a[4:7], 0
    buffer_load_dwordx4 v6, s[28:31], s43 offen offset:1024 nt lds
    v_mfma_f32_16x16x32_bf16 v[64:67], a[228:231], a[32:35], v[64:67]
    v_add_f32 v27, v27, v68
    v_cvt_pk_bf16_f32 v96, v68, v69
    v_mfma_f32_16x16x32_bf16 v[64:67], a[232:235], a[60:63], v[64:67]
    v_add_f32 v27, v27, v69
    v_cvt_pk_bf16_f32 v97, v70, v71
    v_mfma_f32_16x16x32_bf16 v[64:67], a[236:239], a[88:91], v[64:67]
    v_add_f32 v27, v27, v70
    v_add_f32 v27, v27, v71
    v_mfma_f32_16x16x32_bf16 v[68:71], a[224:227], a[8:11], 0
    v_exp_f32 v250, v250
    v_mfma_f32_16x16x32_bf16 v[68:71], a[228:231], a[36:39], v[68:71]
    v_add_f32 v28, v28, v72
    v_cvt_pk_bf16_f32 v100, v72, v73
    v_mfma_f32_16x16x32_bf16 v[68:71], a[232:235], a[64:67], v[68:71]
    v_add_f32 v28, v28, v73
    v_cvt_pk_bf16_f32 v101, v74, v75
    v_mfma_f32_16x16x32_bf16 v[68:71], a[236:239], a[92:95], v[68:71]
    v_add_f32 v28, v28, v74
    v_add_f32 v28, v28, v75
    v_mfma_f32_16x16x32_bf16 v[72:75], a[224:227], a[12:15], 0
    buffer_load_dwordx4 v7, s[28:31], s43 offen offset:2048 nt lds
    v_mfma_f32_16x16x32_bf16 v[72:75], a[228:231], a[40:43], v[72:75]
    v_add_f32 v29, v29, v76
    v_cvt_pk_bf16_f32 v104, v76, v77
    v_mfma_f32_16x16x32_bf16 v[72:75], a[232:235], a[68:71], v[72:75]
    v_add_f32 v29, v29, v77
    v_cvt_pk_bf16_f32 v105, v78, v79
    v_mfma_f32_16x16x32_bf16 v[72:75], a[236:239], a[96:99], v[72:75]
    v_add_f32 v29, v29, v78
    v_add_f32 v29, v29, v79
    v_mfma_f32_16x16x32_bf16 v[76:79], a[224:227], a[16:19], 0
    s_waitcnt vmcnt(15)
    ds_read_b128 a[240:243], v12 offset:20480
    v_add_f32 v30, v30, v80
    v_mfma_f32_16x16x32_bf16 v[76:79], a[228:231], a[44:47], v[76:79]
    ds_read_b128 a[244:247], v13 offset:20480
    v_cvt_pk_bf16_f32 v108, v80, v81
    v_mfma_f32_16x16x32_bf16 v[76:79], a[232:235], a[72:75], v[76:79]
    buffer_load_dwordx4 v8, s[28:31], s43 offen offset:3072 nt lds
    v_mfma_f32_16x16x32_bf16 v[76:79], a[236:239], a[100:103], v[76:79]
    v_add_f32 v30, v30, v81
    v_cvt_pk_bf16_f32 v109, v82, v83
    v_add_f32 v30, v30, v82
    v_add_f32 v30, v30, v83
    v_mfma_f32_16x16x32_bf16 v[80:83], a[224:227], a[20:23], 0
    ds_read_b128 a[248:251], v14 offset:20480
    v_add_f32 v31, v31, v84
    v_mfma_f32_16x16x32_bf16 v[80:83], a[228:231], a[48:51], v[80:83]
    ds_read_b128 a[252:255], v15 offset:20480
    v_cvt_pk_bf16_f32 v112, v84, v85
    v_mfma_f32_16x16x32_bf16 v[80:83], a[232:235], a[76:79], v[80:83]
    s_waitcnt vmcnt(12)
    ds_read_b64_tr_b16 a[0:1], v16 offset:0
    s_add_u32 m0, s42, 16384
    v_mfma_f32_16x16x32_bf16 v[80:83], a[236:239], a[104:107], v[80:83]
    v_add_f32 v31, v31, v85
    v_cvt_pk_bf16_f32 v113, v86, v87
    v_add_f32 v31, v31, v86
    v_add_f32 v31, v31, v87
    v_mfma_f32_16x16x32_bf16 v[84:87], a[224:227], a[24:27], 0
    ds_read_b64_tr_b16 a[2:3], v16 offset:2048
    s_mov_b32 s43, 65536
    v_mfma_f32_16x16x32_bf16 v[84:87], a[228:231], a[52:55], v[84:87]
    ds_read_b64_tr_b16 a[4:5], v17 offset:0
    v_add_f32 v25, v25, v228
    v_mfma_f32_16x16x32_bf16 v[84:87], a[232:235], a[80:83], v[84:87]
    buffer_load_dwordx4 v5, s[28:31], s43 offen offset:0 nt lds
    v_mfma_f32_16x16x32_bf16 v[84:87], a[236:239], a[108:111], v[84:87]
    ds_read_b64_tr_b16 a[6:7], v17 offset:2048
    v_cvt_pk_bf16_f32 v90, v228, v229
    s_waitcnt lgkmcnt(7)
    v_mfma_f32_16x16x32_bf16 v[60:63], a[240:243], a[112:115], v[60:63]
    ds_read_b64_tr_b16 a[8:9], v18 offset:0
    v_and_b32 v1, 496, v10
    s_waitcnt lgkmcnt(7)
    v_mfma_f32_16x16x32_bf16 v[60:63], a[244:247], a[140:143], v[60:63]
    ds_read_b64_tr_b16 a[10:11], v18 offset:2048
    v_lshlrev_b32 v1, 3, v1
    s_waitcnt lgkmcnt(7)
    v_mfma_f32_16x16x32_bf16 v[60:63], a[248:251], a[168:171], v[60:63]
    ds_read_b64_tr_b16 a[12:13], v19 offset:0
    v_mov_b32 v3, 0
    s_waitcnt lgkmcnt(7)
    v_mfma_f32_16x16x32_bf16 v[60:63], a[252:255], a[196:199], v[60:63]
    ds_read_b64_tr_b16 a[14:15], v19 offset:2048
    v_add_f32 v25, v25, v229
    v_mfma_f32_16x16x32_bf16 v[64:67], a[240:243], a[116:119], v[64:67]
    buffer_load_dword v2, v1, s[8:11], 0 offen sc1
    v_mfma_f32_16x16x32_bf16 v[64:67], a[244:247], a[144:147], v[64:67]
    buffer_load_dwordx4 v6, s[28:31], s43 offen offset:1024 nt lds
    v_mfma_f32_16x16x32_bf16 v[64:67], a[248:251], a[172:175], v[64:67]
    buffer_load_dword v4, v3, s[12:15], 0 offen sc1
    v_mfma_f32_16x16x32_bf16 v[64:67], a[252:255], a[200:203], v[64:67]
    v_exp_f32 v251, v251
    v_mfma_f32_16x16x32_bf16 v[68:71], a[240:243], a[120:123], v[68:71]
    v_exp_f32 v252, v252
    v_mfma_f32_16x16x32_bf16 v[68:71], a[244:247], a[148:151], v[68:71]
    v_exp_f32 v253, v253
    v_mfma_f32_16x16x32_bf16 v[68:71], a[248:251], a[176:179], v[68:71]
    v_exp_f32 v254, v254
    v_mfma_f32_16x16x32_bf16 v[68:71], a[252:255], a[204:207], v[68:71]
    v_exp_f32 v255, v255
    v_mfma_f32_16x16x32_bf16 v[72:75], a[240:243], a[124:127], v[72:75]
    s_barrier
    s_waitcnt vmcnt(12)
    ds_read_b128 a[64:67], v22 offset:0
    v_cvt_pk_bf16_f32 v91, v230, v231
    v_mfma_f32_16x16x32_bf16 v[72:75], a[244:247], a[152:155], v[72:75]
    buffer_load_dwordx4 v7, s[28:31], s43 offen offset:2048 nt lds
    v_mfma_f32_16x16x32_bf16 v[72:75], a[248:251], a[180:183], v[72:75]
    ds_read_b64_tr_b16 a[16:17], v16 offset:4096
    v_add_f32 v25, v25, v230
    v_mfma_f32_16x16x32_bf16 v[72:75], a[252:255], a[208:211], v[72:75]
    ds_read_b64_tr_b16 a[18:19], v16 offset:6144
    v_add_f32 v25, v25, v231
    v_mfma_f32_16x16x32_bf16 v[76:79], a[240:243], a[128:131], v[76:79]
    ds_read_b128 a[92:95], v22 offset:7168
    v_add_f32 v26, v26, v232
    v_mfma_f32_16x16x32_bf16 v[76:79], a[244:247], a[156:159], v[76:79]
    ds_read_b64_tr_b16 a[20:21], v17 offset:4096
    v_cvt_pk_bf16_f32 v94, v232, v233
    v_mfma_f32_16x16x32_bf16 v[76:79], a[248:251], a[184:187], v[76:79]
    s_waitcnt lgkmcnt(9)
    ds_read_b64_tr_b16 a[22:23], v17 offset:6144
    v_add_f32 v26, v26, v233
    v_mfma_f32_16x16x32_bf16 v[76:79], a[252:255], a[212:215], v[76:79]
    ds_read_b64_tr_b16 a[24:25], v18 offset:4096
    v_cvt_pk_bf16_f32 v95, v234, v235
    v_mfma_f32_16x16x32_bf16 v[80:83], a[240:243], a[132:135], v[80:83]
    buffer_load_dwordx4 v8, s[28:31], s43 offen offset:3072 nt lds
    v_mfma_f32_16x16x32_bf16 v[80:83], a[244:247], a[160:163], v[80:83]
    ds_read_b64_tr_b16 a[26:27], v18 offset:6144
    v_add_f32 v26, v26, v234
    v_mfma_f32_16x16x32_bf16 v[80:83], a[248:251], a[188:191], v[80:83]
    ds_read_b64_tr_b16 a[28:29], v19 offset:4096
    v_add_f32 v26, v26, v235
    v_mfma_f32_16x16x32_bf16 v[80:83], a[252:255], a[216:219], v[80:83]
    s_waitcnt lgkmcnt(9)
    ds_read_b64_tr_b16 a[30:31], v19 offset:6144
    v_add_f32 v27, v27, v236
    v_mfma_f32_16x16x32_bf16 v[84:87], a[240:243], a[136:139], v[84:87]
    ds_read_b128 a[68:71], v22 offset:1024
    s_add_u32 m0, s42, 20480
    v_mfma_f32_16x16x32_bf16 v[84:87], a[244:247], a[164:167], v[84:87]
    s_mov_b32 s43, 81920
    v_cvt_pk_bf16_f32 v98, v236, v237
    v_mfma_f32_16x16x32_bf16 v[84:87], a[248:251], a[192:195], v[84:87]
    ds_read_b128 a[96:99], v22 offset:8192
    v_add_f32 v27, v27, v237
    v_mfma_f32_16x16x32_bf16 v[84:87], a[252:255], a[220:223], v[84:87]
    v_exp_f32 v32, v32
    s_waitcnt lgkmcnt(11)
    v_mfma_f32_16x16x32_bf16 v[144:147], a[0:3], a[64:67], 0
    buffer_load_dwordx4 v5, s[28:31], s43 offen offset:0 nt lds
    s_waitcnt lgkmcnt(8)
    v_mfma_f32_16x16x32_bf16 v[144:147], a[16:19], a[92:95], v[144:147]
    ds_read_b128 a[72:75], v22 offset:2048
    v_cvt_pk_bf16_f32 v99, v238, v239
    v_mfma_f32_16x16x32_bf16 v[148:151], a[4:7], a[64:67], 0
    v_exp_f32 v33, v33
    s_waitcnt lgkmcnt(7)
    v_mfma_f32_16x16x32_bf16 v[148:151], a[20:23], a[92:95], v[148:151]
    ds_read_b128 a[100:103], v22 offset:9216
    v_add_f32 v27, v27, v238
    v_mfma_f32_16x16x32_bf16 v[152:155], a[8:11], a[64:67], 0
    v_exp_f32 v34, v34
    s_waitcnt lgkmcnt(6)
    v_mfma_f32_16x16x32_bf16 v[152:155], a[24:27], a[92:95], v[152:155]
    ds_read_b128 a[76:79], v22 offset:3072
    v_add_f32 v27, v27, v239
    v_mfma_f32_16x16x32_bf16 v[156:159], a[12:15], a[64:67], 0
    v_exp_f32 v35, v35
    s_waitcnt lgkmcnt(5)
    v_mfma_f32_16x16x32_bf16 v[156:159], a[28:31], a[92:95], v[156:159]
    buffer_load_dwordx4 v6, s[28:31], s43 offen offset:1024 nt lds
    s_waitcnt lgkmcnt(4)
    v_mfma_f32_16x16x32_bf16 v[160:163], a[0:3], a[68:71], 0
    ds_read_b128 a[104:107], v22 offset:10240
    v_add_f32 v28, v28, v240
    s_waitcnt lgkmcnt(4)
    v_mfma_f32_16x16x32_bf16 v[160:163], a[16:19], a[96:99], v[160:163]
    v_exp_f32 v36, v36
    v_mfma_f32_16x16x32_bf16 v[164:167], a[4:7], a[68:71], 0
    ds_read_b128 a[80:83], v22 offset:4096
    v_cvt_pk_bf16_f32 v102, v240, v241
    v_mfma_f32_16x16x32_bf16 v[164:167], a[20:23], a[96:99], v[164:167]
    v_exp_f32 v37, v37
    v_mfma_f32_16x16x32_bf16 v[168:171], a[8:11], a[68:71], 0
    ds_read_b128 a[108:111], v22 offset:11264
    v_add_f32 v28, v28, v241
    v_mfma_f32_16x16x32_bf16 v[168:171], a[24:27], a[96:99], v[168:171]
    v_exp_f32 v38, v38
    v_mfma_f32_16x16x32_bf16 v[172:175], a[12:15], a[68:71], 0
    ds_read_b128 a[84:87], v22 offset:5120
    v_cvt_pk_bf16_f32 v103, v242, v243
    v_mfma_f32_16x16x32_bf16 v[172:175], a[28:31], a[96:99], v[172:175]
    buffer_load_dwordx4 v7, s[28:31], s43 offen offset:2048 nt lds
    s_waitcnt lgkmcnt(6)
    v_mfma_f32_16x16x32_bf16 v[176:179], a[0:3], a[72:75], 0
    ds_read_b128 a[112:115], v22 offset:12288
    v_add_f32 v28, v28, v242
    s_waitcnt lgkmcnt(6)
    v_mfma_f32_16x16x32_bf16 v[176:179], a[16:19], a[100:103], v[176:179]
    v_exp_f32 v39, v39
    v_mfma_f32_16x16x32_bf16 v[180:183], a[4:7], a[72:75], 0
    ds_read_b128 a[88:91], v22 offset:6144
    v_add_f32 v28, v28, v243
    v_mfma_f32_16x16x32_bf16 v[180:183], a[20:23], a[100:103], v[180:183]
    v_exp_f32 v40, v40
    v_mfma_f32_16x16x32_bf16 v[184:187], a[8:11], a[72:75], 0
    ds_read_b128 a[116:119], v22 offset:13312
    v_add_f32 v29, v29, v244
    v_mfma_f32_16x16x32_bf16 v[184:187], a[24:27], a[100:103], v[184:187]
    v_exp_f32 v41, v41
    v_mfma_f32_16x16x32_bf16 v[188:191], a[12:15], a[72:75], 0
    s_waitcnt vmcnt(13)
    buffer_load_dwordx4 v8, s[28:31], s43 offen offset:3072 nt lds
    v_mfma_f32_16x16x32_bf16 v[188:191], a[28:31], a[100:103], v[188:191]
    ds_read_b64_tr_b16 a[32:33], v16 offset:8192
    v_cvt_pk_bf16_f32 v106, v244, v245
    s_waitcnt lgkmcnt(8)
    v_mfma_f32_16x16x32_bf16 v[192:195], a[0:3], a[76:79], 0
    ds_read_b64_tr_b16 a[34:35], v16 offset:10240
    v_add_f32 v29, v29, v245
    s_waitcnt lgkmcnt(8)
    v_mfma_f32_16x16x32_bf16 v[192:195], a[16:19], a[104:107], v[192:195]
    ds_read_b64_tr_b16 a[36:37], v17 offset:8192
    v_cvt_pk_bf16_f32 v107, v246, v247
    v_mfma_f32_16x16x32_bf16 v[196:199], a[4:7], a[76:79], 0
    ds_read_b64_tr_b16 a[38:39], v17 offset:10240
    s_add_u32 m0, s42, 0
    v_mfma_f32_16x16x32_bf16 v[196:199], a[20:23], a[104:107], v[196:199]
    ds_read_b64_tr_b16 a[40:41], v18 offset:8192
    s_mov_b32 s43, 98304
    v_mfma_f32_16x16x32_bf16 v[200:203], a[8:11], a[76:79], 0
    ds_read_b64_tr_b16 a[42:43], v18 offset:10240
    v_add_f32 v29, v29, v246
    v_mfma_f32_16x16x32_bf16 v[200:203], a[24:27], a[104:107], v[200:203]
    ds_read_b64_tr_b16 a[44:45], v19 offset:8192
    v_add_f32 v29, v29, v247
    v_mfma_f32_16x16x32_bf16 v[204:207], a[12:15], a[76:79], 0
    buffer_load_dwordx4 v5, s[28:31], s43 offen offset:0 nt lds
    v_mfma_f32_16x16x32_bf16 v[204:207], a[28:31], a[104:107], v[204:207]
    s_waitcnt lgkmcnt(9)
    ds_read_b128 a[120:123], v22 offset:14336
    v_add_f32 v30, v30, v248
    v_mfma_f32_16x16x32_bf16 v[208:211], a[0:3], a[80:83], 0
    ds_read_b64_tr_b16 a[46:47], v19 offset:10240
    v_cvt_pk_bf16_f32 v110, v248, v249
    v_mfma_f32_16x16x32_bf16 v[208:211], a[16:19], a[108:111], v[208:211]
    ds_read_b128 a[148:151], v22 offset:21504
    v_add_f32 v30, v30, v249
    v_mfma_f32_16x16x32_bf16 v[212:215], a[4:7], a[80:83], 0
    v_exp_f32 v42, v42
    v_mfma_f32_16x16x32_bf16 v[212:215], a[20:23], a[108:111], v[212:215]
    ds_read_b128 a[124:127], v22 offset:15360
    v_cvt_pk_bf16_f32 v111, v250, v251
    v_mfma_f32_16x16x32_bf16 v[216:219], a[8:11], a[80:83], 0
    v_exp_f32 v43, v43
    v_mfma_f32_16x16x32_bf16 v[216:219], a[24:27], a[108:111], v[216:219]
    buffer_load_dwordx4 v6, s[28:31], s43 offen offset:1024 nt lds
    v_mfma_f32_16x16x32_bf16 v[220:223], a[12:15], a[80:83], 0
    s_waitcnt lgkmcnt(9)
    ds_read_b128 a[152:155], v22 offset:22528
    v_add_f32 v30, v30, v250
    v_mfma_f32_16x16x32_bf16 v[220:223], a[28:31], a[108:111], v[220:223]
    v_exp_f32 v44, v44
    v_mfma_f32_16x16x32_bf16 v[224:227], a[0:3], a[84:87], 0
    s_waitcnt vmcnt(12)
    ds_read_b64_tr_b16 a[48:49], v16 offset:12288
    v_add_f32 v30, v30, v251
    v_mfma_f32_16x16x32_bf16 v[224:227], a[16:19], a[112:115], v[224:227]
    ds_read_b64_tr_b16 a[50:51], v16 offset:14336
    v_add_f32 v31, v31, v252
    v_mfma_f32_16x16x32_bf16 v[228:231], a[4:7], a[84:87], 0
    ds_read_b64_tr_b16 a[52:53], v17 offset:12288
    v_cvt_pk_bf16_f32 v114, v252, v253
    v_mfma_f32_16x16x32_bf16 v[228:231], a[20:23], a[112:115], v[228:231]
    s_waitcnt lgkmcnt(9)
    ds_read_b64_tr_b16 a[54:55], v17 offset:14336
    v_add_f32 v31, v31, v253
    v_mfma_f32_16x16x32_bf16 v[232:235], a[8:11], a[84:87], 0
    ds_read_b64_tr_b16 a[56:57], v18 offset:12288
    v_cvt_pk_bf16_f32 v115, v254, v255
    v_mfma_f32_16x16x32_bf16 v[232:235], a[24:27], a[112:115], v[232:235]
    buffer_load_dwordx4 v7, s[28:31], s43 offen offset:2048 nt lds
    v_mfma_f32_16x16x32_bf16 v[236:239], a[12:15], a[84:87], 0
    ds_read_b64_tr_b16 a[58:59], v18 offset:14336
    v_add_f32 v31, v31, v254
    v_mfma_f32_16x16x32_bf16 v[236:239], a[28:31], a[112:115], v[236:239]
    ds_read_b64_tr_b16 a[60:61], v19 offset:12288
    v_add_f32 v31, v31, v255
    v_mfma_f32_16x16x32_bf16 v[240:243], a[0:3], a[88:91], 0
    s_waitcnt lgkmcnt(9)
    ds_read_b64_tr_b16 a[62:63], v19 offset:14336
    v_add_f32 v25, v25, v32
    v_mfma_f32_16x16x32_bf16 v[240:243], a[16:19], a[116:119], v[240:243]
    ds_read_b128 a[128:131], v22 offset:16384
    v_cvt_pk_bf16_f32 v116, v32, v33
    v_mfma_f32_16x16x32_bf16 v[244:247], a[4:7], a[88:91], 0
    v_exp_f32 v45, v45
    v_mfma_f32_16x16x32_bf16 v[244:247], a[20:23], a[116:119], v[244:247]
    ds_read_b128 a[156:159], v22 offset:23552
    v_add_f32 v25, v25, v33
    v_mfma_f32_16x16x32_bf16 v[248:251], a[8:11], a[88:91], 0
    buffer_load_dwordx4 v8, s[28:31], s43 offen offset:3072 nt lds
    v_mfma_f32_16x16x32_bf16 v[248:251], a[24:27], a[116:119], v[248:251]
    ds_read_b128 a[132:135], v22 offset:17408
    v_cvt_pk_bf16_f32 v117, v34, v35
    v_mfma_f32_16x16x32_bf16 v[252:255], a[12:15], a[88:91], 0
    v_exp_f32 v46, v46
    v_mfma_f32_16x16x32_bf16 v[252:255], a[28:31], a[116:119], v[252:255]
    s_waitcnt lgkmcnt(9)
    ds_read_b128 a[160:163], v22 offset:24576
    v_add_f32 v25, v25, v34
    v_mfma_f32_16x16x32_bf16 v[144:147], a[32:35], a[120:123], v[144:147]
    s_add_u32 m0, s42, 4096
    s_mov_b32 s43, 114688
    v_mfma_f32_16x16x32_bf16 v[144:147], a[48:51], a[148:151], v[144:147]
    ds_read_b128 a[136:139], v22 offset:18432
    v_add_f32 v25, v25, v35
    v_mfma_f32_16x16x32_bf16 v[148:151], a[36:39], a[120:123], v[148:151]
    v_exp_f32 v47, v47
    s_waitcnt lgkmcnt(9)
    v_mfma_f32_16x16x32_bf16 v[148:151], a[52:55], a[148:151], v[148:151]
    ds_read_b128 a[164:167], v22 offset:25600
    v_add_f32 v26, v26, v36
    v_mfma_f32_16x16x32_bf16 v[152:155], a[40:43], a[120:123], v[152:155]
    buffer_load_dwordx4 v5, s[28:31], s43 offen offset:0 nt lds
    s_waitcnt lgkmcnt(8)
    v_mfma_f32_16x16x32_bf16 v[152:155], a[56:59], a[148:151], v[152:155]
    ds_read_b128 a[140:143], v22 offset:19456
    v_cvt_pk_bf16_f32 v120, v36, v37
    v_mfma_f32_16x16x32_bf16 v[156:159], a[44:47], a[120:123], v[156:159]
    v_exp_f32 v48, v48
    s_waitcnt lgkmcnt(7)
    v_mfma_f32_16x16x32_bf16 v[156:159], a[60:63], a[148:151], v[156:159]
    ds_read_b128 a[168:171], v22 offset:26624
    v_add_f32 v26, v26, v37
    v_mfma_f32_16x16x32_bf16 v[160:163], a[32:35], a[124:127], v[160:163]
    v_exp_f32 v49, v49
    v_mfma_f32_16x16x32_bf16 v[160:163], a[48:51], a[152:155], v[160:163]
    ds_read_b128 a[144:147], v22 offset:20480
    v_cvt_pk_bf16_f32 v121, v38, v39
    v_mfma_f32_16x16x32_bf16 v[164:167], a[36:39], a[124:127], v[164:167]
    v_exp_f32 v50, v50
    v_mfma_f32_16x16x32_bf16 v[164:167], a[52:55], a[152:155], v[164:167]
    buffer_load_dwordx4 v6, s[28:31], s43 offen offset:1024 nt lds
    v_mfma_f32_16x16x32_bf16 v[168:171], a[40:43], a[124:127], v[168:171]
    ds_read_b128 a[172:175], v22 offset:27648
    v_add_f32 v26, v26, v38
    v_mfma_f32_16x16x32_bf16 v[168:171], a[56:59], a[152:155], v[168:171]
    v_exp_f32 v51, v51
    v_mfma_f32_16x16x32_bf16 v[172:175], a[44:47], a[124:127], v[172:175]
    v_exp_f32 v52, v52
    v_mfma_f32_16x16x32_bf16 v[172:175], a[60:63], a[152:155], v[172:175]
    v_exp_f32 v53, v53
    s_waitcnt lgkmcnt(9)
    v_mfma_f32_16x16x32_bf16 v[176:179], a[32:35], a[128:131], v[176:179]
    v_exp_f32 v54, v54
    s_waitcnt lgkmcnt(8)
    v_mfma_f32_16x16x32_bf16 v[176:179], a[48:51], a[156:159], v[176:179]
    v_exp_f32 v55, v55
    v_mfma_f32_16x16x32_bf16 v[180:183], a[36:39], a[128:131], v[180:183]
    v_exp_f32 v56, v56
    v_mfma_f32_16x16x32_bf16 v[180:183], a[52:55], a[156:159], v[180:183]
    buffer_load_dwordx4 v7, s[28:31], s43 offen offset:2048 nt lds
    v_mfma_f32_16x16x32_bf16 v[184:187], a[40:43], a[128:131], v[184:187]
    v_exp_f32 v57, v57
    v_mfma_f32_16x16x32_bf16 v[184:187], a[56:59], a[156:159], v[184:187]
    v_exp_f32 v58, v58
    v_mfma_f32_16x16x32_bf16 v[188:191], a[44:47], a[128:131], v[188:191]
    s_waitcnt vmcnt(11)
    ds_read_b64_tr_b16 a[0:1], v16 offset:16384
    v_add_f32 v26, v26, v39
    v_mfma_f32_16x16x32_bf16 v[188:191], a[60:63], a[156:159], v[188:191]
    ds_read_b64_tr_b16 a[2:3], v16 offset:18432
    v_add_f32 v27, v27, v40
    s_waitcnt lgkmcnt(9)
    v_mfma_f32_16x16x32_bf16 v[192:195], a[32:35], a[132:135], v[192:195]
    ds_read_b64_tr_b16 a[4:5], v17 offset:16384
    v_cvt_pk_bf16_f32 v124, v40, v41
    s_waitcnt lgkmcnt(9)
    v_mfma_f32_16x16x32_bf16 v[192:195], a[48:51], a[160:163], v[192:195]
    ds_read_b64_tr_b16 a[6:7], v17 offset:18432
    v_add_f32 v27, v27, v41
    v_mfma_f32_16x16x32_bf16 v[196:199], a[36:39], a[132:135], v[196:199]
    buffer_load_dwordx4 v8, s[28:31], s43 offen offset:3072 nt lds
    v_mfma_f32_16x16x32_bf16 v[196:199], a[52:55], a[160:163], v[196:199]
    ds_read_b64_tr_b16 a[8:9], v18 offset:16384
    v_cvt_pk_bf16_f32 v125, v42, v43
    v_mfma_f32_16x16x32_bf16 v[200:203], a[40:43], a[132:135], v[200:203]
    ds_read_b64_tr_b16 a[10:11], v18 offset:18432
    v_add_f32 v27, v27, v42
    v_mfma_f32_16x16x32_bf16 v[200:203], a[56:59], a[160:163], v[200:203]
    ds_read_b64_tr_b16 a[12:13], v19 offset:16384
    v_add_f32 v27, v27, v43
    v_mfma_f32_16x16x32_bf16 v[204:207], a[44:47], a[132:135], v[204:207]
    s_waitcnt lgkmcnt(9)
    ds_read_b64_tr_b16 a[14:15], v19 offset:18432
    s_add_u32 m0, s42, 8192
    v_mfma_f32_16x16x32_bf16 v[204:207], a[60:63], a[160:163], v[204:207]
    s_mov_b32 s43, 131072
    v_add_f32 v28, v28, v44
    v_mfma_f32_16x16x32_bf16 v[208:211], a[32:35], a[136:139], v[208:211]
    v_exp_f32 v59, v59
    v_mfma_f32_16x16x32_bf16 v[208:211], a[48:51], a[164:167], v[208:211]
    v_exp_f32 v60, v60
    v_mfma_f32_16x16x32_bf16 v[212:215], a[36:39], a[136:139], v[212:215]
    buffer_load_dwordx4 v5, s[28:31], s43 offen offset:0 nt lds
    v_mfma_f32_16x16x32_bf16 v[212:215], a[52:55], a[164:167], v[212:215]
    v_exp_f32 v61, v61
    v_mfma_f32_16x16x32_bf16 v[216:219], a[40:43], a[136:139], v[216:219]
    v_exp_f32 v62, v62
    v_mfma_f32_16x16x32_bf16 v[216:219], a[56:59], a[164:167], v[216:219]
    v_exp_f32 v63, v63
    v_mfma_f32_16x16x32_bf16 v[220:223], a[44:47], a[136:139], v[220:223]
    v_exp_f32 v64, v64
    v_mfma_f32_16x16x32_bf16 v[220:223], a[60:63], a[164:167], v[220:223]
    v_exp_f32 v65, v65
    v_mfma_f32_16x16x32_bf16 v[224:227], a[32:35], a[140:143], v[224:227]
    s_waitcnt lgkmcnt(8)
    s_barrier
    s_waitcnt vmcnt(9)
    ds_read_b128 a[64:67], v22 offset:28672
    v_cvt_pk_bf16_f32 v128, v44, v45
    v_mfma_f32_16x16x32_bf16 v[224:227], a[48:51], a[168:171], v[224:227]
    buffer_load_dwordx4 v6, s[28:31], s43 offen offset:1024 nt lds
    v_mfma_f32_16x16x32_bf16 v[228:231], a[36:39], a[140:143], v[228:231]
    ds_read_b64_tr_b16 a[16:17], v16 offset:20480
    v_add_f32 v28, v28, v45
    v_mfma_f32_16x16x32_bf16 v[228:231], a[52:55], a[168:171], v[228:231]
    ds_read_b64_tr_b16 a[18:19], v16 offset:22528
    v_cvt_pk_bf16_f32 v129, v46, v47
    v_mfma_f32_16x16x32_bf16 v[232:235], a[40:43], a[140:143], v[232:235]
    ds_read_b128 a[92:95], v22 offset:35840
    v_add_f32 v28, v28, v46
    v_mfma_f32_16x16x32_bf16 v[232:235], a[56:59], a[168:171], v[232:235]
    ds_read_b64_tr_b16 a[20:21], v17 offset:20480
    v_add_f32 v28, v28, v47
    v_mfma_f32_16x16x32_bf16 v[236:239], a[44:47], a[140:143], v[236:239]
    s_waitcnt lgkmcnt(9)
    ds_read_b64_tr_b16 a[22:23], v17 offset:22528
    v_add_f32 v29, v29, v48
    v_mfma_f32_16x16x32_bf16 v[236:239], a[60:63], a[168:171], v[236:239]
    ds_read_b64_tr_b16 a[24:25], v18 offset:20480
    v_cvt_pk_bf16_f32 v132, v48, v49
    v_mfma_f32_16x16x32_bf16 v[240:243], a[32:35], a[144:147], v[240:243]
    ds_read_b64_tr_b16 a[26:27], v18 offset:22528
    v_add_f32 v29, v29, v49
    v_mfma_f32_16x16x32_bf16 v[240:243], a[48:51], a[172:175], v[240:243]
    buffer_load_dwordx4 v7, s[28:31], s43 offen offset:2048 nt lds
    v_mfma_f32_16x16x32_bf16 v[244:247], a[36:39], a[144:147], v[244:247]
    ds_read_b64_tr_b16 a[28:29], v19 offset:20480
    v_cvt_pk_bf16_f32 v133, v50, v51
    v_mfma_f32_16x16x32_bf16 v[244:247], a[52:55], a[172:175], v[244:247]
    s_waitcnt lgkmcnt(9)
    ds_read_b64_tr_b16 a[30:31], v19 offset:22528
    v_add_f32 v29, v29, v50
    v_mfma_f32_16x16x32_bf16 v[248:251], a[40:43], a[144:147], v[248:251]
    ds_read_b128 a[68:71], v22 offset:29696
    v_add_f32 v29, v29, v51
    v_mfma_f32_16x16x32_bf16 v[248:251], a[56:59], a[172:175], v[248:251]
    ds_write_b64 v23, v[88:89] offset:0
    v_mfma_f32_16x16x32_bf16 v[252:255], a[44:47], a[144:147], v[252:255]
    ds_read_b128 a[96:99], v22 offset:36864
    v_add_f32 v30, v30, v52
    v_mfma_f32_16x16x32_bf16 v[252:255], a[60:63], a[172:175], v[252:255]
    v_exp_f32 v66, v66
    s_waitcnt lgkmcnt(12)
    v_mfma_f32_16x16x32_bf16 v[144:147], a[0:3], a[64:67], v[144:147]
    buffer_load_dwordx4 v8, s[28:31], s43 offen offset:3072 nt lds
    s_waitcnt lgkmcnt(9)
    v_mfma_f32_16x16x32_bf16 v[144:147], a[16:19], a[92:95], v[144:147]
    ds_read_b128 a[72:75], v22 offset:30720
    v_cvt_pk_bf16_f32 v136, v52, v53
    v_mfma_f32_16x16x32_bf16 v[148:151], a[4:7], a[64:67], v[148:151]
    ds_write_b64 v23, v[92:93] offset:1024
    s_waitcnt lgkmcnt(9)
    v_mfma_f32_16x16x32_bf16 v[148:151], a[20:23], a[92:95], v[148:151]
    ds_read_b128 a[100:103], v22 offset:37888
    v_add_f32 v30, v30, v53
    v_mfma_f32_16x16x32_bf16 v[152:155], a[8:11], a[64:67], v[152:155]
    s_add_u32 m0, s42, 12288
    s_mov_b32 s43, 147456
    s_waitcnt lgkmcnt(8)
    v_mfma_f32_16x16x32_bf16 v[152:155], a[24:27], a[92:95], v[152:155]
    ds_read_b128 a[76:79], v22 offset:31744
    v_cvt_pk_bf16_f32 v137, v54, v55
    v_mfma_f32_16x16x32_bf16 v[156:159], a[12:15], a[64:67], v[156:159]
    ds_write_b64 v23, v[96:97] offset:2048
    s_waitcnt lgkmcnt(8)
    v_mfma_f32_16x16x32_bf16 v[156:159], a[28:31], a[92:95], v[156:159]
    ds_read_b128 a[104:107], v22 offset:38912
    v_add_f32 v30, v30, v54
    s_waitcnt lgkmcnt(8)
    v_mfma_f32_16x16x32_bf16 v[160:163], a[0:3], a[68:71], v[160:163]
    buffer_load_dwordx4 v5, s[28:31], s43 offen offset:0 nt lds
    s_waitcnt lgkmcnt(6)
    v_mfma_f32_16x16x32_bf16 v[160:163], a[16:19], a[96:99], v[160:163]
    ds_read_b128 a[80:83], v22 offset:32768
    v_add_f32 v30, v30, v55
    v_mfma_f32_16x16x32_bf16 v[164:167], a[4:7], a[68:71], v[164:167]
    ds_write_b64 v23, v[100:101] offset:3072
    v_mfma_f32_16x16x32_bf16 v[164:167], a[20:23], a[96:99], v[164:167]
    ds_read_b128 a[108:111], v22 offset:39936
    v_add_f32 v31, v31, v56
    v_mfma_f32_16x16x32_bf16 v[168:171], a[8:11], a[68:71], v[168:171]
    v_exp_f32 v67, v67
    v_mfma_f32_16x16x32_bf16 v[168:171], a[24:27], a[96:99], v[168:171]
    ds_read_b128 a[84:87], v22 offset:33792
    v_cvt_pk_bf16_f32 v140, v56, v57
    v_mfma_f32_16x16x32_bf16 v[172:175], a[12:15], a[68:71], v[172:175]
    ds_write_b64 v23, v[104:105] offset:4096
    v_mfma_f32_16x16x32_bf16 v[172:175], a[28:31], a[96:99], v[172:175]
    buffer_load_dwordx4 v6, s[28:31], s43 offen offset:1024 nt lds
    s_waitcnt lgkmcnt(10)
    v_mfma_f32_16x16x32_bf16 v[176:179], a[0:3], a[72:75], v[176:179]
    ds_read_b128 a[112:115], v22 offset:40960
    v_add_f32 v31, v31, v57
    s_waitcnt lgkmcnt(9)
    v_mfma_f32_16x16x32_bf16 v[176:179], a[16:19], a[100:103], v[176:179]
    ds_write_b64 v23, v[108:109] offset:5120
    v_mfma_f32_16x16x32_bf16 v[180:183], a[4:7], a[72:75], v[180:183]
    ds_read_b128 a[88:91], v22 offset:34816
    v_cvt_pk_bf16_f32 v141, v58, v59
    v_mfma_f32_16x16x32_bf16 v[180:183], a[20:23], a[100:103], v[180:183]
    v_exp_f32 v68, v68
    v_mfma_f32_16x16x32_bf16 v[184:187], a[8:11], a[72:75], v[184:187]
    ds_read_b128 a[116:119], v22 offset:41984
    v_add_f32 v31, v31, v58
    v_mfma_f32_16x16x32_bf16 v[184:187], a[24:27], a[100:103], v[184:187]
    ds_write_b64 v23, v[112:113] offset:6144
    v_mfma_f32_16x16x32_bf16 v[188:191], a[12:15], a[72:75], v[188:191]
    s_waitcnt vmcnt(10)
    s_waitcnt lgkmcnt(9)
    ds_read_b64_tr_b16 a[32:33], v16 offset:0
    v_add_f32 v31, v31, v59
    v_mfma_f32_16x16x32_bf16 v[188:191], a[28:31], a[100:103], v[188:191]
    buffer_load_dwordx4 v7, s[28:31], s43 offen offset:2048 nt lds
    v_mfma_f32_16x16x32_bf16 v[192:195], a[0:3], a[76:79], v[192:195]
    ds_read_b64_tr_b16 a[34:35], v16 offset:2048
    v_add_f32 v25, v25, v60
    v_mfma_f32_16x16x32_bf16 v[192:195], a[16:19], a[104:107], v[192:195]
    ds_read_b64_tr_b16 a[36:37], v17 offset:0
    v_cvt_pk_bf16_f32 v118, v60, v61
    v_mfma_f32_16x16x32_bf16 v[196:199], a[4:7], a[76:79], v[196:199]
    ds_read_b64_tr_b16 a[38:39], v17 offset:2048
    v_add_f32 v25, v25, v61
    v_mfma_f32_16x16x32_bf16 v[196:199], a[20:23], a[104:107], v[196:199]
    s_waitcnt lgkmcnt(9)
    ds_read_b64_tr_b16 a[40:41], v18 offset:0
    v_cvt_pk_bf16_f32 v119, v62, v63
    v_mfma_f32_16x16x32_bf16 v[200:203], a[8:11], a[76:79], v[200:203]
    ds_read_b64_tr_b16 a[42:43], v18 offset:2048
    v_add_f32 v25, v25, v62
    v_mfma_f32_16x16x32_bf16 v[200:203], a[24:27], a[104:107], v[200:203]
    ds_read_b64_tr_b16 a[44:45], v19 offset:0
    v_add_f32 v25, v25, v63
    v_mfma_f32_16x16x32_bf16 v[204:207], a[12:15], a[76:79], v[204:207]
    buffer_load_dwordx4 v8, s[28:31], s43 offen offset:3072 nt lds
    v_mfma_f32_16x16x32_bf16 v[204:207], a[28:31], a[104:107], v[204:207]
    ds_read_b128 a[120:123], v22 offset:43008
    v_add_f32 v26, v26, v64
    v_mfma_f32_16x16x32_bf16 v[208:211], a[0:3], a[80:83], v[208:211]
    s_waitcnt lgkmcnt(9)
    ds_read_b64_tr_b16 a[46:47], v19 offset:2048
    v_cvt_pk_bf16_f32 v122, v64, v65
    v_mfma_f32_16x16x32_bf16 v[208:211], a[16:19], a[108:111], v[208:211]
    ds_read_b128 a[148:151], v22 offset:50176
    v_add_f32 v26, v26, v65
    v_mfma_f32_16x16x32_bf16 v[212:215], a[4:7], a[80:83], v[212:215]
    s_add_u32 m0, s42, 16384
    s_mov_b32 s43, 163840
    v_mfma_f32_16x16x32_bf16 v[212:215], a[20:23], a[108:111], v[212:215]
    ds_read_b128 a[124:127], v22 offset:44032
    v_cvt_pk_bf16_f32 v123, v66, v67
    v_mfma_f32_16x16x32_bf16 v[216:219], a[8:11], a[80:83], v[216:219]
    ds_write_b64 v23, v[90:91] offset:8
    v_mfma_f32_16x16x32_bf16 v[216:219], a[24:27], a[108:111], v[216:219]
    s_waitcnt lgkmcnt(9)
    ds_read_b128 a[152:155], v22 offset:51200
    v_add_f32 v26, v26, v66
    v_mfma_f32_16x16x32_bf16 v[220:223], a[12:15], a[80:83], v[220:223]
    buffer_load_dwordx4 v5, s[28:31], s43 offen offset:0 nt lds
    v_mfma_f32_16x16x32_bf16 v[220:223], a[28:31], a[108:111], v[220:223]
    ds_read_b128 a[128:131], v22 offset:45056
    v_add_f32 v26, v26, v67
    v_mfma_f32_16x16x32_bf16 v[224:227], a[0:3], a[84:87], v[224:227]
    s_waitcnt vmcnt(9)
    ds_read_b64_tr_b16 a[48:49], v16 offset:4096
    v_add_f32 v27, v27, v68
    v_mfma_f32_16x16x32_bf16 v[224:227], a[16:19], a[112:115], v[224:227]
    ds_read_b64_tr_b16 a[50:51], v16 offset:6144
    v_mov_b32 v32, v25
    v_mfma_f32_16x16x32_bf16 v[228:231], a[4:7], a[84:87], v[228:231]
    s_waitcnt lgkmcnt(9)
    ds_read_b64_tr_b16 a[52:53], v17 offset:4096
    v_mov_b32 v33, v26
    v_mfma_f32_16x16x32_bf16 v[228:231], a[20:23], a[112:115], v[228:231]
    ds_read_b64_tr_b16 a[54:55], v17 offset:6144
    v_add_u32 v39, s45, v10
    v_mfma_f32_16x16x32_bf16 v[232:235], a[8:11], a[84:87], v[232:235]
    ds_read_b64_tr_b16 a[56:57], v18 offset:4096
    v_subrev_u32 v39, s59, v39
    v_mfma_f32_16x16x32_bf16 v[232:235], a[24:27], a[112:115], v[232:235]
    buffer_load_dwordx4 v6, s[28:31], s43 offen offset:1024 nt lds
    v_mfma_f32_16x16x32_bf16 v[236:239], a[12:15], a[84:87], v[236:239]
    ds_read_b64_tr_b16 a[58:59], v18 offset:6144
    v_mfma_f32_16x16x32_bf16 v[236:239], a[28:31], a[112:115], v[236:239]
    s_waitcnt lgkmcnt(9)
    ds_read_b64_tr_b16 a[60:61], v19 offset:4096
    v_mfma_f32_16x16x32_bf16 v[240:243], a[0:3], a[88:91], v[240:243]
    ds_read_b64_tr_b16 a[62:63], v19 offset:6144
    v_mfma_f32_16x16x32_bf16 v[240:243], a[16:19], a[116:119], v[240:243]
    ds_read_b128 a[156:159], v22 offset:52224
    v_mfma_f32_16x16x32_bf16 v[244:247], a[4:7], a[88:91], v[244:247]
    ds_write_b64 v23, v[94:95] offset:1032
    v_mfma_f32_16x16x32_bf16 v[244:247], a[20:23], a[116:119], v[244:247]
    s_waitcnt lgkmcnt(9)
    ds_read_b128 a[132:135], v22 offset:46080
    v_mfma_f32_16x16x32_bf16 v[248:251], a[8:11], a[88:91], v[248:251]
    v_exp_f32 v69, v69
    v_mfma_f32_16x16x32_bf16 v[248:251], a[24:27], a[116:119], v[248:251]
    buffer_load_dwordx4 v7, s[28:31], s43 offen offset:2048 nt lds
    v_mfma_f32_16x16x32_bf16 v[252:255], a[12:15], a[88:91], v[252:255]
    ds_read_b128 a[160:163], v22 offset:53248
    v_cvt_pk_bf16_f32 v126, v68, v69
    v_mfma_f32_16x16x32_bf16 v[252:255], a[28:31], a[116:119], v[252:255]
    ds_write_b64 v23, v[98:99] offset:2056
    v_mfma_f32_16x16x32_bf16 v[144:147], a[32:35], a[120:123], v[144:147]
    ds_read_b128 a[136:139], v22 offset:47104
    v_add_f32 v27, v27, v69
    s_waitcnt lgkmcnt(12)
    v_mfma_f32_16x16x32_bf16 v[144:147], a[48:51], a[148:151], v[144:147]
    v_exp_f32 v70, v70
    v_mfma_f32_16x16x32_bf16 v[148:151], a[36:39], a[120:123], v[148:151]
    ds_read_b128 a[164:167], v22 offset:54272
    v_add_f32 v27, v27, v70
    s_waitcnt lgkmcnt(11)
    v_mfma_f32_16x16x32_bf16 v[148:151], a[52:55], a[148:151], v[148:151]
    ds_write_b64 v23, v[102:103] offset:3080
    v_mfma_f32_16x16x32_bf16 v[152:155], a[40:43], a[120:123], v[152:155]
    buffer_load_dwordx4 v8, s[28:31], s43 offen offset:3072 nt lds
    s_waitcnt lgkmcnt(10)
    v_mfma_f32_16x16x32_bf16 v[152:155], a[56:59], a[148:151], v[152:155]
    ds_read_b128 a[140:143], v22 offset:48128
    v_mfma_f32_16x16x32_bf16 v[156:159], a[44:47], a[120:123], v[156:159]
    ds_write_b64 v23, v[106:107] offset:4104
    s_waitcnt lgkmcnt(10)
    v_mfma_f32_16x16x32_bf16 v[156:159], a[60:63], a[148:151], v[156:159]
    ds_read_b128 a[168:171], v22 offset:55296
    v_mfma_f32_16x16x32_bf16 v[160:163], a[32:35], a[124:127], v[160:163]
    s_add_u32 m0, s42, 20480
    s_mov_b32 s43, 180224
    v_mfma_f32_16x16x32_bf16 v[160:163], a[48:51], a[152:155], v[160:163]
    ds_read_b128 a[144:147], v22 offset:49152
    v_mfma_f32_16x16x32_bf16 v[164:167], a[36:39], a[124:127], v[164:167]
    ds_write_b64 v23, v[110:111] offset:5128
    v_mfma_f32_16x16x32_bf16 v[164:167], a[52:55], a[152:155], v[164:167]
    s_waitcnt lgkmcnt(9)
    ds_read_b128 a[172:175], v22 offset:56320
    v_mfma_f32_16x16x32_bf16 v[168:171], a[40:43], a[124:127], v[168:171]
    buffer_load_dwordx4 v5, s[28:31], s43 offen offset:0 nt lds
    v_mfma_f32_16x16x32_bf16 v[168:171], a[56:59], a[152:155], v[168:171]
    ds_write_b64 v23, v[114:115] offset:6152
    v_mfma_f32_16x16x32_bf16 v[172:175], a[44:47], a[124:127], v[172:175]
    v_exp_f32 v71, v71
    v_mfma_f32_16x16x32_bf16 v[172:175], a[60:63], a[152:155], v[172:175]
    v_exp_f32 v72, v72
    v_mfma_f32_16x16x32_bf16 v[176:179], a[32:35], a[128:131], v[176:179]
    v_exp_f32 v73, v73
    v_mfma_f32_16x16x32_bf16 v[176:179], a[48:51], a[156:159], v[176:179]
    v_exp_f32 v74, v74
    v_mfma_f32_16x16x32_bf16 v[180:183], a[36:39], a[128:131], v[180:183]
    v_exp_f32 v75, v75
    v_mfma_f32_16x16x32_bf16 v[180:183], a[52:55], a[156:159], v[180:183]
    buffer_load_dwordx4 v6, s[28:31], s43 offen offset:1024 nt lds
    v_mfma_f32_16x16x32_bf16 v[184:187], a[40:43], a[128:131], v[184:187]
    v_exp_f32 v76, v76
    v_mfma_f32_16x16x32_bf16 v[184:187], a[56:59], a[156:159], v[184:187]
    v_exp_f32 v77, v77
    v_mfma_f32_16x16x32_bf16 v[188:191], a[44:47], a[128:131], v[188:191]
    s_waitcnt vmcnt(10)
    ds_read_b64_tr_b16 a[0:1], v16 offset:8192
    v_cvt_pk_bf16_f32 v127, v70, v71
    v_mfma_f32_16x16x32_bf16 v[188:191], a[60:63], a[156:159], v[188:191]
    ds_read_b64_tr_b16 a[2:3], v16 offset:10240
    v_add_f32 v27, v27, v71
    v_mfma_f32_16x16x32_bf16 v[192:195], a[32:35], a[132:135], v[192:195]
    s_waitcnt lgkmcnt(9)
    ds_read_b64_tr_b16 a[4:5], v17 offset:8192
    v_add_f32 v28, v28, v72
    v_mfma_f32_16x16x32_bf16 v[192:195], a[48:51], a[160:163], v[192:195]
    ds_read_b64_tr_b16 a[6:7], v17 offset:10240
    v_cvt_pk_bf16_f32 v130, v72, v73
    v_mfma_f32_16x16x32_bf16 v[196:199], a[36:39], a[132:135], v[196:199]
    ds_read_b64_tr_b16 a[8:9], v18 offset:8192
    v_add_f32 v28, v28, v73
    v_mfma_f32_16x16x32_bf16 v[196:199], a[52:55], a[160:163], v[196:199]
    buffer_load_dwordx4 v7, s[28:31], s43 offen offset:2048 nt lds
    v_mfma_f32_16x16x32_bf16 v[200:203], a[40:43], a[132:135], v[200:203]
    ds_read_b64_tr_b16 a[10:11], v18 offset:10240
    v_cvt_pk_bf16_f32 v131, v74, v75
    v_mfma_f32_16x16x32_bf16 v[200:203], a[56:59], a[160:163], v[200:203]
    s_waitcnt lgkmcnt(9)
    ds_read_b64_tr_b16 a[12:13], v19 offset:8192
    v_add_f32 v28, v28, v74
    v_mfma_f32_16x16x32_bf16 v[204:207], a[44:47], a[132:135], v[204:207]
    ds_read_b64_tr_b16 a[14:15], v19 offset:10240
    v_add_f32 v28, v28, v75
    v_mfma_f32_16x16x32_bf16 v[204:207], a[60:63], a[160:163], v[204:207]
    v_exp_f32 v78, v78
    v_mfma_f32_16x16x32_bf16 v[208:211], a[32:35], a[136:139], v[208:211]
    v_exp_f32 v79, v79
    v_mfma_f32_16x16x32_bf16 v[208:211], a[48:51], a[164:167], v[208:211]
    v_exp_f32 v80, v80
    v_mfma_f32_16x16x32_bf16 v[212:215], a[36:39], a[136:139], v[212:215]
    buffer_load_dwordx4 v8, s[28:31], s43 offen offset:3072 nt lds
    v_mfma_f32_16x16x32_bf16 v[212:215], a[52:55], a[164:167], v[212:215]
    v_exp_f32 v81, v81
    v_mfma_f32_16x16x32_bf16 v[216:219], a[40:43], a[136:139], v[216:219]
    v_exp_f32 v82, v82
    v_mfma_f32_16x16x32_bf16 v[216:219], a[56:59], a[164:167], v[216:219]
    v_exp_f32 v83, v83
    v_mfma_f32_16x16x32_bf16 v[220:223], a[44:47], a[136:139], v[220:223]
    buffer_load_dword v11, v11, s[32:35], 0 offen
    v_mfma_f32_16x16x32_bf16 v[220:223], a[60:63], a[164:167], v[220:223]
    s_add_u32 m0, s42, 0
    s_mov_b32 s43, 196608
    v_mfma_f32_16x16x32_bf16 v[224:227], a[32:35], a[140:143], v[224:227]
    s_waitcnt lgkmcnt(8)
    s_barrier
    s_waitcnt vmcnt(9)
    ds_read_b128 a[64:67], v22 offset:0
    v_add_f32 v29, v29, v76
    v_mfma_f32_16x16x32_bf16 v[224:227], a[48:51], a[168:171], v[224:227]
    ds_read_b64_tr_b16 a[16:17], v16 offset:12288
    v_cvt_pk_bf16_f32 v134, v76, v77
    v_mfma_f32_16x16x32_bf16 v[228:231], a[36:39], a[140:143], v[228:231]
    buffer_load_dwordx4 v5, s[28:31], s43 offen offset:0 nt lds
    v_mfma_f32_16x16x32_bf16 v[228:231], a[52:55], a[168:171], v[228:231]
    ds_read_b64_tr_b16 a[18:19], v16 offset:14336
    v_add_f32 v29, v29, v77
    v_mfma_f32_16x16x32_bf16 v[232:235], a[40:43], a[140:143], v[232:235]
    ds_read_b128 a[92:95], v22 offset:7168
    v_cvt_pk_bf16_f32 v135, v78, v79
    v_mfma_f32_16x16x32_bf16 v[232:235], a[56:59], a[168:171], v[232:235]
    ds_read_b64_tr_b16 a[20:21], v17 offset:12288
    v_add_f32 v29, v29, v78
    v_mfma_f32_16x16x32_bf16 v[236:239], a[44:47], a[140:143], v[236:239]
    s_waitcnt lgkmcnt(9)
    ds_read_b64_tr_b16 a[22:23], v17 offset:14336
    v_add_f32 v29, v29, v79
    v_mfma_f32_16x16x32_bf16 v[236:239], a[60:63], a[168:171], v[236:239]
    ds_read_b64_tr_b16 a[24:25], v18 offset:12288
    v_add_f32 v30, v30, v80
    v_mfma_f32_16x16x32_bf16 v[240:243], a[32:35], a[144:147], v[240:243]
    ds_read_b64_tr_b16 a[26:27], v18 offset:14336
    v_cvt_pk_bf16_f32 v138, v80, v81
    v_mfma_f32_16x16x32_bf16 v[240:243], a[48:51], a[172:175], v[240:243]
    buffer_load_dwordx4 v6, s[28:31], s43 offen offset:1024 nt lds
    v_mfma_f32_16x16x32_bf16 v[244:247], a[36:39], a[144:147], v[244:247]
    ds_read_b64_tr_b16 a[28:29], v19 offset:12288
    v_add_f32 v30, v30, v81
    v_mfma_f32_16x16x32_bf16 v[244:247], a[52:55], a[172:175], v[244:247]
    s_waitcnt lgkmcnt(9)
    ds_read_b64_tr_b16 a[30:31], v19 offset:14336
    v_cvt_pk_bf16_f32 v139, v82, v83
    v_mfma_f32_16x16x32_bf16 v[248:251], a[40:43], a[144:147], v[248:251]
    ds_read_b128 a[68:71], v22 offset:1024
    v_add_f32 v30, v30, v82
    v_mfma_f32_16x16x32_bf16 v[248:251], a[56:59], a[172:175], v[248:251]
    ds_write_b64 v23, v[116:117] offset:28672
    v_mfma_f32_16x16x32_bf16 v[252:255], a[44:47], a[144:147], v[252:255]
    ds_read_b128 a[96:99], v22 offset:8192
    v_add_f32 v30, v30, v83
    v_mfma_f32_16x16x32_bf16 v[252:255], a[60:63], a[172:175], v[252:255]
    v_exp_f32 v84, v84
    s_waitcnt lgkmcnt(12)
    v_mfma_f32_16x16x32_bf16 v[144:147], a[0:3], a[64:67], v[144:147]
    ds_read_b128 a[72:75], v22 offset:2048
    v_add_f32 v31, v31, v84
    s_waitcnt lgkmcnt(10)
    v_mfma_f32_16x16x32_bf16 v[144:147], a[16:19], a[92:95], v[144:147]
    buffer_load_dwordx4 v7, s[28:31], s43 offen offset:2048 nt lds
    v_mfma_f32_16x16x32_bf16 v[148:151], a[4:7], a[64:67], v[148:151]
    ds_read_b128 a[100:103], v22 offset:9216
    v_mov_b32 v34, v27
    s_waitcnt lgkmcnt(9)
    v_mfma_f32_16x16x32_bf16 v[148:151], a[20:23], a[92:95], v[148:151]
    ds_write_b64 v23, v[120:121] offset:29696
    v_mfma_f32_16x16x32_bf16 v[152:155], a[8:11], a[64:67], v[152:155]
    ds_read_b128 a[76:79], v22 offset:3072
    v_mov_b32 v35, v28
    s_waitcnt lgkmcnt(9)
    v_mfma_f32_16x16x32_bf16 v[152:155], a[24:27], a[92:95], v[152:155]
    v_exp_f32 v85, v85
    v_mfma_f32_16x16x32_bf16 v[156:159], a[12:15], a[64:67], v[156:159]
    ds_read_b128 a[104:107], v22 offset:10240
    v_cvt_pk_bf16_f32 v142, v84, v85
    s_waitcnt lgkmcnt(8)
    v_mfma_f32_16x16x32_bf16 v[156:159], a[28:31], a[92:95], v[156:159]
    ds_write_b64 v23, v[124:125] offset:30720
    s_waitcnt lgkmcnt(8)
    v_mfma_f32_16x16x32_bf16 v[160:163], a[0:3], a[68:71], v[160:163]
    buffer_load_dwordx4 v8, s[28:31], s43 offen offset:3072 nt lds
    s_waitcnt lgkmcnt(6)
    v_mfma_f32_16x16x32_bf16 v[160:163], a[16:19], a[96:99], v[160:163]
    ds_read_b128 a[80:83], v22 offset:4096
    v_add_f32 v31, v31, v85
    v_mfma_f32_16x16x32_bf16 v[164:167], a[4:7], a[68:71], v[164:167]
    ds_write_b64 v23, v[128:129] offset:31744
    v_mfma_f32_16x16x32_bf16 v[164:167], a[20:23], a[96:99], v[164:167]
    ds_read_b128 a[108:111], v22 offset:11264
    v_mov_b32 v36, v29
    v_mfma_f32_16x16x32_bf16 v[168:171], a[8:11], a[68:71], v[168:171]
    s_add_u32 m0, s42, 4096
    s_mov_b32 s43, 212992
    v_mfma_f32_16x16x32_bf16 v[168:171], a[24:27], a[96:99], v[168:171]
    ds_read_b128 a[84:87], v22 offset:5120
    v_mov_b32 v37, v30
    v_mfma_f32_16x16x32_bf16 v[172:175], a[12:15], a[68:71], v[172:175]
    ds_write_b64 v23, v[132:133] offset:32768
    v_mfma_f32_16x16x32_bf16 v[172:175], a[28:31], a[96:99], v[172:175]
    ds_read_b128 a[112:115], v22 offset:12288
    s_waitcnt lgkmcnt(11)
    v_mfma_f32_16x16x32_bf16 v[176:179], a[0:3], a[72:75], v[176:179]
    buffer_load_dwordx4 v5, s[28:31], s43 offen offset:0 nt lds
    s_waitcnt lgkmcnt(10)
    v_mfma_f32_16x16x32_bf16 v[176:179], a[16:19], a[100:103], v[176:179]
    ds_read_b128 a[88:91], v22 offset:6144
    v_mfma_f32_16x16x32_bf16 v[180:183], a[4:7], a[72:75], v[180:183]
    ds_write_b64 v23, v[136:137] offset:33792
    v_mfma_f32_16x16x32_bf16 v[180:183], a[20:23], a[100:103], v[180:183]
    ds_read_b128 a[116:119], v22 offset:13312
    v_mfma_f32_16x16x32_bf16 v[184:187], a[8:11], a[72:75], v[184:187]
    v_exp_f32 v86, v86
    v_mfma_f32_16x16x32_bf16 v[184:187], a[24:27], a[100:103], v[184:187]
    s_waitcnt lgkmcnt(9)
    ds_write_b64 v23, v[140:141] offset:34816
    v_mfma_f32_16x16x32_bf16 v[188:191], a[12:15], a[72:75], v[188:191]
    s_waitcnt vmcnt(10)
    ds_read_b64_tr_b16 a[32:33], v16 offset:16384
    v_add_f32 v31, v31, v86
    v_mfma_f32_16x16x32_bf16 v[188:191], a[28:31], a[100:103], v[188:191]
    buffer_load_dwordx4 v6, s[28:31], s43 offen offset:1024 nt lds
    v_mfma_f32_16x16x32_bf16 v[192:195], a[0:3], a[76:79], v[192:195]
    ds_read_b64_tr_b16 a[34:35], v16 offset:18432
    v_mfma_f32_16x16x32_bf16 v[192:195], a[16:19], a[104:107], v[192:195]
    ds_read_b64_tr_b16 a[36:37], v17 offset:16384
    v_mfma_f32_16x16x32_bf16 v[196:199], a[4:7], a[76:79], v[196:199]
    s_waitcnt lgkmcnt(9)
    ds_read_b64_tr_b16 a[38:39], v17 offset:18432
    v_mfma_f32_16x16x32_bf16 v[196:199], a[20:23], a[104:107], v[196:199]
    ds_read_b64_tr_b16 a[40:41], v18 offset:16384
    v_mfma_f32_16x16x32_bf16 v[200:203], a[8:11], a[76:79], v[200:203]
    ds_read_b64_tr_b16 a[42:43], v18 offset:18432
    v_mfma_f32_16x16x32_bf16 v[200:203], a[24:27], a[104:107], v[200:203]
    ds_read_b64_tr_b16 a[44:45], v19 offset:16384
    v_mfma_f32_16x16x32_bf16 v[204:207], a[12:15], a[76:79], v[204:207]
    s_waitcnt lgkmcnt(9)
    ds_read_b128 a[120:123], v22 offset:14336
    v_mfma_f32_16x16x32_bf16 v[204:207], a[28:31], a[104:107], v[204:207]
    buffer_load_dwordx4 v7, s[28:31], s43 offen offset:2048 nt lds
    v_mfma_f32_16x16x32_bf16 v[208:211], a[0:3], a[80:83], v[208:211]
    ds_read_b128 a[148:151], v22 offset:21504
    v_mfma_f32_16x16x32_bf16 v[208:211], a[16:19], a[108:111], v[208:211]
    ds_read_b64_tr_b16 a[46:47], v19 offset:18432
    v_mfma_f32_16x16x32_bf16 v[212:215], a[4:7], a[80:83], v[212:215]
    ds_read_b128 a[124:127], v22 offset:15360
    v_mfma_f32_16x16x32_bf16 v[212:215], a[20:23], a[108:111], v[212:215]
    s_waitcnt lgkmcnt(9)
    ds_write_b64 v23, v[118:119] offset:28680
    v_mfma_f32_16x16x32_bf16 v[216:219], a[8:11], a[80:83], v[216:219]
    ds_read_b128 a[152:155], v22 offset:22528
    v_mfma_f32_16x16x32_bf16 v[216:219], a[24:27], a[108:111], v[216:219]
    v_exp_f32 v87, v87
    v_mfma_f32_16x16x32_bf16 v[220:223], a[12:15], a[80:83], v[220:223]
    buffer_load_dwordx4 v8, s[28:31], s43 offen offset:3072 nt lds
    v_mfma_f32_16x16x32_bf16 v[220:223], a[28:31], a[108:111], v[220:223]
    ds_read_b128 a[128:131], v22 offset:16384
    v_cvt_pk_bf16_f32 v143, v86, v87
    v_mfma_f32_16x16x32_bf16 v[224:227], a[0:3], a[84:87], v[224:227]
    s_waitcnt vmcnt(9)
    ds_read_b64_tr_b16 a[48:49], v16 offset:20480
    v_add_f32 v31, v31, v87
    v_mfma_f32_16x16x32_bf16 v[224:227], a[16:19], a[112:115], v[224:227]
    s_waitcnt lgkmcnt(9)
    ds_read_b64_tr_b16 a[50:51], v16 offset:22528
    v_mov_b32 v38, v31
    v_mfma_f32_16x16x32_bf16 v[228:231], a[4:7], a[84:87], v[228:231]
    ds_read_b64_tr_b16 a[52:53], v17 offset:20480
    s_add_u32 m0, s42, 8192
    v_mfma_f32_16x16x32_bf16 v[228:231], a[20:23], a[112:115], v[228:231]
    ds_read_b64_tr_b16 a[54:55], v17 offset:22528
    s_mov_b32 s43, 229376
    v_mfma_f32_16x16x32_bf16 v[232:235], a[8:11], a[84:87], v[232:235]
    ds_read_b64_tr_b16 a[56:57], v18 offset:20480
    v_mfma_f32_16x16x32_bf16 v[232:235], a[24:27], a[112:115], v[232:235]
    s_waitcnt lgkmcnt(9)
    ds_read_b64_tr_b16 a[58:59], v18 offset:22528
    v_mfma_f32_16x16x32_bf16 v[236:239], a[12:15], a[84:87], v[236:239]
    buffer_load_dwordx4 v5, s[28:31], s43 offen offset:0 nt lds
    v_mfma_f32_16x16x32_bf16 v[236:239], a[28:31], a[112:115], v[236:239]
    ds_read_b64_tr_b16 a[60:61], v19 offset:20480
    v_mfma_f32_16x16x32_bf16 v[240:243], a[0:3], a[88:91], v[240:243]
    ds_read_b64_tr_b16 a[62:63], v19 offset:22528
    v_mfma_f32_16x16x32_bf16 v[240:243], a[16:19], a[116:119], v[240:243]
    ds_read_b128 a[156:159], v22 offset:23552
    v_mfma_f32_16x16x32_bf16 v[244:247], a[4:7], a[88:91], v[244:247]
    s_waitcnt lgkmcnt(9)
    ds_write_b64 v23, v[122:123] offset:29704
    v_mfma_f32_16x16x32_bf16 v[244:247], a[20:23], a[116:119], v[244:247]
    ds_read_b128 a[132:135], v22 offset:17408
    v_mfma_f32_16x16x32_bf16 v[248:251], a[8:11], a[88:91], v[248:251]
    v_permlane32_swap_b32 v25, v32
    v_mfma_f32_16x16x32_bf16 v[248:251], a[24:27], a[116:119], v[248:251]
    buffer_load_dwordx4 v6, s[28:31], s43 offen offset:1024 nt lds
    v_mfma_f32_16x16x32_bf16 v[252:255], a[12:15], a[88:91], v[252:255]
    ds_read_b128 a[160:163], v22 offset:24576
    v_add_f32 v25, v25, v32
    v_mfma_f32_16x16x32_bf16 v[252:255], a[28:31], a[116:119], v[252:255]
    ds_write_b64 v23, v[126:127] offset:30728
    v_mfma_f32_16x16x32_bf16 v[144:147], a[32:35], a[120:123], v[144:147]
    s_waitcnt lgkmcnt(9)
    ds_read_b128 a[136:139], v22 offset:18432
    v_mov_b32 v32, v25
    v_mfma_f32_16x16x32_bf16 v[144:147], a[48:51], a[148:151], v[144:147]
    v_permlane32_swap_b32 v26, v33
    v_mfma_f32_16x16x32_bf16 v[148:151], a[36:39], a[120:123], v[148:151]
    ds_read_b128 a[164:167], v22 offset:25600
    v_add_f32 v26, v26, v33
    v_mfma_f32_16x16x32_bf16 v[148:151], a[52:55], a[148:151], v[148:151]
    ds_write_b64 v23, v[130:131] offset:31752
    v_mfma_f32_16x16x32_bf16 v[152:155], a[40:43], a[120:123], v[152:155]
    ds_read_b128 a[140:143], v22 offset:19456
    v_mov_b32 v33, v26
    s_waitcnt lgkmcnt(11)
    v_mfma_f32_16x16x32_bf16 v[152:155], a[56:59], a[148:151], v[152:155]
    buffer_load_dwordx4 v7, s[28:31], s43 offen offset:2048 nt lds
    v_mfma_f32_16x16x32_bf16 v[156:159], a[44:47], a[120:123], v[156:159]
    ds_read_b128 a[168:171], v22 offset:26624
    s_mov_b32 s48, 0
    s_waitcnt lgkmcnt(10)
    v_mfma_f32_16x16x32_bf16 v[156:159], a[60:63], a[148:151], v[156:159]
    ds_write_b64 v23, v[134:135] offset:32776
    v_mfma_f32_16x16x32_bf16 v[160:163], a[32:35], a[124:127], v[160:163]
    ds_read_b128 a[144:147], v22 offset:20480
    s_mov_b32 s49, 3584
    v_mfma_f32_16x16x32_bf16 v[160:163], a[48:51], a[152:155], v[160:163]
    v_permlane32_swap_b32 v27, v34
    v_mfma_f32_16x16x32_bf16 v[164:167], a[36:39], a[124:127], v[164:167]
    ds_read_b128 a[172:175], v22 offset:27648
    v_add_f32 v27, v27, v34
    v_mfma_f32_16x16x32_bf16 v[164:167], a[52:55], a[152:155], v[164:167]
    s_waitcnt lgkmcnt(9)
    ds_write_b64 v23, v[138:139] offset:33800
    v_mfma_f32_16x16x32_bf16 v[168:171], a[40:43], a[124:127], v[168:171]
    buffer_load_dwordx4 v8, s[28:31], s43 offen offset:3072 nt lds
    v_mfma_f32_16x16x32_bf16 v[168:171], a[56:59], a[152:155], v[168:171]
    v_permlane32_swap_b32 v28, v35
    v_mfma_f32_16x16x32_bf16 v[172:175], a[44:47], a[124:127], v[172:175]
    ds_write_b64 v23, v[142:143] offset:34824
    v_mfma_f32_16x16x32_bf16 v[172:175], a[60:63], a[152:155], v[172:175]
    v_permlane32_swap_b32 v29, v36
    v_mfma_f32_16x16x32_bf16 v[176:179], a[32:35], a[128:131], v[176:179]
    s_add_u32 m0, s42, 12288
    s_mov_b32 s43, 245760
    v_mfma_f32_16x16x32_bf16 v[176:179], a[48:51], a[156:159], v[176:179]
    v_permlane32_swap_b32 v30, v37
    v_mfma_f32_16x16x32_bf16 v[180:183], a[36:39], a[128:131], v[180:183]
    v_permlane32_swap_b32 v31, v38
    v_mfma_f32_16x16x32_bf16 v[180:183], a[52:55], a[156:159], v[180:183]
    v_add_f32 v28, v28, v35
    v_add_f32 v29, v29, v36
    v_mfma_f32_16x16x32_bf16 v[184:187], a[40:43], a[128:131], v[184:187]
    buffer_load_dwordx4 v5, s[28:31], s43 offen offset:0 nt lds
    v_mfma_f32_16x16x32_bf16 v[184:187], a[56:59], a[156:159], v[184:187]
    v_add_f32 v30, v30, v37
    v_add_f32 v31, v31, v38
    v_mfma_f32_16x16x32_bf16 v[188:191], a[44:47], a[128:131], v[188:191]
    s_waitcnt vmcnt(9)
    ds_read_b64_tr_b16 a[0:1], v16 offset:0
    v_mov_b32 v34, v27
    v_mfma_f32_16x16x32_bf16 v[188:191], a[60:63], a[156:159], v[188:191]
    ds_read_b64_tr_b16 a[2:3], v16 offset:2048
    v_mov_b32 v35, v28
    v_mfma_f32_16x16x32_bf16 v[192:195], a[32:35], a[132:135], v[192:195]
    s_waitcnt lgkmcnt(9)
    ds_read_b64_tr_b16 a[4:5], v17 offset:0
    v_mov_b32 v36, v29
    v_mfma_f32_16x16x32_bf16 v[192:195], a[48:51], a[160:163], v[192:195]
    ds_read_b64_tr_b16 a[6:7], v17 offset:2048
    v_mov_b32 v37, v30
    v_mfma_f32_16x16x32_bf16 v[196:199], a[36:39], a[132:135], v[196:199]
    ds_read_b64_tr_b16 a[8:9], v18 offset:0
    v_mov_b32 v38, v31
    v_mfma_f32_16x16x32_bf16 v[196:199], a[52:55], a[160:163], v[196:199]
    buffer_load_dwordx4 v6, s[28:31], s43 offen offset:1024 nt lds
    v_mfma_f32_16x16x32_bf16 v[200:203], a[40:43], a[132:135], v[200:203]
    ds_read_b64_tr_b16 a[10:11], v18 offset:2048
    s_mov_b32 s50, 7168
    v_mfma_f32_16x16x32_bf16 v[200:203], a[56:59], a[160:163], v[200:203]
    s_waitcnt lgkmcnt(9)
    ds_read_b64_tr_b16 a[12:13], v19 offset:0
    s_mov_b32 s51, 10752
    v_mfma_f32_16x16x32_bf16 v[204:207], a[44:47], a[132:135], v[204:207]
    ds_read_b64_tr_b16 a[14:15], v19 offset:2048
    s_mov_b32 s52, 14336
    v_mfma_f32_16x16x32_bf16 v[204:207], a[60:63], a[160:163], v[204:207]
    v_permlane16_swap_b32 v25, v32
    v_mfma_f32_16x16x32_bf16 v[208:211], a[32:35], a[136:139], v[208:211]
    v_permlane16_swap_b32 v26, v33
    v_mfma_f32_16x16x32_bf16 v[208:211], a[48:51], a[164:167], v[208:211]
    v_permlane16_swap_b32 v27, v34
    v_mfma_f32_16x16x32_bf16 v[212:215], a[36:39], a[136:139], v[212:215]
    v_permlane16_swap_b32 v28, v35
    v_mfma_f32_16x16x32_bf16 v[212:215], a[52:55], a[164:167], v[212:215]
    buffer_load_dwordx4 v7, s[28:31], s43 offen offset:2048 nt lds
    v_mfma_f32_16x16x32_bf16 v[216:219], a[40:43], a[136:139], v[216:219]
    v_permlane16_swap_b32 v29, v36
    v_mfma_f32_16x16x32_bf16 v[216:219], a[56:59], a[164:167], v[216:219]
    v_permlane16_swap_b32 v30, v37
    v_mfma_f32_16x16x32_bf16 v[220:223], a[44:47], a[136:139], v[220:223]
    v_permlane16_swap_b32 v31, v38
    v_mfma_f32_16x16x32_bf16 v[220:223], a[60:63], a[164:167], v[220:223]
    v_add_f32 v40, v25, v32
    v_add_f32 v41, v26, v33
    v_add_f32 v42, v27, v34
    v_add_f32 v43, v28, v35
    v_add_f32 v44, v29, v36
    v_add_f32 v45, v30, v37
    v_add_f32 v46, v31, v38
    ds_write_b128 v39, v[40:43] offset:57344
    ds_write_b128 v39, v[44:47] offset:58368
    v_mfma_f32_16x16x32_bf16 v[224:227], a[32:35], a[140:143], v[224:227]
    s_waitcnt lgkmcnt(0)
    s_barrier
    s_waitcnt vmcnt(7)
    ds_read_b128 a[64:67], v22 offset:28672
    s_mov_b32 s53, 17920
    v_mfma_f32_16x16x32_bf16 v[224:227], a[48:51], a[168:171], v[224:227]
    ds_read_b64_tr_b16 a[16:17], v16 offset:4096
    s_mov_b32 s54, 21504
    v_mfma_f32_16x16x32_bf16 v[228:231], a[36:39], a[140:143], v[228:231]
    buffer_load_dwordx4 v8, s[28:31], s43 offen offset:3072 nt lds
    v_mfma_f32_16x16x32_bf16 v[228:231], a[52:55], a[168:171], v[228:231]
    ds_read_b64_tr_b16 a[18:19], v16 offset:6144
    v_mfma_f32_16x16x32_bf16 v[232:235], a[40:43], a[140:143], v[232:235]
    ds_read_b128 a[92:95], v22 offset:35840
    v_mfma_f32_16x16x32_bf16 v[232:235], a[56:59], a[168:171], v[232:235]
    ds_read_b64_tr_b16 a[20:21], v17 offset:4096
    v_mfma_f32_16x16x32_bf16 v[236:239], a[44:47], a[140:143], v[236:239]
    ds_read_b64_tr_b16 a[22:23], v17 offset:6144
    s_add_u32 m0, s42, 16384
    v_mfma_f32_16x16x32_bf16 v[236:239], a[60:63], a[168:171], v[236:239]
    ds_read_b64_tr_b16 a[24:25], v18 offset:4096
    s_mov_b32 s43, 0
    v_mfma_f32_16x16x32_bf16 v[240:243], a[32:35], a[144:147], v[240:243]
    ds_read_b64_tr_b16 a[26:27], v18 offset:6144
    v_mfma_f32_16x16x32_bf16 v[240:243], a[48:51], a[172:175], v[240:243]
    ds_read_b64_tr_b16 a[28:29], v19 offset:4096
    v_mfma_f32_16x16x32_bf16 v[244:247], a[36:39], a[144:147], v[244:247]
    buffer_load_dwordx4 v9, s[32:35], s43 offen offset:0 lds
    v_mfma_f32_16x16x32_bf16 v[244:247], a[52:55], a[172:175], v[244:247]
    ds_read_b64_tr_b16 a[30:31], v19 offset:6144
    s_mov_b32 s43, 6144
    v_mfma_f32_16x16x32_bf16 v[248:251], a[40:43], a[144:147], v[248:251]
    ds_read_b128 a[68:71], v22 offset:29696
    v_mfma_f32_16x16x32_bf16 v[248:251], a[56:59], a[172:175], v[248:251]
    ds_read_b128 v[32:35], v22 offset:57344
    v_mfma_f32_16x16x32_bf16 v[252:255], a[44:47], a[144:147], v[252:255]
    buffer_load_dwordx4 v9, s[32:35], s43 offen offset:1024 lds
    v_mfma_f32_16x16x32_bf16 v[252:255], a[60:63], a[172:175], v[252:255]
    ds_read_b128 a[96:99], v22 offset:36864
    s_mov_b32 s43, 12288
    s_waitcnt lgkmcnt(12)
    v_mfma_f32_16x16x32_bf16 v[144:147], a[0:3], a[64:67], v[144:147]
    ds_read_b128 v[36:39], v22 offset:58368
    v_add_u32 v12, 98304, v20
    s_waitcnt lgkmcnt(10)
    v_mfma_f32_16x16x32_bf16 v[144:147], a[16:19], a[92:95], v[144:147]
    ds_read_b128 v[40:43], v22 offset:59392
    v_lshrrev_b32 v5, 1, v10
    v_mfma_f32_16x16x32_bf16 v[148:151], a[4:7], a[64:67], v[148:151]
    buffer_load_dwordx4 v9, s[32:35], s43 offen offset:2048 lds
    s_waitcnt lgkmcnt(9)
    v_mfma_f32_16x16x32_bf16 v[148:151], a[20:23], a[92:95], v[148:151]
    ds_read_b128 a[72:75], v22 offset:30720
    s_mov_b32 s43, 18432
    v_mfma_f32_16x16x32_bf16 v[152:155], a[8:11], a[64:67], v[152:155]
    ds_read_b128 v[44:47], v22 offset:60416
    s_waitcnt lgkmcnt(9)
    v_mfma_f32_16x16x32_bf16 v[152:155], a[24:27], a[92:95], v[152:155]
    ds_read_b128 v[48:51], v22 offset:61440
    v_mfma_f32_16x16x32_bf16 v[156:159], a[12:15], a[64:67], v[156:159]
    buffer_load_dwordx4 v9, s[32:35], s43 offen offset:3072 lds
    s_waitcnt lgkmcnt(8)
    v_mfma_f32_16x16x32_bf16 v[156:159], a[28:31], a[92:95], v[156:159]
    ds_read_b128 a[100:103], v22 offset:37888
    s_add_u32 m0, s42, 20480
    s_waitcnt lgkmcnt(8)
    v_mfma_f32_16x16x32_bf16 v[160:163], a[0:3], a[68:71], v[160:163]
    s_mov_b32 s43, 114688
    s_waitcnt lgkmcnt(6)
    v_mfma_f32_16x16x32_bf16 v[160:163], a[16:19], a[96:99], v[160:163]
    ds_read_b128 a[76:79], v22 offset:31744
    v_mfma_f32_16x16x32_bf16 v[164:167], a[4:7], a[68:71], v[164:167]
    buffer_load_dwordx4 v9, s[32:35], s43 offen offset:0 lds
    v_mfma_f32_16x16x32_bf16 v[164:167], a[20:23], a[96:99], v[164:167]
    ds_read_b128 a[104:107], v22 offset:38912
    s_mov_b32 s43, 120832
    v_mfma_f32_16x16x32_bf16 v[168:171], a[8:11], a[68:71], v[168:171]
    ds_read_b128 v[52:55], v22 offset:62464
    v_mfma_f32_16x16x32_bf16 v[168:171], a[24:27], a[96:99], v[168:171]
    ds_read_b128 v[56:59], v22 offset:63488
    v_mfma_f32_16x16x32_bf16 v[172:175], a[12:15], a[68:71], v[172:175]
    buffer_load_dwordx4 v9, s[32:35], s43 offen offset:1024 lds
    v_mfma_f32_16x16x32_bf16 v[172:175], a[28:31], a[96:99], v[172:175]
    ds_read_b128 a[80:83], v22 offset:32768
    s_mov_b32 s43, 126976
    s_waitcnt lgkmcnt(8)
    v_mfma_f32_16x16x32_bf16 v[176:179], a[0:3], a[72:75], v[176:179]
    ds_read_b128 v[60:63], v22 offset:64512
    s_waitcnt lgkmcnt(6)
    v_mfma_f32_16x16x32_bf16 v[176:179], a[16:19], a[100:103], v[176:179]
    v_mfma_f32_16x16x32_bf16 v[180:183], a[4:7], a[72:75], v[180:183]
    buffer_load_dwordx4 v9, s[32:35], s43 offen offset:2048 lds
    v_mfma_f32_16x16x32_bf16 v[180:183], a[20:23], a[100:103], v[180:183]
    ds_read_b128 a[108:111], v22 offset:39936
    s_mov_b32 s43, 133120
    v_mfma_f32_16x16x32_bf16 v[184:187], a[8:11], a[72:75], v[184:187]
    v_add_f32 v32, v32, v40
    v_add_f32 v33, v33, v41
    v_mfma_f32_16x16x32_bf16 v[184:187], a[24:27], a[100:103], v[184:187]
    ds_read_b128 a[84:87], v22 offset:33792
    v_add_f32 v34, v34, v42
    v_mfma_f32_16x16x32_bf16 v[188:191], a[12:15], a[72:75], v[188:191]
    s_waitcnt vmcnt(11)
    buffer_load_dwordx4 v9, s[32:35], s43 offen offset:3072 lds
    v_mfma_f32_16x16x32_bf16 v[188:191], a[28:31], a[100:103], v[188:191]
    ds_read_b128 a[112:115], v22 offset:40960
    s_add_u32 m0, s42, 0
    s_waitcnt lgkmcnt(8)
    v_mfma_f32_16x16x32_bf16 v[192:195], a[0:3], a[76:79], v[192:195]
    ds_read_b64_tr_b16 a[32:33], v16 offset:8192
    s_mov_b32 s43, 128
    s_waitcnt lgkmcnt(8)
    v_mfma_f32_16x16x32_bf16 v[192:195], a[16:19], a[104:107], v[192:195]
    ds_read_b128 a[88:91], v22 offset:34816
    v_add_f32 v35, v35, v43
    v_mfma_f32_16x16x32_bf16 v[196:199], a[4:7], a[76:79], v[196:199]
    buffer_load_dwordx4 v9, s[32:35], s43 offen offset:0 lds
    v_mfma_f32_16x16x32_bf16 v[196:199], a[20:23], a[104:107], v[196:199]
    ds_read_b128 a[116:119], v22 offset:41984
    s_mov_b32 s43, 6272
    v_mfma_f32_16x16x32_bf16 v[200:203], a[8:11], a[76:79], v[200:203]
    ds_read_b64_tr_b16 a[34:35], v16 offset:10240
    v_add_f32 v36, v36, v44
    v_mfma_f32_16x16x32_bf16 v[200:203], a[24:27], a[104:107], v[200:203]
    ds_read_b64_tr_b16 a[36:37], v17 offset:8192
    v_add_f32 v37, v37, v45
    v_mfma_f32_16x16x32_bf16 v[204:207], a[12:15], a[76:79], v[204:207]
    buffer_load_dwordx4 v9, s[32:35], s43 offen offset:1024 lds
    v_mfma_f32_16x16x32_bf16 v[204:207], a[28:31], a[104:107], v[204:207]
    ds_read_b128 a[120:123], v22 offset:43008
    s_mov_b32 s43, 12416
    s_waitcnt lgkmcnt(10)
    v_mfma_f32_16x16x32_bf16 v[208:211], a[0:3], a[80:83], v[208:211]
    ds_read_b64_tr_b16 a[38:39], v17 offset:10240
    v_add_f32 v38, v38, v46
    s_waitcnt lgkmcnt(9)
    v_mfma_f32_16x16x32_bf16 v[208:211], a[16:19], a[108:111], v[208:211]
    ds_read_b128 a[148:151], v22 offset:50176
    v_add_f32 v48, v48, v56
    v_mfma_f32_16x16x32_bf16 v[212:215], a[4:7], a[80:83], v[212:215]
    buffer_load_dwordx4 v9, s[32:35], s43 offen offset:2048 lds
    v_mfma_f32_16x16x32_bf16 v[212:215], a[20:23], a[108:111], v[212:215]
    ds_read_b64_tr_b16 a[40:41], v18 offset:8192
    s_mov_b32 s43, 18560
    v_mfma_f32_16x16x32_bf16 v[216:219], a[8:11], a[80:83], v[216:219]
    ds_read_b64_tr_b16 a[42:43], v18 offset:10240
    v_add_f32 v49, v49, v57
    v_mfma_f32_16x16x32_bf16 v[216:219], a[24:27], a[108:111], v[216:219]
    ds_read_b64_tr_b16 a[44:45], v19 offset:8192
    v_add_f32 v50, v50, v58
    v_mfma_f32_16x16x32_bf16 v[220:223], a[12:15], a[80:83], v[220:223]
    buffer_load_dwordx4 v9, s[32:35], s43 offen offset:3072 lds
    v_mfma_f32_16x16x32_bf16 v[220:223], a[28:31], a[108:111], v[220:223]
    s_waitcnt lgkmcnt(9)
    ds_read_b64_tr_b16 a[46:47], v19 offset:10240
    s_add_u32 m0, s42, 4096
    v_mfma_f32_16x16x32_bf16 v[224:227], a[0:3], a[84:87], v[224:227]
    s_waitcnt vmcnt(12)
    ds_read_b64_tr_b16 a[48:49], v16 offset:12288
    s_mov_b32 s43, 114816
    v_mfma_f32_16x16x32_bf16 v[224:227], a[16:19], a[112:115], v[224:227]
    ds_read_b64_tr_b16 a[50:51], v16 offset:14336
    v_add_f32 v51, v51, v59
    v_mfma_f32_16x16x32_bf16 v[228:231], a[4:7], a[84:87], v[228:231]
    buffer_load_dwordx4 v9, s[32:35], s43 offen offset:0 lds
    v_mfma_f32_16x16x32_bf16 v[228:231], a[20:23], a[112:115], v[228:231]
    ds_read_b64_tr_b16 a[52:53], v17 offset:12288
    s_mov_b32 s43, 120960
    v_mfma_f32_16x16x32_bf16 v[232:235], a[8:11], a[84:87], v[232:235]
    s_waitcnt lgkmcnt(9)
    ds_read_b64_tr_b16 a[54:55], v17 offset:14336
    v_add_f32 v52, v52, v60
    v_mfma_f32_16x16x32_bf16 v[232:235], a[24:27], a[112:115], v[232:235]
    ds_read_b64_tr_b16 a[56:57], v18 offset:12288
    v_add_f32 v53, v53, v61
    v_mfma_f32_16x16x32_bf16 v[236:239], a[12:15], a[84:87], v[236:239]
    buffer_load_dwordx4 v9, s[32:35], s43 offen offset:1024 lds
    v_mfma_f32_16x16x32_bf16 v[236:239], a[28:31], a[112:115], v[236:239]
    ds_read_b64_tr_b16 a[58:59], v18 offset:14336
    s_mov_b32 s43, 127104
    v_mfma_f32_16x16x32_bf16 v[240:243], a[0:3], a[88:91], v[240:243]
    ds_read_b64_tr_b16 a[60:61], v19 offset:12288
    v_add_f32 v54, v54, v62
    v_mfma_f32_16x16x32_bf16 v[240:243], a[16:19], a[116:119], v[240:243]
    s_waitcnt lgkmcnt(9)
    ds_read_b64_tr_b16 a[62:63], v19 offset:14336
    v_add_f32 v32, v32, v48
    v_mfma_f32_16x16x32_bf16 v[244:247], a[4:7], a[88:91], v[244:247]
    buffer_load_dwordx4 v9, s[32:35], s43 offen offset:2048 lds
    v_mfma_f32_16x16x32_bf16 v[244:247], a[20:23], a[116:119], v[244:247]
    ds_read_b128 a[124:127], v22 offset:44032
    s_mov_b32 s43, 133248
    v_mfma_f32_16x16x32_bf16 v[248:251], a[8:11], a[88:91], v[248:251]
    v_add_f32 v33, v33, v49
    v_add_f32 v34, v34, v50
    v_mfma_f32_16x16x32_bf16 v[248:251], a[24:27], a[116:119], v[248:251]
    ds_read_b128 a[152:155], v22 offset:51200
    v_add_f32 v35, v35, v51
    v_mfma_f32_16x16x32_bf16 v[252:255], a[12:15], a[88:91], v[252:255]
    buffer_load_dwordx4 v9, s[32:35], s43 offen offset:3072 lds
    v_mfma_f32_16x16x32_bf16 v[252:255], a[28:31], a[116:119], v[252:255]
    ds_read_b128 a[128:131], v22 offset:45056
    s_waitcnt lgkmcnt(11)
    s_add_u32 m0, s42, 8192
    v_mfma_f32_16x16x32_bf16 v[144:147], a[32:35], a[120:123], v[144:147]
    s_mov_b32 s43, 256
    v_add_f32 v36, v36, v52
    s_waitcnt lgkmcnt(9)
    v_mfma_f32_16x16x32_bf16 v[144:147], a[48:51], a[148:151], v[144:147]
    ds_read_b128 a[156:159], v22 offset:52224
    v_add_f32 v37, v37, v53
    v_mfma_f32_16x16x32_bf16 v[148:151], a[36:39], a[120:123], v[148:151]
    ds_read_b128 a[132:135], v22 offset:46080
    v_add_f32 v38, v38, v54
    s_waitcnt lgkmcnt(9)
    v_mfma_f32_16x16x32_bf16 v[148:151], a[52:55], a[148:151], v[148:151]
    ds_read_b128 a[160:163], v22 offset:53248
    v_max3_f32 v40, v32, v33, v34
    v_mfma_f32_16x16x32_bf16 v[152:155], a[40:43], a[120:123], v[152:155]
    ds_read_b128 a[136:139], v22 offset:47104
    buffer_load_dwordx4 v9, s[32:35], s43 offen offset:0 lds
    s_waitcnt lgkmcnt(9)
    v_mfma_f32_16x16x32_bf16 v[152:155], a[56:59], a[148:151], v[152:155]
    ds_read_b128 a[164:167], v22 offset:54272
    s_mov_b32 s43, 6400
    v_mfma_f32_16x16x32_bf16 v[156:159], a[44:47], a[120:123], v[156:159]
    ds_read_b128 a[140:143], v22 offset:48128
    v_min3_f32 v41, v32, v33, v34
    s_waitcnt lgkmcnt(9)
    v_mfma_f32_16x16x32_bf16 v[156:159], a[60:63], a[148:151], v[156:159]
    ds_read_b128 a[168:171], v22 offset:55296
    v_max3_f32 v40, v40, v35, v36
    s_waitcnt lgkmcnt(9)
    v_mfma_f32_16x16x32_bf16 v[160:163], a[32:35], a[124:127], v[160:163]
    ds_read_b128 a[144:147], v22 offset:49152
    v_min3_f32 v41, v41, v35, v36
    s_waitcnt lgkmcnt(9)
    v_mfma_f32_16x16x32_bf16 v[160:163], a[48:51], a[152:155], v[160:163]
    ds_read_b128 a[172:175], v22 offset:56320
    v_max3_f32 v40, v40, v37, v38
    v_mfma_f32_16x16x32_bf16 v[164:167], a[36:39], a[124:127], v[164:167]
    buffer_load_dwordx4 v9, s[32:35], s43 offen offset:1024 lds
    v_mfma_f32_16x16x32_bf16 v[164:167], a[52:55], a[152:155], v[164:167]
    s_mov_b32 s43, 12544
    v_min3_f32 v41, v41, v37, v38
    v_mfma_f32_16x16x32_bf16 v[168:171], a[40:43], a[124:127], v[168:171]
    s_waitcnt lgkmcnt(0)
    s_barrier
    v_cmp_nge_f32 vcc, 0x53800000, v40
    s_cbranch_vccnz L_fallback
    v_mfma_f32_16x16x32_bf16 v[168:171], a[56:59], a[152:155], v[168:171]
    v_cmp_nle_f32 vcc, 0x2b800000, v41
    s_cbranch_vccnz L_fallback
    v_mfma_f32_16x16x32_bf16 v[172:175], a[44:47], a[124:127], v[172:175]
    buffer_load_dwordx4 v9, s[32:35], s43 offen offset:2048 lds
    v_mfma_f32_16x16x32_bf16 v[172:175], a[60:63], a[152:155], v[172:175]
    s_mov_b32 s43, 18688
    v_cvt_pk_bf16_f32 v144, v144, v145
    v_mfma_f32_16x16x32_bf16 v[176:179], a[32:35], a[128:131], v[176:179]
    v_rcp_f32 v25, v32
    v_mfma_f32_16x16x32_bf16 v[176:179], a[48:51], a[156:159], v[176:179]
    v_rcp_f32 v26, v33
    v_mfma_f32_16x16x32_bf16 v[180:183], a[36:39], a[128:131], v[180:183]
    buffer_load_dwordx4 v9, s[32:35], s43 offen offset:3072 lds
    v_mfma_f32_16x16x32_bf16 v[180:183], a[52:55], a[156:159], v[180:183]
    s_add_u32 m0, s42, 12288
    s_mov_b32 s43, 114944
    v_mfma_f32_16x16x32_bf16 v[184:187], a[40:43], a[128:131], v[184:187]
    v_rcp_f32 v27, v34
    v_mfma_f32_16x16x32_bf16 v[184:187], a[56:59], a[156:159], v[184:187]
    v_rcp_f32 v28, v35
    v_mfma_f32_16x16x32_bf16 v[188:191], a[44:47], a[128:131], v[188:191]
    buffer_load_dwordx4 v9, s[32:35], s43 offen offset:0 lds
    v_mfma_f32_16x16x32_bf16 v[188:191], a[60:63], a[156:159], v[188:191]
    s_mov_b32 s43, 121088
    v_cvt_pk_bf16_f32 v145, v146, v147
    v_mfma_f32_16x16x32_bf16 v[192:195], a[32:35], a[132:135], v[192:195]
    v_rcp_f32 v29, v36
    v_mfma_f32_16x16x32_bf16 v[192:195], a[48:51], a[160:163], v[192:195]
    v_rcp_f32 v30, v37
    v_mfma_f32_16x16x32_bf16 v[196:199], a[36:39], a[132:135], v[196:199]
    buffer_load_dwordx4 v9, s[32:35], s43 offen offset:1024 lds
    v_mfma_f32_16x16x32_bf16 v[196:199], a[52:55], a[160:163], v[196:199]
    s_mov_b32 s43, 127232
    v_cvt_pk_bf16_f32 v146, v148, v149
    v_mfma_f32_16x16x32_bf16 v[200:203], a[40:43], a[132:135], v[200:203]
    v_rcp_f32 v31, v38
    v_mfma_f32_16x16x32_bf16 v[200:203], a[56:59], a[160:163], v[200:203]
    v_cvt_pk_bf16_f32 v147, v150, v151
    v_cvt_pk_bf16_f32 v152, v152, v153
    v_mfma_f32_16x16x32_bf16 v[204:207], a[44:47], a[132:135], v[204:207]
    buffer_load_dwordx4 v9, s[32:35], s43 offen offset:2048 lds
    v_mfma_f32_16x16x32_bf16 v[204:207], a[60:63], a[160:163], v[204:207]
    s_mov_b32 s43, 133376
    v_cvt_pk_bf16_f32 v153, v154, v155
    v_mfma_f32_16x16x32_bf16 v[208:211], a[32:35], a[136:139], v[208:211]
    ds_write_b128 v24, v[144:147] offset:0
    v_mfma_f32_16x16x32_bf16 v[208:211], a[48:51], a[164:167], v[208:211]
    v_cvt_pk_bf16_f32 v154, v156, v157
    v_cvt_pk_bf16_f32 v155, v158, v159
    v_mfma_f32_16x16x32_bf16 v[212:215], a[36:39], a[136:139], v[212:215]
    buffer_load_dwordx4 v9, s[32:35], s43 offen offset:3072 lds
    v_mfma_f32_16x16x32_bf16 v[212:215], a[52:55], a[164:167], v[212:215]
    ds_write_b128 v24, v[152:155] offset:7168
    v_mfma_f32_16x16x32_bf16 v[216:219], a[40:43], a[136:139], v[216:219]
    v_cvt_pk_bf16_f32 v160, v160, v161
    v_cvt_pk_bf16_f32 v161, v162, v163
    v_mfma_f32_16x16x32_bf16 v[216:219], a[56:59], a[164:167], v[216:219]
    v_cvt_pk_bf16_f32 v162, v164, v165
    v_cvt_pk_bf16_f32 v163, v166, v167
    v_mfma_f32_16x16x32_bf16 v[220:223], a[44:47], a[136:139], v[220:223]
    s_waitcnt vmcnt(16)
    s_barrier
    ds_read_b64_tr_b16 a[224:225], v20 offset:16384
    v_cvt_pk_bf16_f32 v168, v168, v169
    v_mfma_f32_16x16x32_bf16 v[220:223], a[60:63], a[164:167], v[220:223]
    ds_read_b64_tr_b16 a[226:227], v20 offset:18432
    v_cvt_pk_bf16_f32 v169, v170, v171
    v_mfma_f32_16x16x32_bf16 v[224:227], a[32:35], a[140:143], v[224:227]
    ds_read_b64_tr_b16 a[228:229], v20 offset:40960
    v_cvt_pk_bf16_f32 v170, v172, v173
    v_mfma_f32_16x16x32_bf16 v[224:227], a[48:51], a[168:171], v[224:227]
    ds_read_b64_tr_b16 a[230:231], v20 offset:43008
    v_cvt_pk_bf16_f32 v171, v174, v175
    v_mfma_f32_16x16x32_bf16 v[228:231], a[36:39], a[140:143], v[228:231]
    ds_read_b64_tr_b16 a[232:233], v21 offset:16384
    v_cvt_pk_bf16_f32 v176, v176, v177
    v_mfma_f32_16x16x32_bf16 v[228:231], a[52:55], a[168:171], v[228:231]
    ds_read_b64_tr_b16 a[234:235], v21 offset:18432
    v_cvt_pk_bf16_f32 v177, v178, v179
    v_mfma_f32_16x16x32_bf16 v[232:235], a[40:43], a[140:143], v[232:235]
    ds_read_b64_tr_b16 a[236:237], v21 offset:40960
    v_cvt_pk_bf16_f32 v178, v180, v181
    v_mfma_f32_16x16x32_bf16 v[232:235], a[56:59], a[168:171], v[232:235]
    ds_read_b64_tr_b16 a[238:239], v21 offset:43008
    v_cvt_pk_bf16_f32 v179, v182, v183
    v_mfma_f32_16x16x32_bf16 v[236:239], a[44:47], a[140:143], v[236:239]
    ds_read_b64_tr_b16 a[240:241], v20 offset:20480
    v_cvt_pk_bf16_f32 v184, v184, v185
    v_mfma_f32_16x16x32_bf16 v[236:239], a[60:63], a[168:171], v[236:239]
    ds_read_b64_tr_b16 a[242:243], v20 offset:22528
    v_cvt_pk_bf16_f32 v185, v186, v187
    v_mfma_f32_16x16x32_bf16 v[240:243], a[32:35], a[144:147], v[240:243]
    ds_read_b64_tr_b16 a[244:245], v20 offset:45056
    v_cvt_pk_bf16_f32 v186, v188, v189
    v_mfma_f32_16x16x32_bf16 v[240:243], a[48:51], a[172:175], v[240:243]
    s_waitcnt lgkmcnt(9)
    ds_read_b64_tr_b16 a[246:247], v20 offset:47104
    v_cvt_pk_bf16_f32 v187, v190, v191
    v_mfma_f32_16x16x32_bf16 v[244:247], a[36:39], a[144:147], v[244:247]
    ds_read_b64_tr_b16 a[248:249], v21 offset:20480
    v_cvt_pk_bf16_f32 v192, v192, v193
    v_mfma_f32_16x16x32_bf16 v[244:247], a[52:55], a[172:175], v[244:247]
    ds_read_b64_tr_b16 a[250:251], v21 offset:22528
    v_cvt_pk_bf16_f32 v193, v194, v195
    v_mfma_f32_16x16x32_bf16 v[248:251], a[40:43], a[144:147], v[248:251]
    ds_read_b64_tr_b16 a[252:253], v21 offset:45056
    v_cvt_pk_bf16_f32 v194, v196, v197
    v_mfma_f32_16x16x32_bf16 v[248:251], a[56:59], a[172:175], v[248:251]
    s_waitcnt lgkmcnt(9)
    ds_read_b64_tr_b16 a[254:255], v21 offset:47104
    v_cvt_pk_bf16_f32 v195, v198, v199
    v_mfma_f32_16x16x32_bf16 v[252:255], a[44:47], a[144:147], v[252:255]
    ds_write_b128 v24, v[160:163] offset:1024
    v_mfma_f32_16x16x32_bf16 v[252:255], a[60:63], a[172:175], v[252:255]
    ds_write_b128 v24, v[168:171] offset:8192
    ds_write_b128 v24, v[176:179] offset:2048
    s_waitcnt lgkmcnt(9)
    ds_write_b128 v24, v[184:187] offset:9216
    ds_write_b128 v24, v[192:195] offset:3072
    v_cvt_pk_bf16_f32 v200, v200, v201
    v_cvt_pk_bf16_f32 v201, v202, v203
    v_cvt_pk_bf16_f32 v202, v204, v205
    v_cvt_pk_bf16_f32 v203, v206, v207
    ds_write_b128 v24, v[200:203] offset:10240
    v_cvt_pk_bf16_f32 v208, v208, v209
    v_cvt_pk_bf16_f32 v209, v210, v211
    v_cvt_pk_bf16_f32 v210, v212, v213
    v_cvt_pk_bf16_f32 v211, v214, v215
    ds_write_b128 v24, v[208:211] offset:4096
    v_cvt_pk_bf16_f32 v216, v216, v217
    v_cvt_pk_bf16_f32 v217, v218, v219
    v_cvt_pk_bf16_f32 v218, v220, v221
    v_cvt_pk_bf16_f32 v219, v222, v223
    s_waitcnt lgkmcnt(9)
    ds_write_b128 v24, v[216:219] offset:11264
    v_cvt_pk_bf16_f32 v224, v224, v225
    v_cvt_pk_bf16_f32 v225, v226, v227
    v_cvt_pk_bf16_f32 v226, v228, v229
    v_cvt_pk_bf16_f32 v227, v230, v231
    ds_write_b128 v24, v[224:227] offset:5120
    v_cvt_pk_bf16_f32 v232, v232, v233
    v_cvt_pk_bf16_f32 v233, v234, v235
    v_cvt_pk_bf16_f32 v234, v236, v237
    v_cvt_pk_bf16_f32 v235, v238, v239
    ds_write_b128 v24, v[232:235] offset:12288
    v_cvt_pk_bf16_f32 v240, v240, v241
    v_cvt_pk_bf16_f32 v241, v242, v243
    v_cvt_pk_bf16_f32 v242, v244, v245
    v_cvt_pk_bf16_f32 v243, v246, v247
    ds_write_b128 v24, v[240:243] offset:6144
    v_cvt_pk_bf16_f32 v248, v248, v249
    v_cvt_pk_bf16_f32 v249, v250, v251
    v_cvt_pk_bf16_f32 v250, v252, v253
    v_cvt_pk_bf16_f32 v251, v254, v255
    s_waitcnt lgkmcnt(9)
    ds_write_b128 v24, v[248:251] offset:13312
    s_waitcnt lgkmcnt(0)
    s_barrier
    ds_read_b128 a[0:3], v22 offset:0
    ds_read_b128 a[28:31], v22 offset:7168
    ds_read_b128 a[56:59], v22 offset:14336
    ds_read_b128 a[84:87], v22 offset:21504
    ds_read_b128 a[112:115], v22 offset:28672
    ds_read_b128 a[140:143], v22 offset:35840
    ds_read_b128 a[168:171], v22 offset:43008
    ds_read_b128 a[196:199], v22 offset:50176
    ds_read_b128 a[4:7], v22 offset:1024
    s_waitcnt lgkmcnt(8)
    v_mfma_f32_16x16x32_bf16 v[32:35], a[224:227], a[0:3], 0
    ds_read_b128 a[32:35], v22 offset:8192
    s_add_u32 m0, s42, 16384
    s_waitcnt lgkmcnt(8)
    v_mfma_f32_16x16x32_bf16 v[32:35], a[228:231], a[28:31], v[32:35]
    ds_read_b128 a[60:63], v22 offset:15360
    s_mov_b32 s43, 384
    s_waitcnt lgkmcnt(8)
    v_mfma_f32_16x16x32_bf16 v[32:35], a[232:235], a[56:59], v[32:35]
    ds_read_b128 a[88:91], v22 offset:22528
    buffer_load_dwordx4 v9, s[32:35], s43 offen offset:0 lds
    s_waitcnt lgkmcnt(8)
    v_mfma_f32_16x16x32_bf16 v[32:35], a[236:239], a[84:87], v[32:35]
    ds_read_b128 a[116:119], v22 offset:29696
    s_mov_b32 s43, 6528
    s_waitcnt lgkmcnt(8)
    v_mfma_f32_16x16x32_bf16 v[32:35], a[240:243], a[112:115], v[32:35]
    ds_read_b128 a[144:147], v22 offset:36864
    s_waitcnt lgkmcnt(8)
    v_mfma_f32_16x16x32_bf16 v[32:35], a[244:247], a[140:143], v[32:35]
    ds_read_b128 a[172:175], v22 offset:44032
    s_waitcnt lgkmcnt(8)
    v_mfma_f32_16x16x32_bf16 v[32:35], a[248:251], a[168:171], v[32:35]
    ds_read_b128 a[200:203], v22 offset:51200
    s_waitcnt lgkmcnt(8)
    v_mfma_f32_16x16x32_bf16 v[32:35], a[252:255], a[196:199], v[32:35]
    ds_read_b128 a[8:11], v22 offset:2048
    s_waitcnt lgkmcnt(8)
    v_mfma_f32_16x16x32_bf16 v[36:39], a[224:227], a[4:7], 0
    ds_read_b128 a[36:39], v22 offset:9216
    buffer_load_dwordx4 v9, s[32:35], s43 offen offset:1024 lds
    s_waitcnt lgkmcnt(8)
    v_mfma_f32_16x16x32_bf16 v[36:39], a[228:231], a[32:35], v[36:39]
    ds_read_b128 a[64:67], v22 offset:16384
    s_mov_b32 s43, 12672
    s_waitcnt lgkmcnt(8)
    v_mfma_f32_16x16x32_bf16 v[36:39], a[232:235], a[60:63], v[36:39]
    ds_read_b128 a[92:95], v22 offset:23552
    v_mul_f32 v32, v25, v32
    s_waitcnt lgkmcnt(8)
    v_mfma_f32_16x16x32_bf16 v[36:39], a[236:239], a[88:91], v[36:39]
    ds_read_b128 a[120:123], v22 offset:30720
    v_mul_f32 v33, v25, v33
    s_waitcnt lgkmcnt(8)
    v_mfma_f32_16x16x32_bf16 v[36:39], a[240:243], a[116:119], v[36:39]
    ds_read_b128 a[148:151], v22 offset:37888
    v_mul_f32 v34, v25, v34
    s_waitcnt lgkmcnt(8)
    v_mfma_f32_16x16x32_bf16 v[36:39], a[244:247], a[144:147], v[36:39]
    ds_read_b128 a[176:179], v22 offset:45056
    v_mul_f32 v35, v25, v35
    s_waitcnt lgkmcnt(8)
    v_mfma_f32_16x16x32_bf16 v[36:39], a[248:251], a[172:175], v[36:39]
    ds_read_b128 a[204:207], v22 offset:52224
    buffer_load_dwordx4 v9, s[32:35], s43 offen offset:2048 lds
    s_waitcnt lgkmcnt(8)
    v_mfma_f32_16x16x32_bf16 v[36:39], a[252:255], a[200:203], v[36:39]
    ds_read_b128 a[12:15], v22 offset:3072
    s_mov_b32 s43, 18816
    s_waitcnt lgkmcnt(8)
    v_mfma_f32_16x16x32_bf16 v[40:43], a[224:227], a[8:11], 0
    ds_read_b128 a[40:43], v22 offset:10240
    v_cvt_pk_bf16_f32 v144, v32, v33
    s_waitcnt lgkmcnt(8)
    v_mfma_f32_16x16x32_bf16 v[40:43], a[228:231], a[36:39], v[40:43]
    ds_read_b128 a[68:71], v22 offset:17408
    v_cvt_pk_bf16_f32 v145, v34, v35
    s_waitcnt lgkmcnt(8)
    v_mfma_f32_16x16x32_bf16 v[40:43], a[232:235], a[64:67], v[40:43]
    ds_read_b128 a[96:99], v22 offset:24576
    v_mul_f32 v36, v26, v36
    s_waitcnt lgkmcnt(8)
    v_mfma_f32_16x16x32_bf16 v[40:43], a[236:239], a[92:95], v[40:43]
    ds_read_b128 a[124:127], v22 offset:31744
    v_mul_f32 v37, v26, v37
    s_waitcnt lgkmcnt(8)
    v_mfma_f32_16x16x32_bf16 v[40:43], a[240:243], a[120:123], v[40:43]
    s_waitcnt vmcnt(11)
    s_barrier
    ds_read_b128 a[152:155], v22 offset:38912
    buffer_load_dwordx4 v9, s[32:35], s43 offen offset:3072 lds
    s_waitcnt lgkmcnt(8)
    v_mfma_f32_16x16x32_bf16 v[40:43], a[244:247], a[148:151], v[40:43]
    ds_read_b64_tr_b16 v[88:89], v20 offset:0
    s_add_u32 m0, s42, 20480
    s_waitcnt lgkmcnt(8)
    v_mfma_f32_16x16x32_bf16 v[40:43], a[248:251], a[176:179], v[40:43]
    ds_read_b128 a[180:183], v22 offset:46080
    s_mov_b32 s43, 115072
    s_waitcnt lgkmcnt(8)
    v_mfma_f32_16x16x32_bf16 v[40:43], a[252:255], a[204:207], v[40:43]
    ds_read_b64_tr_b16 v[90:91], v20 offset:2048
    v_mul_f32 v38, v26, v38
    s_waitcnt lgkmcnt(8)
    v_mfma_f32_16x16x32_bf16 v[44:47], a[224:227], a[12:15], 0
    ds_read_b128 a[208:211], v22 offset:53248
    v_mul_f32 v39, v26, v39
    s_waitcnt lgkmcnt(8)
    v_mfma_f32_16x16x32_bf16 v[44:47], a[228:231], a[40:43], v[44:47]
    ds_read_b128 a[16:19], v22 offset:4096
    v_cvt_pk_bf16_f32 v146, v36, v37
    s_waitcnt lgkmcnt(8)
    v_mfma_f32_16x16x32_bf16 v[44:47], a[232:235], a[68:71], v[44:47]
    ds_read_b64_tr_b16 v[92:93], v20 offset:24576
    buffer_load_dwordx4 v9, s[32:35], s43 offen offset:0 lds
    s_waitcnt lgkmcnt(8)
    v_mfma_f32_16x16x32_bf16 v[44:47], a[236:239], a[96:99], v[44:47]
    ds_read_b128 a[44:47], v22 offset:11264
    s_mov_b32 s43, 121216
    s_waitcnt lgkmcnt(8)
    v_mfma_f32_16x16x32_bf16 v[44:47], a[240:243], a[124:127], v[44:47]
    v_cvt_pk_bf16_f32 v147, v38, v39
    buffer_store_dwordx4 v[144:147], v10, s[36:39], s48 offen offset:0 sc1
    s_waitcnt lgkmcnt(7)
    v_mfma_f32_16x16x32_bf16 v[44:47], a[244:247], a[152:155], v[44:47]
    ds_read_b128 a[72:75], v22 offset:18432
    v_mul_f32 v40, v27, v40
    s_waitcnt lgkmcnt(6)
    v_mfma_f32_16x16x32_bf16 v[44:47], a[248:251], a[180:183], v[44:47]
    ds_read_b64_tr_b16 v[94:95], v20 offset:26624
    v_mul_f32 v41, v27, v41
    ds_read_b128 a[100:103], v22 offset:25600
    s_waitcnt lgkmcnt(6)
    v_mfma_f32_16x16x32_bf16 v[44:47], a[252:255], a[208:211], v[44:47]
    ds_read_b128 a[128:131], v22 offset:32768
    v_mul_f32 v42, v27, v42
    s_waitcnt lgkmcnt(6)
    v_mfma_f32_16x16x32_bf16 v[48:51], a[224:227], a[16:19], 0
    ds_read_b64_tr_b16 v[96:97], v21 offset:0
    buffer_load_dwordx4 v9, s[32:35], s43 offen offset:1024 lds
    ds_read_b128 a[156:159], v22 offset:39936
    s_waitcnt lgkmcnt(6)
    v_mfma_f32_16x16x32_bf16 v[48:51], a[228:231], a[44:47], v[48:51]
    ds_read_b64_tr_b16 v[98:99], v21 offset:2048
    s_mov_b32 s43, 127360
    ds_read_b128 a[184:187], v22 offset:47104
    s_waitcnt lgkmcnt(7)
    v_mfma_f32_16x16x32_bf16 v[48:51], a[232:235], a[72:75], v[48:51]
    ds_read_b128 a[212:215], v22 offset:54272
    v_mul_f32 v43, v27, v43
    s_waitcnt lgkmcnt(6)
    v_mfma_f32_16x16x32_bf16 v[48:51], a[236:239], a[100:103], v[48:51]
    ds_read_b64_tr_b16 v[100:101], v21 offset:24576
    v_cvt_pk_bf16_f32 v148, v40, v41
    ds_read_b128 a[20:23], v22 offset:5120
    s_waitcnt lgkmcnt(7)
    v_mfma_f32_16x16x32_bf16 v[48:51], a[240:243], a[128:131], v[48:51]
    ds_read_b128 a[48:51], v22 offset:12288
    v_cvt_pk_bf16_f32 v149, v42, v43
    s_waitcnt lgkmcnt(6)
    v_mfma_f32_16x16x32_bf16 v[48:51], a[244:247], a[156:159], v[48:51]
    ds_read_b64_tr_b16 v[102:103], v21 offset:26624
    v_mul_f32 v44, v28, v44
    ds_read_b128 a[76:79], v22 offset:19456
    s_waitcnt lgkmcnt(6)
    v_mfma_f32_16x16x32_bf16 v[48:51], a[248:251], a[184:187], v[48:51]
    ds_read_b128 a[104:107], v22 offset:26624
    buffer_load_dwordx4 v9, s[32:35], s43 offen offset:2048 lds
    s_waitcnt lgkmcnt(6)
    v_mfma_f32_16x16x32_bf16 v[48:51], a[252:255], a[212:215], v[48:51]
    ds_read_b64_tr_b16 v[104:105], v20 offset:4096
    s_mov_b32 s43, 133504
    ds_read_b128 a[132:135], v22 offset:33792
    s_waitcnt lgkmcnt(6)
    v_mfma_f32_16x16x32_bf16 v[52:55], a[224:227], a[20:23], 0
    ds_read_b64_tr_b16 v[106:107], v20 offset:6144
    v_mul_f32 v45, v28, v45
    ds_read_b128 a[160:163], v22 offset:40960
    s_waitcnt lgkmcnt(7)
    v_mfma_f32_16x16x32_bf16 v[52:55], a[228:231], a[48:51], v[52:55]
    ds_read_b128 a[188:191], v22 offset:48128
    v_mul_f32 v46, v28, v46
    s_waitcnt lgkmcnt(6)
    v_mfma_f32_16x16x32_bf16 v[52:55], a[232:235], a[76:79], v[52:55]
    ds_read_b64_tr_b16 v[108:109], v20 offset:28672
    v_mul_f32 v47, v28, v47
    ds_read_b128 a[216:219], v22 offset:55296
    s_waitcnt lgkmcnt(7)
    v_mfma_f32_16x16x32_bf16 v[52:55], a[236:239], a[104:107], v[52:55]
    ds_read_b128 a[24:27], v22 offset:6144
    v_cvt_pk_bf16_f32 v150, v44, v45
    s_waitcnt lgkmcnt(6)
    v_mfma_f32_16x16x32_bf16 v[52:55], a[240:243], a[132:135], v[52:55]
    v_cvt_pk_bf16_f32 v151, v46, v47
    buffer_store_dwordx4 v[148:151], v10, s[36:39], s48 offen offset:1024 sc1
    ds_read_b64_tr_b16 v[110:111], v20 offset:30720
    ds_read_b128 a[52:55], v22 offset:13312
    s_waitcnt lgkmcnt(6)
    v_mfma_f32_16x16x32_bf16 v[52:55], a[244:247], a[160:163], v[52:55]
    ds_read_b128 a[80:83], v22 offset:20480
    buffer_load_dwordx4 v9, s[32:35], s43 offen offset:3072 lds
    s_waitcnt lgkmcnt(6)
    v_mfma_f32_16x16x32_bf16 v[52:55], a[248:251], a[188:191], v[52:55]
    ds_read_b64_tr_b16 v[112:113], v21 offset:4096
    v_mul_f32 v48, v29, v48
    ds_read_b128 a[108:111], v22 offset:27648
    s_waitcnt lgkmcnt(6)
    v_mfma_f32_16x16x32_bf16 v[52:55], a[252:255], a[216:219], v[52:55]
    ds_read_b64_tr_b16 v[114:115], v21 offset:6144
    v_mul_f32 v49, v29, v49
    ds_read_b128 a[136:139], v22 offset:34816
    s_waitcnt lgkmcnt(7)
    v_mfma_f32_16x16x32_bf16 v[56:59], a[224:227], a[24:27], 0
    ds_read_b128 a[164:167], v22 offset:41984
    v_mul_f32 v50, v29, v50
    s_waitcnt lgkmcnt(6)
    v_mfma_f32_16x16x32_bf16 v[56:59], a[228:231], a[52:55], v[56:59]
    ds_read_b64_tr_b16 v[116:117], v21 offset:28672
    v_mul_f32 v51, v29, v51
    ds_read_b128 a[192:195], v22 offset:49152
    s_waitcnt lgkmcnt(7)
    v_mfma_f32_16x16x32_bf16 v[56:59], a[232:235], a[80:83], v[56:59]
    ds_read_b128 a[220:223], v22 offset:56320
    v_cvt_pk_bf16_f32 v152, v48, v49
    s_waitcnt lgkmcnt(6)
    v_mfma_f32_16x16x32_bf16 v[56:59], a[236:239], a[108:111], v[56:59]
    ds_read_b64_tr_b16 v[118:119], v21 offset:30720
    v_cvt_pk_bf16_f32 v153, v50, v51
    s_waitcnt lgkmcnt(5)
    v_mfma_f32_16x16x32_bf16 v[56:59], a[240:243], a[136:139], v[56:59]
    v_mul_f32 v52, v30, v52
    v_mul_f32 v53, v30, v53
    s_waitcnt lgkmcnt(4)
    v_mfma_f32_16x16x32_bf16 v[56:59], a[244:247], a[164:167], v[56:59]
    v_mul_f32 v54, v30, v54
    v_mul_f32 v55, v30, v55
    s_waitcnt lgkmcnt(2)
    v_mfma_f32_16x16x32_bf16 v[56:59], a[248:251], a[192:195], v[56:59]
    s_waitcnt lgkmcnt(0)
    s_waitcnt vmcnt(10)
    s_barrier
    s_add_u32 m0, s45, 0
    s_mov_b32 s43, 512
    v_mfma_f32_16x16x32_bf16 v[56:59], a[252:255], a[220:223], v[56:59]
    buffer_load_dwordx4 v9, s[32:35], s43 offen offset:0 lds
    v_mfma_f32_16x16x32_bf16 v[60:63], v[88:91], a[0:3], 0
    s_mov_b32 s43, 6656
    v_cvt_pk_bf16_f32 v154, v52, v53
    v_mfma_f32_16x16x32_bf16 v[60:63], v[92:95], a[28:31], v[60:63]
    v_cvt_pk_bf16_f32 v155, v54, v55
    v_lshlrev_b32 v0, 20, v10
    v_mfma_f32_16x16x32_bf16 v[60:63], v[96:99], a[56:59], v[60:63]
    buffer_store_dwordx4 v[152:155], v10, s[36:39], s48 offen offset:2048 sc1
    v_mfma_f32_16x16x32_bf16 v[60:63], v[100:103], a[84:87], v[60:63]
    buffer_load_dwordx4 v9, s[32:35], s43 offen offset:1024 lds
    v_mfma_f32_16x16x32_bf16 v[60:63], v[104:107], a[112:115], v[60:63]
    s_mov_b32 s43, 12800
    v_mul_f32 v56, v31, v56
    v_mfma_f32_16x16x32_bf16 v[60:63], v[108:111], a[140:143], v[60:63]
    v_mul_f32 v57, v31, v57
    v_mul_f32 v58, v31, v58
    v_mfma_f32_16x16x32_bf16 v[60:63], v[112:115], a[168:171], v[60:63]
    v_mul_f32 v59, v31, v59
    v_cvt_pk_bf16_f32 v156, v56, v57
    v_mfma_f32_16x16x32_bf16 v[60:63], v[116:119], a[196:199], v[60:63]
    buffer_load_dwordx4 v9, s[32:35], s43 offen offset:2048 lds
    v_mfma_f32_16x16x32_bf16 v[64:67], v[88:91], a[4:7], 0
    ds_read_b64_tr_b16 a[224:225], v20 offset:8192
    s_mov_b32 s43, 18944
    v_mfma_f32_16x16x32_bf16 v[64:67], v[92:95], a[32:35], v[64:67]
    ds_read_b64_tr_b16 a[226:227], v20 offset:10240
    v_cvt_pk_bf16_f32 v157, v58, v59
    v_mfma_f32_16x16x32_bf16 v[64:67], v[96:99], a[60:63], v[64:67]
    ds_read_b64_tr_b16 a[228:229], v20 offset:32768
    v_mul_f32 v60, v25, v60
    v_mfma_f32_16x16x32_bf16 v[64:67], v[100:103], a[88:91], v[64:67]
    buffer_load_dwordx4 v9, s[32:35], s43 offen offset:3072 lds
    v_mfma_f32_16x16x32_bf16 v[64:67], v[104:107], a[116:119], v[64:67]
    buffer_store_dwordx2 v[156:157], v5, s[36:39], s48 offen offset:3072 sc1
    v_mfma_f32_16x16x32_bf16 v[64:67], v[108:111], a[144:147], v[64:67]
    ds_read_b64_tr_b16 a[230:231], v20 offset:34816
    s_add_u32 m0, s45, 16384
    v_mfma_f32_16x16x32_bf16 v[64:67], v[112:115], a[172:175], v[64:67]
    ds_read_b64_tr_b16 a[232:233], v21 offset:8192
    s_mov_b32 s43, 115200
    v_mfma_f32_16x16x32_bf16 v[64:67], v[116:119], a[200:203], v[64:67]
    buffer_load_dwordx4 v9, s[32:35], s43 offen offset:0 lds
    v_mfma_f32_16x16x32_bf16 v[68:71], v[88:91], a[8:11], 0
    ds_read_b64_tr_b16 a[234:235], v21 offset:10240
    s_mov_b32 s43, 121344
    v_mfma_f32_16x16x32_bf16 v[68:71], v[92:95], a[36:39], v[68:71]
    ds_read_b64_tr_b16 a[236:237], v21 offset:32768
    v_mul_f32 v61, v25, v61
    v_mfma_f32_16x16x32_bf16 v[68:71], v[96:99], a[64:67], v[68:71]
    ds_read_b64_tr_b16 a[238:239], v21 offset:34816
    v_mul_f32 v62, v25, v62
    v_mfma_f32_16x16x32_bf16 v[68:71], v[100:103], a[92:95], v[68:71]
    buffer_load_dwordx4 v9, s[32:35], s43 offen offset:1024 lds
    v_mfma_f32_16x16x32_bf16 v[68:71], v[104:107], a[120:123], v[68:71]
    ds_read_b64_tr_b16 a[240:241], v20 offset:12288
    s_mov_b32 s43, 127488
    v_mfma_f32_16x16x32_bf16 v[68:71], v[108:111], a[148:151], v[68:71]
    ds_read_b64_tr_b16 a[242:243], v20 offset:14336
    v_mul_f32 v63, v25, v63
    v_mfma_f32_16x16x32_bf16 v[68:71], v[112:115], a[176:179], v[68:71]
    ds_read_b64_tr_b16 a[244:245], v20 offset:36864
    v_cvt_pk_bf16_f32 v160, v60, v61
    v_mfma_f32_16x16x32_bf16 v[68:71], v[116:119], a[204:207], v[68:71]
    buffer_load_dwordx4 v9, s[32:35], s43 offen offset:2048 lds
    v_mfma_f32_16x16x32_bf16 v[72:75], v[88:91], a[12:15], 0
    ds_read_b64_tr_b16 a[246:247], v20 offset:38912
    s_mov_b32 s43, 133632
    v_mfma_f32_16x16x32_bf16 v[72:75], v[92:95], a[40:43], v[72:75]
    ds_read_b64_tr_b16 a[248:249], v21 offset:12288
    v_cvt_pk_bf16_f32 v161, v62, v63
    v_mfma_f32_16x16x32_bf16 v[72:75], v[96:99], a[68:71], v[72:75]
    s_waitcnt lgkmcnt(9)
    ds_read_b64_tr_b16 a[250:251], v21 offset:14336
    v_mul_f32 v64, v26, v64
    v_mfma_f32_16x16x32_bf16 v[72:75], v[100:103], a[96:99], v[72:75]
    buffer_load_dwordx4 v9, s[32:35], s43 offen offset:3072 lds
    v_mfma_f32_16x16x32_bf16 v[72:75], v[104:107], a[124:127], v[72:75]
    v_mul_f32 v65, v26, v65
    v_mul_f32 v66, v26, v66
    v_mul_f32 v67, v26, v67
    v_cvt_pk_bf16_f32 v162, v64, v65
    v_cvt_pk_bf16_f32 v163, v66, v67
    buffer_store_dwordx4 v[160:163], v10, s[36:39], s49 offen offset:0 sc1
    v_mfma_f32_16x16x32_bf16 v[72:75], v[108:111], a[152:155], v[72:75]
    ds_read_b64_tr_b16 a[252:253], v21 offset:36864
    s_add_u32 m0, s45, 32768
    v_mfma_f32_16x16x32_bf16 v[72:75], v[112:115], a[180:183], v[72:75]
    ds_read_b64_tr_b16 a[254:255], v21 offset:38912
    s_mov_b32 s43, 640
    v_mfma_f32_16x16x32_bf16 v[72:75], v[116:119], a[208:211], v[72:75]
    buffer_load_dwordx4 v9, s[32:35], s43 offen offset:0 lds
    v_mfma_f32_16x16x32_bf16 v[76:79], v[88:91], a[16:19], 0
    s_mov_b32 s43, 6784
    v_mul_f32 v68, v27, v68
    v_mfma_f32_16x16x32_bf16 v[76:79], v[92:95], a[44:47], v[76:79]
    v_mul_f32 v69, v27, v69
    v_mul_f32 v70, v27, v70
    v_mfma_f32_16x16x32_bf16 v[76:79], v[96:99], a[72:75], v[76:79]
    v_mul_f32 v71, v27, v71
    v_cvt_pk_bf16_f32 v164, v68, v69
    v_mfma_f32_16x16x32_bf16 v[76:79], v[100:103], a[100:103], v[76:79]
    buffer_load_dwordx4 v9, s[32:35], s43 offen offset:1024 lds
    v_mfma_f32_16x16x32_bf16 v[76:79], v[104:107], a[128:131], v[76:79]
    s_mov_b32 s43, 12928
    v_cvt_pk_bf16_f32 v165, v70, v71
    v_mfma_f32_16x16x32_bf16 v[76:79], v[108:111], a[156:159], v[76:79]
    v_mul_f32 v72, v28, v72
    v_mul_f32 v73, v28, v73
    v_mfma_f32_16x16x32_bf16 v[76:79], v[112:115], a[184:187], v[76:79]
    v_mul_f32 v74, v28, v74
    v_mul_f32 v75, v28, v75
    v_mfma_f32_16x16x32_bf16 v[76:79], v[116:119], a[212:215], v[76:79]
    buffer_load_dwordx4 v9, s[32:35], s43 offen offset:2048 lds
    v_mfma_f32_16x16x32_bf16 v[80:83], v[88:91], a[20:23], 0
    s_mov_b32 s43, 19072
    v_cvt_pk_bf16_f32 v166, v72, v73
    v_mfma_f32_16x16x32_bf16 v[80:83], v[92:95], a[48:51], v[80:83]
    v_cvt_pk_bf16_f32 v167, v74, v75
    v_mfma_f32_16x16x32_bf16 v[80:83], v[96:99], a[76:79], v[80:83]
    buffer_store_dwordx4 v[164:167], v10, s[36:39], s49 offen offset:1024 sc1
    v_mfma_f32_16x16x32_bf16 v[80:83], v[100:103], a[104:107], v[80:83]
    buffer_load_dwordx4 v9, s[32:35], s43 offen offset:3072 lds
    v_mfma_f32_16x16x32_bf16 v[80:83], v[104:107], a[132:135], v[80:83]
    s_add_u32 m0, s45, 49152
    s_mov_b32 s43, 115328
    v_mfma_f32_16x16x32_bf16 v[80:83], v[108:111], a[160:163], v[80:83]
    v_mul_f32 v76, v29, v76
    v_mul_f32 v77, v29, v77
    v_mfma_f32_16x16x32_bf16 v[80:83], v[112:115], a[188:191], v[80:83]
    v_mul_f32 v78, v29, v78
    v_mul_f32 v79, v29, v79
    v_mfma_f32_16x16x32_bf16 v[80:83], v[116:119], a[216:219], v[80:83]
    buffer_load_dwordx4 v9, s[32:35], s43 offen offset:0 lds
    v_mfma_f32_16x16x32_bf16 v[84:87], v[88:91], a[24:27], 0
    s_mov_b32 s43, 121472
    v_cvt_pk_bf16_f32 v168, v76, v77
    v_mfma_f32_16x16x32_bf16 v[84:87], v[92:95], a[52:55], v[84:87]
    v_cvt_pk_bf16_f32 v169, v78, v79
    v_mfma_f32_16x16x32_bf16 v[84:87], v[96:99], a[80:83], v[84:87]
    v_mfma_f32_16x16x32_bf16 v[84:87], v[100:103], a[108:111], v[84:87]
    buffer_load_dwordx4 v9, s[32:35], s43 offen offset:1024 lds
    v_mfma_f32_16x16x32_bf16 v[84:87], v[104:107], a[136:139], v[84:87]
    s_mov_b32 s43, 127616
    v_mul_f32 v80, v30, v80
    v_mfma_f32_16x16x32_bf16 v[84:87], v[108:111], a[164:167], v[84:87]
    v_mul_f32 v81, v30, v81
    v_mul_f32 v82, v30, v82
    v_mfma_f32_16x16x32_bf16 v[84:87], v[112:115], a[192:195], v[84:87]
    v_mul_f32 v83, v30, v83
    v_cvt_pk_bf16_f32 v170, v80, v81
    v_mfma_f32_16x16x32_bf16 v[84:87], v[116:119], a[220:223], v[84:87]
    buffer_load_dwordx4 v9, s[32:35], s43 offen offset:2048 lds
    v_mfma_f32_16x16x32_bf16 v[32:35], a[224:227], a[0:3], 0
    s_mov_b32 s43, 133760
    v_cvt_pk_bf16_f32 v171, v82, v83
    v_mfma_f32_16x16x32_bf16 v[32:35], a[228:231], a[28:31], v[32:35]
    buffer_store_dwordx4 v[168:171], v10, s[36:39], s49 offen offset:2048 sc1
    s_waitcnt lgkmcnt(10)
    v_mfma_f32_16x16x32_bf16 v[32:35], a[232:235], a[56:59], v[32:35]
    v_mul_f32 v84, v31, v84
    v_mul_f32 v85, v31, v85
    s_waitcnt lgkmcnt(8)
    v_mfma_f32_16x16x32_bf16 v[32:35], a[236:239], a[84:87], v[32:35]
    buffer_load_dwordx4 v9, s[32:35], s43 offen offset:3072 lds
    s_waitcnt lgkmcnt(6)
    v_mfma_f32_16x16x32_bf16 v[32:35], a[240:243], a[112:115], v[32:35]
    s_add_u32 m0, s42, 0
    s_mov_b32 s43, 768
    s_waitcnt lgkmcnt(4)
    v_mfma_f32_16x16x32_bf16 v[32:35], a[244:247], a[140:143], v[32:35]
    v_mul_f32 v86, v31, v86
    v_mul_f32 v87, v31, v87
    s_waitcnt lgkmcnt(2)
    v_mfma_f32_16x16x32_bf16 v[32:35], a[248:251], a[168:171], v[32:35]
    v_cvt_pk_bf16_f32 v172, v84, v85
    v_cvt_pk_bf16_f32 v173, v86, v87
    s_waitcnt lgkmcnt(0)
    v_mfma_f32_16x16x32_bf16 v[32:35], a[252:255], a[196:199], v[32:35]
    buffer_load_dwordx4 v9, s[32:35], s43 offen offset:0 lds
    v_mfma_f32_16x16x32_bf16 v[36:39], a[224:227], a[4:7], 0
    s_mov_b32 s43, 6912
    v_mfma_f32_16x16x32_bf16 v[36:39], a[228:231], a[32:35], v[36:39]
    buffer_store_dwordx2 v[172:173], v5, s[36:39], s49 offen offset:3072 sc1
    v_mfma_f32_16x16x32_bf16 v[36:39], a[232:235], a[60:63], v[36:39]
    v_mfma_f32_16x16x32_bf16 v[36:39], a[236:239], a[88:91], v[36:39]
    buffer_load_dwordx4 v9, s[32:35], s43 offen offset:1024 lds
    v_mfma_f32_16x16x32_bf16 v[36:39], a[240:243], a[116:119], v[36:39]
    s_mov_b32 s43, 13056
    v_mul_f32 v32, v25, v32
    v_mfma_f32_16x16x32_bf16 v[36:39], a[244:247], a[144:147], v[36:39]
    v_mul_f32 v33, v25, v33
    v_mul_f32 v34, v25, v34
    v_mfma_f32_16x16x32_bf16 v[36:39], a[248:251], a[172:175], v[36:39]
    v_mul_f32 v35, v25, v35
    v_cvt_pk_bf16_f32 v176, v32, v33
    v_mfma_f32_16x16x32_bf16 v[36:39], a[252:255], a[200:203], v[36:39]
    buffer_load_dwordx4 v9, s[32:35], s43 offen offset:2048 lds
    v_mfma_f32_16x16x32_bf16 v[40:43], a[224:227], a[8:11], 0
    s_mov_b32 s43, 19200
    v_cvt_pk_bf16_f32 v177, v34, v35
    v_mfma_f32_16x16x32_bf16 v[40:43], a[228:231], a[36:39], v[40:43]
    v_mfma_f32_16x16x32_bf16 v[40:43], a[232:235], a[64:67], v[40:43]
    v_mfma_f32_16x16x32_bf16 v[40:43], a[236:239], a[92:95], v[40:43]
    buffer_load_dwordx4 v9, s[32:35], s43 offen offset:3072 lds
    v_mfma_f32_16x16x32_bf16 v[40:43], a[240:243], a[120:123], v[40:43]
    s_add_u32 m0, s42, 4096
    s_mov_b32 s43, 115456
    v_mfma_f32_16x16x32_bf16 v[40:43], a[244:247], a[148:151], v[40:43]
    v_mul_f32 v36, v26, v36
    v_mul_f32 v37, v26, v37
    v_mfma_f32_16x16x32_bf16 v[40:43], a[248:251], a[176:179], v[40:43]
    v_mul_f32 v38, v26, v38
    v_mul_f32 v39, v26, v39
    v_mfma_f32_16x16x32_bf16 v[40:43], a[252:255], a[204:207], v[40:43]
    buffer_load_dwordx4 v9, s[32:35], s43 offen offset:0 lds
    v_mfma_f32_16x16x32_bf16 v[44:47], a[224:227], a[12:15], 0
    s_waitcnt vmcnt(27)
    s_barrier
    ds_read_b64_tr_b16 v[88:89], v20 offset:16384
    s_mov_b32 s43, 121600
    v_mfma_f32_16x16x32_bf16 v[44:47], a[228:231], a[40:43], v[44:47]
    ds_read_b64_tr_b16 v[90:91], v20 offset:18432
    v_cvt_pk_bf16_f32 v178, v36, v37
    v_mfma_f32_16x16x32_bf16 v[44:47], a[232:235], a[68:71], v[44:47]
    ds_read_b64_tr_b16 v[92:93], v20 offset:40960
    v_cvt_pk_bf16_f32 v179, v38, v39
    v_mfma_f32_16x16x32_bf16 v[44:47], a[236:239], a[96:99], v[44:47]
    buffer_load_dwordx4 v9, s[32:35], s43 offen offset:1024 lds
    v_mfma_f32_16x16x32_bf16 v[44:47], a[240:243], a[124:127], v[44:47]
    buffer_store_dwordx4 v[176:179], v10, s[36:39], s50 offen offset:0 sc1
    v_mfma_f32_16x16x32_bf16 v[44:47], a[244:247], a[152:155], v[44:47]
    ds_read_b64_tr_b16 v[94:95], v20 offset:43008
    s_mov_b32 s43, 127744
    v_mfma_f32_16x16x32_bf16 v[44:47], a[248:251], a[180:183], v[44:47]
    ds_read_b64_tr_b16 v[96:97], v21 offset:16384
    v_mul_f32 v40, v27, v40
    v_mfma_f32_16x16x32_bf16 v[44:47], a[252:255], a[208:211], v[44:47]
    buffer_load_dwordx4 v9, s[32:35], s43 offen offset:2048 lds
    v_mfma_f32_16x16x32_bf16 v[48:51], a[224:227], a[16:19], 0
    ds_read_b64_tr_b16 v[98:99], v21 offset:18432
    s_mov_b32 s43, 133888
    v_mfma_f32_16x16x32_bf16 v[48:51], a[228:231], a[44:47], v[48:51]
    ds_read_b64_tr_b16 v[100:101], v21 offset:40960
    v_mul_f32 v41, v27, v41
    v_mfma_f32_16x16x32_bf16 v[48:51], a[232:235], a[72:75], v[48:51]
    ds_read_b64_tr_b16 v[102:103], v21 offset:43008
    v_mul_f32 v42, v27, v42
    v_mfma_f32_16x16x32_bf16 v[48:51], a[236:239], a[100:103], v[48:51]
    buffer_load_dwordx4 v9, s[32:35], s43 offen offset:3072 lds
    v_mfma_f32_16x16x32_bf16 v[48:51], a[240:243], a[128:131], v[48:51]
    ds_read_b64_tr_b16 v[104:105], v20 offset:20480
    v_mul_f32 v43, v27, v43
    v_mfma_f32_16x16x32_bf16 v[48:51], a[244:247], a[156:159], v[48:51]
    ds_read_b64_tr_b16 v[106:107], v20 offset:22528
    v_cvt_pk_bf16_f32 v180, v40, v41
    v_mfma_f32_16x16x32_bf16 v[48:51], a[248:251], a[184:187], v[48:51]
    ds_read_b64_tr_b16 v[108:109], v20 offset:45056
    v_cvt_pk_bf16_f32 v181, v42, v43
    v_mfma_f32_16x16x32_bf16 v[48:51], a[252:255], a[212:215], v[48:51]
    ds_read_b64_tr_b16 v[110:111], v20 offset:47104
    v_mul_f32 v44, v28, v44
    v_mfma_f32_16x16x32_bf16 v[52:55], a[224:227], a[20:23], 0
    ds_read_b64_tr_b16 v[112:113], v21 offset:20480
    v_mul_f32 v45, v28, v45
    v_mfma_f32_16x16x32_bf16 v[52:55], a[228:231], a[48:51], v[52:55]
    s_waitcnt lgkmcnt(9)
    ds_read_b64_tr_b16 v[114:115], v21 offset:22528
    v_mul_f32 v46, v28, v46
    v_mfma_f32_16x16x32_bf16 v[52:55], a[232:235], a[76:79], v[52:55]
    ds_read_b64_tr_b16 v[116:117], v21 offset:45056
    v_mul_f32 v47, v28, v47
    v_mfma_f32_16x16x32_bf16 v[52:55], a[236:239], a[104:107], v[52:55]
    ds_read_b64_tr_b16 v[118:119], v21 offset:47104
    v_cvt_pk_bf16_f32 v182, v44, v45
    v_mfma_f32_16x16x32_bf16 v[52:55], a[240:243], a[132:135], v[52:55]
    v_cvt_pk_bf16_f32 v183, v46, v47
    buffer_store_dwordx4 v[180:183], v10, s[36:39], s50 offen offset:1024 sc1
    v_mfma_f32_16x16x32_bf16 v[52:55], a[244:247], a[160:163], v[52:55]
    v_mul_f32 v48, v29, v48
    v_mul_f32 v49, v29, v49
    v_mfma_f32_16x16x32_bf16 v[52:55], a[248:251], a[188:191], v[52:55]
    v_mul_f32 v50, v29, v50
    v_mul_f32 v51, v29, v51
    v_mfma_f32_16x16x32_bf16 v[52:55], a[252:255], a[216:219], v[52:55]
    v_cvt_pk_bf16_f32 v184, v48, v49
    v_cvt_pk_bf16_f32 v185, v50, v51
    v_mfma_f32_16x16x32_bf16 v[56:59], a[224:227], a[24:27], 0
    v_mfma_f32_16x16x32_bf16 v[56:59], a[228:231], a[52:55], v[56:59]
    v_mfma_f32_16x16x32_bf16 v[56:59], a[232:235], a[80:83], v[56:59]
    v_mfma_f32_16x16x32_bf16 v[56:59], a[236:239], a[108:111], v[56:59]
    v_mfma_f32_16x16x32_bf16 v[56:59], a[240:243], a[136:139], v[56:59]
    v_mfma_f32_16x16x32_bf16 v[56:59], a[244:247], a[164:167], v[56:59]
    v_mul_f32 v52, v30, v52
    v_mul_f32 v53, v30, v53
    v_mfma_f32_16x16x32_bf16 v[56:59], a[248:251], a[192:195], v[56:59]
    v_mul_f32 v54, v30, v54
    v_mul_f32 v55, v30, v55
    v_mfma_f32_16x16x32_bf16 v[56:59], a[252:255], a[220:223], v[56:59]
    v_cvt_pk_bf16_f32 v186, v52, v53
    v_cvt_pk_bf16_f32 v187, v54, v55
    v_mfma_f32_16x16x32_bf16 v[60:63], v[88:91], a[0:3], 0
    buffer_store_dwordx4 v[184:187], v10, s[36:39], s50 offen offset:2048 sc1
    v_mfma_f32_16x16x32_bf16 v[60:63], v[92:95], a[28:31], v[60:63]
    s_waitcnt lgkmcnt(10)
    v_mfma_f32_16x16x32_bf16 v[60:63], v[96:99], a[56:59], v[60:63]
    s_waitcnt lgkmcnt(8)
    v_mfma_f32_16x16x32_bf16 v[60:63], v[100:103], a[84:87], v[60:63]
    v_mul_f32 v56, v31, v56
    v_mul_f32 v57, v31, v57
    s_waitcnt lgkmcnt(6)
    v_mfma_f32_16x16x32_bf16 v[60:63], v[104:107], a[112:115], v[60:63]
    v_mul_f32 v58, v31, v58
    v_mul_f32 v59, v31, v59
    s_waitcnt lgkmcnt(4)
    v_mfma_f32_16x16x32_bf16 v[60:63], v[108:111], a[140:143], v[60:63]
    v_cvt_pk_bf16_f32 v188, v56, v57
    v_cvt_pk_bf16_f32 v189, v58, v59
    s_waitcnt lgkmcnt(2)
    v_mfma_f32_16x16x32_bf16 v[60:63], v[112:115], a[168:171], v[60:63]
    buffer_store_dwordx2 v[188:189], v5, s[36:39], s50 offen offset:3072 sc1
    s_waitcnt lgkmcnt(0)
    v_mfma_f32_16x16x32_bf16 v[60:63], v[116:119], a[196:199], v[60:63]
    v_mfma_f32_16x16x32_bf16 v[64:67], v[88:91], a[4:7], 0
    v_mfma_f32_16x16x32_bf16 v[64:67], v[92:95], a[32:35], v[64:67]
    v_mfma_f32_16x16x32_bf16 v[64:67], v[96:99], a[60:63], v[64:67]
    v_mfma_f32_16x16x32_bf16 v[64:67], v[100:103], a[88:91], v[64:67]
    v_mfma_f32_16x16x32_bf16 v[64:67], v[104:107], a[116:119], v[64:67]
    v_mfma_f32_16x16x32_bf16 v[64:67], v[108:111], a[144:147], v[64:67]
    v_mfma_f32_16x16x32_bf16 v[64:67], v[112:115], a[172:175], v[64:67]
    v_mfma_f32_16x16x32_bf16 v[64:67], v[116:119], a[200:203], v[64:67]
    v_mul_f32 v60, v25, v60
    v_mul_f32 v61, v25, v61
    v_mfma_f32_16x16x32_bf16 v[68:71], v[88:91], a[8:11], 0
    v_mul_f32 v62, v25, v62
    v_mul_f32 v63, v25, v63
    v_mfma_f32_16x16x32_bf16 v[68:71], v[92:95], a[36:39], v[68:71]
    v_cvt_pk_bf16_f32 v192, v60, v61
    v_cvt_pk_bf16_f32 v193, v62, v63
    v_mfma_f32_16x16x32_bf16 v[68:71], v[96:99], a[64:67], v[68:71]
    v_mul_f32 v64, v26, v64
    v_mul_f32 v65, v26, v65
    v_mfma_f32_16x16x32_bf16 v[68:71], v[100:103], a[92:95], v[68:71]
    v_mul_f32 v66, v26, v66
    v_mul_f32 v67, v26, v67
    v_mfma_f32_16x16x32_bf16 v[68:71], v[104:107], a[120:123], v[68:71]
    v_cvt_pk_bf16_f32 v194, v64, v65
    v_cvt_pk_bf16_f32 v195, v66, v67
    v_mfma_f32_16x16x32_bf16 v[68:71], v[108:111], a[148:151], v[68:71]
    buffer_store_dwordx4 v[192:195], v10, s[36:39], s51 offen offset:0 sc1
    v_mfma_f32_16x16x32_bf16 v[68:71], v[112:115], a[176:179], v[68:71]
    v_mfma_f32_16x16x32_bf16 v[68:71], v[116:119], a[204:207], v[68:71]
    v_mfma_f32_16x16x32_bf16 v[72:75], v[88:91], a[12:15], 0
    s_waitcnt vmcnt(25)
    s_barrier
    ds_read_b64_tr_b16 a[224:225], v12 offset:0
    v_mfma_f32_16x16x32_bf16 v[72:75], v[92:95], a[40:43], v[72:75]
    ds_read_b64_tr_b16 a[226:227], v12 offset:2048
    v_mfma_f32_16x16x32_bf16 v[72:75], v[96:99], a[68:71], v[72:75]
    ds_read_b64_tr_b16 a[228:229], v12 offset:4096
    v_mul_f32 v68, v27, v68
    v_mfma_f32_16x16x32_bf16 v[72:75], v[100:103], a[96:99], v[72:75]
    ds_read_b64_tr_b16 a[230:231], v12 offset:6144
    v_mul_f32 v69, v27, v69
    v_mfma_f32_16x16x32_bf16 v[72:75], v[104:107], a[124:127], v[72:75]
    ds_read_b64_tr_b16 a[232:233], v12 offset:8192
    v_mul_f32 v70, v27, v70
    v_mfma_f32_16x16x32_bf16 v[72:75], v[108:111], a[152:155], v[72:75]
    ds_read_b64_tr_b16 a[234:235], v12 offset:10240
    v_mul_f32 v71, v27, v71
    v_mfma_f32_16x16x32_bf16 v[72:75], v[112:115], a[180:183], v[72:75]
    ds_read_b64_tr_b16 a[236:237], v12 offset:12288
    v_cvt_pk_bf16_f32 v196, v68, v69
    v_mfma_f32_16x16x32_bf16 v[72:75], v[116:119], a[208:211], v[72:75]
    ds_read_b64_tr_b16 a[238:239], v12 offset:14336
    v_cvt_pk_bf16_f32 v197, v70, v71
    v_mfma_f32_16x16x32_bf16 v[76:79], v[88:91], a[16:19], 0
    ds_read_b64_tr_b16 a[240:241], v12 offset:16384
    v_mfma_f32_16x16x32_bf16 v[76:79], v[92:95], a[44:47], v[76:79]
    ds_read_b64_tr_b16 a[242:243], v12 offset:18432
    v_mfma_f32_16x16x32_bf16 v[76:79], v[96:99], a[72:75], v[76:79]
    ds_read_b64_tr_b16 a[244:245], v12 offset:20480
    v_mul_f32 v72, v28, v72
    v_mfma_f32_16x16x32_bf16 v[76:79], v[100:103], a[100:103], v[76:79]
    ds_read_b64_tr_b16 a[246:247], v12 offset:22528
    v_mul_f32 v73, v28, v73
    v_mfma_f32_16x16x32_bf16 v[76:79], v[104:107], a[128:131], v[76:79]
    ds_read_b64_tr_b16 a[248:249], v12 offset:24576
    v_mul_f32 v74, v28, v74
    v_mfma_f32_16x16x32_bf16 v[76:79], v[108:111], a[156:159], v[76:79]
    s_waitcnt lgkmcnt(9)
    ds_read_b64_tr_b16 a[250:251], v12 offset:26624
    v_mul_f32 v75, v28, v75
    v_mfma_f32_16x16x32_bf16 v[76:79], v[112:115], a[184:187], v[76:79]
    ds_read_b64_tr_b16 a[252:253], v12 offset:28672
    v_cvt_pk_bf16_f32 v198, v72, v73
    v_mfma_f32_16x16x32_bf16 v[76:79], v[116:119], a[212:215], v[76:79]
    ds_read_b64_tr_b16 a[254:255], v12 offset:30720
    v_cvt_pk_bf16_f32 v199, v74, v75
    v_mfma_f32_16x16x32_bf16 v[80:83], v[88:91], a[20:23], 0
    buffer_store_dwordx4 v[196:199], v10, s[36:39], s51 offen offset:1024 sc1
    v_mfma_f32_16x16x32_bf16 v[80:83], v[92:95], a[48:51], v[80:83]
    v_mfma_f32_16x16x32_bf16 v[80:83], v[96:99], a[76:79], v[80:83]
    v_mfma_f32_16x16x32_bf16 v[80:83], v[100:103], a[104:107], v[80:83]
    v_mfma_f32_16x16x32_bf16 v[80:83], v[104:107], a[132:135], v[80:83]
    v_mul_f32 v76, v29, v76
    v_mul_f32 v77, v29, v77
    v_mfma_f32_16x16x32_bf16 v[80:83], v[108:111], a[160:163], v[80:83]
    v_mul_f32 v78, v29, v78
    v_mul_f32 v79, v29, v79
    v_mfma_f32_16x16x32_bf16 v[80:83], v[112:115], a[188:191], v[80:83]
    v_cvt_pk_bf16_f32 v200, v76, v77
    v_cvt_pk_bf16_f32 v201, v78, v79
    v_mfma_f32_16x16x32_bf16 v[80:83], v[116:119], a[216:219], v[80:83]
    v_mfma_f32_16x16x32_bf16 v[84:87], v[88:91], a[24:27], 0
    v_mfma_f32_16x16x32_bf16 v[84:87], v[92:95], a[52:55], v[84:87]
    v_mfma_f32_16x16x32_bf16 v[84:87], v[96:99], a[80:83], v[84:87]
    v_mfma_f32_16x16x32_bf16 v[84:87], v[100:103], a[108:111], v[84:87]
    v_mfma_f32_16x16x32_bf16 v[84:87], v[104:107], a[136:139], v[84:87]
    v_mfma_f32_16x16x32_bf16 v[84:87], v[108:111], a[164:167], v[84:87]
    v_mfma_f32_16x16x32_bf16 v[84:87], v[112:115], a[192:195], v[84:87]
    v_mfma_f32_16x16x32_bf16 v[84:87], v[116:119], a[220:223], v[84:87]
    v_mul_f32 v80, v30, v80
    v_mul_f32 v81, v30, v81
    v_mfma_f32_16x16x32_bf16 v[32:35], a[224:227], a[0:3], 0
    v_mul_f32 v82, v30, v82
    v_mul_f32 v83, v30, v83
    v_mfma_f32_16x16x32_bf16 v[32:35], a[228:231], a[28:31], v[32:35]
    v_cvt_pk_bf16_f32 v202, v80, v81
    v_cvt_pk_bf16_f32 v203, v82, v83
    s_waitcnt lgkmcnt(10)
    v_mfma_f32_16x16x32_bf16 v[32:35], a[232:235], a[56:59], v[32:35]
    buffer_store_dwordx4 v[200:203], v10, s[36:39], s51 offen offset:2048 sc1
    s_waitcnt lgkmcnt(8)
    v_mfma_f32_16x16x32_bf16 v[32:35], a[236:239], a[84:87], v[32:35]
    v_mul_f32 v84, v31, v84
    v_mul_f32 v85, v31, v85
    s_waitcnt lgkmcnt(6)
    v_mfma_f32_16x16x32_bf16 v[32:35], a[240:243], a[112:115], v[32:35]
    v_mul_f32 v86, v31, v86
    v_mul_f32 v87, v31, v87
    s_waitcnt lgkmcnt(4)
    v_mfma_f32_16x16x32_bf16 v[32:35], a[244:247], a[140:143], v[32:35]
    v_cvt_pk_bf16_f32 v204, v84, v85
    v_cvt_pk_bf16_f32 v205, v86, v87
    s_waitcnt lgkmcnt(2)
    v_mfma_f32_16x16x32_bf16 v[32:35], a[248:251], a[168:171], v[32:35]
    s_waitcnt lgkmcnt(0)
    v_mfma_f32_16x16x32_bf16 v[32:35], a[252:255], a[196:199], v[32:35]
    v_mfma_f32_16x16x32_bf16 v[36:39], a[224:227], a[4:7], 0
    buffer_store_dwordx2 v[204:205], v5, s[36:39], s51 offen offset:3072 sc1
    v_mfma_f32_16x16x32_bf16 v[36:39], a[228:231], a[32:35], v[36:39]
    v_mfma_f32_16x16x32_bf16 v[36:39], a[232:235], a[60:63], v[36:39]
    v_mfma_f32_16x16x32_bf16 v[36:39], a[236:239], a[88:91], v[36:39]
    s_waitcnt vmcnt(4)
    v_and_b32 v4, -16, v4
    v_add_u32 v4, 19, v4
    buffer_store_dword v4, v0, s[12:15], 0 offen sc1
    v_mul_f32 v32, v25, v32
    v_mul_f32 v33, v25, v33
    v_mfma_f32_16x16x32_bf16 v[36:39], a[240:243], a[116:119], v[36:39]
    v_mul_f32 v34, v25, v34
    v_mul_f32 v35, v25, v35
    v_mfma_f32_16x16x32_bf16 v[36:39], a[244:247], a[144:147], v[36:39]
    v_cvt_pk_bf16_f32 v208, v32, v33
    v_cvt_pk_bf16_f32 v209, v34, v35
    v_mfma_f32_16x16x32_bf16 v[36:39], a[248:251], a[172:175], v[36:39]
    v_mfma_f32_16x16x32_bf16 v[36:39], a[252:255], a[200:203], v[36:39]
    v_mfma_f32_16x16x32_bf16 v[40:43], a[224:227], a[8:11], 0
    v_mfma_f32_16x16x32_bf16 v[40:43], a[228:231], a[36:39], v[40:43]
    v_mfma_f32_16x16x32_bf16 v[40:43], a[232:235], a[64:67], v[40:43]
    v_mfma_f32_16x16x32_bf16 v[40:43], a[236:239], a[92:95], v[40:43]
    v_mfma_f32_16x16x32_bf16 v[40:43], a[240:243], a[120:123], v[40:43]
    v_mfma_f32_16x16x32_bf16 v[40:43], a[244:247], a[148:151], v[40:43]
    v_mfma_f32_16x16x32_bf16 v[40:43], a[248:251], a[176:179], v[40:43]
    v_mfma_f32_16x16x32_bf16 v[40:43], a[252:255], a[204:207], v[40:43]
    v_mul_f32 v36, v26, v36
    v_mul_f32 v37, v26, v37
    v_mfma_f32_16x16x32_bf16 v[44:47], a[224:227], a[12:15], 0
    s_barrier
    ds_read_b64_tr_b16 v[88:89], v12 offset:32768
    v_mul_f32 v38, v26, v38
    v_mfma_f32_16x16x32_bf16 v[44:47], a[228:231], a[40:43], v[44:47]
    ds_read_b64_tr_b16 v[90:91], v12 offset:34816
    v_mul_f32 v39, v26, v39
    v_mfma_f32_16x16x32_bf16 v[44:47], a[232:235], a[68:71], v[44:47]
    ds_read_b64_tr_b16 v[92:93], v12 offset:36864
    v_cvt_pk_bf16_f32 v210, v36, v37
    v_mfma_f32_16x16x32_bf16 v[44:47], a[236:239], a[96:99], v[44:47]
    ds_read_b64_tr_b16 v[94:95], v12 offset:38912
    v_cvt_pk_bf16_f32 v211, v38, v39
    v_mfma_f32_16x16x32_bf16 v[44:47], a[240:243], a[124:127], v[44:47]
    buffer_store_dwordx4 v[208:211], v10, s[36:39], s52 offen offset:0 sc1
    v_mfma_f32_16x16x32_bf16 v[44:47], a[244:247], a[152:155], v[44:47]
    ds_read_b64_tr_b16 v[96:97], v12 offset:40960
    v_mul_f32 v40, v27, v40
    v_mfma_f32_16x16x32_bf16 v[44:47], a[248:251], a[180:183], v[44:47]
    ds_read_b64_tr_b16 v[98:99], v12 offset:43008
    v_mul_f32 v41, v27, v41
    v_mfma_f32_16x16x32_bf16 v[44:47], a[252:255], a[208:211], v[44:47]
    ds_read_b64_tr_b16 v[100:101], v12 offset:45056
    v_mul_f32 v42, v27, v42
    v_mfma_f32_16x16x32_bf16 v[48:51], a[224:227], a[16:19], 0
    ds_read_b64_tr_b16 v[102:103], v12 offset:47104
    v_mul_f32 v43, v27, v43
    v_mfma_f32_16x16x32_bf16 v[48:51], a[228:231], a[44:47], v[48:51]
    ds_read_b64_tr_b16 v[104:105], v12 offset:49152
    v_cvt_pk_bf16_f32 v212, v40, v41
    v_mfma_f32_16x16x32_bf16 v[48:51], a[232:235], a[72:75], v[48:51]
    ds_read_b64_tr_b16 v[106:107], v12 offset:51200
    v_cvt_pk_bf16_f32 v213, v42, v43
    v_mfma_f32_16x16x32_bf16 v[48:51], a[236:239], a[100:103], v[48:51]
    ds_read_b64_tr_b16 v[108:109], v12 offset:53248
    v_mul_f32 v44, v28, v44
    v_mfma_f32_16x16x32_bf16 v[48:51], a[240:243], a[128:131], v[48:51]
    ds_read_b64_tr_b16 v[110:111], v12 offset:55296
    v_mul_f32 v45, v28, v45
    v_mfma_f32_16x16x32_bf16 v[48:51], a[244:247], a[156:159], v[48:51]
    ds_read_b64_tr_b16 v[112:113], v12 offset:57344
    v_mul_f32 v46, v28, v46
    v_mfma_f32_16x16x32_bf16 v[48:51], a[248:251], a[184:187], v[48:51]
    s_waitcnt lgkmcnt(9)
    ds_read_b64_tr_b16 v[114:115], v12 offset:59392
    v_mul_f32 v47, v28, v47
    v_mfma_f32_16x16x32_bf16 v[48:51], a[252:255], a[212:215], v[48:51]
    ds_read_b64_tr_b16 v[116:117], v12 offset:61440
    v_cvt_pk_bf16_f32 v214, v44, v45
    v_mfma_f32_16x16x32_bf16 v[52:55], a[224:227], a[20:23], 0
    ds_read_b64_tr_b16 v[118:119], v12 offset:63488
    v_cvt_pk_bf16_f32 v215, v46, v47
    v_mfma_f32_16x16x32_bf16 v[52:55], a[228:231], a[48:51], v[52:55]
    buffer_store_dwordx4 v[212:215], v10, s[36:39], s52 offen offset:1024 sc1
    v_mfma_f32_16x16x32_bf16 v[52:55], a[232:235], a[76:79], v[52:55]
    v_mul_f32 v48, v29, v48
    v_mul_f32 v49, v29, v49
    v_mfma_f32_16x16x32_bf16 v[52:55], a[236:239], a[104:107], v[52:55]
    v_mul_f32 v50, v29, v50
    v_mul_f32 v51, v29, v51
    v_mfma_f32_16x16x32_bf16 v[52:55], a[240:243], a[132:135], v[52:55]
    v_cvt_pk_bf16_f32 v216, v48, v49
    v_cvt_pk_bf16_f32 v217, v50, v51
    v_mfma_f32_16x16x32_bf16 v[52:55], a[244:247], a[160:163], v[52:55]
    v_mfma_f32_16x16x32_bf16 v[52:55], a[248:251], a[188:191], v[52:55]
    v_mfma_f32_16x16x32_bf16 v[52:55], a[252:255], a[216:219], v[52:55]
    v_mfma_f32_16x16x32_bf16 v[56:59], a[224:227], a[24:27], 0
    v_mfma_f32_16x16x32_bf16 v[56:59], a[228:231], a[52:55], v[56:59]
    v_mfma_f32_16x16x32_bf16 v[56:59], a[232:235], a[80:83], v[56:59]
    v_mfma_f32_16x16x32_bf16 v[56:59], a[236:239], a[108:111], v[56:59]
    v_mfma_f32_16x16x32_bf16 v[56:59], a[240:243], a[136:139], v[56:59]
    v_mfma_f32_16x16x32_bf16 v[56:59], a[244:247], a[164:167], v[56:59]
    v_mfma_f32_16x16x32_bf16 v[56:59], a[248:251], a[192:195], v[56:59]
    v_mfma_f32_16x16x32_bf16 v[56:59], a[252:255], a[220:223], v[56:59]
    v_mul_f32 v52, v30, v52
    v_mul_f32 v53, v30, v53
    v_mfma_f32_16x16x32_bf16 v[60:63], v[88:91], a[0:3], 0
    v_mul_f32 v54, v30, v54
    v_mul_f32 v55, v30, v55
    v_mfma_f32_16x16x32_bf16 v[60:63], v[92:95], a[28:31], v[60:63]
    v_cvt_pk_bf16_f32 v218, v52, v53
    v_cvt_pk_bf16_f32 v219, v54, v55
    s_waitcnt lgkmcnt(10)
    v_mfma_f32_16x16x32_bf16 v[60:63], v[96:99], a[56:59], v[60:63]
    buffer_store_dwordx4 v[216:219], v10, s[36:39], s52 offen offset:2048 sc1
    s_waitcnt lgkmcnt(8)
    v_mfma_f32_16x16x32_bf16 v[60:63], v[100:103], a[84:87], v[60:63]
    v_mul_f32 v56, v31, v56
    v_mul_f32 v57, v31, v57
    s_waitcnt lgkmcnt(6)
    v_mfma_f32_16x16x32_bf16 v[60:63], v[104:107], a[112:115], v[60:63]
    v_mul_f32 v58, v31, v58
    v_mul_f32 v59, v31, v59
    s_waitcnt lgkmcnt(4)
    v_mfma_f32_16x16x32_bf16 v[60:63], v[108:111], a[140:143], v[60:63]
    v_cvt_pk_bf16_f32 v220, v56, v57
    v_cvt_pk_bf16_f32 v221, v58, v59
    s_waitcnt lgkmcnt(2)
    v_mfma_f32_16x16x32_bf16 v[60:63], v[112:115], a[168:171], v[60:63]
    s_waitcnt lgkmcnt(0)
    v_mfma_f32_16x16x32_bf16 v[60:63], v[116:119], a[196:199], v[60:63]
    v_mfma_f32_16x16x32_bf16 v[64:67], v[88:91], a[4:7], 0
    buffer_store_dwordx2 v[220:221], v5, s[36:39], s52 offen offset:3072 sc1
    v_mfma_f32_16x16x32_bf16 v[64:67], v[92:95], a[32:35], v[64:67]
    v_mfma_f32_16x16x32_bf16 v[64:67], v[96:99], a[60:63], v[64:67]
    v_mfma_f32_16x16x32_bf16 v[64:67], v[100:103], a[88:91], v[64:67]
    v_mfma_f32_16x16x32_bf16 v[64:67], v[104:107], a[116:119], v[64:67]
    v_mfma_f32_16x16x32_bf16 v[64:67], v[108:111], a[144:147], v[64:67]
    v_mfma_f32_16x16x32_bf16 v[64:67], v[112:115], a[172:175], v[64:67]
    v_mul_f32 v60, v25, v60
    v_mul_f32 v61, v25, v61
    v_mfma_f32_16x16x32_bf16 v[64:67], v[116:119], a[200:203], v[64:67]
    v_mul_f32 v62, v25, v62
    v_mul_f32 v63, v25, v63
    v_mfma_f32_16x16x32_bf16 v[68:71], v[88:91], a[8:11], 0
    v_cvt_pk_bf16_f32 v224, v60, v61
    v_cvt_pk_bf16_f32 v225, v62, v63
    v_mfma_f32_16x16x32_bf16 v[68:71], v[92:95], a[36:39], v[68:71]
    v_mfma_f32_16x16x32_bf16 v[68:71], v[96:99], a[64:67], v[68:71]
    v_mfma_f32_16x16x32_bf16 v[68:71], v[100:103], a[92:95], v[68:71]
    v_mul_f32 v64, v26, v64
    v_mul_f32 v65, v26, v65
    v_mfma_f32_16x16x32_bf16 v[68:71], v[104:107], a[120:123], v[68:71]
    v_mul_f32 v66, v26, v66
    v_mul_f32 v67, v26, v67
    v_mfma_f32_16x16x32_bf16 v[68:71], v[108:111], a[148:151], v[68:71]
    v_cvt_pk_bf16_f32 v226, v64, v65
    v_cvt_pk_bf16_f32 v227, v66, v67
    v_mfma_f32_16x16x32_bf16 v[68:71], v[112:115], a[176:179], v[68:71]
    buffer_store_dwordx4 v[224:227], v10, s[36:39], s53 offen offset:0 sc1
    v_mfma_f32_16x16x32_bf16 v[68:71], v[116:119], a[204:207], v[68:71]
    v_mfma_f32_16x16x32_bf16 v[72:75], v[88:91], a[12:15], 0
    s_barrier
    ds_read_b64_tr_b16 a[224:225], v20 offset:0
    v_mfma_f32_16x16x32_bf16 v[72:75], v[92:95], a[40:43], v[72:75]
    ds_read_b64_tr_b16 a[226:227], v20 offset:2048
    v_mfma_f32_16x16x32_bf16 v[72:75], v[96:99], a[68:71], v[72:75]
    ds_read_b64_tr_b16 a[228:229], v20 offset:24576
    v_mfma_f32_16x16x32_bf16 v[72:75], v[100:103], a[96:99], v[72:75]
    ds_read_b64_tr_b16 a[230:231], v20 offset:26624
    v_mul_f32 v68, v27, v68
    v_mfma_f32_16x16x32_bf16 v[72:75], v[104:107], a[124:127], v[72:75]
    ds_read_b64_tr_b16 a[232:233], v21 offset:0
    v_mul_f32 v69, v27, v69
    v_mfma_f32_16x16x32_bf16 v[72:75], v[108:111], a[152:155], v[72:75]
    ds_read_b64_tr_b16 a[234:235], v21 offset:2048
    v_mul_f32 v70, v27, v70
    v_mfma_f32_16x16x32_bf16 v[72:75], v[112:115], a[180:183], v[72:75]
    ds_read_b64_tr_b16 a[236:237], v21 offset:24576
    v_mul_f32 v71, v27, v71
    v_mfma_f32_16x16x32_bf16 v[72:75], v[116:119], a[208:211], v[72:75]
    ds_read_b64_tr_b16 a[238:239], v21 offset:26624
    v_cvt_pk_bf16_f32 v228, v68, v69
    v_mfma_f32_16x16x32_bf16 v[76:79], v[88:91], a[16:19], 0
    ds_read_b64_tr_b16 a[240:241], v20 offset:4096
    v_cvt_pk_bf16_f32 v229, v70, v71
    v_mfma_f32_16x16x32_bf16 v[76:79], v[92:95], a[44:47], v[76:79]
    ds_read_b64_tr_b16 a[242:243], v20 offset:6144
    v_mfma_f32_16x16x32_bf16 v[76:79], v[96:99], a[72:75], v[76:79]
    ds_read_b64_tr_b16 a[244:245], v20 offset:28672
    v_mul_f32 v72, v28, v72
    v_mfma_f32_16x16x32_bf16 v[76:79], v[100:103], a[100:103], v[76:79]
    ds_read_b64_tr_b16 a[246:247], v20 offset:30720
    v_mul_f32 v73, v28, v73
    v_mfma_f32_16x16x32_bf16 v[76:79], v[104:107], a[128:131], v[76:79]
    ds_read_b64_tr_b16 a[248:249], v21 offset:4096
    v_mul_f32 v74, v28, v74
    v_mfma_f32_16x16x32_bf16 v[76:79], v[108:111], a[156:159], v[76:79]
    s_waitcnt lgkmcnt(9)
    ds_read_b64_tr_b16 a[250:251], v21 offset:6144
    v_mul_f32 v75, v28, v75
    v_mfma_f32_16x16x32_bf16 v[76:79], v[112:115], a[184:187], v[76:79]
    ds_read_b64_tr_b16 a[252:253], v21 offset:28672
    v_cvt_pk_bf16_f32 v230, v72, v73
    v_mfma_f32_16x16x32_bf16 v[76:79], v[116:119], a[212:215], v[76:79]
    ds_read_b64_tr_b16 a[254:255], v21 offset:30720
    v_cvt_pk_bf16_f32 v231, v74, v75
    v_mfma_f32_16x16x32_bf16 v[80:83], v[88:91], a[20:23], 0
    buffer_store_dwordx4 v[228:231], v10, s[36:39], s53 offen offset:1024 sc1
    v_mfma_f32_16x16x32_bf16 v[80:83], v[92:95], a[48:51], v[80:83]
    v_mfma_f32_16x16x32_bf16 v[80:83], v[96:99], a[76:79], v[80:83]
    v_mfma_f32_16x16x32_bf16 v[80:83], v[100:103], a[104:107], v[80:83]
    v_mfma_f32_16x16x32_bf16 v[80:83], v[104:107], a[132:135], v[80:83]
    v_mul_f32 v76, v29, v76
    v_mul_f32 v77, v29, v77
    v_mfma_f32_16x16x32_bf16 v[80:83], v[108:111], a[160:163], v[80:83]
    v_mul_f32 v78, v29, v78
    v_mul_f32 v79, v29, v79
    v_mfma_f32_16x16x32_bf16 v[80:83], v[112:115], a[188:191], v[80:83]
    v_cvt_pk_bf16_f32 v232, v76, v77
    v_cvt_pk_bf16_f32 v233, v78, v79
    v_mfma_f32_16x16x32_bf16 v[80:83], v[116:119], a[216:219], v[80:83]
    v_mfma_f32_16x16x32_bf16 v[84:87], v[88:91], a[24:27], 0
    v_mfma_f32_16x16x32_bf16 v[84:87], v[92:95], a[52:55], v[84:87]
    v_mfma_f32_16x16x32_bf16 v[84:87], v[96:99], a[80:83], v[84:87]
    v_mfma_f32_16x16x32_bf16 v[84:87], v[100:103], a[108:111], v[84:87]
    v_mfma_f32_16x16x32_bf16 v[84:87], v[104:107], a[136:139], v[84:87]
    v_mfma_f32_16x16x32_bf16 v[84:87], v[108:111], a[164:167], v[84:87]
    v_mfma_f32_16x16x32_bf16 v[84:87], v[112:115], a[192:195], v[84:87]
    v_mfma_f32_16x16x32_bf16 v[84:87], v[116:119], a[220:223], v[84:87]
    v_mul_f32 v80, v30, v80
    v_mul_f32 v81, v30, v81
    v_mfma_f32_16x16x32_bf16 v[32:35], a[224:227], a[0:3], 0
    v_mul_f32 v82, v30, v82
    v_mul_f32 v83, v30, v83
    v_mfma_f32_16x16x32_bf16 v[32:35], a[228:231], a[28:31], v[32:35]
    v_cvt_pk_bf16_f32 v234, v80, v81
    v_cvt_pk_bf16_f32 v235, v82, v83
    s_waitcnt lgkmcnt(10)
    v_mfma_f32_16x16x32_bf16 v[32:35], a[232:235], a[56:59], v[32:35]
    buffer_store_dwordx4 v[232:235], v10, s[36:39], s53 offen offset:2048 sc1
    s_waitcnt lgkmcnt(8)
    v_mfma_f32_16x16x32_bf16 v[32:35], a[236:239], a[84:87], v[32:35]
    v_mul_f32 v84, v31, v84
    v_mul_f32 v85, v31, v85
    s_waitcnt lgkmcnt(6)
    v_mfma_f32_16x16x32_bf16 v[32:35], a[240:243], a[112:115], v[32:35]
    v_mul_f32 v86, v31, v86
    v_mul_f32 v87, v31, v87
    s_waitcnt lgkmcnt(4)
    v_mfma_f32_16x16x32_bf16 v[32:35], a[244:247], a[140:143], v[32:35]
    v_cvt_pk_bf16_f32 v236, v84, v85
    v_cvt_pk_bf16_f32 v237, v86, v87
    s_waitcnt lgkmcnt(2)
    v_mfma_f32_16x16x32_bf16 v[32:35], a[248:251], a[168:171], v[32:35]
    s_waitcnt lgkmcnt(0)
    v_mfma_f32_16x16x32_bf16 v[32:35], a[252:255], a[196:199], v[32:35]
    v_mfma_f32_16x16x32_bf16 v[36:39], a[224:227], a[4:7], 0
    buffer_store_dwordx2 v[236:237], v5, s[36:39], s53 offen offset:3072 sc1
    v_mfma_f32_16x16x32_bf16 v[36:39], a[228:231], a[32:35], v[36:39]
    v_mfma_f32_16x16x32_bf16 v[36:39], a[232:235], a[60:63], v[36:39]
    v_mfma_f32_16x16x32_bf16 v[36:39], a[236:239], a[88:91], v[36:39]
    v_mfma_f32_16x16x32_bf16 v[36:39], a[240:243], a[116:119], v[36:39]
    v_mfma_f32_16x16x32_bf16 v[36:39], a[244:247], a[144:147], v[36:39]
    v_mfma_f32_16x16x32_bf16 v[36:39], a[248:251], a[172:175], v[36:39]
    v_mul_f32 v32, v25, v32
    v_mul_f32 v33, v25, v33
    v_mfma_f32_16x16x32_bf16 v[36:39], a[252:255], a[200:203], v[36:39]
    v_mul_f32 v34, v25, v34
    v_mul_f32 v35, v25, v35
    v_mfma_f32_16x16x32_bf16 v[40:43], a[224:227], a[8:11], 0
    v_cvt_pk_bf16_f32 v240, v32, v33
    v_cvt_pk_bf16_f32 v241, v34, v35
    v_mfma_f32_16x16x32_bf16 v[40:43], a[228:231], a[36:39], v[40:43]
    v_mfma_f32_16x16x32_bf16 v[40:43], a[232:235], a[64:67], v[40:43]
    v_mfma_f32_16x16x32_bf16 v[40:43], a[236:239], a[92:95], v[40:43]
    v_mul_f32 v36, v26, v36
    v_mul_f32 v37, v26, v37
    v_mfma_f32_16x16x32_bf16 v[40:43], a[240:243], a[120:123], v[40:43]
    v_mul_f32 v38, v26, v38
    v_mul_f32 v39, v26, v39
    v_mfma_f32_16x16x32_bf16 v[40:43], a[244:247], a[148:151], v[40:43]
    v_cvt_pk_bf16_f32 v242, v36, v37
    v_cvt_pk_bf16_f32 v243, v38, v39
    v_mfma_f32_16x16x32_bf16 v[40:43], a[248:251], a[176:179], v[40:43]
    buffer_store_dwordx4 v[240:243], v10, s[36:39], s54 offen offset:0 sc1
    v_mfma_f32_16x16x32_bf16 v[40:43], a[252:255], a[204:207], v[40:43]
    v_mfma_f32_16x16x32_bf16 v[44:47], a[224:227], a[12:15], 0
    v_mfma_f32_16x16x32_bf16 v[44:47], a[228:231], a[40:43], v[44:47]
    v_mfma_f32_16x16x32_bf16 v[44:47], a[232:235], a[68:71], v[44:47]
    v_mfma_f32_16x16x32_bf16 v[44:47], a[236:239], a[96:99], v[44:47]
    v_mfma_f32_16x16x32_bf16 v[44:47], a[240:243], a[124:127], v[44:47]
    v_mfma_f32_16x16x32_bf16 v[44:47], a[244:247], a[152:155], v[44:47]
    v_mfma_f32_16x16x32_bf16 v[44:47], a[248:251], a[180:183], v[44:47]
    v_mfma_f32_16x16x32_bf16 v[44:47], a[252:255], a[208:211], v[44:47]
    v_mul_f32 v40, v27, v40
    v_mul_f32 v41, v27, v41
    v_mfma_f32_16x16x32_bf16 v[48:51], a[224:227], a[16:19], 0
    v_mul_f32 v42, v27, v42
    v_mul_f32 v43, v27, v43
    v_mfma_f32_16x16x32_bf16 v[48:51], a[228:231], a[44:47], v[48:51]
    v_cvt_pk_bf16_f32 v244, v40, v41
    v_cvt_pk_bf16_f32 v245, v42, v43
    v_mfma_f32_16x16x32_bf16 v[48:51], a[232:235], a[72:75], v[48:51]
    v_mul_f32 v44, v28, v44
    v_mul_f32 v45, v28, v45
    v_mfma_f32_16x16x32_bf16 v[48:51], a[236:239], a[100:103], v[48:51]
    v_mul_f32 v46, v28, v46
    v_mul_f32 v47, v28, v47
    v_mfma_f32_16x16x32_bf16 v[48:51], a[240:243], a[128:131], v[48:51]
    v_cvt_pk_bf16_f32 v246, v44, v45
    v_cvt_pk_bf16_f32 v247, v46, v47
    v_mfma_f32_16x16x32_bf16 v[48:51], a[244:247], a[156:159], v[48:51]
    buffer_store_dwordx4 v[244:247], v10, s[36:39], s54 offen offset:1024 sc1
    v_mfma_f32_16x16x32_bf16 v[48:51], a[248:251], a[184:187], v[48:51]
    v_mfma_f32_16x16x32_bf16 v[48:51], a[252:255], a[212:215], v[48:51]
    v_mfma_f32_16x16x32_bf16 v[52:55], a[224:227], a[20:23], 0
    v_mfma_f32_16x16x32_bf16 v[52:55], a[228:231], a[48:51], v[52:55]
    v_mfma_f32_16x16x32_bf16 v[52:55], a[232:235], a[76:79], v[52:55]
    v_mfma_f32_16x16x32_bf16 v[52:55], a[236:239], a[104:107], v[52:55]
    v_mfma_f32_16x16x32_bf16 v[52:55], a[240:243], a[132:135], v[52:55]
    v_mfma_f32_16x16x32_bf16 v[52:55], a[244:247], a[160:163], v[52:55]
    v_mfma_f32_16x16x32_bf16 v[52:55], a[248:251], a[188:191], v[52:55]
    v_mfma_f32_16x16x32_bf16 v[52:55], a[252:255], a[216:219], v[52:55]
    v_mul_f32 v48, v29, v48
    v_mul_f32 v49, v29, v49
    v_mfma_f32_16x16x32_bf16 v[56:59], a[224:227], a[24:27], 0
    v_mul_f32 v50, v29, v50
    v_mul_f32 v51, v29, v51
    v_mfma_f32_16x16x32_bf16 v[56:59], a[228:231], a[52:55], v[56:59]
    v_cvt_pk_bf16_f32 v248, v48, v49
    v_cvt_pk_bf16_f32 v249, v50, v51
    v_mfma_f32_16x16x32_bf16 v[56:59], a[232:235], a[80:83], v[56:59]
    v_mul_f32 v52, v30, v52
    v_mul_f32 v53, v30, v53
    v_mfma_f32_16x16x32_bf16 v[56:59], a[236:239], a[108:111], v[56:59]
    v_mul_f32 v54, v30, v54
    v_mul_f32 v55, v30, v55
    v_mfma_f32_16x16x32_bf16 v[56:59], a[240:243], a[136:139], v[56:59]
    v_cvt_pk_bf16_f32 v250, v52, v53
    v_cvt_pk_bf16_f32 v251, v54, v55
    v_mfma_f32_16x16x32_bf16 v[56:59], a[244:247], a[164:167], v[56:59]
    buffer_store_dwordx4 v[248:251], v10, s[36:39], s54 offen offset:2048 sc1
    v_mfma_f32_16x16x32_bf16 v[56:59], a[248:251], a[192:195], v[56:59]
    v_mfma_f32_16x16x32_bf16 v[56:59], a[252:255], a[220:223], v[56:59]
    s_nop 7
    v_mul_f32 v56, v31, v56
    v_mul_f32 v57, v31, v57
    v_mul_f32 v58, v31, v58
    v_mul_f32 v59, v31, v59
    v_cvt_pk_bf16_f32 v252, v56, v57
    v_cvt_pk_bf16_f32 v253, v58, v59
    buffer_store_dwordx2 v[252:253], v5, s[36:39], s54 offen offset:3072 sc1
    buffer_load_dword v17, v1, s[8:11], 0 offen sc1
    v_lshrrev_b32 v128, 4, v10
    v_and_b32 v129, 15, v128
    v_lshrrev_b32 v130, 4, v128
    v_lshlrev_b32 v0, 24, v128
    v_and_b32 v131, 16, v10
    v_mov_b32 v132, 0x3f80
    v_lshlrev_b32 v131, v131, v132
    v_bfe_u32 v132, v128, 1, 3
    v_cmp_eq_u32 vcc, 0, v132
    v_cmp_eq_u32 s[24:25], 1, v132
    s_nop 0
    v_cndmask_b32 v120, 0, v131, vcc
    v_cndmask_b32 v121, 0, v131, s[24:25]
    v_cmp_eq_u32 vcc, 2, v132
    v_cmp_eq_u32 s[24:25], 3, v132
    s_nop 0
    v_cndmask_b32 v122, 0, v131, vcc
    v_cndmask_b32 v123, 0, v131, s[24:25]
    v_cmp_eq_u32 vcc, 4, v132
    v_cmp_eq_u32 s[24:25], 5, v132
    s_nop 0
    v_cndmask_b32 v124, 0, v131, vcc
    v_cndmask_b32 v125, 0, v131, s[24:25]
    v_cmp_eq_u32 vcc, 6, v132
    v_cmp_eq_u32 s[24:25], 7, v132
    s_nop 0
    v_cndmask_b32 v126, 0, v131, vcc
    v_cndmask_b32 v127, 0, v131, s[24:25]
    v_and_b32 v131, 7, v128
    v_bfe_u32 v132, v128, 3, 1
    v_mul_u32_u24 v6, 100352, v130
    v_mul_u32_u24 v133, 25088, v132
    v_lshl_add_u32 v6, v131, 4, v6
    v_add_u32 v6, v6, v133
    v_lshl_add_u32 v133, v130, 3, v131
    v_lshlrev_b32 v133, 6, v133
    v_lshl_add_u32 v133, v132, 5, v133
    s_lshl_b32 s40, s3, 3
    s_add_u32 s40, s40, 98304
    v_add_u32 v8, s40, v133
    s_lshl_b32 s40, s3, 10
    s_add_u32 s40, s40, 98304
    v_add_u32 v9, s40, v10
    s_lshr_b32 s24, s55, 1
    s_cmp_eq_u32 s24, 6
    s_cselect_b32 s25, 2, 1
    s_cselect_b32 s26, 1, 16
    v_bfe_u32 v131, v128, 2, 3
    v_lshrrev_b32 v132, 5, v128
    v_mul_u32_u24 v131, s25, v131
    v_mul_u32_u24 v132, s26, v132
    v_add_u32 v131, v131, v132
    v_mul_u32_u24 v131, 896, v131
    v_and_b32 v132, 48, v10
    v_add_u32 v7, v131, v132
    s_lshr_b32 s25, s24, 1
    s_lshl_b32 s25, s25, 5
    s_and_b32 s24, s24, 1
    s_lshl_b32 s24, s24, 3
    s_add_u32 s24, s24, s25
    s_mul_i32 s24, s24, 896
    s_and_b32 s25, s55, 1
    s_lshl_b32 s25, s25, 6
    s_add_u32 s24, s24, s25
    s_lshl_b32 s25, s3, 7
    s_add_u32 s30, s24, s25
    s_cmp_eq_u32 s3, 3
    s_cselect_b32 s31, 0x1000000, s30
    s_waitcnt vmcnt(1)
    v_and_b32 v4, -16, v4
    v_add_u32 v4, 23, v4
    buffer_store_dword v4, v0, s[12:15], 0 offen sc1
    s_waitcnt vmcnt(1)
    v_cmp_ne_u32 vcc, v17, v2
    v_and_b32 v3, 15, v17
    v_cmp_le_u32 s[26:27], 3, v3
    s_and_b64 vcc, vcc, s[26:27]
    s_cmp_eq_u64 vcc, -1
    s_cbranch_scc0 L_spin0
L_spun0:
    s_add_u32 s43, s57, 0
    buffer_load_dwordx4 v[144:147], v6, s[60:63], s43 offen sc1
    s_add_u32 s43, s57, 401408
    buffer_load_dwordx4 v[148:151], v6, s[60:63], s43 offen sc1
    s_add_u32 s43, s57, 802816
    buffer_load_dwordx4 v[152:155], v6, s[60:63], s43 offen sc1
    s_add_u32 s43, s57, 1204224
    buffer_load_dwordx4 v[156:159], v6, s[60:63], s43 offen sc1
    s_add_u32 s43, s57, 3584
    buffer_load_dwordx4 v[160:163], v6, s[60:63], s43 offen sc1
    s_add_u32 s43, s57, 404992
    buffer_load_dwordx4 v[164:167], v6, s[60:63], s43 offen sc1
    s_add_u32 s43, s57, 806400
    buffer_load_dwordx4 v[168:171], v6, s[60:63], s43 offen sc1
    s_add_u32 s43, s57, 1207808
    buffer_load_dwordx4 v[172:175], v6, s[60:63], s43 offen sc1
    buffer_load_dword v18, v1, s[8:11], 0 offen sc1
    s_add_u32 s43, s57, 7168
    buffer_load_dwordx4 v[176:179], v6, s[60:63], s43 offen sc1
    s_add_u32 s43, s57, 408576
    buffer_load_dwordx4 v[180:183], v6, s[60:63], s43 offen sc1
    s_add_u32 s43, s57, 809984
    buffer_load_dwordx4 v[184:187], v6, s[60:63], s43 offen sc1
    s_add_u32 s43, s57, 1211392
    buffer_load_dwordx4 v[188:191], v6, s[60:63], s43 offen sc1
    s_waitcnt vmcnt(12)
    v_mfma_f32_16x16x32_bf16 v[128:131], v[120:123], v[144:147], 0
    s_waitcnt vmcnt(11)
    v_mfma_f32_16x16x32_bf16 v[128:131], v[120:123], v[148:151], v[128:131]
    s_waitcnt vmcnt(10)
    v_mfma_f32_16x16x32_bf16 v[128:131], v[120:123], v[152:155], v[128:131]
    s_waitcnt vmcnt(9)
    v_mfma_f32_16x16x32_bf16 v[128:131], v[120:123], v[156:159], v[128:131]
    s_waitcnt vmcnt(8)
    v_mfma_f32_16x16x32_bf16 v[128:131], v[124:127], v[160:163], v[128:131]
    s_waitcnt vmcnt(7)
    v_mfma_f32_16x16x32_bf16 v[128:131], v[124:127], v[164:167], v[128:131]
    s_waitcnt vmcnt(6)
    v_mfma_f32_16x16x32_bf16 v[128:131], v[124:127], v[168:171], v[128:131]
    s_waitcnt vmcnt(5)
    v_mfma_f32_16x16x32_bf16 v[128:131], v[124:127], v[172:175], v[128:131]
    s_nop 7
    v_cvt_pk_bf16_f32 v128, v128, v129
    v_cvt_pk_bf16_f32 v129, v130, v131
    ds_write_b64 v8, v[128:129] offset:0
    s_waitcnt vmcnt(4)
    v_cmp_ne_u32 vcc, v18, v2
    v_and_b32 v3, 15, v18
    v_cmp_le_u32 s[26:27], 7, v3
    s_and_b64 vcc, vcc, s[26:27]
    s_cmp_eq_u64 vcc, -1
    s_cbranch_scc0 L_spin1
L_spun1:
    s_add_u32 s43, s57, 10752
    buffer_load_dwordx4 v[192:195], v6, s[60:63], s43 offen sc1
    s_add_u32 s43, s57, 412160
    buffer_load_dwordx4 v[196:199], v6, s[60:63], s43 offen sc1
    s_add_u32 s43, s57, 813568
    buffer_load_dwordx4 v[200:203], v6, s[60:63], s43 offen sc1
    s_add_u32 s43, s57, 1214976
    buffer_load_dwordx4 v[204:207], v6, s[60:63], s43 offen sc1
    s_add_u32 s43, s57, 14336
    buffer_load_dwordx4 v[208:211], v6, s[60:63], s43 offen sc1
    s_add_u32 s43, s57, 415744
    buffer_load_dwordx4 v[212:215], v6, s[60:63], s43 offen sc1
    s_add_u32 s43, s57, 817152
    buffer_load_dwordx4 v[216:219], v6, s[60:63], s43 offen sc1
    s_add_u32 s43, s57, 1218560
    buffer_load_dwordx4 v[220:223], v6, s[60:63], s43 offen sc1
    s_add_u32 s43, s57, 17920
    buffer_load_dwordx4 v[224:227], v6, s[60:63], s43 offen sc1
    s_add_u32 s43, s57, 419328
    buffer_load_dwordx4 v[228:231], v6, s[60:63], s43 offen sc1
    s_add_u32 s43, s57, 820736
    buffer_load_dwordx4 v[232:235], v6, s[60:63], s43 offen sc1
    s_add_u32 s43, s57, 1222144
    buffer_load_dwordx4 v[236:239], v6, s[60:63], s43 offen sc1
    s_add_u32 s43, s57, 21504
    buffer_load_dwordx4 v[240:243], v6, s[60:63], s43 offen sc1
    s_add_u32 s43, s57, 422912
    buffer_load_dwordx4 v[244:247], v6, s[60:63], s43 offen sc1
    s_add_u32 s43, s57, 824320
    buffer_load_dwordx4 v[248:251], v6, s[60:63], s43 offen sc1
    s_add_u32 s43, s57, 1225728
    buffer_load_dwordx4 v[252:255], v6, s[60:63], s43 offen sc1
    s_waitcnt vmcnt(19)
    v_mfma_f32_16x16x32_bf16 v[132:135], v[120:123], v[176:179], 0
    s_waitcnt vmcnt(18)
    v_mfma_f32_16x16x32_bf16 v[132:135], v[120:123], v[180:183], v[132:135]
    s_waitcnt vmcnt(17)
    v_mfma_f32_16x16x32_bf16 v[132:135], v[120:123], v[184:187], v[132:135]
    s_waitcnt vmcnt(16)
    v_mfma_f32_16x16x32_bf16 v[132:135], v[120:123], v[188:191], v[132:135]
    s_waitcnt vmcnt(15)
    v_mfma_f32_16x16x32_bf16 v[132:135], v[124:127], v[192:195], v[132:135]
    s_waitcnt vmcnt(14)
    v_mfma_f32_16x16x32_bf16 v[132:135], v[124:127], v[196:199], v[132:135]
    s_waitcnt vmcnt(13)
    v_mfma_f32_16x16x32_bf16 v[132:135], v[124:127], v[200:203], v[132:135]
    s_waitcnt vmcnt(12)
    v_mfma_f32_16x16x32_bf16 v[132:135], v[124:127], v[204:207], v[132:135]
    s_waitcnt vmcnt(11)
    v_mfma_f32_16x16x32_bf16 v[136:139], v[120:123], v[208:211], 0
    s_waitcnt vmcnt(10)
    v_mfma_f32_16x16x32_bf16 v[136:139], v[120:123], v[212:215], v[136:139]
    s_waitcnt vmcnt(9)
    v_mfma_f32_16x16x32_bf16 v[136:139], v[120:123], v[216:219], v[136:139]
    s_waitcnt vmcnt(8)
    v_mfma_f32_16x16x32_bf16 v[136:139], v[120:123], v[220:223], v[136:139]
    v_cvt_pk_bf16_f32 v132, v132, v133
    v_cvt_pk_bf16_f32 v133, v134, v135
    ds_write_b64 v8, v[132:133] offset:2048
    s_waitcnt vmcnt(7)
    v_mfma_f32_16x16x32_bf16 v[136:139], v[124:127], v[224:227], v[136:139]
    s_waitcnt vmcnt(6)
    v_mfma_f32_16x16x32_bf16 v[136:139], v[124:127], v[228:231], v[136:139]
    s_waitcnt vmcnt(5)
    v_mfma_f32_16x16x32_bf16 v[136:139], v[124:127], v[232:235], v[136:139]
    s_waitcnt vmcnt(4)
    v_mfma_f32_16x16x32_bf16 v[136:139], v[124:127], v[236:239], v[136:139]
    s_waitcnt vmcnt(3)
    v_mfma_f32_16x16x32_bf16 v[140:143], v[120:123], v[240:243], 0
    s_waitcnt vmcnt(2)
    v_mfma_f32_16x16x32_bf16 v[140:143], v[120:123], v[244:247], v[140:143]
    s_waitcnt vmcnt(1)
    v_mfma_f32_16x16x32_bf16 v[140:143], v[120:123], v[248:251], v[140:143]
    s_waitcnt vmcnt(0)
    v_mfma_f32_16x16x32_bf16 v[140:143], v[120:123], v[252:255], v[140:143]
    v_cvt_pk_bf16_f32 v136, v136, v137
    v_cvt_pk_bf16_f32 v137, v138, v139
    ds_write_b64 v8, v[136:137] offset:4096
    s_nop 4
    v_cvt_pk_bf16_f32 v140, v140, v141
    v_cvt_pk_bf16_f32 v141, v142, v143
    ds_write_b64 v8, v[140:141] offset:6144
    s_waitcnt lgkmcnt(0)
    s_barrier
    ds_read_b128 v[128:131], v9
    ds_read_b128 v[132:135], v9 offset:4096
    s_waitcnt lgkmcnt(1)
    buffer_store_dwordx4 v[128:131], v7, s[64:67], s30 offen
    s_waitcnt lgkmcnt(0)
    buffer_store_dwordx4 v[132:135], v7, s[64:67], s31 offen offset:512
L_exit:
    s_endpgm
L_spin0:
    s_mov_b32 s28, 0
L_spinl0:
    buffer_load_dword v3, v1, s[8:11], 0 offen sc1
    s_waitcnt vmcnt(0)
    v_cmp_ne_u32 vcc, v3, v2
    v_and_b32 v3, 15, v3
    v_cmp_le_u32 s[26:27], 3, v3
    s_and_b64 vcc, vcc, s[26:27]
    s_cmp_eq_u64 vcc, -1
    s_cbranch_scc1 L_spinx0
    s_add_u32 s28, s28, 1
    s_and_b32 s29, s28, 7
    s_cbranch_scc1 L_spinl0
    v_and_b32 v4, -16, v4
    v_add_u32 v4, 23, v4
    buffer_store_dword v4, v0, s[12:15], 0 offen sc1
    s_cmp_lt_u32 s28, 400000
    s_cbranch_scc1 L_spinl0
L_spinx0:
    s_cmp_lt_u32 s28, 8
    s_cbranch_scc1 L_spun0
    v_and_b32 v4, -16, v4
    v_add_u32 v4, 23, v4
    buffer_store_dword v4, v0, s[12:15], 0 offen sc1
    s_waitcnt vmcnt(0)
    s_branch L_spun0
L_spin1:
    s_mov_b32 s28, 0
L_spinl1:
    buffer_load_dword v3, v1, s[8:11], 0 offen sc1
    s_waitcnt vmcnt(0)
    v_cmp_ne_u32 vcc, v3, v2
    v_and_b32 v3, 15, v3
    v_cmp_le_u32 s[26:27], 7, v3
    s_and_b64 vcc, vcc, s[26:27]
    s_cmp_eq_u64 vcc, -1
    s_cbranch_scc1 L_spinx1
    s_add_u32 s28, s28, 1
    s_and_b32 s29, s28, 7
    s_cbranch_scc1 L_spinl1
    v_and_b32 v4, -16, v4
    v_add_u32 v4, 23, v4
    buffer_store_dword v4, v0, s[12:15], 0 offen sc1
    s_cmp_lt_u32 s28, 400000
    s_cbranch_scc1 L_spinl1
L_spinx1:
    s_cmp_lt_u32 s28, 8
    s_cbranch_scc1 L_spun1
    v_and_b32 v4, -16, v4
    v_add_u32 v4, 23, v4
    buffer_store_dword v4, v0, s[12:15], 0 offen sc1
    s_waitcnt vmcnt(0)
    s_branch L_spun1
L_spin2:
    s_mov_b32 s28, 0
L_spinl2:
    buffer_load_dword v3, v1, s[8:11], 0 offen sc1
    s_waitcnt vmcnt(0)
    v_cmp_ne_u32 vcc, v3, v2
    v_and_b32 v3, 15, v3
    v_cmp_le_u32 s[26:27], 7, v3
    s_and_b64 vcc, vcc, s[26:27]
    s_cmp_eq_u64 vcc, -1
    s_cbranch_scc1 L_spinx2
    s_add_u32 s28, s28, 1
    s_and_b32 s29, s28, 7
    s_cbranch_scc1 L_spinl2
    v_and_b32 v4, -16, v4
    v_add_u32 v4, 23, v4
    buffer_store_dword v4, v0, s[12:15], 0 offen sc1
    s_cmp_lt_u32 s28, 400000
    s_cbranch_scc1 L_spinl2
L_spinx2:
    s_cmp_lt_u32 s28, 8
    s_cbranch_scc1 L_spun2
    v_and_b32 v4, -16, v4
    v_add_u32 v4, 23, v4
    buffer_store_dword v4, v0, s[12:15], 0 offen sc1
    s_waitcnt vmcnt(0)
    s_branch L_spun2
L_end:
L_fallback:
    s_waitcnt vmcnt(0) lgkmcnt(0)
    s_nop 15
    s_barrier
    v_accvgpr_write_b32 a250, v2
    v_accvgpr_write_b32 a251, v4
    v_lshrrev_b32 v0, 4, v10
    s_lshl_b32 s40, s3, 6
    v_add_u32 v0, s40, v0
    s_load_dwordx2 s[68:69], s[0:1], 8
    v_lshrrev_b32 v43, 6, v0
    v_and_b32 v1, 63, v0
    v_readfirstlane_b32 s3, v43
    v_lshrrev_b32 v38, 3, v1
    v_and_b32 v39, 7, v1
    v_lshrrev_b32 v40, 5, v1
    v_and_b32 v41, 31, v1
    v_lshrrev_b32 v42, 4, v1
    s_lshl_b32 s42, s3, 12
    v_lshl_add_u32 v32, v43, 5, v38
    v_mul_u32_u24 v33, 896, v32
    v_xor_b32 v34, v39, v42
    v_lshlrev_b32 v34, 4, v34
    v_xor_b32 v35, 64, v34
    v_add_u32 v2, v33, v34
    v_add_u32 v3, v33, v35
    v_add_u32 v4, 12288, v2
    v_add_u32 v5, 18432, v3
    v_add_u32 v3, 6144, v3
    v_lshl_add_u32 v36, v43, 3, v40
    v_lshlrev_b32 v34, 2, v40
    v_xor_b32 v34, v41, v34
    v_lshlrev_b32 v34, 4, v34
    v_xor_b32 v35, 128, v34
    v_lshl_add_u32 v6, v36, 13, v34
    v_lshl_add_u32 v7, v36, 13, v35
    v_add_u32 v8, 30720, v6
    v_add_u32 v9, 46080, v7
    v_add_u32 v7, 15360, v7
    v_lshl_add_u32 v34, v43, 1, v40
    v_xor_b32 v34, v41, v34
    v_lshlrev_b32 v34, 4, v34
    v_xor_b32 v35, 128, v34
    v_lshl_add_u32 v11, v36, 9, v34
    v_lshl_add_u32 v12, v36, 9, v35
    s_waitcnt lgkmcnt(0)
    s_lshl_b32 s70, s58, 3
    s_lshr_b32 s71, s56, 1
    s_add_u32 s70, s70, s71
    s_lshl_b32 s70, s70, 18
    s_add_u32 s24, s68, s70
    s_addc_u32 s25, s69, 0
    s_mov_b32 s26, 262144
    s_mov_b32 s27, 0x20000
    v_and_b32 v34, 1, v42
    v_lshlrev_b32 v34, 2, v34
    v_xor_b32 v34, v39, v34
    v_lshlrev_b32 v37, 4, v34
    v_lshl_add_u32 v10, v32, 13, v37
    s_add_u32 m0, s42, 0
    s_mov_b32 s43, 0
    buffer_load_dwordx4 v2, s[16:19], s43 offen offset:0 lds
    buffer_load_dwordx4 v3, s[16:19], s43 offen offset:1024 lds
    buffer_load_dwordx4 v4, s[16:19], s43 offen offset:2048 lds
    buffer_load_dwordx4 v5, s[16:19], s43 offen offset:3072 lds
    s_add_u32 m0, s42, 16384
    s_mov_b32 s43, 0
    buffer_load_dwordx4 v6, s[20:23], s43 offen offset:0 lds
    buffer_load_dwordx4 v7, s[20:23], s43 offen offset:1024 lds
    buffer_load_dwordx4 v8, s[20:23], s43 offen offset:2048 lds
    buffer_load_dwordx4 v9, s[20:23], s43 offen offset:3072 lds
    s_add_u32 m0, s42, 32768
    s_mov_b32 s43, 262144
    buffer_load_dwordx4 v6, s[20:23], s43 offen offset:0 lds
    buffer_load_dwordx4 v7, s[20:23], s43 offen offset:1024 lds
    buffer_load_dwordx4 v8, s[20:23], s43 offen offset:2048 lds
    buffer_load_dwordx4 v9, s[20:23], s43 offen offset:3072 lds
    s_lshl_b32 s70, s58, 4
    s_add_u32 s70, s70, s56
    s_mul_i32 s70, s70, 100352
    s_add_u32 s36, s6, s70
    s_addc_u32 s37, s7, 0
    s_mov_b32 s38, 100352
    s_mov_b32 s39, 0x20000
    s_mov_b32 s44, 0x3db8aa3b
    s_mov_b32 s45, 0x41a00000
    v_add_u32 v14, v33, v37
    v_and_b32 v34, 1, v38
    v_lshl_add_u32 v34, v42, 3, v34
    v_lshl_add_u32 v34, v43, 5, v34
    v_lshl_add_u32 v13, v34, 9, v37
    v_and_b32 v34, 15, v1
    v_and_b32 v35, 1, v42
    v_mul_u32_u24 v15, 25088, v40
    s_cmp_eq_u32 s3, 3
    s_cbranch_scc1 LF_w3
    v_lshl_add_u32 v15, v34, 4, v15
    v_lshl_add_u32 v15, v35, 3, v15
    v_lshl_add_u32 v15, v43, 10, v15
    s_mov_b32 s70, 256
    s_branch LF_wj
LF_w3:
    v_lshl_add_u32 v15, v34, 3, v15
    v_add_u32 v15, 3072, v15
    v_lshl_add_u32 v15, v35, 30, v15
    s_mov_b32 s70, 128
LF_wj:
    v_add_u32 v125, s70, v15
    v_add_u32 v127, s70, v125
    v_add_u32 v0, s70, v127
    v_bfe_u32 v34, v1, 1, 3
    v_xor_b32 v34, v34, v40
    v_lshlrev_b32 v34, 4, v34
    v_lshl_add_u32 v34, v41, 7, v34
    v_lshl_add_u32 v16, v43, 12, v34
    v_xor_b32 v17, 32, v16
    v_xor_b32 v18, 64, v16
    v_xor_b32 v19, 96, v16
    v_bfe_u32 v44, v1, 2, 2
    v_and_b32 v45, 3, v1
    v_and_b32 v46, 1, v42
    v_and_b32 v34, 1, v45
    v_lshrrev_b32 v35, 1, v45
    v_lshl_add_u32 v47, v34, 1, v35
    v_lshl_add_u32 v47, v46, 2, v47
    v_lshlrev_b32 v47, 3, v47
    v_lshl_add_u32 v36, v40, 3, v44
    v_lshl_add_u32 v32, v36, 9, v47
    v_lshl_add_u32 v20, v44, 6, v32
    v_xor_b32 v21, 64, v20
    v_xor_b32 v22, 128, v20
    v_xor_b32 v23, 192, v20
    v_lshrrev_b32 v33, 1, v44
    v_lshl_add_u32 v32, v36, 7, v47
    v_lshl_add_u32 v114, v33, 6, v32
    v_xor_b32 v115, 64, v114
    v_lshl_add_u32 v36, v40, 2, v44
    v_lshlrev_b32 v36, 7, v36
    v_lshl_add_u32 v36, v33, 6, v36
    v_lshl_add_u32 v32, v46, 2, v45
    v_lshl_add_u32 v116, v32, 3, v36
    v_xor_b32 v117, 64, v116
    v_lshl_add_u32 v32, v46, 1, v35
    v_lshl_add_u32 v32, v34, 2, v32
    v_lshl_add_u32 v112, v32, 3, v36
    v_xor_b32 v113, 64, v112
    v_bfe_u32 v32, v1, 1, 2
    v_bfe_u32 v33, v1, 3, 2
    v_and_b32 v34, 1, v1
    v_lshl_add_u32 v34, v33, 1, v34
    v_lshl_add_u32 v34, v32, 3, v34
    v_and_b32 v35, 15, v1
    v_xor_b32 v35, v35, v40
    v_lshlrev_b32 v35, 4, v35
    v_lshl_add_u32 v24, v34, 9, v35
    v_xor_b32 v25, 32, v24
    v_xor_b32 v26, 64, v24
    v_xor_b32 v27, 96, v24
    v_xor_b32 v28, 128, v24
    v_xor_b32 v29, 160, v24
    v_xor_b32 v30, 192, v24
    v_xor_b32 v31, 224, v24
    s_add_u32 m0, s42, 49152
    s_mov_b32 s43, 128
    buffer_load_dwordx4 v2, s[16:19], s43 offen offset:0 lds
    buffer_load_dwordx4 v3, s[16:19], s43 offen offset:1024 lds
    buffer_load_dwordx4 v4, s[16:19], s43 offen offset:2048 lds
    buffer_load_dwordx4 v5, s[16:19], s43 offen offset:3072 lds
    s_add_u32 m0, s42, 65536
    s_mov_b32 s43, 524288
    buffer_load_dwordx4 v6, s[20:23], s43 offen offset:0 lds
    buffer_load_dwordx4 v7, s[20:23], s43 offen offset:1024 lds
    buffer_load_dwordx4 v8, s[20:23], s43 offen offset:2048 lds
    buffer_load_dwordx4 v9, s[20:23], s43 offen offset:3072 lds
    s_waitcnt vmcnt(12)
    s_barrier
    ds_read_b128 a[64:67], v16 offset:0
    ds_read_b64_tr_b16 a[176:177], v20 offset:16384
    ds_read_b64_tr_b16 a[178:179], v20 offset:18432
    ds_read_b64_tr_b16 a[180:181], v21 offset:16384
    ds_read_b64_tr_b16 a[182:183], v21 offset:18432
    ds_read_b64_tr_b16 a[184:185], v22 offset:16384
    ds_read_b64_tr_b16 a[186:187], v22 offset:18432
    ds_read_b64_tr_b16 a[188:189], v23 offset:16384
    ds_read_b64_tr_b16 a[190:191], v23 offset:18432
    s_waitcnt lgkmcnt(6)
    v_mfma_f32_32x32x16_bf16 v[128:143], a[176:179], a[64:67], 0
    ds_read_b64_tr_b16 a[192:193], v20 offset:16640
    ds_read_b64_tr_b16 a[194:195], v20 offset:18688
    ds_read_b128 a[68:71], v17 offset:0
    s_add_u32 m0, s42, 81920
    s_mov_b32 s43, 786432
    buffer_load_dwordx4 v6, s[20:23], s43 offen offset:0 lds
    s_waitcnt lgkmcnt(7)
    v_mfma_f32_32x32x16_bf16 v[144:159], a[180:183], a[64:67], 0
    ds_read_b64_tr_b16 a[196:197], v21 offset:16640
    ds_read_b64_tr_b16 a[198:199], v21 offset:18688
    ds_read_b128 a[72:75], v18 offset:0
    s_waitcnt lgkmcnt(8)
    v_mfma_f32_32x32x16_bf16 v[160:175], a[184:187], a[64:67], 0
    ds_read_b64_tr_b16 a[200:201], v22 offset:16640
    ds_read_b64_tr_b16 a[202:203], v22 offset:18688
    ds_read_b128 a[76:79], v19 offset:0
    buffer_load_dwordx4 v7, s[20:23], s43 offen offset:1024 lds
    s_waitcnt lgkmcnt(9)
    v_mfma_f32_32x32x16_bf16 v[176:191], a[188:191], a[64:67], 0
    ds_read_b64_tr_b16 a[204:205], v23 offset:16640
    ds_read_b64_tr_b16 a[206:207], v23 offset:18688
    s_waitcnt lgkmcnt(9)
    v_mfma_f32_32x32x16_bf16 v[192:207], a[192:195], a[64:67], 0
    ds_read_b64_tr_b16 a[176:177], v20 offset:24576
    ds_read_b64_tr_b16 a[178:179], v20 offset:26624
    buffer_load_dwordx4 v8, s[20:23], s43 offen offset:2048 lds
    s_waitcnt lgkmcnt(8)
    v_mfma_f32_32x32x16_bf16 v[208:223], a[196:199], a[64:67], 0
    ds_read_b64_tr_b16 a[180:181], v21 offset:24576
    ds_read_b64_tr_b16 a[182:183], v21 offset:26624
    s_waitcnt lgkmcnt(7)
    v_mfma_f32_32x32x16_bf16 v[224:239], a[200:203], a[64:67], 0
    ds_read_b64_tr_b16 a[184:185], v22 offset:24576
    ds_read_b64_tr_b16 a[186:187], v22 offset:26624
    buffer_load_dwordx4 v9, s[20:23], s43 offen offset:3072 lds
    s_waitcnt lgkmcnt(6)
    v_mfma_f32_32x32x16_bf16 v[240:255], a[204:207], a[64:67], 0
    ds_read_b64_tr_b16 a[188:189], v23 offset:24576
    ds_read_b64_tr_b16 a[190:191], v23 offset:26624
    s_waitcnt lgkmcnt(6)
    v_mfma_f32_32x32x16_bf16 v[128:143], a[176:179], a[68:71], v[128:143]
    ds_read_b64_tr_b16 a[192:193], v20 offset:24832
    ds_read_b64_tr_b16 a[194:195], v20 offset:26880
    s_add_u32 m0, s42, 98304
    s_mov_b32 s43, 256
    buffer_load_dwordx4 v2, s[16:19], s43 offen offset:0 lds
    s_waitcnt lgkmcnt(6)
    v_mfma_f32_32x32x16_bf16 v[144:159], a[180:183], a[68:71], v[144:159]
    ds_read_b64_tr_b16 a[196:197], v21 offset:24832
    ds_read_b64_tr_b16 a[198:199], v21 offset:26880
    s_waitcnt lgkmcnt(6)
    v_mfma_f32_32x32x16_bf16 v[160:175], a[184:187], a[68:71], v[160:175]
    ds_read_b64_tr_b16 a[200:201], v22 offset:24832
    ds_read_b64_tr_b16 a[202:203], v22 offset:26880
    buffer_load_dwordx4 v3, s[16:19], s43 offen offset:1024 lds
    s_waitcnt lgkmcnt(6)
    v_mfma_f32_32x32x16_bf16 v[176:191], a[188:191], a[68:71], v[176:191]
    ds_read_b64_tr_b16 a[204:205], v23 offset:24832
    ds_read_b64_tr_b16 a[206:207], v23 offset:26880
    s_waitcnt lgkmcnt(6)
    v_mfma_f32_32x32x16_bf16 v[192:207], a[192:195], a[68:71], v[192:207]
    s_waitcnt vmcnt(14)
    s_barrier
    ds_read_b64_tr_b16 a[176:177], v20 offset:32768
    ds_read_b64_tr_b16 a[178:179], v20 offset:34816
    s_waitcnt lgkmcnt(6)
    v_mfma_f32_32x32x16_bf16 v[208:223], a[196:199], a[68:71], v[208:223]
    ds_read_b64_tr_b16 a[180:181], v21 offset:32768
    ds_read_b64_tr_b16 a[182:183], v21 offset:34816
    buffer_load_dwordx4 v4, s[16:19], s43 offen offset:2048 lds
    s_waitcnt lgkmcnt(6)
    v_mfma_f32_32x32x16_bf16 v[224:239], a[200:203], a[68:71], v[224:239]
    ds_read_b64_tr_b16 a[184:185], v22 offset:32768
    ds_read_b64_tr_b16 a[186:187], v22 offset:34816
    s_waitcnt lgkmcnt(6)
    v_mfma_f32_32x32x16_bf16 v[240:255], a[204:207], a[68:71], v[240:255]
    ds_read_b64_tr_b16 a[188:189], v23 offset:32768
    ds_read_b64_tr_b16 a[190:191], v23 offset:34816
    buffer_load_dwordx4 v5, s[16:19], s43 offen offset:3072 lds
    s_waitcnt lgkmcnt(6)
    v_mfma_f32_32x32x16_bf16 v[128:143], a[176:179], a[72:75], v[128:143]
    ds_read_b64_tr_b16 a[192:193], v20 offset:33024
    ds_read_b64_tr_b16 a[194:195], v20 offset:35072
    s_waitcnt lgkmcnt(6)
    v_mfma_f32_32x32x16_bf16 v[144:159], a[180:183], a[72:75], v[144:159]
    ds_read_b64_tr_b16 a[196:197], v21 offset:33024
    ds_read_b64_tr_b16 a[198:199], v21 offset:35072
    s_add_u32 m0, s42, 114688
    s_mov_b32 s43, 1048576
    buffer_load_dwordx4 v6, s[20:23], s43 offen offset:0 lds
    s_waitcnt lgkmcnt(6)
    v_mfma_f32_32x32x16_bf16 v[160:175], a[184:187], a[72:75], v[160:175]
    ds_read_b64_tr_b16 a[200:201], v22 offset:33024
    ds_read_b64_tr_b16 a[202:203], v22 offset:35072
    s_waitcnt lgkmcnt(6)
    v_mfma_f32_32x32x16_bf16 v[176:191], a[188:191], a[72:75], v[176:191]
    ds_read_b64_tr_b16 a[204:205], v23 offset:33024
    ds_read_b64_tr_b16 a[206:207], v23 offset:35072
    buffer_load_dwordx4 v7, s[20:23], s43 offen offset:1024 lds
    s_waitcnt lgkmcnt(6)
    v_mfma_f32_32x32x16_bf16 v[192:207], a[192:195], a[72:75], v[192:207]
    ds_read_b64_tr_b16 a[176:177], v20 offset:40960
    ds_read_b64_tr_b16 a[178:179], v20 offset:43008
    s_waitcnt lgkmcnt(6)
    v_mfma_f32_32x32x16_bf16 v[208:223], a[196:199], a[72:75], v[208:223]
    ds_read_b64_tr_b16 a[180:181], v21 offset:40960
    ds_read_b64_tr_b16 a[182:183], v21 offset:43008
    buffer_load_dwordx4 v8, s[20:23], s43 offen offset:2048 lds
    s_waitcnt lgkmcnt(6)
    v_mfma_f32_32x32x16_bf16 v[224:239], a[200:203], a[72:75], v[224:239]
    ds_read_b64_tr_b16 a[184:185], v22 offset:40960
    ds_read_b64_tr_b16 a[186:187], v22 offset:43008
    s_waitcnt lgkmcnt(6)
    v_mfma_f32_32x32x16_bf16 v[240:255], a[204:207], a[72:75], v[240:255]
    ds_read_b64_tr_b16 a[188:189], v23 offset:40960
    ds_read_b64_tr_b16 a[190:191], v23 offset:43008
    buffer_load_dwordx4 v9, s[20:23], s43 offen offset:3072 lds
    s_waitcnt lgkmcnt(6)
    v_mfma_f32_32x32x16_bf16 v[128:143], a[176:179], a[76:79], v[128:143]
    ds_read_b64_tr_b16 a[192:193], v20 offset:41216
    ds_read_b64_tr_b16 a[194:195], v20 offset:43264
    s_waitcnt lgkmcnt(6)
    v_mfma_f32_32x32x16_bf16 v[144:159], a[180:183], a[76:79], v[144:159]
    ds_read_b64_tr_b16 a[196:197], v21 offset:41216
    ds_read_b64_tr_b16 a[198:199], v21 offset:43264
    s_add_u32 m0, s42, 131072
    s_mov_b32 s43, 1310720
    buffer_load_dwordx4 v6, s[20:23], s43 offen offset:0 lds
    s_waitcnt lgkmcnt(6)
    v_mfma_f32_32x32x16_bf16 v[160:175], a[184:187], a[76:79], v[160:175]
    ds_read_b64_tr_b16 a[200:201], v22 offset:41216
    ds_read_b64_tr_b16 a[202:203], v22 offset:43264
    s_waitcnt lgkmcnt(6)
    v_mfma_f32_32x32x16_bf16 v[176:191], a[188:191], a[76:79], v[176:191]
    ds_read_b64_tr_b16 a[204:205], v23 offset:41216
    ds_read_b64_tr_b16 a[206:207], v23 offset:43264
    buffer_load_dwordx4 v7, s[20:23], s43 offen offset:1024 lds
    s_waitcnt lgkmcnt(6)
    v_mfma_f32_32x32x16_bf16 v[192:207], a[192:195], a[76:79], v[192:207]
    s_waitcnt vmcnt(14)
    s_barrier
    v_add_u32 v20, 0x10000, v20
    ds_read_b64_tr_b16 a[176:177], v20 offset:0
    ds_read_b64_tr_b16 a[178:179], v20 offset:2048
    s_waitcnt lgkmcnt(6)
    v_mfma_f32_32x32x16_bf16 v[208:223], a[196:199], a[76:79], v[208:223]
    v_add_u32 v21, 0x10000, v21
    ds_read_b64_tr_b16 a[180:181], v21 offset:0
    ds_read_b64_tr_b16 a[182:183], v21 offset:2048
    ds_read_b128 a[80:83], v16 offset:49152
    buffer_load_dwordx4 v8, s[20:23], s43 offen offset:2048 lds
    s_waitcnt lgkmcnt(7)
    v_mfma_f32_32x32x16_bf16 v[224:239], a[200:203], a[76:79], v[224:239]
    v_add_u32 v22, 0x10000, v22
    ds_read_b64_tr_b16 a[184:185], v22 offset:0
    ds_read_b64_tr_b16 a[186:187], v22 offset:2048
    ds_read_b128 a[84:87], v17 offset:49152
    s_waitcnt lgkmcnt(8)
    v_mfma_f32_32x32x16_bf16 v[240:255], a[204:207], a[76:79], v[240:255]
    v_add_u32 v23, 0x10000, v23
    ds_read_b64_tr_b16 a[188:189], v23 offset:0
    ds_read_b64_tr_b16 a[190:191], v23 offset:2048
    ds_read_b128 a[88:91], v18 offset:49152
    buffer_load_dwordx4 v9, s[20:23], s43 offen offset:3072 lds
    s_waitcnt lgkmcnt(6)
    v_mfma_f32_32x32x16_bf16 v[128:143], a[176:179], a[80:83], v[128:143]
    ds_read_b64_tr_b16 a[192:193], v20 offset:256
    ds_read_b64_tr_b16 a[194:195], v20 offset:2304
    ds_read_b128 a[92:95], v19 offset:49152
    v_mfma_f32_32x32x16_bf16 v[144:159], a[180:183], a[80:83], v[144:159]
    ds_read_b64_tr_b16 a[196:197], v21 offset:256
    ds_read_b64_tr_b16 a[198:199], v21 offset:2304
    s_add_u32 m0, s42, 147456
    s_mov_b32 s43, 384
    buffer_load_dwordx4 v2, s[16:19], s43 offen offset:0 lds
    s_waitcnt lgkmcnt(9)
    v_mfma_f32_32x32x16_bf16 v[160:175], a[184:187], a[80:83], v[160:175]
    ds_read_b64_tr_b16 a[200:201], v22 offset:256
    ds_read_b64_tr_b16 a[202:203], v22 offset:2304
    s_waitcnt lgkmcnt(8)
    v_mfma_f32_32x32x16_bf16 v[176:191], a[188:191], a[80:83], v[176:191]
    ds_read_b64_tr_b16 a[204:205], v23 offset:256
    ds_read_b64_tr_b16 a[206:207], v23 offset:2304
    buffer_load_dwordx4 v3, s[16:19], s43 offen offset:1024 lds
    s_waitcnt lgkmcnt(7)
    v_mfma_f32_32x32x16_bf16 v[192:207], a[192:195], a[80:83], v[192:207]
    ds_read_b64_tr_b16 a[176:177], v20 offset:8192
    ds_read_b64_tr_b16 a[178:179], v20 offset:10240
    s_waitcnt lgkmcnt(6)
    v_mfma_f32_32x32x16_bf16 v[208:223], a[196:199], a[80:83], v[208:223]
    ds_read_b64_tr_b16 a[180:181], v21 offset:8192
    ds_read_b64_tr_b16 a[182:183], v21 offset:10240
    buffer_load_dwordx4 v4, s[16:19], s43 offen offset:2048 lds
    s_waitcnt lgkmcnt(6)
    v_mfma_f32_32x32x16_bf16 v[224:239], a[200:203], a[80:83], v[224:239]
    ds_read_b64_tr_b16 a[184:185], v22 offset:8192
    ds_read_b64_tr_b16 a[186:187], v22 offset:10240
    s_waitcnt lgkmcnt(6)
    v_mfma_f32_32x32x16_bf16 v[240:255], a[204:207], a[80:83], v[240:255]
    ds_read_b64_tr_b16 a[188:189], v23 offset:8192
    ds_read_b64_tr_b16 a[190:191], v23 offset:10240
    buffer_load_dwordx4 v5, s[16:19], s43 offen offset:3072 lds
    s_waitcnt lgkmcnt(6)
    v_mfma_f32_32x32x16_bf16 v[128:143], a[176:179], a[84:87], v[128:143]
    ds_read_b64_tr_b16 a[192:193], v20 offset:8448
    ds_read_b64_tr_b16 a[194:195], v20 offset:10496
    s_waitcnt lgkmcnt(6)
    v_mfma_f32_32x32x16_bf16 v[144:159], a[180:183], a[84:87], v[144:159]
    ds_read_b64_tr_b16 a[196:197], v21 offset:8448
    ds_read_b64_tr_b16 a[198:199], v21 offset:10496
    s_add_u32 m0, s42, 0
    s_mov_b32 s43, 1572864
    buffer_load_dwordx4 v6, s[20:23], s43 offen offset:0 lds
    s_waitcnt lgkmcnt(6)
    v_mfma_f32_32x32x16_bf16 v[160:175], a[184:187], a[84:87], v[160:175]
    ds_read_b64_tr_b16 a[200:201], v22 offset:8448
    ds_read_b64_tr_b16 a[202:203], v22 offset:10496
    s_waitcnt lgkmcnt(6)
    v_mfma_f32_32x32x16_bf16 v[176:191], a[188:191], a[84:87], v[176:191]
    ds_read_b64_tr_b16 a[204:205], v23 offset:8448
    ds_read_b64_tr_b16 a[206:207], v23 offset:10496
    buffer_load_dwordx4 v7, s[20:23], s43 offen offset:1024 lds
    s_waitcnt lgkmcnt(6)
    v_mfma_f32_32x32x16_bf16 v[192:207], a[192:195], a[84:87], v[192:207]
    s_waitcnt vmcnt(18)
    s_barrier
    ds_read_b64_tr_b16 a[176:177], v20 offset:16384
    ds_read_b64_tr_b16 a[178:179], v20 offset:18432
    s_waitcnt lgkmcnt(6)
    v_mfma_f32_32x32x16_bf16 v[208:223], a[196:199], a[84:87], v[208:223]
    ds_read_b64_tr_b16 a[180:181], v21 offset:16384
    ds_read_b64_tr_b16 a[182:183], v21 offset:18432
    buffer_load_dwordx4 v8, s[20:23], s43 offen offset:2048 lds
    s_waitcnt lgkmcnt(6)
    v_mfma_f32_32x32x16_bf16 v[224:239], a[200:203], a[84:87], v[224:239]
    ds_read_b64_tr_b16 a[184:185], v22 offset:16384
    ds_read_b64_tr_b16 a[186:187], v22 offset:18432
    s_waitcnt lgkmcnt(6)
    v_mfma_f32_32x32x16_bf16 v[240:255], a[204:207], a[84:87], v[240:255]
    ds_read_b64_tr_b16 a[188:189], v23 offset:16384
    ds_read_b64_tr_b16 a[190:191], v23 offset:18432
    buffer_load_dwordx4 v9, s[20:23], s43 offen offset:3072 lds
    s_waitcnt lgkmcnt(6)
    v_mfma_f32_32x32x16_bf16 v[128:143], a[176:179], a[88:91], v[128:143]
    ds_read_b64_tr_b16 a[192:193], v20 offset:16640
    ds_read_b64_tr_b16 a[194:195], v20 offset:18688
    s_waitcnt lgkmcnt(6)
    v_mfma_f32_32x32x16_bf16 v[144:159], a[180:183], a[88:91], v[144:159]
    ds_read_b64_tr_b16 a[196:197], v21 offset:16640
    ds_read_b64_tr_b16 a[198:199], v21 offset:18688
    s_add_u32 m0, s42, 16384
    s_mov_b32 s43, 1835008
    buffer_load_dwordx4 v6, s[20:23], s43 offen offset:0 lds
    s_waitcnt lgkmcnt(6)
    v_mfma_f32_32x32x16_bf16 v[160:175], a[184:187], a[88:91], v[160:175]
    ds_read_b64_tr_b16 a[200:201], v22 offset:16640
    ds_read_b64_tr_b16 a[202:203], v22 offset:18688
    s_waitcnt lgkmcnt(6)
    v_mfma_f32_32x32x16_bf16 v[176:191], a[188:191], a[88:91], v[176:191]
    ds_read_b64_tr_b16 a[204:205], v23 offset:16640
    ds_read_b64_tr_b16 a[206:207], v23 offset:18688
    buffer_load_dwordx4 v7, s[20:23], s43 offen offset:1024 lds
    s_waitcnt lgkmcnt(6)
    v_mfma_f32_32x32x16_bf16 v[192:207], a[192:195], a[88:91], v[192:207]
    ds_read_b64_tr_b16 a[176:177], v20 offset:24576
    ds_read_b64_tr_b16 a[178:179], v20 offset:26624
    s_waitcnt lgkmcnt(6)
    v_mfma_f32_32x32x16_bf16 v[208:223], a[196:199], a[88:91], v[208:223]
    ds_read_b64_tr_b16 a[180:181], v21 offset:24576
    ds_read_b64_tr_b16 a[182:183], v21 offset:26624
    buffer_load_dwordx4 v8, s[20:23], s43 offen offset:2048 lds
    s_waitcnt lgkmcnt(6)
    v_mfma_f32_32x32x16_bf16 v[224:239], a[200:203], a[88:91], v[224:239]
    ds_read_b64_tr_b16 a[184:185], v22 offset:24576
    ds_read_b64_tr_b16 a[186:187], v22 offset:26624
    s_waitcnt lgkmcnt(6)
    v_mfma_f32_32x32x16_bf16 v[240:255], a[204:207], a[88:91], v[240:255]
    ds_read_b64_tr_b16 a[188:189], v23 offset:24576
    ds_read_b64_tr_b16 a[190:191], v23 offset:26624
    buffer_load_dwordx4 v9, s[20:23], s43 offen offset:3072 lds
    s_waitcnt lgkmcnt(6)
    v_mfma_f32_32x32x16_bf16 v[128:143], a[176:179], a[92:95], v[128:143]
    ds_read_b64_tr_b16 a[192:193], v20 offset:24832
    ds_read_b64_tr_b16 a[194:195], v20 offset:26880
    s_waitcnt lgkmcnt(6)
    v_mfma_f32_32x32x16_bf16 v[144:159], a[180:183], a[92:95], v[144:159]
    ds_read_b64_tr_b16 a[196:197], v21 offset:24832
    ds_read_b64_tr_b16 a[198:199], v21 offset:26880
    s_add_u32 m0, s42, 32768
    s_mov_b32 s43, 512
    buffer_load_dwordx4 v2, s[16:19], s43 offen offset:0 lds
    s_waitcnt lgkmcnt(6)
    v_mfma_f32_32x32x16_bf16 v[160:175], a[184:187], a[92:95], v[160:175]
    ds_read_b64_tr_b16 a[200:201], v22 offset:24832
    ds_read_b64_tr_b16 a[202:203], v22 offset:26880
    s_waitcnt lgkmcnt(6)
    v_mfma_f32_32x32x16_bf16 v[176:191], a[188:191], a[92:95], v[176:191]
    ds_read_b64_tr_b16 a[204:205], v23 offset:24832
    ds_read_b64_tr_b16 a[206:207], v23 offset:26880
    buffer_load_dwordx4 v3, s[16:19], s43 offen offset:1024 lds
    s_waitcnt lgkmcnt(6)
    v_mfma_f32_32x32x16_bf16 v[192:207], a[192:195], a[92:95], v[192:207]
    s_waitcnt vmcnt(18)
    s_barrier
    ds_read_b64_tr_b16 a[176:177], v20 offset:49152
    ds_read_b64_tr_b16 a[178:179], v20 offset:51200
    s_waitcnt lgkmcnt(6)
    v_mfma_f32_32x32x16_bf16 v[208:223], a[196:199], a[92:95], v[208:223]
    ds_read_b64_tr_b16 a[180:181], v21 offset:49152
    ds_read_b64_tr_b16 a[182:183], v21 offset:51200
    v_add_u32 v16, 0x10000, v16
    ds_read_b128 a[96:99], v16 offset:32768
    buffer_load_dwordx4 v4, s[16:19], s43 offen offset:2048 lds
    s_waitcnt lgkmcnt(7)
    v_mfma_f32_32x32x16_bf16 v[224:239], a[200:203], a[92:95], v[224:239]
    ds_read_b64_tr_b16 a[184:185], v22 offset:49152
    ds_read_b64_tr_b16 a[186:187], v22 offset:51200
    v_add_u32 v17, 0x10000, v17
    ds_read_b128 a[100:103], v17 offset:32768
    s_waitcnt lgkmcnt(8)
    v_mfma_f32_32x32x16_bf16 v[240:255], a[204:207], a[92:95], v[240:255]
    ds_read_b64_tr_b16 a[188:189], v23 offset:49152
    ds_read_b64_tr_b16 a[190:191], v23 offset:51200
    v_add_u32 v18, 0x10000, v18
    ds_read_b128 a[104:107], v18 offset:32768
    buffer_load_dwordx4 v5, s[16:19], s43 offen offset:3072 lds
    s_waitcnt lgkmcnt(6)
    v_mfma_f32_32x32x16_bf16 v[128:143], a[176:179], a[96:99], v[128:143]
    ds_read_b64_tr_b16 a[192:193], v20 offset:49408
    ds_read_b64_tr_b16 a[194:195], v20 offset:51456
    v_add_u32 v19, 0x10000, v19
    ds_read_b128 a[108:111], v19 offset:32768
    v_mfma_f32_32x32x16_bf16 v[144:159], a[180:183], a[96:99], v[144:159]
    ds_read_b64_tr_b16 a[196:197], v21 offset:49408
    ds_read_b64_tr_b16 a[198:199], v21 offset:51456
    s_add_u32 m0, s42, 49152
    s_mov_b32 s43, 2097152
    buffer_load_dwordx4 v6, s[20:23], s43 offen offset:0 lds
    s_waitcnt lgkmcnt(9)
    v_mfma_f32_32x32x16_bf16 v[160:175], a[184:187], a[96:99], v[160:175]
    ds_read_b64_tr_b16 a[200:201], v22 offset:49408
    ds_read_b64_tr_b16 a[202:203], v22 offset:51456
    s_waitcnt lgkmcnt(8)
    v_mfma_f32_32x32x16_bf16 v[176:191], a[188:191], a[96:99], v[176:191]
    ds_read_b64_tr_b16 a[204:205], v23 offset:49408
    ds_read_b64_tr_b16 a[206:207], v23 offset:51456
    buffer_load_dwordx4 v7, s[20:23], s43 offen offset:1024 lds
    s_waitcnt lgkmcnt(7)
    v_mfma_f32_32x32x16_bf16 v[192:207], a[192:195], a[96:99], v[192:207]
    ds_read_b64_tr_b16 a[176:177], v20 offset:57344
    ds_read_b64_tr_b16 a[178:179], v20 offset:59392
    s_waitcnt lgkmcnt(6)
    v_mfma_f32_32x32x16_bf16 v[208:223], a[196:199], a[96:99], v[208:223]
    ds_read_b64_tr_b16 a[180:181], v21 offset:57344
    ds_read_b64_tr_b16 a[182:183], v21 offset:59392
    buffer_load_dwordx4 v8, s[20:23], s43 offen offset:2048 lds
    s_waitcnt lgkmcnt(6)
    v_mfma_f32_32x32x16_bf16 v[224:239], a[200:203], a[96:99], v[224:239]
    ds_read_b64_tr_b16 a[184:185], v22 offset:57344
    ds_read_b64_tr_b16 a[186:187], v22 offset:59392
    s_waitcnt lgkmcnt(6)
    v_mfma_f32_32x32x16_bf16 v[240:255], a[204:207], a[96:99], v[240:255]
    ds_read_b64_tr_b16 a[188:189], v23 offset:57344
    ds_read_b64_tr_b16 a[190:191], v23 offset:59392
    buffer_load_dwordx4 v9, s[20:23], s43 offen offset:3072 lds
    s_waitcnt lgkmcnt(6)
    v_mfma_f32_32x32x16_bf16 v[128:143], a[176:179], a[100:103], v[128:143]
    ds_read_b64_tr_b16 a[192:193], v20 offset:57600
    ds_read_b64_tr_b16 a[194:195], v20 offset:59648
    s_waitcnt lgkmcnt(6)
    v_mfma_f32_32x32x16_bf16 v[144:159], a[180:183], a[100:103], v[144:159]
    ds_read_b64_tr_b16 a[196:197], v21 offset:57600
    ds_read_b64_tr_b16 a[198:199], v21 offset:59648
    s_waitcnt lgkmcnt(6)
    v_mfma_f32_32x32x16_bf16 v[160:175], a[184:187], a[100:103], v[160:175]
    ds_read_b64_tr_b16 a[200:201], v22 offset:57600
    ds_read_b64_tr_b16 a[202:203], v22 offset:59648
    s_waitcnt lgkmcnt(6)
    v_mfma_f32_32x32x16_bf16 v[176:191], a[188:191], a[100:103], v[176:191]
    ds_read_b64_tr_b16 a[204:205], v23 offset:57600
    ds_read_b64_tr_b16 a[206:207], v23 offset:59648
    s_add_u32 m0, s42, 65536
    s_mov_b32 s43, 2359296
    buffer_load_dwordx4 v6, s[20:23], s43 offen offset:0 lds
    s_waitcnt lgkmcnt(6)
    v_mfma_f32_32x32x16_bf16 v[192:207], a[192:195], a[100:103], v[192:207]
    s_waitcnt vmcnt(21)
    s_barrier
    v_add_u32 v20, 0x10000, v20
    ds_read_b64_tr_b16 a[176:177], v20 offset:0
    ds_read_b64_tr_b16 a[178:179], v20 offset:2048
    s_waitcnt lgkmcnt(6)
    v_mfma_f32_32x32x16_bf16 v[208:223], a[196:199], a[100:103], v[208:223]
    v_add_u32 v21, 0x10000, v21
    ds_read_b64_tr_b16 a[180:181], v21 offset:0
    ds_read_b64_tr_b16 a[182:183], v21 offset:2048
    buffer_load_dwordx4 v7, s[20:23], s43 offen offset:1024 lds
    s_waitcnt lgkmcnt(6)
    v_mfma_f32_32x32x16_bf16 v[224:239], a[200:203], a[100:103], v[224:239]
    v_add_u32 v22, 0x10000, v22
    ds_read_b64_tr_b16 a[184:185], v22 offset:0
    ds_read_b64_tr_b16 a[186:187], v22 offset:2048
    s_waitcnt lgkmcnt(6)
    v_mfma_f32_32x32x16_bf16 v[240:255], a[204:207], a[100:103], v[240:255]
    v_add_u32 v23, 0x10000, v23
    ds_read_b64_tr_b16 a[188:189], v23 offset:0
    ds_read_b64_tr_b16 a[190:191], v23 offset:2048
    buffer_load_dwordx4 v8, s[20:23], s43 offen offset:2048 lds
    s_waitcnt lgkmcnt(6)
    v_mfma_f32_32x32x16_bf16 v[128:143], a[176:179], a[104:107], v[128:143]
    ds_read_b64_tr_b16 a[192:193], v20 offset:256
    ds_read_b64_tr_b16 a[194:195], v20 offset:2304
    s_waitcnt lgkmcnt(6)
    v_mfma_f32_32x32x16_bf16 v[144:159], a[180:183], a[104:107], v[144:159]
    ds_read_b64_tr_b16 a[196:197], v21 offset:256
    ds_read_b64_tr_b16 a[198:199], v21 offset:2304
    buffer_load_dwordx4 v9, s[20:23], s43 offen offset:3072 lds
    s_waitcnt lgkmcnt(6)
    v_mfma_f32_32x32x16_bf16 v[160:175], a[184:187], a[104:107], v[160:175]
    ds_read_b64_tr_b16 a[200:201], v22 offset:256
    ds_read_b64_tr_b16 a[202:203], v22 offset:2304
    s_waitcnt lgkmcnt(6)
    v_mfma_f32_32x32x16_bf16 v[176:191], a[188:191], a[104:107], v[176:191]
    ds_read_b64_tr_b16 a[204:205], v23 offset:256
    ds_read_b64_tr_b16 a[206:207], v23 offset:2304
    s_add_u32 m0, s42, 81920
    s_mov_b32 s43, 640
    buffer_load_dwordx4 v2, s[16:19], s43 offen offset:0 lds
    s_waitcnt lgkmcnt(6)
    v_mfma_f32_32x32x16_bf16 v[192:207], a[192:195], a[104:107], v[192:207]
    ds_read_b64_tr_b16 a[176:177], v20 offset:8192
    ds_read_b64_tr_b16 a[178:179], v20 offset:10240
    s_waitcnt lgkmcnt(6)
    v_mfma_f32_32x32x16_bf16 v[208:223], a[196:199], a[104:107], v[208:223]
    ds_read_b64_tr_b16 a[180:181], v21 offset:8192
    ds_read_b64_tr_b16 a[182:183], v21 offset:10240
    buffer_load_dwordx4 v3, s[16:19], s43 offen offset:1024 lds
    s_waitcnt lgkmcnt(6)
    v_mfma_f32_32x32x16_bf16 v[224:239], a[200:203], a[104:107], v[224:239]
    ds_read_b64_tr_b16 a[184:185], v22 offset:8192
    ds_read_b64_tr_b16 a[186:187], v22 offset:10240
    s_waitcnt lgkmcnt(6)
    v_mfma_f32_32x32x16_bf16 v[240:255], a[204:207], a[104:107], v[240:255]
    ds_read_b64_tr_b16 a[188:189], v23 offset:8192
    ds_read_b64_tr_b16 a[190:191], v23 offset:10240
    buffer_load_dwordx4 v4, s[16:19], s43 offen offset:2048 lds
    s_waitcnt lgkmcnt(6)
    v_mfma_f32_32x32x16_bf16 v[128:143], a[176:179], a[108:111], v[128:143]
    ds_read_b64_tr_b16 a[192:193], v20 offset:8448
    ds_read_b64_tr_b16 a[194:195], v20 offset:10496
    s_waitcnt lgkmcnt(6)
    v_mfma_f32_32x32x16_bf16 v[144:159], a[180:183], a[108:111], v[144:159]
    ds_read_b64_tr_b16 a[196:197], v21 offset:8448
    ds_read_b64_tr_b16 a[198:199], v21 offset:10496
    buffer_load_dwordx4 v5, s[16:19], s43 offen offset:3072 lds
    s_waitcnt lgkmcnt(6)
    v_mfma_f32_32x32x16_bf16 v[160:175], a[184:187], a[108:111], v[160:175]
    ds_read_b64_tr_b16 a[200:201], v22 offset:8448
    ds_read_b64_tr_b16 a[202:203], v22 offset:10496
    s_waitcnt lgkmcnt(6)
    v_mfma_f32_32x32x16_bf16 v[176:191], a[188:191], a[108:111], v[176:191]
    ds_read_b64_tr_b16 a[204:205], v23 offset:8448
    ds_read_b64_tr_b16 a[206:207], v23 offset:10496
    s_waitcnt lgkmcnt(6)
    v_mfma_f32_32x32x16_bf16 v[192:207], a[192:195], a[108:111], v[192:207]
    s_waitcnt vmcnt(20)
    s_barrier
    v_add_u32 v20, 0xfffe0000, v20
    ds_read_b64_tr_b16 a[176:177], v20 offset:0
    ds_read_b64_tr_b16 a[178:179], v20 offset:2048
    s_waitcnt lgkmcnt(6)
    v_mfma_f32_32x32x16_bf16 v[208:223], a[196:199], a[108:111], v[208:223]
    v_add_u32 v21, 0xfffe0000, v21
    ds_read_b64_tr_b16 a[180:181], v21 offset:0
    ds_read_b64_tr_b16 a[182:183], v21 offset:2048
    v_add_u32 v16, 0x10000, v16
    ds_read_b128 a[112:115], v16 offset:16384
    s_add_u32 m0, s42, 98304
    s_mov_b32 s43, 768
    buffer_load_dwordx4 v2, s[16:19], s43 offen offset:0 lds
    s_waitcnt lgkmcnt(7)
    v_mfma_f32_32x32x16_bf16 v[224:239], a[200:203], a[108:111], v[224:239]
    v_add_u32 v22, 0xfffe0000, v22
    ds_read_b64_tr_b16 a[184:185], v22 offset:0
    ds_read_b64_tr_b16 a[186:187], v22 offset:2048
    v_add_u32 v17, 0x10000, v17
    ds_read_b128 a[116:119], v17 offset:16384
    s_waitcnt lgkmcnt(8)
    v_mfma_f32_32x32x16_bf16 v[240:255], a[204:207], a[108:111], v[240:255]
    v_add_u32 v23, 0xfffe0000, v23
    ds_read_b64_tr_b16 a[188:189], v23 offset:0
    ds_read_b64_tr_b16 a[190:191], v23 offset:2048
    v_add_u32 v18, 0x10000, v18
    ds_read_b128 a[120:123], v18 offset:16384
    buffer_load_dwordx4 v3, s[16:19], s43 offen offset:1024 lds
    s_waitcnt lgkmcnt(6)
    v_mfma_f32_32x32x16_bf16 v[128:143], a[176:179], a[112:115], v[128:143]
    ds_read_b64_tr_b16 a[192:193], v20 offset:256
    ds_read_b64_tr_b16 a[194:195], v20 offset:2304
    v_add_u32 v19, 0x10000, v19
    ds_read_b128 a[124:127], v19 offset:16384
    v_mfma_f32_32x32x16_bf16 v[144:159], a[180:183], a[112:115], v[144:159]
    ds_read_b64_tr_b16 a[196:197], v21 offset:256
    ds_read_b64_tr_b16 a[198:199], v21 offset:2304
    buffer_load_dwordx4 v4, s[16:19], s43 offen offset:2048 lds
    s_waitcnt lgkmcnt(9)
    v_mfma_f32_32x32x16_bf16 v[160:175], a[184:187], a[112:115], v[160:175]
    ds_read_b64_tr_b16 a[200:201], v22 offset:256
    ds_read_b64_tr_b16 a[202:203], v22 offset:2304
    s_waitcnt lgkmcnt(8)
    v_mfma_f32_32x32x16_bf16 v[176:191], a[188:191], a[112:115], v[176:191]
    ds_read_b64_tr_b16 a[204:205], v23 offset:256
    ds_read_b64_tr_b16 a[206:207], v23 offset:2304
    buffer_load_dwordx4 v5, s[16:19], s43 offen offset:3072 lds
    s_waitcnt lgkmcnt(7)
    v_mfma_f32_32x32x16_bf16 v[192:207], a[192:195], a[112:115], v[192:207]
    ds_read_b64_tr_b16 a[176:177], v20 offset:8192
    ds_read_b64_tr_b16 a[178:179], v20 offset:10240
    s_waitcnt lgkmcnt(6)
    v_mfma_f32_32x32x16_bf16 v[208:223], a[196:199], a[112:115], v[208:223]
    ds_read_b64_tr_b16 a[180:181], v21 offset:8192
    ds_read_b64_tr_b16 a[182:183], v21 offset:10240
    s_waitcnt lgkmcnt(6)
    v_mfma_f32_32x32x16_bf16 v[224:239], a[200:203], a[112:115], v[224:239]
    ds_read_b64_tr_b16 a[184:185], v22 offset:8192
    ds_read_b64_tr_b16 a[186:187], v22 offset:10240
    s_waitcnt lgkmcnt(6)
    v_mfma_f32_32x32x16_bf16 v[240:255], a[204:207], a[112:115], v[240:255]
    ds_read_b64_tr_b16 a[188:189], v23 offset:8192
    ds_read_b64_tr_b16 a[190:191], v23 offset:10240
    s_add_u32 m0, s42, 114688
    s_mov_b32 s43, 2621440
    buffer_load_dwordx4 v10, s[20:23], s43 offen offset:0 lds
    s_waitcnt lgkmcnt(6)
    v_mfma_f32_32x32x16_bf16 v[128:143], a[176:179], a[116:119], v[128:143]
    ds_read_b64_tr_b16 a[192:193], v20 offset:8448
    ds_read_b64_tr_b16 a[194:195], v20 offset:10496
    s_waitcnt lgkmcnt(6)
    v_mfma_f32_32x32x16_bf16 v[144:159], a[180:183], a[116:119], v[144:159]
    ds_read_b64_tr_b16 a[196:197], v21 offset:8448
    ds_read_b64_tr_b16 a[198:199], v21 offset:10496
    s_waitcnt lgkmcnt(6)
    v_mfma_f32_32x32x16_bf16 v[160:175], a[184:187], a[116:119], v[160:175]
    ds_read_b64_tr_b16 a[200:201], v22 offset:8448
    ds_read_b64_tr_b16 a[202:203], v22 offset:10496
    s_waitcnt lgkmcnt(6)
    v_mfma_f32_32x32x16_bf16 v[176:191], a[188:191], a[116:119], v[176:191]
    ds_read_b64_tr_b16 a[204:205], v23 offset:8448
    ds_read_b64_tr_b16 a[206:207], v23 offset:10496
    s_mov_b32 s43, 2685952
    buffer_load_dwordx4 v10, s[20:23], s43 offen offset:1024 lds
    s_waitcnt lgkmcnt(6)
    v_mfma_f32_32x32x16_bf16 v[192:207], a[192:195], a[116:119], v[192:207]
    s_waitcnt vmcnt(22)
    s_barrier
    ds_read_b64_tr_b16 a[176:177], v20 offset:16384
    ds_read_b64_tr_b16 a[178:179], v20 offset:18432
    s_waitcnt lgkmcnt(6)
    v_mfma_f32_32x32x16_bf16 v[208:223], a[196:199], a[116:119], v[208:223]
    ds_read_b64_tr_b16 a[180:181], v21 offset:16384
    ds_read_b64_tr_b16 a[182:183], v21 offset:18432
    s_mov_b32 s43, 2750464
    buffer_load_dwordx4 v10, s[20:23], s43 offen offset:2048 lds
    s_waitcnt lgkmcnt(6)
    v_mfma_f32_32x32x16_bf16 v[224:239], a[200:203], a[116:119], v[224:239]
    ds_read_b64_tr_b16 a[184:185], v22 offset:16384
    ds_read_b64_tr_b16 a[186:187], v22 offset:18432
    s_waitcnt lgkmcnt(6)
    v_mfma_f32_32x32x16_bf16 v[240:255], a[204:207], a[116:119], v[240:255]
    ds_read_b64_tr_b16 a[188:189], v23 offset:16384
    ds_read_b64_tr_b16 a[190:191], v23 offset:18432
    s_mov_b32 s43, 2814976
    buffer_load_dwordx4 v10, s[20:23], s43 offen offset:3072 lds
    s_waitcnt lgkmcnt(6)
    v_mfma_f32_32x32x16_bf16 v[128:143], a[176:179], a[120:123], v[128:143]
    ds_read_b64_tr_b16 a[192:193], v20 offset:16640
    ds_read_b64_tr_b16 a[194:195], v20 offset:18688
    s_waitcnt lgkmcnt(6)
    v_mfma_f32_32x32x16_bf16 v[144:159], a[180:183], a[120:123], v[144:159]
    ds_read_b64_tr_b16 a[196:197], v21 offset:16640
    ds_read_b64_tr_b16 a[198:199], v21 offset:18688
    s_add_u32 m0, s42, 131072
    s_mov_b32 s43, 2621568
    buffer_load_dwordx4 v10, s[20:23], s43 offen offset:0 lds
    s_waitcnt lgkmcnt(6)
    v_mfma_f32_32x32x16_bf16 v[160:175], a[184:187], a[120:123], v[160:175]
    ds_read_b64_tr_b16 a[200:201], v22 offset:16640
    ds_read_b64_tr_b16 a[202:203], v22 offset:18688
    s_waitcnt lgkmcnt(6)
    v_mfma_f32_32x32x16_bf16 v[176:191], a[188:191], a[120:123], v[176:191]
    ds_read_b64_tr_b16 a[204:205], v23 offset:16640
    ds_read_b64_tr_b16 a[206:207], v23 offset:18688
    s_mov_b32 s43, 2686080
    buffer_load_dwordx4 v10, s[20:23], s43 offen offset:1024 lds
    s_waitcnt lgkmcnt(6)
    v_mfma_f32_32x32x16_bf16 v[192:207], a[192:195], a[120:123], v[192:207]
    ds_read_b64_tr_b16 a[176:177], v20 offset:24576
    ds_read_b64_tr_b16 a[178:179], v20 offset:26624
    s_waitcnt lgkmcnt(6)
    v_mfma_f32_32x32x16_bf16 v[208:223], a[196:199], a[120:123], v[208:223]
    ds_read_b64_tr_b16 a[180:181], v21 offset:24576
    ds_read_b64_tr_b16 a[182:183], v21 offset:26624
    s_mov_b32 s43, 2750592
    buffer_load_dwordx4 v10, s[20:23], s43 offen offset:2048 lds
    s_waitcnt lgkmcnt(6)
    v_mfma_f32_32x32x16_bf16 v[224:239], a[200:203], a[120:123], v[224:239]
    ds_read_b64_tr_b16 a[184:185], v22 offset:24576
    ds_read_b64_tr_b16 a[186:187], v22 offset:26624
    s_waitcnt lgkmcnt(6)
    v_mfma_f32_32x32x16_bf16 v[240:255], a[204:207], a[120:123], v[240:255]
    ds_read_b64_tr_b16 a[188:189], v23 offset:24576
    ds_read_b64_tr_b16 a[190:191], v23 offset:26624
    s_mov_b32 s43, 2815104
    buffer_load_dwordx4 v10, s[20:23], s43 offen offset:3072 lds
    s_waitcnt lgkmcnt(6)
    v_mfma_f32_32x32x16_bf16 v[128:143], a[176:179], a[124:127], v[128:143]
    ds_read_b64_tr_b16 a[192:193], v20 offset:24832
    ds_read_b64_tr_b16 a[194:195], v20 offset:26880
    s_waitcnt lgkmcnt(6)
    v_mfma_f32_32x32x16_bf16 v[144:159], a[180:183], a[124:127], v[144:159]
    ds_read_b64_tr_b16 a[196:197], v21 offset:24832
    ds_read_b64_tr_b16 a[198:199], v21 offset:26880
    s_waitcnt lgkmcnt(6)
    v_mfma_f32_32x32x16_bf16 v[160:175], a[184:187], a[124:127], v[160:175]
    ds_read_b64_tr_b16 a[200:201], v22 offset:24832
    ds_read_b64_tr_b16 a[202:203], v22 offset:26880
    s_waitcnt lgkmcnt(6)
    v_mfma_f32_32x32x16_bf16 v[176:191], a[188:191], a[124:127], v[176:191]
    ds_read_b64_tr_b16 a[204:205], v23 offset:24832
    ds_read_b64_tr_b16 a[206:207], v23 offset:26880
    s_add_u32 m0, s42, 147456
    s_mov_b32 s43, 2621696
    buffer_load_dwordx4 v10, s[20:23], s43 offen offset:0 lds
    s_waitcnt lgkmcnt(6)
    v_mfma_f32_32x32x16_bf16 v[192:207], a[192:195], a[124:127], v[192:207]
    s_waitcnt vmcnt(21)
    s_barrier
    ds_read_b64_tr_b16 a[176:177], v20 offset:49152
    ds_read_b64_tr_b16 a[178:179], v20 offset:51200
    s_waitcnt lgkmcnt(6)
    v_mfma_f32_32x32x16_bf16 v[208:223], a[196:199], a[124:127], v[208:223]
    ds_read_b64_tr_b16 a[180:181], v21 offset:49152
    ds_read_b64_tr_b16 a[182:183], v21 offset:51200
    v_add_u32 v16, 0xfffe0000, v16
    ds_read_b128 a[128:131], v16 offset:32768
    s_mov_b32 s43, 2686208
    buffer_load_dwordx4 v10, s[20:23], s43 offen offset:1024 lds
    s_waitcnt lgkmcnt(7)
    v_mfma_f32_32x32x16_bf16 v[224:239], a[200:203], a[124:127], v[224:239]
    ds_read_b64_tr_b16 a[184:185], v22 offset:49152
    ds_read_b64_tr_b16 a[186:187], v22 offset:51200
    v_add_u32 v17, 0xfffe0000, v17
    ds_read_b128 a[132:135], v17 offset:32768
    s_waitcnt lgkmcnt(8)
    v_mfma_f32_32x32x16_bf16 v[240:255], a[204:207], a[124:127], v[240:255]
    ds_read_b64_tr_b16 a[188:189], v23 offset:49152
    ds_read_b64_tr_b16 a[190:191], v23 offset:51200
    v_add_u32 v18, 0xfffe0000, v18
    ds_read_b128 a[136:139], v18 offset:32768
    s_mov_b32 s43, 2750720
    buffer_load_dwordx4 v10, s[20:23], s43 offen offset:2048 lds
    s_waitcnt lgkmcnt(6)
    v_mfma_f32_32x32x16_bf16 v[128:143], a[176:179], a[128:131], v[128:143]
    ds_read_b64_tr_b16 a[192:193], v20 offset:49408
    ds_read_b64_tr_b16 a[194:195], v20 offset:51456
    v_add_u32 v19, 0xfffe0000, v19
    ds_read_b128 a[140:143], v19 offset:32768
    v_mfma_f32_32x32x16_bf16 v[144:159], a[180:183], a[128:131], v[144:159]
    ds_read_b64_tr_b16 a[196:197], v21 offset:49408
    ds_read_b64_tr_b16 a[198:199], v21 offset:51456
    s_mov_b32 s43, 2815232
    buffer_load_dwordx4 v10, s[20:23], s43 offen offset:3072 lds
    s_waitcnt lgkmcnt(9)
    v_mfma_f32_32x32x16_bf16 v[160:175], a[184:187], a[128:131], v[160:175]
    ds_read_b64_tr_b16 a[200:201], v22 offset:49408
    ds_read_b64_tr_b16 a[202:203], v22 offset:51456
    s_waitcnt lgkmcnt(8)
    v_mfma_f32_32x32x16_bf16 v[176:191], a[188:191], a[128:131], v[176:191]
    ds_read_b64_tr_b16 a[204:205], v23 offset:49408
    ds_read_b64_tr_b16 a[206:207], v23 offset:51456
    s_waitcnt lgkmcnt(7)
    v_mfma_f32_32x32x16_bf16 v[192:207], a[192:195], a[128:131], v[192:207]
    ds_read_b64_tr_b16 a[176:177], v20 offset:57344
    ds_read_b64_tr_b16 a[178:179], v20 offset:59392
    s_waitcnt lgkmcnt(6)
    v_mfma_f32_32x32x16_bf16 v[208:223], a[196:199], a[128:131], v[208:223]
    ds_read_b64_tr_b16 a[180:181], v21 offset:57344
    ds_read_b64_tr_b16 a[182:183], v21 offset:59392
    s_add_u32 m0, s42, 0
    s_mov_b32 s43, 2621824
    buffer_load_dwordx4 v10, s[20:23], s43 offen offset:0 lds
    s_waitcnt lgkmcnt(6)
    v_mfma_f32_32x32x16_bf16 v[224:239], a[200:203], a[128:131], v[224:239]
    ds_read_b64_tr_b16 a[184:185], v22 offset:57344
    ds_read_b64_tr_b16 a[186:187], v22 offset:59392
    s_waitcnt lgkmcnt(6)
    v_mfma_f32_32x32x16_bf16 v[240:255], a[204:207], a[128:131], v[240:255]
    ds_read_b64_tr_b16 a[188:189], v23 offset:57344
    ds_read_b64_tr_b16 a[190:191], v23 offset:59392
    s_waitcnt lgkmcnt(6)
    v_mfma_f32_32x32x16_bf16 v[128:143], a[176:179], a[132:135], v[128:143]
    ds_read_b64_tr_b16 a[192:193], v20 offset:57600
    ds_read_b64_tr_b16 a[194:195], v20 offset:59648
    s_waitcnt lgkmcnt(6)
    v_mfma_f32_32x32x16_bf16 v[144:159], a[180:183], a[132:135], v[144:159]
    ds_read_b64_tr_b16 a[196:197], v21 offset:57600
    ds_read_b64_tr_b16 a[198:199], v21 offset:59648
    s_mov_b32 s43, 2686336
    buffer_load_dwordx4 v10, s[20:23], s43 offen offset:1024 lds
    s_waitcnt lgkmcnt(6)
    v_mfma_f32_32x32x16_bf16 v[160:175], a[184:187], a[132:135], v[160:175]
    ds_read_b64_tr_b16 a[200:201], v22 offset:57600
    ds_read_b64_tr_b16 a[202:203], v22 offset:59648
    s_waitcnt lgkmcnt(6)
    v_mfma_f32_32x32x16_bf16 v[176:191], a[188:191], a[132:135], v[176:191]
    ds_read_b64_tr_b16 a[204:205], v23 offset:57600
    ds_read_b64_tr_b16 a[206:207], v23 offset:59648
    s_waitcnt lgkmcnt(6)
    v_mfma_f32_32x32x16_bf16 v[192:207], a[192:195], a[132:135], v[192:207]
    s_waitcnt vmcnt(22)
    s_barrier
    v_add_u32 v20, 0x10000, v20
    ds_read_b64_tr_b16 a[176:177], v20 offset:0
    ds_read_b64_tr_b16 a[178:179], v20 offset:2048
    s_waitcnt lgkmcnt(6)
    v_mfma_f32_32x32x16_bf16 v[208:223], a[196:199], a[132:135], v[208:223]
    v_add_u32 v21, 0x10000, v21
    ds_read_b64_tr_b16 a[180:181], v21 offset:0
    ds_read_b64_tr_b16 a[182:183], v21 offset:2048
    s_mov_b32 s43, 2750848
    buffer_load_dwordx4 v10, s[20:23], s43 offen offset:2048 lds
    s_waitcnt lgkmcnt(6)
    v_mfma_f32_32x32x16_bf16 v[224:239], a[200:203], a[132:135], v[224:239]
    v_add_u32 v22, 0x10000, v22
    ds_read_b64_tr_b16 a[184:185], v22 offset:0
    ds_read_b64_tr_b16 a[186:187], v22 offset:2048
    s_waitcnt lgkmcnt(6)
    v_mfma_f32_32x32x16_bf16 v[240:255], a[204:207], a[132:135], v[240:255]
    v_add_u32 v23, 0x10000, v23
    ds_read_b64_tr_b16 a[188:189], v23 offset:0
    ds_read_b64_tr_b16 a[190:191], v23 offset:2048
    s_mov_b32 s43, 2815360
    buffer_load_dwordx4 v10, s[20:23], s43 offen offset:3072 lds
    s_waitcnt lgkmcnt(6)
    v_mfma_f32_32x32x16_bf16 v[128:143], a[176:179], a[136:139], v[128:143]
    ds_read_b64_tr_b16 a[192:193], v20 offset:256
    ds_read_b64_tr_b16 a[194:195], v20 offset:2304
    s_waitcnt lgkmcnt(6)
    v_mfma_f32_32x32x16_bf16 v[144:159], a[180:183], a[136:139], v[144:159]
    ds_read_b64_tr_b16 a[196:197], v21 offset:256
    ds_read_b64_tr_b16 a[198:199], v21 offset:2304
    s_add_u32 m0, s42, 16384
    s_mov_b32 s43, 0
    buffer_load_dwordx4 v11, s[24:27], s43 offen offset:0 nt lds
    s_waitcnt lgkmcnt(6)
    v_mfma_f32_32x32x16_bf16 v[160:175], a[184:187], a[136:139], v[160:175]
    ds_read_b64_tr_b16 a[200:201], v22 offset:256
    ds_read_b64_tr_b16 a[202:203], v22 offset:2304
    s_waitcnt lgkmcnt(6)
    v_mfma_f32_32x32x16_bf16 v[176:191], a[188:191], a[136:139], v[176:191]
    ds_read_b64_tr_b16 a[204:205], v23 offset:256
    ds_read_b64_tr_b16 a[206:207], v23 offset:2304
    buffer_load_dwordx4 v12, s[24:27], s43 offen offset:1024 nt lds
    s_waitcnt lgkmcnt(6)
    v_mfma_f32_32x32x16_bf16 v[192:207], a[192:195], a[136:139], v[192:207]
    ds_read_b64_tr_b16 a[176:177], v20 offset:8192
    ds_read_b64_tr_b16 a[178:179], v20 offset:10240
    s_waitcnt lgkmcnt(6)
    v_mfma_f32_32x32x16_bf16 v[208:223], a[196:199], a[136:139], v[208:223]
    ds_read_b64_tr_b16 a[180:181], v21 offset:8192
    ds_read_b64_tr_b16 a[182:183], v21 offset:10240
    buffer_load_dwordx4 v11, s[24:27], s43 offen offset:2048 nt lds
    s_waitcnt lgkmcnt(6)
    v_mfma_f32_32x32x16_bf16 v[224:239], a[200:203], a[136:139], v[224:239]
    ds_read_b64_tr_b16 a[184:185], v22 offset:8192
    ds_read_b64_tr_b16 a[186:187], v22 offset:10240
    s_waitcnt lgkmcnt(6)
    v_mfma_f32_32x32x16_bf16 v[240:255], a[204:207], a[136:139], v[240:255]
    ds_read_b64_tr_b16 a[188:189], v23 offset:8192
    ds_read_b64_tr_b16 a[190:191], v23 offset:10240
    buffer_load_dwordx4 v12, s[24:27], s43 offen offset:3072 nt lds
    s_waitcnt lgkmcnt(6)
    v_mfma_f32_32x32x16_bf16 v[128:143], a[176:179], a[140:143], v[128:143]
    ds_read_b64_tr_b16 a[192:193], v20 offset:8448
    ds_read_b64_tr_b16 a[194:195], v20 offset:10496
    s_waitcnt lgkmcnt(6)
    v_mfma_f32_32x32x16_bf16 v[144:159], a[180:183], a[140:143], v[144:159]
    ds_read_b64_tr_b16 a[196:197], v21 offset:8448
    ds_read_b64_tr_b16 a[198:199], v21 offset:10496
    s_waitcnt lgkmcnt(6)
    v_mfma_f32_32x32x16_bf16 v[160:175], a[184:187], a[140:143], v[160:175]
    ds_read_b64_tr_b16 a[200:201], v22 offset:8448
    ds_read_b64_tr_b16 a[202:203], v22 offset:10496
    s_waitcnt lgkmcnt(6)
    v_mfma_f32_32x32x16_bf16 v[176:191], a[188:191], a[140:143], v[176:191]
    ds_read_b64_tr_b16 a[204:205], v23 offset:8448
    ds_read_b64_tr_b16 a[206:207], v23 offset:10496
    s_add_u32 m0, s42, 32768
    s_mov_b32 s43, 16384
    buffer_load_dwordx4 v11, s[24:27], s43 offen offset:0 nt lds
    s_waitcnt lgkmcnt(6)
    v_mfma_f32_32x32x16_bf16 v[192:207], a[192:195], a[140:143], v[192:207]
    s_waitcnt vmcnt(17)
    s_barrier
    v_add_u32 v114, 0x10000, v114
    ds_read_b64_tr_b16 a[176:177], v114 offset:49152
    ds_read_b64_tr_b16 a[178:179], v114 offset:49664
    s_waitcnt lgkmcnt(6)
    v_mfma_f32_32x32x16_bf16 v[208:223], a[196:199], a[140:143], v[208:223]
    v_add_u32 v115, 0x10000, v115
    ds_read_b64_tr_b16 a[180:181], v115 offset:49152
    ds_read_b64_tr_b16 a[182:183], v115 offset:49664
    v_add_u32 v16, 0x10000, v16
    ds_read_b128 a[144:147], v16 offset:16384
    buffer_load_dwordx4 v12, s[24:27], s43 offen offset:1024 nt lds
    s_waitcnt lgkmcnt(7)
    v_mfma_f32_32x32x16_bf16 v[224:239], a[200:203], a[140:143], v[224:239]
    ds_read_b64_tr_b16 a[184:185], v114 offset:51200
    ds_read_b64_tr_b16 a[186:187], v114 offset:51712
    v_add_u32 v17, 0x10000, v17
    ds_read_b128 a[148:151], v17 offset:16384
    s_waitcnt lgkmcnt(8)
    v_mfma_f32_32x32x16_bf16 v[240:255], a[204:207], a[140:143], v[240:255]
    ds_read_b64_tr_b16 a[188:189], v115 offset:51200
    ds_read_b64_tr_b16 a[190:191], v115 offset:51712
    v_add_u32 v18, 0x10000, v18
    ds_read_b128 a[152:155], v18 offset:16384
    buffer_load_dwordx4 v11, s[24:27], s43 offen offset:2048 nt lds
    s_waitcnt lgkmcnt(6)
    v_mfma_f32_32x32x16_bf16 v[128:143], a[176:179], a[144:147], v[128:143]
    ds_read_b64_tr_b16 a[192:193], v114 offset:53248
    ds_read_b64_tr_b16 a[194:195], v114 offset:53760
    v_add_u32 v19, 0x10000, v19
    ds_read_b128 a[156:159], v19 offset:16384
    v_mfma_f32_32x32x16_bf16 v[144:159], a[180:183], a[144:147], v[144:159]
    ds_read_b64_tr_b16 a[196:197], v115 offset:53248
    ds_read_b64_tr_b16 a[198:199], v115 offset:53760
    ds_read_b128 a[160:163], v16 offset:32768
    buffer_load_dwordx4 v12, s[24:27], s43 offen offset:3072 nt lds
    s_waitcnt lgkmcnt(9)
    v_mfma_f32_32x32x16_bf16 v[128:143], a[184:187], a[148:151], v[128:143]
    ds_read_b64_tr_b16 a[200:201], v114 offset:55296
    ds_read_b64_tr_b16 a[202:203], v114 offset:55808
    ds_read_b128 a[164:167], v17 offset:32768
    s_waitcnt lgkmcnt(10)
    v_mfma_f32_32x32x16_bf16 v[144:159], a[188:191], a[148:151], v[144:159]
    ds_read_b64_tr_b16 a[204:205], v115 offset:55296
    ds_read_b64_tr_b16 a[206:207], v115 offset:55808
    ds_read_b128 a[168:171], v18 offset:32768
    s_waitcnt lgkmcnt(10)
    v_mfma_f32_32x32x16_bf16 v[128:143], a[192:195], a[152:155], v[128:143]
    ds_read_b64_tr_b16 a[176:177], v114 offset:57344
    ds_read_b64_tr_b16 a[178:179], v114 offset:57856
    ds_read_b128 a[172:175], v19 offset:32768
    s_waitcnt lgkmcnt(10)
    v_mfma_f32_32x32x16_bf16 v[144:159], a[196:199], a[152:155], v[144:159]
    ds_read_b64_tr_b16 a[180:181], v115 offset:57344
    ds_read_b64_tr_b16 a[182:183], v115 offset:57856
    s_add_u32 m0, s42, 49152
    s_mov_b32 s43, 32768
    buffer_load_dwordx4 v11, s[24:27], s43 offen offset:0 nt lds
    s_waitcnt lgkmcnt(9)
    v_mfma_f32_32x32x16_bf16 v[128:143], a[200:203], a[156:159], v[128:143]
    ds_read_b64_tr_b16 a[184:185], v114 offset:59392
    ds_read_b64_tr_b16 a[186:187], v114 offset:59904
    s_waitcnt lgkmcnt(8)
    v_mfma_f32_32x32x16_bf16 v[144:159], a[204:207], a[156:159], v[144:159]
    ds_read_b64_tr_b16 a[188:189], v115 offset:59392
    ds_read_b64_tr_b16 a[190:191], v115 offset:59904
    s_waitcnt lgkmcnt(7)
    v_mfma_f32_32x32x16_bf16 v[128:143], a[176:179], a[160:163], v[128:143]
    ds_read_b64_tr_b16 a[192:193], v114 offset:61440
    ds_read_b64_tr_b16 a[194:195], v114 offset:61952
    s_waitcnt lgkmcnt(6)
    v_mfma_f32_32x32x16_bf16 v[144:159], a[180:183], a[160:163], v[144:159]
    ds_read_b64_tr_b16 a[196:197], v115 offset:61440
    ds_read_b64_tr_b16 a[198:199], v115 offset:61952
    buffer_load_dwordx4 v12, s[24:27], s43 offen offset:1024 nt lds
    s_waitcnt lgkmcnt(6)
    v_mfma_f32_32x32x16_bf16 v[128:143], a[184:187], a[164:167], v[128:143]
    ds_read_b64_tr_b16 a[200:201], v114 offset:63488
    ds_read_b64_tr_b16 a[202:203], v114 offset:64000
    s_waitcnt lgkmcnt(6)
    v_mfma_f32_32x32x16_bf16 v[144:159], a[188:191], a[164:167], v[144:159]
    ds_read_b64_tr_b16 a[204:205], v115 offset:63488
    ds_read_b64_tr_b16 a[206:207], v115 offset:64000
    s_waitcnt lgkmcnt(6)
    v_mfma_f32_32x32x16_bf16 v[128:143], a[192:195], a[168:171], v[128:143]
    s_waitcnt vmcnt(18)
    s_barrier
    v_add_u32 v114, 0x10000, v114
    ds_read_b64_tr_b16 a[176:177], v114 offset:0
    ds_read_b64_tr_b16 a[178:179], v114 offset:512
    s_waitcnt lgkmcnt(6)
    v_mfma_f32_32x32x16_bf16 v[144:159], a[196:199], a[168:171], v[144:159]
    v_add_u32 v115, 0x10000, v115
    ds_read_b64_tr_b16 a[180:181], v115 offset:0
    ds_read_b64_tr_b16 a[182:183], v115 offset:512
    buffer_load_dwordx4 v11, s[24:27], s43 offen offset:2048 nt lds
    s_waitcnt lgkmcnt(6)
    v_mfma_f32_32x32x16_bf16 v[128:143], a[200:203], a[172:175], v[128:143]
    ds_read_b64_tr_b16 a[184:185], v114 offset:2048
    ds_read_b64_tr_b16 a[186:187], v114 offset:2560
    s_waitcnt lgkmcnt(6)
    v_mfma_f32_32x32x16_bf16 v[144:159], a[204:207], a[172:175], v[144:159]
    ds_read_b64_tr_b16 a[188:189], v115 offset:2048
    ds_read_b64_tr_b16 a[190:191], v115 offset:2560
    buffer_load_dwordx4 v12, s[24:27], s43 offen offset:3072 nt lds
    s_waitcnt lgkmcnt(6)
    v_mfma_f32_32x32x16_bf16 v[160:175], a[176:179], a[144:147], v[160:175]
    ds_read_b64_tr_b16 a[192:193], v114 offset:4096
    ds_read_b64_tr_b16 a[194:195], v114 offset:4608
    s_waitcnt lgkmcnt(6)
    v_mfma_f32_32x32x16_bf16 v[176:191], a[180:183], a[144:147], v[176:191]
    ds_read_b64_tr_b16 a[196:197], v115 offset:4096
    ds_read_b64_tr_b16 a[198:199], v115 offset:4608
    s_add_u32 m0, s42, 65536
    s_mov_b32 s43, 49152
    buffer_load_dwordx4 v11, s[24:27], s43 offen offset:0 nt lds
    v_mul_f32 v128, s44, v128
    s_waitcnt lgkmcnt(6)
    v_mfma_f32_32x32x16_bf16 v[160:175], a[184:187], a[148:151], v[160:175]
    ds_read_b64_tr_b16 a[200:201], v114 offset:6144
    ds_read_b64_tr_b16 a[202:203], v114 offset:6656
    v_mul_f32 v129, s44, v129
    v_mul_f32 v130, s44, v130
    v_mul_f32 v131, s44, v131
    v_mul_f32 v132, s44, v132
    s_waitcnt lgkmcnt(6)
    v_mfma_f32_32x32x16_bf16 v[176:191], a[188:191], a[148:151], v[176:191]
    ds_read_b64_tr_b16 a[204:205], v115 offset:6144
    ds_read_b64_tr_b16 a[206:207], v115 offset:6656
    buffer_load_dwordx4 v12, s[24:27], s43 offen offset:1024 nt lds
    v_mul_f32 v133, s44, v133
    v_mul_f32 v134, s44, v134
    v_mul_f32 v135, s44, v135
    s_waitcnt lgkmcnt(6)
    v_mfma_f32_32x32x16_bf16 v[160:175], a[192:195], a[152:155], v[160:175]
    ds_read_b64_tr_b16 a[176:177], v114 offset:8192
    ds_read_b64_tr_b16 a[178:179], v114 offset:8704
    v_cvt_pk_bf16_f32 v128, v128, v129
    v_cvt_pk_bf16_f32 v130, v130, v131
    v_cvt_pk_bf16_f32 v132, v132, v133
    v_cvt_pk_bf16_f32 v134, v134, v135
    s_waitcnt lgkmcnt(6)
    v_mfma_f32_32x32x16_bf16 v[176:191], a[196:199], a[152:155], v[176:191]
    ds_read_b64_tr_b16 a[180:181], v115 offset:8192
    ds_read_b64_tr_b16 a[182:183], v115 offset:8704
    buffer_load_dwordx4 v11, s[24:27], s43 offen offset:2048 nt lds
    v_accvgpr_write_b32 a0, v128
    v_accvgpr_write_b32 a1, v130
    v_accvgpr_write_b32 a2, v132
    s_waitcnt lgkmcnt(6)
    v_mfma_f32_32x32x16_bf16 v[160:175], a[200:203], a[156:159], v[160:175]
    ds_read_b64_tr_b16 a[184:185], v114 offset:10240
    ds_read_b64_tr_b16 a[186:187], v114 offset:10752
    v_accvgpr_write_b32 a3, v134
    v_mul_f32 v136, s44, v136
    v_mul_f32 v137, s44, v137
    v_mul_f32 v138, s44, v138
    s_waitcnt lgkmcnt(6)
    v_mfma_f32_32x32x16_bf16 v[176:191], a[204:207], a[156:159], v[176:191]
    ds_read_b64_tr_b16 a[188:189], v115 offset:10240
    ds_read_b64_tr_b16 a[190:191], v115 offset:10752
    buffer_load_dwordx4 v12, s[24:27], s43 offen offset:3072 nt lds
    v_mul_f32 v139, s44, v139
    v_mul_f32 v140, s44, v140
    v_mul_f32 v141, s44, v141
    s_waitcnt lgkmcnt(6)
    v_mfma_f32_32x32x16_bf16 v[160:175], a[176:179], a[160:163], v[160:175]
    ds_read_b64_tr_b16 a[192:193], v114 offset:12288
    ds_read_b64_tr_b16 a[194:195], v114 offset:12800
    v_mul_f32 v142, s44, v142
    v_mul_f32 v143, s44, v143
    v_cvt_pk_bf16_f32 v136, v136, v137
    v_cvt_pk_bf16_f32 v138, v138, v139
    s_waitcnt lgkmcnt(6)
    v_mfma_f32_32x32x16_bf16 v[176:191], a[180:183], a[160:163], v[176:191]
    ds_read_b64_tr_b16 a[196:197], v115 offset:12288
    ds_read_b64_tr_b16 a[198:199], v115 offset:12800
    s_add_u32 m0, s42, 81920
    s_mov_b32 s43, 65536
    buffer_load_dwordx4 v11, s[24:27], s43 offen offset:0 nt lds
    v_cvt_pk_bf16_f32 v140, v140, v141
    s_waitcnt lgkmcnt(6)
    v_mfma_f32_32x32x16_bf16 v[160:175], a[184:187], a[164:167], v[160:175]
    ds_read_b64_tr_b16 a[200:201], v114 offset:14336
    ds_read_b64_tr_b16 a[202:203], v114 offset:14848
    v_cvt_pk_bf16_f32 v142, v142, v143
    v_accvgpr_write_b32 a4, v136
    v_accvgpr_write_b32 a5, v138
    v_accvgpr_write_b32 a6, v140
    s_waitcnt lgkmcnt(6)
    v_mfma_f32_32x32x16_bf16 v[176:191], a[188:191], a[164:167], v[176:191]
    ds_read_b64_tr_b16 a[204:205], v115 offset:14336
    ds_read_b64_tr_b16 a[206:207], v115 offset:14848
    buffer_load_dwordx4 v12, s[24:27], s43 offen offset:1024 nt lds
    v_accvgpr_write_b32 a7, v142
    v_mul_f32 v144, s44, v144
    v_mul_f32 v145, s44, v145
    s_waitcnt lgkmcnt(6)
    v_mfma_f32_32x32x16_bf16 v[160:175], a[192:195], a[168:171], v[160:175]
    s_waitcnt vmcnt(22)
    s_barrier
    ds_read_b64_tr_b16 a[176:177], v114 offset:16384
    ds_read_b64_tr_b16 a[178:179], v114 offset:16896
    s_waitcnt lgkmcnt(6)
    v_mfma_f32_32x32x16_bf16 v[176:191], a[196:199], a[168:171], v[176:191]
    ds_read_b64_tr_b16 a[180:181], v115 offset:16384
    ds_read_b64_tr_b16 a[182:183], v115 offset:16896
    buffer_load_dwordx4 v11, s[24:27], s43 offen offset:2048 nt lds
    v_mul_f32 v146, s44, v146
    v_mul_f32 v147, s44, v147
    v_mul_f32 v148, s44, v148
    s_waitcnt lgkmcnt(6)
    v_mfma_f32_32x32x16_bf16 v[160:175], a[200:203], a[172:175], v[160:175]
    ds_read_b64_tr_b16 a[184:185], v114 offset:18432
    ds_read_b64_tr_b16 a[186:187], v114 offset:18944
    v_mul_f32 v149, s44, v149
    v_mul_f32 v150, s44, v150
    v_mul_f32 v151, s44, v151
    v_cvt_pk_bf16_f32 v144, v144, v145
    s_waitcnt lgkmcnt(6)
    v_mfma_f32_32x32x16_bf16 v[176:191], a[204:207], a[172:175], v[176:191]
    ds_read_b64_tr_b16 a[188:189], v115 offset:18432
    ds_read_b64_tr_b16 a[190:191], v115 offset:18944
    buffer_load_dwordx4 v12, s[24:27], s43 offen offset:3072 nt lds
    v_cvt_pk_bf16_f32 v146, v146, v147
    v_cvt_pk_bf16_f32 v148, v148, v149
    v_cvt_pk_bf16_f32 v150, v150, v151
    s_waitcnt lgkmcnt(6)
    v_mfma_f32_32x32x16_bf16 v[192:207], a[176:179], a[144:147], v[192:207]
    ds_read_b64_tr_b16 a[192:193], v114 offset:20480
    ds_read_b64_tr_b16 a[194:195], v114 offset:20992
    v_accvgpr_write_b32 a8, v144
    v_accvgpr_write_b32 a9, v146
    v_accvgpr_write_b32 a10, v148
    v_accvgpr_write_b32 a11, v150
    s_waitcnt lgkmcnt(6)
    v_mfma_f32_32x32x16_bf16 v[208:223], a[180:183], a[144:147], v[208:223]
    ds_read_b64_tr_b16 a[196:197], v115 offset:20480
    ds_read_b64_tr_b16 a[198:199], v115 offset:20992
    s_add_u32 m0, s42, 98304
    s_mov_b32 s43, 81920
    buffer_load_dwordx4 v11, s[24:27], s43 offen offset:0 nt lds
    v_mul_f32 v152, s44, v152
    s_waitcnt lgkmcnt(6)
    v_mfma_f32_32x32x16_bf16 v[192:207], a[184:187], a[148:151], v[192:207]
    ds_read_b64_tr_b16 a[200:201], v114 offset:22528
    ds_read_b64_tr_b16 a[202:203], v114 offset:23040
    v_mul_f32 v153, s44, v153
    v_mul_f32 v154, s44, v154
    v_mul_f32 v155, s44, v155
    v_mul_f32 v156, s44, v156
    s_waitcnt lgkmcnt(6)
    v_mfma_f32_32x32x16_bf16 v[208:223], a[188:191], a[148:151], v[208:223]
    ds_read_b64_tr_b16 a[204:205], v115 offset:22528
    ds_read_b64_tr_b16 a[206:207], v115 offset:23040
    buffer_load_dwordx4 v12, s[24:27], s43 offen offset:1024 nt lds
    v_mul_f32 v157, s44, v157
    v_mul_f32 v158, s44, v158
    v_mul_f32 v159, s44, v159
    s_waitcnt lgkmcnt(6)
    v_mfma_f32_32x32x16_bf16 v[192:207], a[192:195], a[152:155], v[192:207]
    ds_read_b64_tr_b16 a[176:177], v114 offset:24576
    ds_read_b64_tr_b16 a[178:179], v114 offset:25088
    v_cvt_pk_bf16_f32 v152, v152, v153
    v_cvt_pk_bf16_f32 v154, v154, v155
    v_cvt_pk_bf16_f32 v156, v156, v157
    v_cvt_pk_bf16_f32 v158, v158, v159
    s_waitcnt lgkmcnt(6)
    v_mfma_f32_32x32x16_bf16 v[208:223], a[196:199], a[152:155], v[208:223]
    ds_read_b64_tr_b16 a[180:181], v115 offset:24576
    ds_read_b64_tr_b16 a[182:183], v115 offset:25088
    buffer_load_dwordx4 v11, s[24:27], s43 offen offset:2048 nt lds
    v_accvgpr_write_b32 a12, v152
    v_accvgpr_write_b32 a13, v154
    v_accvgpr_write_b32 a14, v156
    s_waitcnt lgkmcnt(6)
    v_mfma_f32_32x32x16_bf16 v[192:207], a[200:203], a[156:159], v[192:207]
    ds_read_b64_tr_b16 a[184:185], v114 offset:26624
    ds_read_b64_tr_b16 a[186:187], v114 offset:27136
    v_accvgpr_write_b32 a15, v158
    v_mul_f32 v160, s44, v160
    v_mul_f32 v161, s44, v161
    v_mul_f32 v162, s44, v162
    s_waitcnt lgkmcnt(6)
    v_mfma_f32_32x32x16_bf16 v[208:223], a[204:207], a[156:159], v[208:223]
    ds_read_b64_tr_b16 a[188:189], v115 offset:26624
    ds_read_b64_tr_b16 a[190:191], v115 offset:27136
    buffer_load_dwordx4 v12, s[24:27], s43 offen offset:3072 nt lds
    v_mul_f32 v163, s44, v163
    v_mul_f32 v164, s44, v164
    v_mul_f32 v165, s44, v165
    s_waitcnt lgkmcnt(6)
    v_mfma_f32_32x32x16_bf16 v[192:207], a[176:179], a[160:163], v[192:207]
    ds_read_b64_tr_b16 a[192:193], v114 offset:28672
    ds_read_b64_tr_b16 a[194:195], v114 offset:29184
    v_mul_f32 v166, s44, v166
    v_mul_f32 v167, s44, v167
    v_cvt_pk_bf16_f32 v160, v160, v161
    v_cvt_pk_bf16_f32 v162, v162, v163
    s_waitcnt lgkmcnt(6)
    v_mfma_f32_32x32x16_bf16 v[208:223], a[180:183], a[160:163], v[208:223]
    ds_read_b64_tr_b16 a[196:197], v115 offset:28672
    ds_read_b64_tr_b16 a[198:199], v115 offset:29184
    v_cvt_pk_bf16_f32 v164, v164, v165
    v_cvt_pk_bf16_f32 v166, v166, v167
    v_accvgpr_write_b32 a16, v160
    v_accvgpr_write_b32 a17, v162
    s_waitcnt lgkmcnt(6)
    v_mfma_f32_32x32x16_bf16 v[192:207], a[184:187], a[164:167], v[192:207]
    ds_read_b64_tr_b16 a[200:201], v114 offset:30720
    ds_read_b64_tr_b16 a[202:203], v114 offset:31232
    v_accvgpr_write_b32 a18, v164
    v_accvgpr_write_b32 a19, v166
    v_mul_f32 v168, s44, v168
    v_mul_f32 v169, s44, v169
    s_waitcnt lgkmcnt(6)
    v_mfma_f32_32x32x16_bf16 v[208:223], a[188:191], a[164:167], v[208:223]
    ds_read_b64_tr_b16 a[204:205], v115 offset:30720
    ds_read_b64_tr_b16 a[206:207], v115 offset:31232
    s_add_u32 m0, s42, 114688
    s_mov_b32 s43, 98304
    buffer_load_dwordx4 v11, s[24:27], s43 offen offset:0 nt lds
    v_mul_f32 v170, s44, v170
    s_waitcnt lgkmcnt(6)
    v_mfma_f32_32x32x16_bf16 v[192:207], a[192:195], a[168:171], v[192:207]
    s_waitcnt vmcnt(25)
    s_barrier
    v_add_u32 v114, 0xfffe0000, v114
    ds_read_b64_tr_b16 a[176:177], v114 offset:0
    ds_read_b64_tr_b16 a[178:179], v114 offset:512
    s_waitcnt lgkmcnt(6)
    v_mfma_f32_32x32x16_bf16 v[208:223], a[196:199], a[168:171], v[208:223]
    v_add_u32 v115, 0xfffe0000, v115
    ds_read_b64_tr_b16 a[180:181], v115 offset:0
    ds_read_b64_tr_b16 a[182:183], v115 offset:512
    buffer_load_dwordx4 v12, s[24:27], s43 offen offset:1024 nt lds
    v_mul_f32 v171, s44, v171
    v_mul_f32 v172, s44, v172
    s_waitcnt lgkmcnt(6)
    v_mfma_f32_32x32x16_bf16 v[192:207], a[200:203], a[172:175], v[192:207]
    ds_read_b64_tr_b16 a[184:185], v114 offset:2048
    ds_read_b64_tr_b16 a[186:187], v114 offset:2560
    v_mul_f32 v173, s44, v173
    v_mul_f32 v174, s44, v174
    v_mul_f32 v175, s44, v175
    v_cvt_pk_bf16_f32 v168, v168, v169
    s_waitcnt lgkmcnt(6)
    v_mfma_f32_32x32x16_bf16 v[208:223], a[204:207], a[172:175], v[208:223]
    ds_read_b64_tr_b16 a[188:189], v115 offset:2048
    ds_read_b64_tr_b16 a[190:191], v115 offset:2560
    buffer_load_dwordx4 v11, s[24:27], s43 offen offset:2048 nt lds
    v_cvt_pk_bf16_f32 v170, v170, v171
    v_cvt_pk_bf16_f32 v172, v172, v173
    v_cvt_pk_bf16_f32 v174, v174, v175
    s_waitcnt lgkmcnt(6)
    v_mfma_f32_32x32x16_bf16 v[224:239], a[176:179], a[144:147], v[224:239]
    ds_read_b64_tr_b16 a[192:193], v114 offset:4096
    ds_read_b64_tr_b16 a[194:195], v114 offset:4608
    v_accvgpr_write_b32 a20, v168
    v_accvgpr_write_b32 a21, v170
    v_accvgpr_write_b32 a22, v172
    v_accvgpr_write_b32 a23, v174
    s_waitcnt lgkmcnt(6)
    v_mfma_f32_32x32x16_bf16 v[240:255], a[180:183], a[144:147], v[240:255]
    ds_read_b64_tr_b16 a[196:197], v115 offset:4096
    ds_read_b64_tr_b16 a[198:199], v115 offset:4608
    buffer_load_dwordx4 v12, s[24:27], s43 offen offset:3072 nt lds
    v_mul_f32 v176, s44, v176
    v_mul_f32 v177, s44, v177
    v_mul_f32 v178, s44, v178
    s_waitcnt lgkmcnt(6)
    v_mfma_f32_32x32x16_bf16 v[224:239], a[184:187], a[148:151], v[224:239]
    ds_read_b64_tr_b16 a[200:201], v114 offset:6144
    ds_read_b64_tr_b16 a[202:203], v114 offset:6656
    v_mul_f32 v179, s44, v179
    v_mul_f32 v180, s44, v180
    v_mul_f32 v181, s44, v181
    v_mul_f32 v182, s44, v182
    s_waitcnt lgkmcnt(6)
    v_mfma_f32_32x32x16_bf16 v[240:255], a[188:191], a[148:151], v[240:255]
    ds_read_b64_tr_b16 a[204:205], v115 offset:6144
    ds_read_b64_tr_b16 a[206:207], v115 offset:6656
    v_mul_f32 v183, s44, v183
    v_cvt_pk_bf16_f32 v176, v176, v177
    v_cvt_pk_bf16_f32 v178, v178, v179
    v_cvt_pk_bf16_f32 v180, v180, v181
    s_waitcnt lgkmcnt(6)
    v_mfma_f32_32x32x16_bf16 v[224:239], a[192:195], a[152:155], v[224:239]
    ds_read_b64_tr_b16 a[176:177], v114 offset:8192
    ds_read_b64_tr_b16 a[178:179], v114 offset:8704
    v_cvt_pk_bf16_f32 v182, v182, v183
    v_accvgpr_write_b32 a24, v176
    v_accvgpr_write_b32 a25, v178
    v_accvgpr_write_b32 a26, v180
    s_waitcnt lgkmcnt(6)
    v_mfma_f32_32x32x16_bf16 v[240:255], a[196:199], a[152:155], v[240:255]
    ds_read_b64_tr_b16 a[180:181], v115 offset:8192
    ds_read_b64_tr_b16 a[182:183], v115 offset:8704
    s_add_u32 m0, s42, 131072
    s_mov_b32 s43, 114688
    buffer_load_dwordx4 v11, s[24:27], s43 offen offset:0 nt lds
    v_accvgpr_write_b32 a27, v182
    s_waitcnt lgkmcnt(6)
    v_mfma_f32_32x32x16_bf16 v[224:239], a[200:203], a[156:159], v[224:239]
    ds_read_b64_tr_b16 a[184:185], v114 offset:10240
    ds_read_b64_tr_b16 a[186:187], v114 offset:10752
    v_mul_f32 v184, s44, v184
    v_mul_f32 v185, s44, v185
    v_mul_f32 v186, s44, v186
    v_mul_f32 v187, s44, v187
    s_waitcnt lgkmcnt(6)
    v_mfma_f32_32x32x16_bf16 v[240:255], a[204:207], a[156:159], v[240:255]
    ds_read_b64_tr_b16 a[188:189], v115 offset:10240
    ds_read_b64_tr_b16 a[190:191], v115 offset:10752
    v_mul_f32 v188, s44, v188
    v_mul_f32 v189, s44, v189
    v_mul_f32 v190, s44, v190
    v_mul_f32 v191, s44, v191
    s_waitcnt lgkmcnt(6)
    v_mfma_f32_32x32x16_bf16 v[224:239], a[176:179], a[160:163], v[224:239]
    ds_read_b64_tr_b16 a[192:193], v114 offset:12288
    ds_read_b64_tr_b16 a[194:195], v114 offset:12800
    v_cvt_pk_bf16_f32 v184, v184, v185
    v_cvt_pk_bf16_f32 v186, v186, v187
    v_cvt_pk_bf16_f32 v188, v188, v189
    v_cvt_pk_bf16_f32 v190, v190, v191
    s_waitcnt lgkmcnt(6)
    v_mfma_f32_32x32x16_bf16 v[240:255], a[180:183], a[160:163], v[240:255]
    ds_read_b64_tr_b16 a[196:197], v115 offset:12288
    ds_read_b64_tr_b16 a[198:199], v115 offset:12800
    buffer_load_dwordx4 v12, s[24:27], s43 offen offset:1024 nt lds
    v_accvgpr_write_b32 a28, v184
    v_accvgpr_write_b32 a29, v186
    v_accvgpr_write_b32 a30, v188
    s_waitcnt lgkmcnt(6)
    v_mfma_f32_32x32x16_bf16 v[224:239], a[184:187], a[164:167], v[224:239]
    ds_read_b64_tr_b16 a[200:201], v114 offset:14336
    ds_read_b64_tr_b16 a[202:203], v114 offset:14848
    v_accvgpr_write_b32 a31, v190
    v_mul_f32 v192, s44, v192
    v_mul_f32 v193, s44, v193
    v_mul_f32 v194, s44, v194
    s_waitcnt lgkmcnt(6)
    v_mfma_f32_32x32x16_bf16 v[240:255], a[188:191], a[164:167], v[240:255]
    ds_read_b64_tr_b16 a[204:205], v115 offset:14336
    ds_read_b64_tr_b16 a[206:207], v115 offset:14848
    v_mul_f32 v195, s44, v195
    v_mul_f32 v196, s44, v196
    v_mul_f32 v197, s44, v197
    v_mul_f32 v198, s44, v198
    s_waitcnt lgkmcnt(6)
    v_mfma_f32_32x32x16_bf16 v[224:239], a[192:195], a[168:171], v[224:239]
    s_waitcnt vmcnt(26)
    s_barrier
    ds_read_b128 a[176:179], v24 offset:16384
    v_mul_f32 v199, s44, v199
    s_waitcnt lgkmcnt(5)
    v_mfma_f32_32x32x16_bf16 v[240:255], a[196:199], a[168:171], v[240:255]
    ds_read_b128 a[180:183], v25 offset:16384
    buffer_load_dwordx4 v11, s[24:27], s43 offen offset:2048 nt lds
    v_cvt_pk_bf16_f32 v192, v192, v193
    v_cvt_pk_bf16_f32 v194, v194, v195
    v_cvt_pk_bf16_f32 v196, v196, v197
    v_cvt_pk_bf16_f32 v198, v198, v199
    s_waitcnt lgkmcnt(4)
    v_mfma_f32_32x32x16_bf16 v[224:239], a[200:203], a[172:175], v[224:239]
    ds_read_b128 a[184:187], v26 offset:16384
    v_accvgpr_write_b32 a32, v192
    v_accvgpr_write_b32 a33, v194
    v_accvgpr_write_b32 a34, v196
    v_accvgpr_write_b32 a35, v198
    v_mul_f32 v200, s44, v200
    s_waitcnt lgkmcnt(3)
    v_mfma_f32_32x32x16_bf16 v[240:255], a[204:207], a[172:175], v[240:255]
    ds_read_b128 a[188:191], v27 offset:16384
    buffer_load_dwordx4 v12, s[24:27], s43 offen offset:3072 nt lds
    v_mul_f32 v201, s44, v201
    v_mul_f32 v202, s44, v202
    v_mul_f32 v203, s44, v203
    v_mul_f32 v204, s44, v204
    s_waitcnt lgkmcnt(3)
    v_mfma_f32_32x32x16_bf16 v[64:79], a[176:179], a[0:3], 0
    ds_read_b128 a[192:195], v28 offset:16384
    v_mul_f32 v205, s44, v205
    v_mul_f32 v206, s44, v206
    v_mul_f32 v207, s44, v207
    v_cvt_pk_bf16_f32 v200, v200, v201
    v_cvt_pk_bf16_f32 v202, v202, v203
    s_waitcnt lgkmcnt(3)
    v_mfma_f32_32x32x16_bf16 v[64:79], a[180:183], a[4:7], v[64:79]
    ds_read_b128 a[196:199], v29 offset:16384
    v_cvt_pk_bf16_f32 v204, v204, v205
    v_cvt_pk_bf16_f32 v206, v206, v207
    v_accvgpr_write_b32 a36, v200
    v_accvgpr_write_b32 a37, v202
    v_accvgpr_write_b32 a38, v204
    s_waitcnt lgkmcnt(3)
    v_mfma_f32_32x32x16_bf16 v[64:79], a[184:187], a[8:11], v[64:79]
    ds_read_b128 a[200:203], v30 offset:16384
    v_accvgpr_write_b32 a39, v206
    v_mul_f32 v208, s44, v208
    v_mul_f32 v209, s44, v209
    v_mul_f32 v210, s44, v210
    v_mul_f32 v211, s44, v211
    s_waitcnt lgkmcnt(3)
    v_mfma_f32_32x32x16_bf16 v[64:79], a[188:191], a[12:15], v[64:79]
    ds_read_b128 a[204:207], v31 offset:16384
    s_add_u32 m0, s42, 147456
    s_mov_b32 s43, 131072
    buffer_load_dwordx4 v11, s[24:27], s43 offen offset:0 nt lds
    v_mul_f32 v212, s44, v212
    v_mul_f32 v213, s44, v213
    s_waitcnt lgkmcnt(3)
    v_mfma_f32_32x32x16_bf16 v[64:79], a[192:195], a[16:19], v[64:79]
    ds_read_b128 a[176:179], v24 offset:16640
    v_mul_f32 v214, s44, v214
    v_mul_f32 v215, s44, v215
    v_cvt_pk_bf16_f32 v208, v208, v209
    v_cvt_pk_bf16_f32 v210, v210, v211
    v_cvt_pk_bf16_f32 v212, v212, v213
    s_waitcnt lgkmcnt(3)
    v_mfma_f32_32x32x16_bf16 v[64:79], a[196:199], a[20:23], v[64:79]
    ds_read_b128 a[180:183], v25 offset:16640
    v_cvt_pk_bf16_f32 v214, v214, v215
    v_accvgpr_write_b32 a40, v208
    v_accvgpr_write_b32 a41, v210
    v_accvgpr_write_b32 a42, v212
    v_accvgpr_write_b32 a43, v214
    s_waitcnt lgkmcnt(3)
    v_mfma_f32_32x32x16_bf16 v[64:79], a[200:203], a[24:27], v[64:79]
    ds_read_b128 a[184:187], v26 offset:16640
    v_mul_f32 v216, s44, v216
    v_mul_f32 v217, s44, v217
    v_mul_f32 v218, s44, v218
    v_mul_f32 v219, s44, v219
    v_mul_f32 v220, s44, v220
    s_waitcnt lgkmcnt(3)
    v_mfma_f32_32x32x16_bf16 v[64:79], a[204:207], a[28:31], v[64:79]
    ds_read_b128 a[188:191], v27 offset:16640
    buffer_load_dwordx4 v12, s[24:27], s43 offen offset:1024 nt lds
    v_mul_f32 v221, s44, v221
    v_mul_f32 v222, s44, v222
    v_mul_f32 v223, s44, v223
    v_cvt_pk_bf16_f32 v216, v216, v217
    s_waitcnt lgkmcnt(3)
    v_mfma_f32_32x32x16_bf16 v[64:79], a[176:179], a[32:35], v[64:79]
    ds_read_b128 a[192:195], v28 offset:16640
    v_cvt_pk_bf16_f32 v218, v218, v219
    v_cvt_pk_bf16_f32 v220, v220, v221
    v_cvt_pk_bf16_f32 v222, v222, v223
    v_accvgpr_write_b32 a44, v216
    v_accvgpr_write_b32 a45, v218
    s_waitcnt lgkmcnt(3)
    v_mfma_f32_32x32x16_bf16 v[64:79], a[180:183], a[36:39], v[64:79]
    ds_read_b128 a[196:199], v29 offset:16640
    v_accvgpr_write_b32 a46, v220
    v_accvgpr_write_b32 a47, v222
    v_mul_f32 v224, s44, v224
    v_mul_f32 v225, s44, v225
    v_mul_f32 v226, s44, v226
    s_waitcnt lgkmcnt(3)
    v_mfma_f32_32x32x16_bf16 v[64:79], a[184:187], a[40:43], v[64:79]
    ds_read_b128 a[200:203], v30 offset:16640
    v_mul_f32 v227, s44, v227
    v_mul_f32 v228, s44, v228
    v_mul_f32 v229, s44, v229
    v_mul_f32 v230, s44, v230
    v_mul_f32 v231, s44, v231
    s_waitcnt lgkmcnt(3)
    v_mfma_f32_32x32x16_bf16 v[64:79], a[188:191], a[44:47], v[64:79]
    ds_read_b128 a[204:207], v31 offset:16640
    buffer_load_dwordx4 v11, s[24:27], s43 offen offset:2048 nt lds
    v_cvt_pk_bf16_f32 v224, v224, v225
    v_cvt_pk_bf16_f32 v226, v226, v227
    v_cvt_pk_bf16_f32 v228, v228, v229
    v_cvt_pk_bf16_f32 v230, v230, v231
    v_accvgpr_write_b32 a48, v224
    v_accvgpr_write_b32 a49, v226
    v_accvgpr_write_b32 a50, v228
    v_accvgpr_write_b32 a51, v230
    s_waitcnt lgkmcnt(3)
    s_nop 0
    v_mfma_f32_32x32x16_bf16 v[64:79], a[192:195], a[48:51], v[64:79]
    s_waitcnt vmcnt(27)
    s_barrier
    ds_read_b128 a[176:179], v24 offset:32768
    v_mul_f32 v232, s44, v232
    v_mul_f32 v233, s44, v233
    v_mul_f32 v234, s44, v234
    v_mul_f32 v235, s44, v235
    v_mul_f32 v236, s44, v236
    v_mul_f32 v237, s44, v237
    v_mul_f32 v238, s44, v238
    v_mul_f32 v239, s44, v239
    v_cvt_pk_bf16_f32 v232, v232, v233
    v_cvt_pk_bf16_f32 v234, v234, v235
    v_cvt_pk_bf16_f32 v236, v236, v237
    v_cvt_pk_bf16_f32 v238, v238, v239
    v_accvgpr_write_b32 a52, v232
    v_accvgpr_write_b32 a53, v234
    v_accvgpr_write_b32 a54, v236
    v_accvgpr_write_b32 a55, v238
    s_waitcnt lgkmcnt(3)
    s_nop 0
    v_mfma_f32_32x32x16_bf16 v[64:79], a[196:199], a[52:55], v[64:79]
    ds_read_b128 a[180:183], v25 offset:32768
    buffer_load_dwordx4 v12, s[24:27], s43 offen offset:3072 nt lds
    v_mul_f32 v240, s44, v240
    v_mul_f32 v241, s44, v241
    v_mul_f32 v242, s44, v242
    v_mul_f32 v243, s44, v243
    v_mul_f32 v244, s44, v244
    v_mul_f32 v245, s44, v245
    v_mul_f32 v246, s44, v246
    v_mul_f32 v247, s44, v247
    v_cvt_pk_bf16_f32 v240, v240, v241
    v_cvt_pk_bf16_f32 v242, v242, v243
    v_cvt_pk_bf16_f32 v244, v244, v245
    v_cvt_pk_bf16_f32 v246, v246, v247
    v_accvgpr_write_b32 a56, v240
    v_accvgpr_write_b32 a57, v242
    v_accvgpr_write_b32 a58, v244
    v_accvgpr_write_b32 a59, v246
    s_waitcnt lgkmcnt(3)
    s_nop 0
    v_mfma_f32_32x32x16_bf16 v[64:79], a[200:203], a[56:59], v[64:79]
    ds_read_b128 a[184:187], v26 offset:32768
    v_mul_f32 v248, s44, v248
    v_mul_f32 v249, s44, v249
    v_mul_f32 v250, s44, v250
    v_mul_f32 v251, s44, v251
    v_mul_f32 v252, s44, v252
    v_mul_f32 v253, s44, v253
    v_mul_f32 v254, s44, v254
    v_mul_f32 v255, s44, v255
    v_cvt_pk_bf16_f32 v248, v248, v249
    v_cvt_pk_bf16_f32 v250, v250, v251
    v_cvt_pk_bf16_f32 v252, v252, v253
    v_cvt_pk_bf16_f32 v254, v254, v255
    v_accvgpr_write_b32 a60, v248
    v_accvgpr_write_b32 a61, v250
    v_accvgpr_write_b32 a62, v252
    v_accvgpr_write_b32 a63, v254
    s_waitcnt lgkmcnt(3)
    s_nop 0
    v_mfma_f32_32x32x16_bf16 v[64:79], a[204:207], a[60:63], v[64:79]
    ds_read_b128 a[188:191], v27 offset:32768
    s_waitcnt lgkmcnt(3)
    v_mfma_f32_32x32x16_bf16 v[80:95], a[176:179], a[0:3], 0
    ds_read_b128 a[192:195], v28 offset:32768
    s_waitcnt lgkmcnt(3)
    v_mfma_f32_32x32x16_bf16 v[80:95], a[180:183], a[4:7], v[80:95]
    ds_read_b128 a[196:199], v29 offset:32768
    s_add_u32 m0, s42, 0
    s_mov_b32 s43, 147456
    buffer_load_dwordx4 v11, s[24:27], s43 offen offset:0 nt lds
    s_waitcnt lgkmcnt(3)
    v_mfma_f32_32x32x16_bf16 v[80:95], a[184:187], a[8:11], v[80:95]
    ds_read_b128 a[200:203], v30 offset:32768
    v_max3_f32 v119, v64, v65, v66
    v_max3_f32 v123, v67, v68, v69
    v_max3_f32 v124, v70, v71, v72
    v_max3_f32 v119, v119, v73, v74
    v_max3_f32 v123, v123, v75, v76
    s_waitcnt lgkmcnt(3)
    v_mfma_f32_32x32x16_bf16 v[80:95], a[188:191], a[12:15], v[80:95]
    ds_read_b128 a[204:207], v31 offset:32768
    v_max3_f32 v124, v124, v77, v78
    v_max_f32 v119, v119, v79
    v_max3_f32 v119, v119, v123, v124
    v_mov_b32 v120, v119
    v_mov_b32 v118, 0
    s_waitcnt lgkmcnt(3)
    v_mfma_f32_32x32x16_bf16 v[80:95], a[192:195], a[16:19], v[80:95]
    ds_read_b128 a[176:179], v24 offset:33024
    v_mov_b32 v126, 0
    v_permlane32_swap_b32 v119, v120
    v_max_f32 v119, v119, v120
    v_sub_f32 v96, 0, v119
    v_sub_f32 v97, 0, v119
    s_waitcnt lgkmcnt(3)
    v_mfma_f32_32x32x16_bf16 v[80:95], a[196:199], a[20:23], v[80:95]
    ds_read_b128 a[180:183], v25 offset:33024
    buffer_load_dwordx4 v12, s[24:27], s43 offen offset:1024 nt lds
    v_sub_f32 v98, 0, v119
    v_sub_f32 v99, 0, v119
    v_sub_f32 v100, 0, v119
    v_sub_f32 v101, 0, v119
    s_waitcnt lgkmcnt(3)
    v_mfma_f32_32x32x16_bf16 v[80:95], a[200:203], a[24:27], v[80:95]
    ds_read_b128 a[184:187], v26 offset:33024
    v_sub_f32 v102, 0, v119
    v_sub_f32 v103, 0, v119
    v_sub_f32 v104, 0, v119
    v_sub_f32 v105, 0, v119
    v_sub_f32 v106, 0, v119
    s_waitcnt lgkmcnt(3)
    v_mfma_f32_32x32x16_bf16 v[80:95], a[204:207], a[28:31], v[80:95]
    ds_read_b128 a[188:191], v27 offset:33024
    v_sub_f32 v107, 0, v119
    v_sub_f32 v108, 0, v119
    v_sub_f32 v109, 0, v119
    v_sub_f32 v110, 0, v119
    v_sub_f32 v111, 0, v119
    s_waitcnt lgkmcnt(3)
    v_mfma_f32_32x32x16_bf16 v[80:95], a[176:179], a[32:35], v[80:95]
    ds_read_b128 a[192:195], v28 offset:33024
    v_add_f32 v64, v64, v96
    v_add_f32 v65, v65, v96
    v_add_f32 v66, v66, v96
    v_add_f32 v67, v67, v96
    v_add_f32 v68, v68, v96
    s_waitcnt lgkmcnt(3)
    v_mfma_f32_32x32x16_bf16 v[80:95], a[180:183], a[36:39], v[80:95]
    ds_read_b128 a[196:199], v29 offset:33024
    buffer_load_dwordx4 v11, s[24:27], s43 offen offset:2048 nt lds
    v_add_f32 v69, v69, v96
    v_add_f32 v70, v70, v96
    v_add_f32 v71, v71, v96
    v_add_f32 v72, v72, v96
    s_waitcnt lgkmcnt(3)
    v_mfma_f32_32x32x16_bf16 v[80:95], a[184:187], a[40:43], v[80:95]
    ds_read_b128 a[200:203], v30 offset:33024
    v_add_f32 v73, v73, v96
    v_add_f32 v74, v74, v96
    v_add_f32 v75, v75, v96
    v_add_f32 v76, v76, v96
    v_add_f32 v77, v77, v96
    s_waitcnt lgkmcnt(3)
    v_mfma_f32_32x32x16_bf16 v[80:95], a[188:191], a[44:47], v[80:95]
    ds_read_b128 a[204:207], v31 offset:33024
    v_add_f32 v78, v78, v96
    v_add_f32 v79, v79, v96
    v_exp_f32 v64, v64
    s_waitcnt lgkmcnt(3)
    v_mfma_f32_32x32x16_bf16 v[80:95], a[192:195], a[48:51], v[80:95]
    s_waitcnt vmcnt(27)
    s_barrier
    ds_read_b128 a[176:179], v24 offset:49152
    s_waitcnt lgkmcnt(3)
    v_mfma_f32_32x32x16_bf16 v[80:95], a[196:199], a[52:55], v[80:95]
    ds_read_b128 a[180:183], v25 offset:49152
    buffer_load_dwordx4 v12, s[24:27], s43 offen offset:3072 nt lds
    v_exp_f32 v65, v65
    v_exp_f32 v66, v66
    s_waitcnt lgkmcnt(3)
    v_mfma_f32_32x32x16_bf16 v[80:95], a[200:203], a[56:59], v[80:95]
    ds_read_b128 a[184:187], v26 offset:49152
    v_add_f32 v118, v118, v64
    v_exp_f32 v67, v67
    v_add_f32 v126, v126, v65
    v_cvt_pk_bf16_f32 v128, v64, v65
    s_waitcnt lgkmcnt(3)
    v_mfma_f32_32x32x16_bf16 v[80:95], a[204:207], a[60:63], v[80:95]
    ds_read_b128 a[188:191], v27 offset:49152
    v_exp_f32 v68, v68
    v_add_f32 v118, v118, v66
    v_exp_f32 v69, v69
    v_add_f32 v126, v126, v67
    v_cvt_pk_bf16_f32 v129, v66, v67
    v_exp_f32 v70, v70
    v_add_f32 v118, v118, v68
    v_exp_f32 v71, v71
    v_add_f32 v126, v126, v69
    v_cvt_pk_bf16_f32 v130, v68, v69
    v_exp_f32 v72, v72
    v_add_f32 v118, v118, v70
    v_exp_f32 v73, v73
    v_add_f32 v126, v126, v71
    v_cvt_pk_bf16_f32 v131, v70, v71
    v_exp_f32 v74, v74
    v_add_f32 v118, v118, v72
    v_exp_f32 v75, v75
    v_add_f32 v126, v126, v73
    v_cvt_pk_bf16_f32 v132, v72, v73
    v_exp_f32 v76, v76
    v_add_f32 v118, v118, v74
    v_exp_f32 v77, v77
    v_add_f32 v126, v126, v75
    v_cvt_pk_bf16_f32 v133, v74, v75
    v_exp_f32 v78, v78
    v_add_f32 v118, v118, v76
    v_exp_f32 v79, v79
    v_add_f32 v126, v126, v77
    v_cvt_pk_bf16_f32 v134, v76, v77
    v_add_f32 v118, v118, v78
    v_add_f32 v126, v126, v79
    v_cvt_pk_bf16_f32 v135, v78, v79
    s_waitcnt lgkmcnt(3)
    v_mfma_f32_32x32x16_bf16 v[64:79], a[176:179], a[0:3], v[96:111]
    ds_read_b128 a[192:195], v28 offset:49152
    v_add_f32 v80, v80, v96
    v_add_f32 v81, v81, v96
    v_add_f32 v82, v82, v96
    v_add_f32 v83, v83, v96
    v_add_f32 v84, v84, v96
    s_waitcnt lgkmcnt(3)
    v_mfma_f32_32x32x16_bf16 v[64:79], a[180:183], a[4:7], v[64:79]
    ds_read_b128 a[196:199], v29 offset:49152
    s_add_u32 m0, s42, 16384
    s_mov_b32 s43, 163840
    buffer_load_dwordx4 v11, s[24:27], s43 offen offset:0 nt lds
    v_add_f32 v85, v85, v96
    v_add_f32 v86, v86, v96
    s_waitcnt lgkmcnt(3)
    v_mfma_f32_32x32x16_bf16 v[64:79], a[184:187], a[8:11], v[64:79]
    ds_read_b128 a[200:203], v30 offset:49152
    v_add_f32 v87, v87, v96
    v_add_f32 v88, v88, v96
    v_add_f32 v89, v89, v96
    v_add_f32 v90, v90, v96
    v_add_f32 v91, v91, v96
    s_waitcnt lgkmcnt(3)
    v_mfma_f32_32x32x16_bf16 v[64:79], a[188:191], a[12:15], v[64:79]
    ds_read_b128 a[204:207], v31 offset:49152
    v_add_f32 v92, v92, v96
    v_add_f32 v93, v93, v96
    v_add_f32 v94, v94, v96
    v_add_f32 v95, v95, v96
    v_max3_f32 v119, v80, v81, v82
    s_waitcnt lgkmcnt(3)
    v_mfma_f32_32x32x16_bf16 v[64:79], a[192:195], a[16:19], v[64:79]
    ds_read_b128 a[176:179], v24 offset:49408
    v_max3_f32 v123, v83, v84, v85
    v_max3_f32 v124, v86, v87, v88
    v_max3_f32 v119, v119, v89, v90
    v_max3_f32 v123, v123, v91, v92
    v_max3_f32 v124, v124, v93, v94
    s_waitcnt lgkmcnt(3)
    v_mfma_f32_32x32x16_bf16 v[64:79], a[196:199], a[20:23], v[64:79]
    ds_read_b128 a[180:183], v25 offset:49408
    buffer_load_dwordx4 v12, s[24:27], s43 offen offset:1024 nt lds
    v_max_f32 v119, v119, v95
    v_max3_f32 v119, v119, v123, v124
    v_cmp_lt_f32 vcc, s45, v119
    s_cbranch_vccnz LF_stub1
LF_ret1:
    s_waitcnt lgkmcnt(3)
    v_mfma_f32_32x32x16_bf16 v[64:79], a[200:203], a[24:27], v[64:79]
    ds_read_b128 a[184:187], v26 offset:49408
    v_exp_f32 v80, v80
    v_exp_f32 v81, v81
    s_waitcnt lgkmcnt(3)
    v_mfma_f32_32x32x16_bf16 v[64:79], a[204:207], a[28:31], v[64:79]
    ds_read_b128 a[188:191], v27 offset:49408
    v_exp_f32 v82, v82
    v_add_f32 v118, v118, v80
    v_exp_f32 v83, v83
    s_waitcnt lgkmcnt(3)
    v_mfma_f32_32x32x16_bf16 v[64:79], a[176:179], a[32:35], v[64:79]
    ds_read_b128 a[192:195], v28 offset:49408
    v_add_f32 v126, v126, v81
    v_cvt_pk_bf16_f32 v136, v80, v81
    v_exp_f32 v84, v84
    v_add_f32 v118, v118, v82
    s_waitcnt lgkmcnt(3)
    v_mfma_f32_32x32x16_bf16 v[64:79], a[180:183], a[36:39], v[64:79]
    ds_read_b128 a[196:199], v29 offset:49408
    buffer_load_dwordx4 v11, s[24:27], s43 offen offset:2048 nt lds
    v_exp_f32 v85, v85
    v_add_f32 v126, v126, v83
    v_cvt_pk_bf16_f32 v137, v82, v83
    s_waitcnt lgkmcnt(3)
    v_mfma_f32_32x32x16_bf16 v[64:79], a[184:187], a[40:43], v[64:79]
    ds_read_b128 a[200:203], v30 offset:49408
    v_exp_f32 v86, v86
    v_add_f32 v118, v118, v84
    v_exp_f32 v87, v87
    s_waitcnt lgkmcnt(3)
    v_mfma_f32_32x32x16_bf16 v[64:79], a[188:191], a[44:47], v[64:79]
    ds_read_b128 a[204:207], v31 offset:49408
    v_add_f32 v126, v126, v85
    v_cvt_pk_bf16_f32 v138, v84, v85
    v_exp_f32 v88, v88
    v_add_f32 v118, v118, v86
    s_waitcnt lgkmcnt(3)
    v_mfma_f32_32x32x16_bf16 v[64:79], a[192:195], a[48:51], v[64:79]
    s_waitcnt vmcnt(27)
    s_barrier
    v_add_u32 v24, 0x10000, v24
    ds_read_b128 a[176:179], v24 offset:0
    s_waitcnt lgkmcnt(3)
    v_mfma_f32_32x32x16_bf16 v[64:79], a[196:199], a[52:55], v[64:79]
    v_add_u32 v25, 0x10000, v25
    ds_read_b128 a[180:183], v25 offset:0
    buffer_load_dwordx4 v12, s[24:27], s43 offen offset:3072 nt lds
    v_exp_f32 v89, v89
    v_add_f32 v126, v126, v87
    s_waitcnt lgkmcnt(3)
    v_mfma_f32_32x32x16_bf16 v[64:79], a[200:203], a[56:59], v[64:79]
    v_add_u32 v26, 0x10000, v26
    ds_read_b128 a[184:187], v26 offset:0
    v_cvt_pk_bf16_f32 v139, v86, v87
    v_exp_f32 v90, v90
    v_add_f32 v118, v118, v88
    s_waitcnt lgkmcnt(3)
    v_mfma_f32_32x32x16_bf16 v[64:79], a[204:207], a[60:63], v[64:79]
    v_add_u32 v27, 0x10000, v27
    ds_read_b128 a[188:191], v27 offset:0
    v_exp_f32 v91, v91
    v_add_f32 v126, v126, v89
    v_cvt_pk_bf16_f32 v140, v88, v89
    v_exp_f32 v92, v92
    v_add_f32 v118, v118, v90
    v_exp_f32 v93, v93
    v_add_f32 v126, v126, v91
    v_cvt_pk_bf16_f32 v141, v90, v91
    v_exp_f32 v94, v94
    v_add_f32 v118, v118, v92
    v_exp_f32 v95, v95
    v_add_f32 v126, v126, v93
    v_cvt_pk_bf16_f32 v142, v92, v93
    v_add_f32 v118, v118, v94
    v_add_f32 v126, v126, v95
    v_cvt_pk_bf16_f32 v143, v94, v95
    s_waitcnt lgkmcnt(3)
    v_mfma_f32_32x32x16_bf16 v[80:95], a[176:179], a[0:3], v[96:111]
    v_add_u32 v28, 0x10000, v28
    ds_read_b128 a[192:195], v28 offset:0
    v_max3_f32 v119, v64, v65, v66
    v_max3_f32 v123, v67, v68, v69
    v_max3_f32 v124, v70, v71, v72
    v_max3_f32 v119, v119, v73, v74
    s_waitcnt lgkmcnt(3)
    v_mfma_f32_32x32x16_bf16 v[80:95], a[180:183], a[4:7], v[80:95]
    v_add_u32 v29, 0x10000, v29
    ds_read_b128 a[196:199], v29 offset:0
    s_add_u32 m0, s42, 32768
    s_mov_b32 s43, 180224
    buffer_load_dwordx4 v11, s[24:27], s43 offen offset:0 nt lds
    v_max3_f32 v123, v123, v75, v76
    s_waitcnt lgkmcnt(3)
    v_mfma_f32_32x32x16_bf16 v[80:95], a[184:187], a[8:11], v[80:95]
    v_add_u32 v30, 0x10000, v30
    ds_read_b128 a[200:203], v30 offset:0
    v_max3_f32 v124, v124, v77, v78
    v_max_f32 v119, v119, v79
    v_max3_f32 v119, v119, v123, v124
    v_cmp_lt_f32 vcc, s45, v119
    s_waitcnt lgkmcnt(3)
    v_mfma_f32_32x32x16_bf16 v[80:95], a[188:191], a[12:15], v[80:95]
    v_add_u32 v31, 0x10000, v31
    ds_read_b128 a[204:207], v31 offset:0
    s_cbranch_vccnz LF_stub2
LF_ret2:
    v_exp_f32 v64, v64
    s_waitcnt lgkmcnt(3)
    v_mfma_f32_32x32x16_bf16 v[80:95], a[192:195], a[16:19], v[80:95]
    ds_read_b128 a[176:179], v24 offset:256
    v_exp_f32 v65, v65
    v_exp_f32 v66, v66
    v_add_f32 v118, v118, v64
    s_waitcnt lgkmcnt(3)
    v_mfma_f32_32x32x16_bf16 v[80:95], a[196:199], a[20:23], v[80:95]
    ds_read_b128 a[180:183], v25 offset:256
    buffer_load_dwordx4 v12, s[24:27], s43 offen offset:1024 nt lds
    v_exp_f32 v67, v67
    v_add_f32 v126, v126, v65
    v_cvt_pk_bf16_f32 v144, v64, v65
    s_waitcnt lgkmcnt(3)
    v_mfma_f32_32x32x16_bf16 v[80:95], a[200:203], a[24:27], v[80:95]
    ds_read_b128 a[184:187], v26 offset:256
    v_exp_f32 v68, v68
    v_add_f32 v118, v118, v66
    v_exp_f32 v69, v69
    s_waitcnt lgkmcnt(3)
    v_mfma_f32_32x32x16_bf16 v[80:95], a[204:207], a[28:31], v[80:95]
    ds_read_b128 a[188:191], v27 offset:256
    v_add_f32 v126, v126, v67
    v_cvt_pk_bf16_f32 v145, v66, v67
    v_exp_f32 v70, v70
    v_add_f32 v118, v118, v68
    s_waitcnt lgkmcnt(3)
    v_mfma_f32_32x32x16_bf16 v[80:95], a[176:179], a[32:35], v[80:95]
    ds_read_b128 a[192:195], v28 offset:256
    v_exp_f32 v71, v71
    v_add_f32 v126, v126, v69
    v_cvt_pk_bf16_f32 v146, v68, v69
    s_waitcnt lgkmcnt(3)
    v_mfma_f32_32x32x16_bf16 v[80:95], a[180:183], a[36:39], v[80:95]
    ds_read_b128 a[196:199], v29 offset:256
    buffer_load_dwordx4 v11, s[24:27], s43 offen offset:2048 nt lds
    v_exp_f32 v72, v72
    v_add_f32 v118, v118, v70
    s_waitcnt lgkmcnt(3)
    v_mfma_f32_32x32x16_bf16 v[80:95], a[184:187], a[40:43], v[80:95]
    ds_read_b128 a[200:203], v30 offset:256
    v_exp_f32 v73, v73
    v_add_f32 v126, v126, v71
    v_cvt_pk_bf16_f32 v147, v70, v71
    s_waitcnt lgkmcnt(3)
    v_mfma_f32_32x32x16_bf16 v[80:95], a[188:191], a[44:47], v[80:95]
    ds_read_b128 a[204:207], v31 offset:256
    v_exp_f32 v74, v74
    v_add_f32 v118, v118, v72
    v_exp_f32 v75, v75
    s_waitcnt lgkmcnt(3)
    v_mfma_f32_32x32x16_bf16 v[80:95], a[192:195], a[48:51], v[80:95]
    s_waitcnt vmcnt(27)
    s_barrier
    ds_read_b128 a[176:179], v24 offset:16384
    v_add_f32 v126, v126, v73
    s_waitcnt lgkmcnt(3)
    v_mfma_f32_32x32x16_bf16 v[80:95], a[196:199], a[52:55], v[80:95]
    ds_read_b128 a[180:183], v25 offset:16384
    buffer_load_dwordx4 v12, s[24:27], s43 offen offset:3072 nt lds
    v_cvt_pk_bf16_f32 v148, v72, v73
    v_exp_f32 v76, v76
    v_add_f32 v118, v118, v74
    s_waitcnt lgkmcnt(3)
    v_mfma_f32_32x32x16_bf16 v[80:95], a[200:203], a[56:59], v[80:95]
    ds_read_b128 a[184:187], v26 offset:16384
    v_exp_f32 v77, v77
    v_add_f32 v126, v126, v75
    v_cvt_pk_bf16_f32 v149, v74, v75
    s_waitcnt lgkmcnt(3)
    v_mfma_f32_32x32x16_bf16 v[80:95], a[204:207], a[60:63], v[80:95]
    ds_read_b128 a[188:191], v27 offset:16384
    v_exp_f32 v78, v78
    v_add_f32 v118, v118, v76
    v_exp_f32 v79, v79
    v_add_f32 v126, v126, v77
    v_cvt_pk_bf16_f32 v150, v76, v77
    v_add_f32 v118, v118, v78
    v_add_f32 v126, v126, v79
    v_cvt_pk_bf16_f32 v151, v78, v79
    s_waitcnt lgkmcnt(3)
    v_mfma_f32_32x32x16_bf16 v[64:79], a[176:179], a[0:3], v[96:111]
    ds_read_b128 a[192:195], v28 offset:16384
    v_max3_f32 v119, v80, v81, v82
    v_max3_f32 v123, v83, v84, v85
    v_max3_f32 v124, v86, v87, v88
    v_max3_f32 v119, v119, v89, v90
    v_max3_f32 v123, v123, v91, v92
    s_waitcnt lgkmcnt(3)
    v_mfma_f32_32x32x16_bf16 v[64:79], a[180:183], a[4:7], v[64:79]
    ds_read_b128 a[196:199], v29 offset:16384
    s_add_u32 m0, s42, 49152
    s_mov_b32 s43, 196608
    buffer_load_dwordx4 v11, s[24:27], s43 offen offset:0 nt lds
    v_max3_f32 v124, v124, v93, v94
    v_max_f32 v119, v119, v95
    s_waitcnt lgkmcnt(3)
    v_mfma_f32_32x32x16_bf16 v[64:79], a[184:187], a[8:11], v[64:79]
    ds_read_b128 a[200:203], v30 offset:16384
    v_max3_f32 v119, v119, v123, v124
    v_cmp_lt_f32 vcc, s45, v119
    s_cbranch_vccnz LF_stub3
LF_ret3:
    v_exp_f32 v80, v80
    s_waitcnt lgkmcnt(3)
    v_mfma_f32_32x32x16_bf16 v[64:79], a[188:191], a[12:15], v[64:79]
    ds_read_b128 a[204:207], v31 offset:16384
    v_exp_f32 v81, v81
    v_exp_f32 v82, v82
    v_add_f32 v118, v118, v80
    s_waitcnt lgkmcnt(3)
    v_mfma_f32_32x32x16_bf16 v[64:79], a[192:195], a[16:19], v[64:79]
    ds_read_b128 a[176:179], v24 offset:16640
    v_exp_f32 v83, v83
    v_add_f32 v126, v126, v81
    v_cvt_pk_bf16_f32 v152, v80, v81
    s_waitcnt lgkmcnt(3)
    v_mfma_f32_32x32x16_bf16 v[64:79], a[196:199], a[20:23], v[64:79]
    ds_read_b128 a[180:183], v25 offset:16640
    buffer_load_dwordx4 v12, s[24:27], s43 offen offset:1024 nt lds
    v_exp_f32 v84, v84
    v_add_f32 v118, v118, v82
    s_waitcnt lgkmcnt(3)
    v_mfma_f32_32x32x16_bf16 v[64:79], a[200:203], a[24:27], v[64:79]
    ds_read_b128 a[184:187], v26 offset:16640
    v_exp_f32 v85, v85
    v_add_f32 v126, v126, v83
    v_cvt_pk_bf16_f32 v153, v82, v83
    s_waitcnt lgkmcnt(3)
    v_mfma_f32_32x32x16_bf16 v[64:79], a[204:207], a[28:31], v[64:79]
    ds_read_b128 a[188:191], v27 offset:16640
    v_exp_f32 v86, v86
    v_add_f32 v118, v118, v84
    v_exp_f32 v87, v87
    s_waitcnt lgkmcnt(3)
    v_mfma_f32_32x32x16_bf16 v[64:79], a[176:179], a[32:35], v[64:79]
    ds_read_b128 a[192:195], v28 offset:16640
    v_add_f32 v126, v126, v85
    v_cvt_pk_bf16_f32 v154, v84, v85
    v_exp_f32 v88, v88
    v_add_f32 v118, v118, v86
    s_waitcnt lgkmcnt(3)
    v_mfma_f32_32x32x16_bf16 v[64:79], a[180:183], a[36:39], v[64:79]
    ds_read_b128 a[196:199], v29 offset:16640
    buffer_load_dwordx4 v11, s[24:27], s43 offen offset:2048 nt lds
    v_exp_f32 v89, v89
    v_add_f32 v126, v126, v87
    v_cvt_pk_bf16_f32 v155, v86, v87
    s_waitcnt lgkmcnt(3)
    v_mfma_f32_32x32x16_bf16 v[64:79], a[184:187], a[40:43], v[64:79]
    ds_read_b128 a[200:203], v30 offset:16640
    v_exp_f32 v90, v90
    v_add_f32 v118, v118, v88
    v_exp_f32 v91, v91
    s_waitcnt lgkmcnt(3)
    v_mfma_f32_32x32x16_bf16 v[64:79], a[188:191], a[44:47], v[64:79]
    ds_read_b128 a[204:207], v31 offset:16640
    v_add_f32 v126, v126, v89
    v_cvt_pk_bf16_f32 v156, v88, v89
    v_exp_f32 v92, v92
    v_add_f32 v118, v118, v90
    s_waitcnt lgkmcnt(3)
    v_mfma_f32_32x32x16_bf16 v[64:79], a[192:195], a[48:51], v[64:79]
    s_waitcnt vmcnt(27)
    s_barrier
    ds_read_b128 a[176:179], v24 offset:32768
    s_waitcnt lgkmcnt(3)
    v_mfma_f32_32x32x16_bf16 v[64:79], a[196:199], a[52:55], v[64:79]
    ds_read_b128 a[180:183], v25 offset:32768
    buffer_load_dwordx4 v12, s[24:27], s43 offen offset:3072 nt lds
    v_exp_f32 v93, v93
    v_add_f32 v126, v126, v91
    v_cvt_pk_bf16_f32 v157, v90, v91
    s_waitcnt lgkmcnt(3)
    v_mfma_f32_32x32x16_bf16 v[64:79], a[200:203], a[56:59], v[64:79]
    ds_read_b128 a[184:187], v26 offset:32768
    v_exp_f32 v94, v94
    v_add_f32 v118, v118, v92
    v_exp_f32 v95, v95
    s_waitcnt lgkmcnt(3)
    v_mfma_f32_32x32x16_bf16 v[64:79], a[204:207], a[60:63], v[64:79]
    ds_read_b128 a[188:191], v27 offset:32768
    v_add_f32 v126, v126, v93
    v_cvt_pk_bf16_f32 v158, v92, v93
    v_add_f32 v118, v118, v94
    v_add_f32 v126, v126, v95
    v_cvt_pk_bf16_f32 v159, v94, v95
    s_waitcnt lgkmcnt(3)
    v_mfma_f32_32x32x16_bf16 v[80:95], a[176:179], a[0:3], v[96:111]
    ds_read_b128 a[192:195], v28 offset:32768
    s_waitcnt lgkmcnt(3)
    v_mfma_f32_32x32x16_bf16 v[80:95], a[180:183], a[4:7], v[80:95]
    ds_read_b128 a[196:199], v29 offset:32768
    s_add_u32 m0, s42, 65536
    s_mov_b32 s43, 212992
    buffer_load_dwordx4 v11, s[24:27], s43 offen offset:0 nt lds
    v_max3_f32 v119, v64, v65, v66
    v_max3_f32 v123, v67, v68, v69
    s_waitcnt lgkmcnt(3)
    v_mfma_f32_32x32x16_bf16 v[80:95], a[184:187], a[8:11], v[80:95]
    ds_read_b128 a[200:203], v30 offset:32768
    v_max3_f32 v124, v70, v71, v72
    v_max3_f32 v119, v119, v73, v74
    v_max3_f32 v123, v123, v75, v76
    v_max3_f32 v124, v124, v77, v78
    v_max_f32 v119, v119, v79
    s_waitcnt lgkmcnt(3)
    v_mfma_f32_32x32x16_bf16 v[80:95], a[188:191], a[12:15], v[80:95]
    ds_read_b128 a[204:207], v31 offset:32768
    v_max3_f32 v119, v119, v123, v124
    v_cmp_lt_f32 vcc, s45, v119
    s_cbranch_vccnz LF_stub4
LF_ret4:
    v_exp_f32 v64, v64
    s_waitcnt lgkmcnt(3)
    v_mfma_f32_32x32x16_bf16 v[80:95], a[192:195], a[16:19], v[80:95]
    ds_read_b128 a[176:179], v24 offset:33024
    v_exp_f32 v65, v65
    v_exp_f32 v66, v66
    v_add_f32 v118, v118, v64
    s_waitcnt lgkmcnt(3)
    v_mfma_f32_32x32x16_bf16 v[80:95], a[196:199], a[20:23], v[80:95]
    ds_read_b128 a[180:183], v25 offset:33024
    buffer_load_dwordx4 v12, s[24:27], s43 offen offset:1024 nt lds
    v_exp_f32 v67, v67
    v_add_f32 v126, v126, v65
    v_cvt_pk_bf16_f32 v160, v64, v65
    s_waitcnt lgkmcnt(3)
    v_mfma_f32_32x32x16_bf16 v[80:95], a[200:203], a[24:27], v[80:95]
    ds_read_b128 a[184:187], v26 offset:33024
    v_exp_f32 v68, v68
    v_add_f32 v118, v118, v66
    v_exp_f32 v69, v69
    s_waitcnt lgkmcnt(3)
    v_mfma_f32_32x32x16_bf16 v[80:95], a[204:207], a[28:31], v[80:95]
    ds_read_b128 a[188:191], v27 offset:33024
    v_add_f32 v126, v126, v67
    v_cvt_pk_bf16_f32 v161, v66, v67
    v_exp_f32 v70, v70
    v_add_f32 v118, v118, v68
    s_waitcnt lgkmcnt(3)
    v_mfma_f32_32x32x16_bf16 v[80:95], a[176:179], a[32:35], v[80:95]
    ds_read_b128 a[192:195], v28 offset:33024
    v_exp_f32 v71, v71
    v_add_f32 v126, v126, v69
    v_cvt_pk_bf16_f32 v162, v68, v69
    s_waitcnt lgkmcnt(3)
    v_mfma_f32_32x32x16_bf16 v[80:95], a[180:183], a[36:39], v[80:95]
    ds_read_b128 a[196:199], v29 offset:33024
    buffer_load_dwordx4 v11, s[24:27], s43 offen offset:2048 nt lds
    v_exp_f32 v72, v72
    v_add_f32 v118, v118, v70
    s_waitcnt lgkmcnt(3)
    v_mfma_f32_32x32x16_bf16 v[80:95], a[184:187], a[40:43], v[80:95]
    ds_read_b128 a[200:203], v30 offset:33024
    v_exp_f32 v73, v73
    v_add_f32 v126, v126, v71
    v_cvt_pk_bf16_f32 v163, v70, v71
    s_waitcnt lgkmcnt(3)
    v_mfma_f32_32x32x16_bf16 v[80:95], a[188:191], a[44:47], v[80:95]
    ds_read_b128 a[204:207], v31 offset:33024
    v_exp_f32 v74, v74
    v_add_f32 v118, v118, v72
    v_exp_f32 v75, v75
    s_waitcnt lgkmcnt(3)
    v_mfma_f32_32x32x16_bf16 v[80:95], a[192:195], a[48:51], v[80:95]
    s_waitcnt vmcnt(27)
    s_barrier
    ds_read_b128 a[176:179], v24 offset:49152
    v_add_f32 v126, v126, v73
    s_waitcnt lgkmcnt(3)
    v_mfma_f32_32x32x16_bf16 v[80:95], a[196:199], a[52:55], v[80:95]
    ds_read_b128 a[180:183], v25 offset:49152
    buffer_load_dwordx4 v12, s[24:27], s43 offen offset:3072 nt lds
    v_cvt_pk_bf16_f32 v164, v72, v73
    v_exp_f32 v76, v76
    v_add_f32 v118, v118, v74
    s_waitcnt lgkmcnt(3)
    v_mfma_f32_32x32x16_bf16 v[80:95], a[200:203], a[56:59], v[80:95]
    ds_read_b128 a[184:187], v26 offset:49152
    v_exp_f32 v77, v77
    v_add_f32 v126, v126, v75
    v_cvt_pk_bf16_f32 v165, v74, v75
    s_waitcnt lgkmcnt(3)
    v_mfma_f32_32x32x16_bf16 v[80:95], a[204:207], a[60:63], v[80:95]
    ds_read_b128 a[188:191], v27 offset:49152
    v_exp_f32 v78, v78
    v_add_f32 v118, v118, v76
    v_exp_f32 v79, v79
    v_add_f32 v126, v126, v77
    v_cvt_pk_bf16_f32 v166, v76, v77
    v_add_f32 v118, v118, v78
    v_add_f32 v126, v126, v79
    v_cvt_pk_bf16_f32 v167, v78, v79
    s_waitcnt lgkmcnt(3)
    v_mfma_f32_32x32x16_bf16 v[64:79], a[176:179], a[0:3], v[96:111]
    ds_read_b128 a[192:195], v28 offset:49152
    v_max3_f32 v119, v80, v81, v82
    v_max3_f32 v123, v83, v84, v85
    v_max3_f32 v124, v86, v87, v88
    v_max3_f32 v119, v119, v89, v90
    v_max3_f32 v123, v123, v91, v92
    s_waitcnt lgkmcnt(3)
    v_mfma_f32_32x32x16_bf16 v[64:79], a[180:183], a[4:7], v[64:79]
    ds_read_b128 a[196:199], v29 offset:49152
    s_add_u32 m0, s42, 81920
    s_mov_b32 s43, 229376
    buffer_load_dwordx4 v11, s[24:27], s43 offen offset:0 nt lds
    v_max3_f32 v124, v124, v93, v94
    v_max_f32 v119, v119, v95
    s_waitcnt lgkmcnt(3)
    v_mfma_f32_32x32x16_bf16 v[64:79], a[184:187], a[8:11], v[64:79]
    ds_read_b128 a[200:203], v30 offset:49152
    v_max3_f32 v119, v119, v123, v124
    v_cmp_lt_f32 vcc, s45, v119
    s_cbranch_vccnz LF_stub5
LF_ret5:
    v_exp_f32 v80, v80
    s_waitcnt lgkmcnt(3)
    v_mfma_f32_32x32x16_bf16 v[64:79], a[188:191], a[12:15], v[64:79]
    ds_read_b128 a[204:207], v31 offset:49152
    v_exp_f32 v81, v81
    v_exp_f32 v82, v82
    v_add_f32 v118, v118, v80
    s_waitcnt lgkmcnt(3)
    v_mfma_f32_32x32x16_bf16 v[64:79], a[192:195], a[16:19], v[64:79]
    ds_read_b128 a[176:179], v24 offset:49408
    v_exp_f32 v83, v83
    v_add_f32 v126, v126, v81
    v_cvt_pk_bf16_f32 v168, v80, v81
    s_waitcnt lgkmcnt(3)
    v_mfma_f32_32x32x16_bf16 v[64:79], a[196:199], a[20:23], v[64:79]
    ds_read_b128 a[180:183], v25 offset:49408
    buffer_load_dwordx4 v12, s[24:27], s43 offen offset:1024 nt lds
    v_exp_f32 v84, v84
    v_add_f32 v118, v118, v82
    s_waitcnt lgkmcnt(3)
    v_mfma_f32_32x32x16_bf16 v[64:79], a[200:203], a[24:27], v[64:79]
    ds_read_b128 a[184:187], v26 offset:49408
    v_exp_f32 v85, v85
    v_add_f32 v126, v126, v83
    v_cvt_pk_bf16_f32 v169, v82, v83
    s_waitcnt lgkmcnt(3)
    v_mfma_f32_32x32x16_bf16 v[64:79], a[204:207], a[28:31], v[64:79]
    ds_read_b128 a[188:191], v27 offset:49408
    v_exp_f32 v86, v86
    v_add_f32 v118, v118, v84
    v_exp_f32 v87, v87
    s_waitcnt lgkmcnt(3)
    v_mfma_f32_32x32x16_bf16 v[64:79], a[176:179], a[32:35], v[64:79]
    ds_read_b128 a[192:195], v28 offset:49408
    v_add_f32 v126, v126, v85
    v_cvt_pk_bf16_f32 v170, v84, v85
    v_exp_f32 v88, v88
    v_add_f32 v118, v118, v86
    s_waitcnt lgkmcnt(3)
    v_mfma_f32_32x32x16_bf16 v[64:79], a[180:183], a[36:39], v[64:79]
    ds_read_b128 a[196:199], v29 offset:49408
    buffer_load_dwordx4 v11, s[24:27], s43 offen offset:2048 nt lds
    v_exp_f32 v89, v89
    v_add_f32 v126, v126, v87
    v_cvt_pk_bf16_f32 v171, v86, v87
    s_waitcnt lgkmcnt(3)
    v_mfma_f32_32x32x16_bf16 v[64:79], a[184:187], a[40:43], v[64:79]
    ds_read_b128 a[200:203], v30 offset:49408
    v_exp_f32 v90, v90
    v_add_f32 v118, v118, v88
    v_exp_f32 v91, v91
    s_waitcnt lgkmcnt(3)
    v_mfma_f32_32x32x16_bf16 v[64:79], a[188:191], a[44:47], v[64:79]
    ds_read_b128 a[204:207], v31 offset:49408
    v_add_f32 v126, v126, v89
    v_cvt_pk_bf16_f32 v172, v88, v89
    v_exp_f32 v92, v92
    v_add_f32 v118, v118, v90
    s_waitcnt lgkmcnt(3)
    v_mfma_f32_32x32x16_bf16 v[64:79], a[192:195], a[48:51], v[64:79]
    s_waitcnt vmcnt(27)
    s_barrier
    v_add_u32 v24, 0x10000, v24
    ds_read_b128 a[176:179], v24 offset:0
    s_waitcnt lgkmcnt(3)
    v_mfma_f32_32x32x16_bf16 v[64:79], a[196:199], a[52:55], v[64:79]
    v_add_u32 v25, 0x10000, v25
    ds_read_b128 a[180:183], v25 offset:0
    buffer_load_dwordx4 v12, s[24:27], s43 offen offset:3072 nt lds
    v_exp_f32 v93, v93
    v_add_f32 v126, v126, v91
    s_waitcnt lgkmcnt(3)
    v_mfma_f32_32x32x16_bf16 v[64:79], a[200:203], a[56:59], v[64:79]
    v_add_u32 v26, 0x10000, v26
    ds_read_b128 a[184:187], v26 offset:0
    v_cvt_pk_bf16_f32 v173, v90, v91
    v_exp_f32 v94, v94
    v_add_f32 v118, v118, v92
    s_waitcnt lgkmcnt(3)
    v_mfma_f32_32x32x16_bf16 v[64:79], a[204:207], a[60:63], v[64:79]
    v_add_u32 v27, 0x10000, v27
    ds_read_b128 a[188:191], v27 offset:0
    v_exp_f32 v95, v95
    v_add_f32 v126, v126, v93
    v_cvt_pk_bf16_f32 v174, v92, v93
    v_add_f32 v118, v118, v94
    v_add_f32 v126, v126, v95
    v_cvt_pk_bf16_f32 v175, v94, v95
    s_waitcnt lgkmcnt(3)
    v_mfma_f32_32x32x16_bf16 v[80:95], a[176:179], a[0:3], v[96:111]
    v_add_u32 v28, 0x10000, v28
    ds_read_b128 a[192:195], v28 offset:0
    v_max3_f32 v119, v64, v65, v66
    v_max3_f32 v123, v67, v68, v69
    v_max3_f32 v124, v70, v71, v72
    v_max3_f32 v119, v119, v73, v74
    s_waitcnt lgkmcnt(3)
    v_mfma_f32_32x32x16_bf16 v[80:95], a[180:183], a[4:7], v[80:95]
    v_add_u32 v29, 0x10000, v29
    ds_read_b128 a[196:199], v29 offset:0
    s_add_u32 m0, s42, 98304
    s_mov_b32 s43, 245760
    buffer_load_dwordx4 v11, s[24:27], s43 offen offset:0 nt lds
    v_max3_f32 v123, v123, v75, v76
    s_waitcnt lgkmcnt(3)
    v_mfma_f32_32x32x16_bf16 v[80:95], a[184:187], a[8:11], v[80:95]
    v_add_u32 v30, 0x10000, v30
    ds_read_b128 a[200:203], v30 offset:0
    v_max3_f32 v124, v124, v77, v78
    v_max_f32 v119, v119, v79
    v_max3_f32 v119, v119, v123, v124
    v_cmp_lt_f32 vcc, s45, v119
    s_waitcnt lgkmcnt(3)
    v_mfma_f32_32x32x16_bf16 v[80:95], a[188:191], a[12:15], v[80:95]
    v_add_u32 v31, 0x10000, v31
    ds_read_b128 a[204:207], v31 offset:0
    s_cbranch_vccnz LF_stub6
LF_ret6:
    v_exp_f32 v64, v64
    s_waitcnt lgkmcnt(3)
    v_mfma_f32_32x32x16_bf16 v[80:95], a[192:195], a[16:19], v[80:95]
    ds_read_b128 a[176:179], v24 offset:256
    v_exp_f32 v65, v65
    v_exp_f32 v66, v66
    v_add_f32 v118, v118, v64
    s_waitcnt lgkmcnt(3)
    v_mfma_f32_32x32x16_bf16 v[80:95], a[196:199], a[20:23], v[80:95]
    ds_read_b128 a[180:183], v25 offset:256
    buffer_load_dwordx4 v12, s[24:27], s43 offen offset:1024 nt lds
    v_exp_f32 v67, v67
    v_add_f32 v126, v126, v65
    v_cvt_pk_bf16_f32 v176, v64, v65
    s_waitcnt lgkmcnt(3)
    v_mfma_f32_32x32x16_bf16 v[80:95], a[200:203], a[24:27], v[80:95]
    ds_read_b128 a[184:187], v26 offset:256
    v_exp_f32 v68, v68
    v_add_f32 v118, v118, v66
    v_exp_f32 v69, v69
    s_waitcnt lgkmcnt(3)
    v_mfma_f32_32x32x16_bf16 v[80:95], a[204:207], a[28:31], v[80:95]
    ds_read_b128 a[188:191], v27 offset:256
    v_add_f32 v126, v126, v67
    v_cvt_pk_bf16_f32 v177, v66, v67
    v_exp_f32 v70, v70
    v_add_f32 v118, v118, v68
    s_waitcnt lgkmcnt(3)
    v_mfma_f32_32x32x16_bf16 v[80:95], a[176:179], a[32:35], v[80:95]
    ds_read_b128 a[192:195], v28 offset:256
    v_exp_f32 v71, v71
    v_add_f32 v126, v126, v69
    v_cvt_pk_bf16_f32 v178, v68, v69
    s_waitcnt lgkmcnt(3)
    v_mfma_f32_32x32x16_bf16 v[80:95], a[180:183], a[36:39], v[80:95]
    ds_read_b128 a[196:199], v29 offset:256
    buffer_load_dwordx4 v11, s[24:27], s43 offen offset:2048 nt lds
    v_exp_f32 v72, v72
    v_add_f32 v118, v118, v70
    s_waitcnt lgkmcnt(3)
    v_mfma_f32_32x32x16_bf16 v[80:95], a[184:187], a[40:43], v[80:95]
    ds_read_b128 a[200:203], v30 offset:256
    v_exp_f32 v73, v73
    v_add_f32 v126, v126, v71
    v_cvt_pk_bf16_f32 v179, v70, v71
    s_waitcnt lgkmcnt(3)
    v_mfma_f32_32x32x16_bf16 v[80:95], a[188:191], a[44:47], v[80:95]
    ds_read_b128 a[204:207], v31 offset:256
    v_exp_f32 v74, v74
    v_add_f32 v118, v118, v72
    v_exp_f32 v75, v75
    s_waitcnt lgkmcnt(3)
    v_mfma_f32_32x32x16_bf16 v[80:95], a[192:195], a[48:51], v[80:95]
    s_waitcnt vmcnt(27)
    s_barrier
    ds_read_b128 a[176:179], v24 offset:16384
    v_add_f32 v126, v126, v73
    s_waitcnt lgkmcnt(3)
    v_mfma_f32_32x32x16_bf16 v[80:95], a[196:199], a[52:55], v[80:95]
    ds_read_b128 a[180:183], v25 offset:16384
    buffer_load_dwordx4 v12, s[24:27], s43 offen offset:3072 nt lds
    v_cvt_pk_bf16_f32 v180, v72, v73
    v_exp_f32 v76, v76
    v_add_f32 v118, v118, v74
    s_waitcnt lgkmcnt(3)
    v_mfma_f32_32x32x16_bf16 v[80:95], a[200:203], a[56:59], v[80:95]
    ds_read_b128 a[184:187], v26 offset:16384
    v_exp_f32 v77, v77
    v_add_f32 v126, v126, v75
    v_cvt_pk_bf16_f32 v181, v74, v75
    s_waitcnt lgkmcnt(3)
    v_mfma_f32_32x32x16_bf16 v[80:95], a[204:207], a[60:63], v[80:95]
    ds_read_b128 a[188:191], v27 offset:16384
    v_exp_f32 v78, v78
    v_add_f32 v118, v118, v76
    v_exp_f32 v79, v79
    v_add_f32 v126, v126, v77
    v_cvt_pk_bf16_f32 v182, v76, v77
    v_add_f32 v118, v118, v78
    v_add_f32 v126, v126, v79
    v_cvt_pk_bf16_f32 v183, v78, v79
    s_waitcnt lgkmcnt(3)
    v_mfma_f32_32x32x16_bf16 v[64:79], a[176:179], a[0:3], v[96:111]
    ds_read_b128 a[192:195], v28 offset:16384
    v_max3_f32 v119, v80, v81, v82
    v_max3_f32 v123, v83, v84, v85
    v_max3_f32 v124, v86, v87, v88
    v_max3_f32 v119, v119, v89, v90
    v_max3_f32 v123, v123, v91, v92
    s_waitcnt lgkmcnt(3)
    v_mfma_f32_32x32x16_bf16 v[64:79], a[180:183], a[4:7], v[64:79]
    ds_read_b128 a[196:199], v29 offset:16384
    s_add_u32 m0, s42, 114688
    s_mov_b32 s43, 0
    buffer_load_dwordx4 v13, s[28:31], s43 offen offset:0 nt lds
    v_max3_f32 v124, v124, v93, v94
    v_max_f32 v119, v119, v95
    s_waitcnt lgkmcnt(3)
    v_mfma_f32_32x32x16_bf16 v[64:79], a[184:187], a[8:11], v[64:79]
    ds_read_b128 a[200:203], v30 offset:16384
    v_max3_f32 v119, v119, v123, v124
    v_cmp_lt_f32 vcc, s45, v119
    s_cbranch_vccnz LF_stub7
LF_ret7:
    v_exp_f32 v80, v80
    s_waitcnt lgkmcnt(3)
    v_mfma_f32_32x32x16_bf16 v[64:79], a[188:191], a[12:15], v[64:79]
    ds_read_b128 a[204:207], v31 offset:16384
    v_exp_f32 v81, v81
    v_exp_f32 v82, v82
    v_add_f32 v118, v118, v80
    s_waitcnt lgkmcnt(3)
    v_mfma_f32_32x32x16_bf16 v[64:79], a[192:195], a[16:19], v[64:79]
    ds_read_b128 a[176:179], v24 offset:16640
    v_exp_f32 v83, v83
    v_add_f32 v126, v126, v81
    v_cvt_pk_bf16_f32 v184, v80, v81
    s_waitcnt lgkmcnt(3)
    v_mfma_f32_32x32x16_bf16 v[64:79], a[196:199], a[20:23], v[64:79]
    ds_read_b128 a[180:183], v25 offset:16640
    buffer_load_dwordx4 v13, s[28:31], s43 offen offset:1024 nt lds
    v_exp_f32 v84, v84
    v_add_f32 v118, v118, v82
    s_waitcnt lgkmcnt(3)
    v_mfma_f32_32x32x16_bf16 v[64:79], a[200:203], a[24:27], v[64:79]
    ds_read_b128 a[184:187], v26 offset:16640
    v_exp_f32 v85, v85
    v_add_f32 v126, v126, v83
    v_cvt_pk_bf16_f32 v185, v82, v83
    s_waitcnt lgkmcnt(3)
    v_mfma_f32_32x32x16_bf16 v[64:79], a[204:207], a[28:31], v[64:79]
    ds_read_b128 a[188:191], v27 offset:16640
    v_exp_f32 v86, v86
    v_add_f32 v118, v118, v84
    v_exp_f32 v87, v87
    s_waitcnt lgkmcnt(3)
    v_mfma_f32_32x32x16_bf16 v[64:79], a[176:179], a[32:35], v[64:79]
    ds_read_b128 a[192:195], v28 offset:16640
    v_add_f32 v126, v126, v85
    v_cvt_pk_bf16_f32 v186, v84, v85
    v_exp_f32 v88, v88
    v_add_f32 v118, v118, v86
    s_waitcnt lgkmcnt(3)
    v_mfma_f32_32x32x16_bf16 v[64:79], a[180:183], a[36:39], v[64:79]
    ds_read_b128 a[196:199], v29 offset:16640
    buffer_load_dwordx4 v13, s[28:31], s43 offen offset:2048 nt lds
    v_exp_f32 v89, v89
    v_add_f32 v126, v126, v87
    v_cvt_pk_bf16_f32 v187, v86, v87
    s_waitcnt lgkmcnt(3)
    v_mfma_f32_32x32x16_bf16 v[64:79], a[184:187], a[40:43], v[64:79]
    ds_read_b128 a[200:203], v30 offset:16640
    v_exp_f32 v90, v90
    v_add_f32 v118, v118, v88
    v_exp_f32 v91, v91
    s_waitcnt lgkmcnt(3)
    v_mfma_f32_32x32x16_bf16 v[64:79], a[188:191], a[44:47], v[64:79]
    ds_read_b128 a[204:207], v31 offset:16640
    v_add_f32 v126, v126, v89
    v_cvt_pk_bf16_f32 v188, v88, v89
    v_exp_f32 v92, v92
    v_add_f32 v118, v118, v90
    s_waitcnt lgkmcnt(3)
    v_mfma_f32_32x32x16_bf16 v[64:79], a[192:195], a[48:51], v[64:79]
    s_waitcnt vmcnt(27)
    s_barrier
    v_add_u32 v24, 0xfffe0000, v24
    ds_read_b128 a[176:179], v24 offset:0
    s_waitcnt lgkmcnt(3)
    v_mfma_f32_32x32x16_bf16 v[64:79], a[196:199], a[52:55], v[64:79]
    v_add_u32 v25, 0xfffe0000, v25
    ds_read_b128 a[180:183], v25 offset:0
    buffer_load_dwordx4 v13, s[28:31], s43 offen offset:3072 nt lds
    v_exp_f32 v93, v93
    v_add_f32 v126, v126, v91
    s_waitcnt lgkmcnt(3)
    v_mfma_f32_32x32x16_bf16 v[64:79], a[200:203], a[56:59], v[64:79]
    v_add_u32 v26, 0xfffe0000, v26
    ds_read_b128 a[184:187], v26 offset:0
    v_cvt_pk_bf16_f32 v189, v90, v91
    v_exp_f32 v94, v94
    v_add_f32 v118, v118, v92
    s_waitcnt lgkmcnt(3)
    v_mfma_f32_32x32x16_bf16 v[64:79], a[204:207], a[60:63], v[64:79]
    v_add_u32 v27, 0xfffe0000, v27
    ds_read_b128 a[188:191], v27 offset:0
    v_exp_f32 v95, v95
    v_add_f32 v126, v126, v93
    v_cvt_pk_bf16_f32 v190, v92, v93
    v_add_f32 v118, v118, v94
    v_add_f32 v126, v126, v95
    v_cvt_pk_bf16_f32 v191, v94, v95
    s_waitcnt lgkmcnt(3)
    v_mfma_f32_32x32x16_bf16 v[80:95], a[176:179], a[0:3], v[96:111]
    v_add_u32 v28, 0xfffe0000, v28
    ds_read_b128 a[192:195], v28 offset:0
    v_max3_f32 v119, v64, v65, v66
    v_max3_f32 v123, v67, v68, v69
    v_max3_f32 v124, v70, v71, v72
    v_max3_f32 v119, v119, v73, v74
    s_waitcnt lgkmcnt(3)
    v_mfma_f32_32x32x16_bf16 v[80:95], a[180:183], a[4:7], v[80:95]
    v_add_u32 v29, 0xfffe0000, v29
    ds_read_b128 a[196:199], v29 offset:0
    s_add_u32 m0, s42, 131072
    s_mov_b32 s43, 65536
    buffer_load_dwordx4 v13, s[28:31], s43 offen offset:0 nt lds
    v_max3_f32 v123, v123, v75, v76
    s_waitcnt lgkmcnt(3)
    v_mfma_f32_32x32x16_bf16 v[80:95], a[184:187], a[8:11], v[80:95]
    v_add_u32 v30, 0xfffe0000, v30
    ds_read_b128 a[200:203], v30 offset:0
    v_max3_f32 v124, v124, v77, v78
    v_max_f32 v119, v119, v79
    v_max3_f32 v119, v119, v123, v124
    v_cmp_lt_f32 vcc, s45, v119
    s_waitcnt lgkmcnt(3)
    v_mfma_f32_32x32x16_bf16 v[80:95], a[188:191], a[12:15], v[80:95]
    v_add_u32 v31, 0xfffe0000, v31
    ds_read_b128 a[204:207], v31 offset:0
    s_cbranch_vccnz LF_stub8
LF_ret8:
    v_exp_f32 v64, v64
    s_waitcnt lgkmcnt(3)
    v_mfma_f32_32x32x16_bf16 v[80:95], a[192:195], a[16:19], v[80:95]
    ds_read_b128 a[176:179], v24 offset:256
    v_exp_f32 v65, v65
    v_exp_f32 v66, v66
    v_add_f32 v118, v118, v64
    s_waitcnt lgkmcnt(3)
    v_mfma_f32_32x32x16_bf16 v[80:95], a[196:199], a[20:23], v[80:95]
    ds_read_b128 a[180:183], v25 offset:256
    buffer_load_dwordx4 v13, s[28:31], s43 offen offset:1024 nt lds
    v_exp_f32 v67, v67
    v_add_f32 v126, v126, v65
    v_cvt_pk_bf16_f32 v192, v64, v65
    s_waitcnt lgkmcnt(3)
    v_mfma_f32_32x32x16_bf16 v[80:95], a[200:203], a[24:27], v[80:95]
    ds_read_b128 a[184:187], v26 offset:256
    v_exp_f32 v68, v68
    v_add_f32 v118, v118, v66
    v_exp_f32 v69, v69
    s_waitcnt lgkmcnt(3)
    v_mfma_f32_32x32x16_bf16 v[80:95], a[204:207], a[28:31], v[80:95]
    ds_read_b128 a[188:191], v27 offset:256
    v_add_f32 v126, v126, v67
    v_cvt_pk_bf16_f32 v193, v66, v67
    v_exp_f32 v70, v70
    v_add_f32 v118, v118, v68
    s_waitcnt lgkmcnt(3)
    v_mfma_f32_32x32x16_bf16 v[80:95], a[176:179], a[32:35], v[80:95]
    ds_read_b128 a[192:195], v28 offset:256
    v_exp_f32 v71, v71
    v_add_f32 v126, v126, v69
    v_cvt_pk_bf16_f32 v194, v68, v69
    s_waitcnt lgkmcnt(3)
    v_mfma_f32_32x32x16_bf16 v[80:95], a[180:183], a[36:39], v[80:95]
    ds_read_b128 a[196:199], v29 offset:256
    buffer_load_dwordx4 v13, s[28:31], s43 offen offset:2048 nt lds
    v_exp_f32 v72, v72
    v_add_f32 v118, v118, v70
    s_waitcnt lgkmcnt(3)
    v_mfma_f32_32x32x16_bf16 v[80:95], a[184:187], a[40:43], v[80:95]
    ds_read_b128 a[200:203], v30 offset:256
    v_exp_f32 v73, v73
    v_add_f32 v126, v126, v71
    v_cvt_pk_bf16_f32 v195, v70, v71
    s_waitcnt lgkmcnt(3)
    v_mfma_f32_32x32x16_bf16 v[80:95], a[188:191], a[44:47], v[80:95]
    ds_read_b128 a[204:207], v31 offset:256
    v_exp_f32 v74, v74
    v_add_f32 v118, v118, v72
    v_exp_f32 v75, v75
    s_waitcnt lgkmcnt(3)
    v_mfma_f32_32x32x16_bf16 v[80:95], a[192:195], a[48:51], v[80:95]
    s_waitcnt vmcnt(27)
    s_barrier
    ds_read_b128 a[176:179], v24 offset:16384
    v_add_f32 v126, v126, v73
    s_waitcnt lgkmcnt(3)
    v_mfma_f32_32x32x16_bf16 v[80:95], a[196:199], a[52:55], v[80:95]
    ds_read_b128 a[180:183], v25 offset:16384
    buffer_load_dwordx4 v13, s[28:31], s43 offen offset:3072 nt lds
    v_cvt_pk_bf16_f32 v196, v72, v73
    v_exp_f32 v76, v76
    v_add_f32 v118, v118, v74
    s_waitcnt lgkmcnt(3)
    v_mfma_f32_32x32x16_bf16 v[80:95], a[200:203], a[56:59], v[80:95]
    ds_read_b128 a[184:187], v26 offset:16384
    v_exp_f32 v77, v77
    v_add_f32 v126, v126, v75
    v_cvt_pk_bf16_f32 v197, v74, v75
    s_waitcnt lgkmcnt(3)
    v_mfma_f32_32x32x16_bf16 v[80:95], a[204:207], a[60:63], v[80:95]
    ds_read_b128 a[188:191], v27 offset:16384
    v_exp_f32 v78, v78
    v_add_f32 v118, v118, v76
    v_exp_f32 v79, v79
    v_add_f32 v126, v126, v77
    v_cvt_pk_bf16_f32 v198, v76, v77
    v_add_f32 v118, v118, v78
    v_add_f32 v126, v126, v79
    v_cvt_pk_bf16_f32 v199, v78, v79
    s_waitcnt lgkmcnt(3)
    v_mfma_f32_32x32x16_bf16 v[64:79], a[176:179], a[0:3], v[96:111]
    ds_read_b128 a[192:195], v28 offset:16384
    v_max3_f32 v119, v80, v81, v82
    v_max3_f32 v123, v83, v84, v85
    v_max3_f32 v124, v86, v87, v88
    v_max3_f32 v119, v119, v89, v90
    v_max3_f32 v123, v123, v91, v92
    s_waitcnt lgkmcnt(3)
    v_mfma_f32_32x32x16_bf16 v[64:79], a[180:183], a[4:7], v[64:79]
    ds_read_b128 a[196:199], v29 offset:16384
    s_add_u32 m0, s42, 147456
    s_mov_b32 s43, 131072
    buffer_load_dwordx4 v13, s[28:31], s43 offen offset:0 nt lds
    v_max3_f32 v124, v124, v93, v94
    v_max_f32 v119, v119, v95
    s_waitcnt lgkmcnt(3)
    v_mfma_f32_32x32x16_bf16 v[64:79], a[184:187], a[8:11], v[64:79]
    ds_read_b128 a[200:203], v30 offset:16384
    v_max3_f32 v119, v119, v123, v124
    v_cmp_lt_f32 vcc, s45, v119
    s_cbranch_vccnz LF_stub9
LF_ret9:
    v_exp_f32 v80, v80
    s_waitcnt lgkmcnt(3)
    v_mfma_f32_32x32x16_bf16 v[64:79], a[188:191], a[12:15], v[64:79]
    ds_read_b128 a[204:207], v31 offset:16384
    v_exp_f32 v81, v81
    v_exp_f32 v82, v82
    v_add_f32 v118, v118, v80
    s_waitcnt lgkmcnt(3)
    v_mfma_f32_32x32x16_bf16 v[64:79], a[192:195], a[16:19], v[64:79]
    ds_read_b128 a[176:179], v24 offset:16640
    v_exp_f32 v83, v83
    v_add_f32 v126, v126, v81
    v_cvt_pk_bf16_f32 v200, v80, v81
    s_waitcnt lgkmcnt(3)
    v_mfma_f32_32x32x16_bf16 v[64:79], a[196:199], a[20:23], v[64:79]
    ds_read_b128 a[180:183], v25 offset:16640
    buffer_load_dwordx4 v13, s[28:31], s43 offen offset:1024 nt lds
    v_exp_f32 v84, v84
    v_add_f32 v118, v118, v82
    s_waitcnt lgkmcnt(3)
    v_mfma_f32_32x32x16_bf16 v[64:79], a[200:203], a[24:27], v[64:79]
    ds_read_b128 a[184:187], v26 offset:16640
    v_exp_f32 v85, v85
    v_add_f32 v126, v126, v83
    v_cvt_pk_bf16_f32 v201, v82, v83
    s_waitcnt lgkmcnt(3)
    v_mfma_f32_32x32x16_bf16 v[64:79], a[204:207], a[28:31], v[64:79]
    ds_read_b128 a[188:191], v27 offset:16640
    v_exp_f32 v86, v86
    v_add_f32 v118, v118, v84
    v_exp_f32 v87, v87
    s_waitcnt lgkmcnt(3)
    v_mfma_f32_32x32x16_bf16 v[64:79], a[176:179], a[32:35], v[64:79]
    ds_read_b128 a[192:195], v28 offset:16640
    v_add_f32 v126, v126, v85
    v_cvt_pk_bf16_f32 v202, v84, v85
    v_exp_f32 v88, v88
    v_add_f32 v118, v118, v86
    s_waitcnt lgkmcnt(3)
    v_mfma_f32_32x32x16_bf16 v[64:79], a[180:183], a[36:39], v[64:79]
    ds_read_b128 a[196:199], v29 offset:16640
    buffer_load_dwordx4 v13, s[28:31], s43 offen offset:2048 nt lds
    v_exp_f32 v89, v89
    v_add_f32 v126, v126, v87
    v_cvt_pk_bf16_f32 v203, v86, v87
    s_waitcnt lgkmcnt(3)
    v_mfma_f32_32x32x16_bf16 v[64:79], a[184:187], a[40:43], v[64:79]
    ds_read_b128 a[200:203], v30 offset:16640
    v_exp_f32 v90, v90
    v_add_f32 v118, v118, v88
    v_exp_f32 v91, v91
    s_waitcnt lgkmcnt(3)
    v_mfma_f32_32x32x16_bf16 v[64:79], a[188:191], a[44:47], v[64:79]
    ds_read_b128 a[204:207], v31 offset:16640
    v_add_f32 v126, v126, v89
    v_cvt_pk_bf16_f32 v204, v88, v89
    v_exp_f32 v92, v92
    v_add_f32 v118, v118, v90
    s_waitcnt lgkmcnt(3)
    v_mfma_f32_32x32x16_bf16 v[64:79], a[192:195], a[48:51], v[64:79]
    s_waitcnt vmcnt(27)
    s_barrier
    ds_read_b128 a[176:179], v24 offset:32768
    s_waitcnt lgkmcnt(3)
    v_mfma_f32_32x32x16_bf16 v[64:79], a[196:199], a[52:55], v[64:79]
    ds_read_b128 a[180:183], v25 offset:32768
    buffer_load_dwordx4 v13, s[28:31], s43 offen offset:3072 nt lds
    v_exp_f32 v93, v93
    v_add_f32 v126, v126, v91
    v_cvt_pk_bf16_f32 v205, v90, v91
    s_waitcnt lgkmcnt(3)
    v_mfma_f32_32x32x16_bf16 v[64:79], a[200:203], a[56:59], v[64:79]
    ds_read_b128 a[184:187], v26 offset:32768
    v_exp_f32 v94, v94
    v_add_f32 v118, v118, v92
    v_exp_f32 v95, v95
    s_waitcnt lgkmcnt(3)
    v_mfma_f32_32x32x16_bf16 v[64:79], a[204:207], a[60:63], v[64:79]
    ds_read_b128 a[188:191], v27 offset:32768
    v_add_f32 v126, v126, v93
    v_cvt_pk_bf16_f32 v206, v92, v93
    v_add_f32 v118, v118, v94
    v_add_f32 v126, v126, v95
    v_cvt_pk_bf16_f32 v207, v94, v95
    s_waitcnt lgkmcnt(3)
    v_mfma_f32_32x32x16_bf16 v[80:95], a[176:179], a[0:3], v[96:111]
    ds_read_b128 a[192:195], v28 offset:32768
    s_waitcnt lgkmcnt(3)
    v_mfma_f32_32x32x16_bf16 v[80:95], a[180:183], a[4:7], v[80:95]
    ds_read_b128 a[196:199], v29 offset:32768
    s_add_u32 m0, s42, 0
    s_mov_b32 s43, 196608
    buffer_load_dwordx4 v13, s[28:31], s43 offen offset:0 nt lds
    v_max3_f32 v119, v64, v65, v66
    v_max3_f32 v123, v67, v68, v69
    s_waitcnt lgkmcnt(3)
    v_mfma_f32_32x32x16_bf16 v[80:95], a[184:187], a[8:11], v[80:95]
    ds_read_b128 a[200:203], v30 offset:32768
    v_max3_f32 v124, v70, v71, v72
    v_max3_f32 v119, v119, v73, v74
    v_max3_f32 v123, v123, v75, v76
    v_max3_f32 v124, v124, v77, v78
    v_max_f32 v119, v119, v79
    s_waitcnt lgkmcnt(3)
    v_mfma_f32_32x32x16_bf16 v[80:95], a[188:191], a[12:15], v[80:95]
    ds_read_b128 a[204:207], v31 offset:32768
    v_max3_f32 v119, v119, v123, v124
    v_cmp_lt_f32 vcc, s45, v119
    s_cbranch_vccnz LF_stub10
LF_ret10:
    v_exp_f32 v64, v64
    s_waitcnt lgkmcnt(3)
    v_mfma_f32_32x32x16_bf16 v[80:95], a[192:195], a[16:19], v[80:95]
    ds_read_b128 a[176:179], v24 offset:33024
    v_exp_f32 v65, v65
    v_exp_f32 v66, v66
    v_add_f32 v118, v118, v64
    s_waitcnt lgkmcnt(3)
    v_mfma_f32_32x32x16_bf16 v[80:95], a[196:199], a[20:23], v[80:95]
    ds_read_b128 a[180:183], v25 offset:33024
    buffer_load_dwordx4 v13, s[28:31], s43 offen offset:1024 nt lds
    v_exp_f32 v67, v67
    v_add_f32 v126, v126, v65
    v_cvt_pk_bf16_f32 v208, v64, v65
    s_waitcnt lgkmcnt(3)
    v_mfma_f32_32x32x16_bf16 v[80:95], a[200:203], a[24:27], v[80:95]
    ds_read_b128 a[184:187], v26 offset:33024
    v_exp_f32 v68, v68
    v_add_f32 v118, v118, v66
    v_exp_f32 v69, v69
    s_waitcnt lgkmcnt(3)
    v_mfma_f32_32x32x16_bf16 v[80:95], a[204:207], a[28:31], v[80:95]
    ds_read_b128 a[188:191], v27 offset:33024
    v_add_f32 v126, v126, v67
    v_cvt_pk_bf16_f32 v209, v66, v67
    v_exp_f32 v70, v70
    v_add_f32 v118, v118, v68
    s_waitcnt lgkmcnt(3)
    v_mfma_f32_32x32x16_bf16 v[80:95], a[176:179], a[32:35], v[80:95]
    ds_read_b128 a[192:195], v28 offset:33024
    v_exp_f32 v71, v71
    v_add_f32 v126, v126, v69
    v_cvt_pk_bf16_f32 v210, v68, v69
    s_waitcnt lgkmcnt(3)
    v_mfma_f32_32x32x16_bf16 v[80:95], a[180:183], a[36:39], v[80:95]
    ds_read_b128 a[196:199], v29 offset:33024
    buffer_load_dwordx4 v13, s[28:31], s43 offen offset:2048 nt lds
    v_exp_f32 v72, v72
    v_add_f32 v118, v118, v70
    s_waitcnt lgkmcnt(3)
    v_mfma_f32_32x32x16_bf16 v[80:95], a[184:187], a[40:43], v[80:95]
    ds_read_b128 a[200:203], v30 offset:33024
    v_exp_f32 v73, v73
    v_add_f32 v126, v126, v71
    v_cvt_pk_bf16_f32 v211, v70, v71
    s_waitcnt lgkmcnt(3)
    v_mfma_f32_32x32x16_bf16 v[80:95], a[188:191], a[44:47], v[80:95]
    ds_read_b128 a[204:207], v31 offset:33024
    v_exp_f32 v74, v74
    v_add_f32 v118, v118, v72
    v_exp_f32 v75, v75
    s_waitcnt lgkmcnt(3)
    v_mfma_f32_32x32x16_bf16 v[80:95], a[192:195], a[48:51], v[80:95]
    s_waitcnt vmcnt(27)
    s_barrier
    ds_read_b128 a[176:179], v24 offset:49152
    v_add_f32 v126, v126, v73
    s_waitcnt lgkmcnt(3)
    v_mfma_f32_32x32x16_bf16 v[80:95], a[196:199], a[52:55], v[80:95]
    ds_read_b128 a[180:183], v25 offset:49152
    buffer_load_dwordx4 v13, s[28:31], s43 offen offset:3072 nt lds
    v_cvt_pk_bf16_f32 v212, v72, v73
    v_exp_f32 v76, v76
    v_add_f32 v118, v118, v74
    s_waitcnt lgkmcnt(3)
    v_mfma_f32_32x32x16_bf16 v[80:95], a[200:203], a[56:59], v[80:95]
    ds_read_b128 a[184:187], v26 offset:49152
    v_exp_f32 v77, v77
    v_add_f32 v126, v126, v75
    v_cvt_pk_bf16_f32 v213, v74, v75
    s_waitcnt lgkmcnt(3)
    v_mfma_f32_32x32x16_bf16 v[80:95], a[204:207], a[60:63], v[80:95]
    ds_read_b128 a[188:191], v27 offset:49152
    v_exp_f32 v78, v78
    v_add_f32 v118, v118, v76
    v_exp_f32 v79, v79
    v_add_f32 v126, v126, v77
    v_cvt_pk_bf16_f32 v214, v76, v77
    v_add_f32 v118, v118, v78
    v_add_f32 v126, v126, v79
    v_cvt_pk_bf16_f32 v215, v78, v79
    s_waitcnt lgkmcnt(3)
    v_mfma_f32_32x32x16_bf16 v[64:79], a[176:179], a[0:3], v[96:111]
    ds_read_b128 a[192:195], v28 offset:49152
    v_max3_f32 v119, v80, v81, v82
    v_max3_f32 v123, v83, v84, v85
    v_max3_f32 v124, v86, v87, v88
    v_max3_f32 v119, v119, v89, v90
    v_max3_f32 v123, v123, v91, v92
    s_waitcnt lgkmcnt(3)
    v_mfma_f32_32x32x16_bf16 v[64:79], a[180:183], a[4:7], v[64:79]
    ds_read_b128 a[196:199], v29 offset:49152
    s_add_u32 m0, s42, 16384
    s_mov_b32 s43, 128
    buffer_load_dwordx4 v13, s[28:31], s43 offen offset:0 nt lds
    v_max3_f32 v124, v124, v93, v94
    v_max_f32 v119, v119, v95
    s_waitcnt lgkmcnt(3)
    v_mfma_f32_32x32x16_bf16 v[64:79], a[184:187], a[8:11], v[64:79]
    ds_read_b128 a[200:203], v30 offset:49152
    v_max3_f32 v119, v119, v123, v124
    v_cmp_lt_f32 vcc, s45, v119
    s_cbranch_vccnz LF_stub11
LF_ret11:
    v_exp_f32 v80, v80
    s_waitcnt lgkmcnt(3)
    v_mfma_f32_32x32x16_bf16 v[64:79], a[188:191], a[12:15], v[64:79]
    ds_read_b128 a[204:207], v31 offset:49152
    v_exp_f32 v81, v81
    v_exp_f32 v82, v82
    v_add_f32 v118, v118, v80
    s_waitcnt lgkmcnt(3)
    v_mfma_f32_32x32x16_bf16 v[64:79], a[192:195], a[16:19], v[64:79]
    ds_read_b128 a[176:179], v24 offset:49408
    v_exp_f32 v83, v83
    v_add_f32 v126, v126, v81
    v_cvt_pk_bf16_f32 v216, v80, v81
    s_waitcnt lgkmcnt(3)
    v_mfma_f32_32x32x16_bf16 v[64:79], a[196:199], a[20:23], v[64:79]
    ds_read_b128 a[180:183], v25 offset:49408
    buffer_load_dwordx4 v13, s[28:31], s43 offen offset:1024 nt lds
    v_exp_f32 v84, v84
    v_add_f32 v118, v118, v82
    s_waitcnt lgkmcnt(3)
    v_mfma_f32_32x32x16_bf16 v[64:79], a[200:203], a[24:27], v[64:79]
    ds_read_b128 a[184:187], v26 offset:49408
    v_exp_f32 v85, v85
    v_add_f32 v126, v126, v83
    v_cvt_pk_bf16_f32 v217, v82, v83
    s_waitcnt lgkmcnt(3)
    v_mfma_f32_32x32x16_bf16 v[64:79], a[204:207], a[28:31], v[64:79]
    ds_read_b128 a[188:191], v27 offset:49408
    v_exp_f32 v86, v86
    v_add_f32 v118, v118, v84
    v_exp_f32 v87, v87
    s_waitcnt lgkmcnt(3)
    v_mfma_f32_32x32x16_bf16 v[64:79], a[176:179], a[32:35], v[64:79]
    ds_read_b128 a[192:195], v28 offset:49408
    v_add_f32 v126, v126, v85
    v_cvt_pk_bf16_f32 v218, v84, v85
    v_exp_f32 v88, v88
    v_add_f32 v118, v118, v86
    s_waitcnt lgkmcnt(3)
    v_mfma_f32_32x32x16_bf16 v[64:79], a[180:183], a[36:39], v[64:79]
    ds_read_b128 a[196:199], v29 offset:49408
    buffer_load_dwordx4 v13, s[28:31], s43 offen offset:2048 nt lds
    v_exp_f32 v89, v89
    v_add_f32 v126, v126, v87
    v_cvt_pk_bf16_f32 v219, v86, v87
    s_waitcnt lgkmcnt(3)
    v_mfma_f32_32x32x16_bf16 v[64:79], a[184:187], a[40:43], v[64:79]
    ds_read_b128 a[200:203], v30 offset:49408
    v_exp_f32 v90, v90
    v_add_f32 v118, v118, v88
    v_exp_f32 v91, v91
    s_waitcnt lgkmcnt(3)
    v_mfma_f32_32x32x16_bf16 v[64:79], a[188:191], a[44:47], v[64:79]
    ds_read_b128 a[204:207], v31 offset:49408
    v_add_f32 v126, v126, v89
    v_cvt_pk_bf16_f32 v220, v88, v89
    v_exp_f32 v92, v92
    v_add_f32 v118, v118, v90
    s_waitcnt lgkmcnt(3)
    v_mfma_f32_32x32x16_bf16 v[64:79], a[192:195], a[48:51], v[64:79]
    s_waitcnt vmcnt(27)
    s_barrier
    v_add_u32 v24, 0x10000, v24
    ds_read_b128 a[176:179], v24 offset:0
    s_waitcnt lgkmcnt(3)
    v_mfma_f32_32x32x16_bf16 v[64:79], a[196:199], a[52:55], v[64:79]
    v_add_u32 v25, 0x10000, v25
    ds_read_b128 a[180:183], v25 offset:0
    buffer_load_dwordx4 v13, s[28:31], s43 offen offset:3072 nt lds
    v_exp_f32 v93, v93
    v_add_f32 v126, v126, v91
    s_waitcnt lgkmcnt(3)
    v_mfma_f32_32x32x16_bf16 v[64:79], a[200:203], a[56:59], v[64:79]
    v_add_u32 v26, 0x10000, v26
    ds_read_b128 a[184:187], v26 offset:0
    v_cvt_pk_bf16_f32 v221, v90, v91
    v_exp_f32 v94, v94
    v_add_f32 v118, v118, v92
    s_waitcnt lgkmcnt(3)
    v_mfma_f32_32x32x16_bf16 v[64:79], a[204:207], a[60:63], v[64:79]
    v_add_u32 v27, 0x10000, v27
    ds_read_b128 a[188:191], v27 offset:0
    v_exp_f32 v95, v95
    v_add_f32 v126, v126, v93
    v_cvt_pk_bf16_f32 v222, v92, v93
    v_add_f32 v118, v118, v94
    v_add_f32 v126, v126, v95
    v_cvt_pk_bf16_f32 v223, v94, v95
    s_waitcnt lgkmcnt(3)
    v_mfma_f32_32x32x16_bf16 v[80:95], a[176:179], a[0:3], v[96:111]
    v_add_u32 v28, 0x10000, v28
    ds_read_b128 a[192:195], v28 offset:0
    v_max3_f32 v119, v64, v65, v66
    v_max3_f32 v123, v67, v68, v69
    v_max3_f32 v124, v70, v71, v72
    v_max3_f32 v119, v119, v73, v74
    s_waitcnt lgkmcnt(3)
    v_mfma_f32_32x32x16_bf16 v[80:95], a[180:183], a[4:7], v[80:95]
    v_add_u32 v29, 0x10000, v29
    ds_read_b128 a[196:199], v29 offset:0
    s_add_u32 m0, s42, 32768
    s_mov_b32 s43, 65664
    buffer_load_dwordx4 v13, s[28:31], s43 offen offset:0 nt lds
    v_max3_f32 v123, v123, v75, v76
    s_waitcnt lgkmcnt(3)
    v_mfma_f32_32x32x16_bf16 v[80:95], a[184:187], a[8:11], v[80:95]
    v_add_u32 v30, 0x10000, v30
    ds_read_b128 a[200:203], v30 offset:0
    v_max3_f32 v124, v124, v77, v78
    v_max_f32 v119, v119, v79
    v_max3_f32 v119, v119, v123, v124
    v_cmp_lt_f32 vcc, s45, v119
    s_waitcnt lgkmcnt(3)
    v_mfma_f32_32x32x16_bf16 v[80:95], a[188:191], a[12:15], v[80:95]
    v_add_u32 v31, 0x10000, v31
    ds_read_b128 a[204:207], v31 offset:0
    s_cbranch_vccnz LF_stub12
LF_ret12:
    v_exp_f32 v64, v64
    s_waitcnt lgkmcnt(3)
    v_mfma_f32_32x32x16_bf16 v[80:95], a[192:195], a[16:19], v[80:95]
    ds_read_b128 a[176:179], v24 offset:256
    v_exp_f32 v65, v65
    v_exp_f32 v66, v66
    v_add_f32 v118, v118, v64
    s_waitcnt lgkmcnt(3)
    v_mfma_f32_32x32x16_bf16 v[80:95], a[196:199], a[20:23], v[80:95]
    ds_read_b128 a[180:183], v25 offset:256
    buffer_load_dwordx4 v13, s[28:31], s43 offen offset:1024 nt lds
    v_exp_f32 v67, v67
    v_add_f32 v126, v126, v65
    v_cvt_pk_bf16_f32 v224, v64, v65
    s_waitcnt lgkmcnt(3)
    v_mfma_f32_32x32x16_bf16 v[80:95], a[200:203], a[24:27], v[80:95]
    ds_read_b128 a[184:187], v26 offset:256
    v_exp_f32 v68, v68
    v_add_f32 v118, v118, v66
    v_exp_f32 v69, v69
    s_waitcnt lgkmcnt(3)
    v_mfma_f32_32x32x16_bf16 v[80:95], a[204:207], a[28:31], v[80:95]
    ds_read_b128 a[188:191], v27 offset:256
    v_add_f32 v126, v126, v67
    v_cvt_pk_bf16_f32 v225, v66, v67
    v_exp_f32 v70, v70
    v_add_f32 v118, v118, v68
    s_waitcnt lgkmcnt(3)
    v_mfma_f32_32x32x16_bf16 v[80:95], a[176:179], a[32:35], v[80:95]
    ds_read_b128 a[192:195], v28 offset:256
    v_exp_f32 v71, v71
    v_add_f32 v126, v126, v69
    v_cvt_pk_bf16_f32 v226, v68, v69
    s_waitcnt lgkmcnt(3)
    v_mfma_f32_32x32x16_bf16 v[80:95], a[180:183], a[36:39], v[80:95]
    ds_read_b128 a[196:199], v29 offset:256
    buffer_load_dwordx4 v13, s[28:31], s43 offen offset:2048 nt lds
    v_exp_f32 v72, v72
    v_add_f32 v118, v118, v70
    s_waitcnt lgkmcnt(3)
    v_mfma_f32_32x32x16_bf16 v[80:95], a[184:187], a[40:43], v[80:95]
    ds_read_b128 a[200:203], v30 offset:256
    v_exp_f32 v73, v73
    v_add_f32 v126, v126, v71
    v_cvt_pk_bf16_f32 v227, v70, v71
    s_waitcnt lgkmcnt(3)
    v_mfma_f32_32x32x16_bf16 v[80:95], a[188:191], a[44:47], v[80:95]
    ds_read_b128 a[204:207], v31 offset:256
    v_exp_f32 v74, v74
    v_add_f32 v118, v118, v72
    v_exp_f32 v75, v75
    s_waitcnt lgkmcnt(3)
    v_mfma_f32_32x32x16_bf16 v[80:95], a[192:195], a[48:51], v[80:95]
    s_waitcnt vmcnt(27)
    s_barrier
    ds_read_b128 a[176:179], v24 offset:16384
    v_add_f32 v126, v126, v73
    s_waitcnt lgkmcnt(3)
    v_mfma_f32_32x32x16_bf16 v[80:95], a[196:199], a[52:55], v[80:95]
    ds_read_b128 a[180:183], v25 offset:16384
    buffer_load_dwordx4 v13, s[28:31], s43 offen offset:3072 nt lds
    v_cvt_pk_bf16_f32 v228, v72, v73
    v_exp_f32 v76, v76
    v_add_f32 v118, v118, v74
    s_waitcnt lgkmcnt(3)
    v_mfma_f32_32x32x16_bf16 v[80:95], a[200:203], a[56:59], v[80:95]
    ds_read_b128 a[184:187], v26 offset:16384
    v_exp_f32 v77, v77
    v_add_f32 v126, v126, v75
    v_cvt_pk_bf16_f32 v229, v74, v75
    s_waitcnt lgkmcnt(3)
    v_mfma_f32_32x32x16_bf16 v[80:95], a[204:207], a[60:63], v[80:95]
    ds_read_b128 a[188:191], v27 offset:16384
    v_exp_f32 v78, v78
    v_add_f32 v118, v118, v76
    v_exp_f32 v79, v79
    v_add_f32 v126, v126, v77
    v_cvt_pk_bf16_f32 v230, v76, v77
    v_add_f32 v118, v118, v78
    v_add_f32 v126, v126, v79
    v_cvt_pk_bf16_f32 v231, v78, v79
    s_waitcnt lgkmcnt(3)
    v_mfma_f32_32x32x16_bf16 v[64:79], a[176:179], a[0:3], v[96:111]
    ds_read_b128 a[192:195], v28 offset:16384
    v_max3_f32 v119, v80, v81, v82
    v_max3_f32 v123, v83, v84, v85
    v_max3_f32 v124, v86, v87, v88
    v_max3_f32 v119, v119, v89, v90
    v_max3_f32 v123, v123, v91, v92
    s_waitcnt lgkmcnt(3)
    v_mfma_f32_32x32x16_bf16 v[64:79], a[180:183], a[4:7], v[64:79]
    ds_read_b128 a[196:199], v29 offset:16384
    s_add_u32 m0, s42, 49152
    s_mov_b32 s43, 131200
    buffer_load_dwordx4 v13, s[28:31], s43 offen offset:0 nt lds
    v_max3_f32 v124, v124, v93, v94
    v_max_f32 v119, v119, v95
    s_waitcnt lgkmcnt(3)
    v_mfma_f32_32x32x16_bf16 v[64:79], a[184:187], a[8:11], v[64:79]
    ds_read_b128 a[200:203], v30 offset:16384
    v_max3_f32 v119, v119, v123, v124
    v_cmp_lt_f32 vcc, s45, v119
    s_cbranch_vccnz LF_stub13
LF_ret13:
    v_exp_f32 v80, v80
    s_waitcnt lgkmcnt(3)
    v_mfma_f32_32x32x16_bf16 v[64:79], a[188:191], a[12:15], v[64:79]
    ds_read_b128 a[204:207], v31 offset:16384
    v_exp_f32 v81, v81
    v_exp_f32 v82, v82
    v_add_f32 v118, v118, v80
    s_waitcnt lgkmcnt(3)
    v_mfma_f32_32x32x16_bf16 v[64:79], a[192:195], a[16:19], v[64:79]
    ds_read_b128 a[176:179], v24 offset:16640
    v_exp_f32 v83, v83
    v_add_f32 v126, v126, v81
    v_cvt_pk_bf16_f32 v232, v80, v81
    s_waitcnt lgkmcnt(3)
    v_mfma_f32_32x32x16_bf16 v[64:79], a[196:199], a[20:23], v[64:79]
    ds_read_b128 a[180:183], v25 offset:16640
    buffer_load_dwordx4 v13, s[28:31], s43 offen offset:1024 nt lds
    v_exp_f32 v84, v84
    v_add_f32 v118, v118, v82
    s_waitcnt lgkmcnt(3)
    v_mfma_f32_32x32x16_bf16 v[64:79], a[200:203], a[24:27], v[64:79]
    ds_read_b128 a[184:187], v26 offset:16640
    v_exp_f32 v85, v85
    v_add_f32 v126, v126, v83
    v_cvt_pk_bf16_f32 v233, v82, v83
    s_waitcnt lgkmcnt(3)
    v_mfma_f32_32x32x16_bf16 v[64:79], a[204:207], a[28:31], v[64:79]
    ds_read_b128 a[188:191], v27 offset:16640
    v_exp_f32 v86, v86
    v_add_f32 v118, v118, v84
    v_exp_f32 v87, v87
    s_waitcnt lgkmcnt(3)
    v_mfma_f32_32x32x16_bf16 v[64:79], a[176:179], a[32:35], v[64:79]
    ds_read_b128 a[192:195], v28 offset:16640
    v_add_f32 v126, v126, v85
    v_cvt_pk_bf16_f32 v234, v84, v85
    v_exp_f32 v88, v88
    v_add_f32 v118, v118, v86
    s_waitcnt lgkmcnt(3)
    v_mfma_f32_32x32x16_bf16 v[64:79], a[180:183], a[36:39], v[64:79]
    ds_read_b128 a[196:199], v29 offset:16640
    buffer_load_dwordx4 v13, s[28:31], s43 offen offset:2048 nt lds
    v_exp_f32 v89, v89
    v_add_f32 v126, v126, v87
    v_cvt_pk_bf16_f32 v235, v86, v87
    s_waitcnt lgkmcnt(3)
    v_mfma_f32_32x32x16_bf16 v[64:79], a[184:187], a[40:43], v[64:79]
    ds_read_b128 a[200:203], v30 offset:16640
    v_exp_f32 v90, v90
    v_add_f32 v118, v118, v88
    v_exp_f32 v91, v91
    s_waitcnt lgkmcnt(3)
    v_mfma_f32_32x32x16_bf16 v[64:79], a[188:191], a[44:47], v[64:79]
    ds_read_b128 a[204:207], v31 offset:16640
    v_add_f32 v126, v126, v89
    v_cvt_pk_bf16_f32 v236, v88, v89
    v_exp_f32 v92, v92
    v_add_f32 v118, v118, v90
    s_waitcnt lgkmcnt(3)
    v_mfma_f32_32x32x16_bf16 v[64:79], a[192:195], a[48:51], v[64:79]
    s_waitcnt vmcnt(27)
    s_barrier
    ds_read_b128 a[176:179], v24 offset:32768
    s_waitcnt lgkmcnt(3)
    v_mfma_f32_32x32x16_bf16 v[64:79], a[196:199], a[52:55], v[64:79]
    ds_read_b128 a[180:183], v25 offset:32768
    buffer_load_dwordx4 v13, s[28:31], s43 offen offset:3072 nt lds
    v_exp_f32 v93, v93
    v_add_f32 v126, v126, v91
    v_cvt_pk_bf16_f32 v237, v90, v91
    s_waitcnt lgkmcnt(3)
    v_mfma_f32_32x32x16_bf16 v[64:79], a[200:203], a[56:59], v[64:79]
    ds_read_b128 a[184:187], v26 offset:32768
    v_exp_f32 v94, v94
    v_add_f32 v118, v118, v92
    v_exp_f32 v95, v95
    s_waitcnt lgkmcnt(3)
    v_mfma_f32_32x32x16_bf16 v[64:79], a[204:207], a[60:63], v[64:79]
    ds_read_b128 a[188:191], v27 offset:32768
    v_add_f32 v126, v126, v93
    v_cvt_pk_bf16_f32 v238, v92, v93
    v_add_f32 v118, v118, v94
    v_add_f32 v126, v126, v95
    v_cvt_pk_bf16_f32 v239, v94, v95
    s_waitcnt lgkmcnt(3)
    v_mfma_f32_32x32x16_bf16 v[80:95], a[176:179], a[0:3], v[96:111]
    ds_read_b128 a[192:195], v28 offset:32768
    s_waitcnt lgkmcnt(3)
    v_mfma_f32_32x32x16_bf16 v[80:95], a[180:183], a[4:7], v[80:95]
    ds_read_b128 a[196:199], v29 offset:32768
    s_add_u32 m0, s42, 65536
    s_mov_b32 s43, 196736
    buffer_load_dwordx4 v13, s[28:31], s43 offen offset:0 nt lds
    v_max3_f32 v119, v64, v65, v66
    v_max3_f32 v123, v67, v68, v69
    s_waitcnt lgkmcnt(3)
    v_mfma_f32_32x32x16_bf16 v[80:95], a[184:187], a[8:11], v[80:95]
    ds_read_b128 a[200:203], v30 offset:32768
    v_max3_f32 v124, v70, v71, v72
    v_max3_f32 v119, v119, v73, v74
    v_max3_f32 v123, v123, v75, v76
    v_max3_f32 v124, v124, v77, v78
    v_max_f32 v119, v119, v79
    s_waitcnt lgkmcnt(3)
    v_mfma_f32_32x32x16_bf16 v[80:95], a[188:191], a[12:15], v[80:95]
    ds_read_b128 a[204:207], v31 offset:32768
    v_max3_f32 v119, v119, v123, v124
    v_cmp_lt_f32 vcc, s45, v119
    s_cbranch_vccnz LF_stub14
LF_ret14:
    v_exp_f32 v64, v64
    s_waitcnt lgkmcnt(3)
    v_mfma_f32_32x32x16_bf16 v[80:95], a[192:195], a[16:19], v[80:95]
    ds_read_b128 a[176:179], v24 offset:33024
    v_exp_f32 v65, v65
    v_exp_f32 v66, v66
    v_add_f32 v118, v118, v64
    s_waitcnt lgkmcnt(3)
    v_mfma_f32_32x32x16_bf16 v[80:95], a[196:199], a[20:23], v[80:95]
    ds_read_b128 a[180:183], v25 offset:33024
    buffer_load_dwordx4 v13, s[28:31], s43 offen offset:1024 nt lds
    v_exp_f32 v67, v67
    v_add_f32 v126, v126, v65
    v_cvt_pk_bf16_f32 v240, v64, v65
    s_waitcnt lgkmcnt(3)
    v_mfma_f32_32x32x16_bf16 v[80:95], a[200:203], a[24:27], v[80:95]
    ds_read_b128 a[184:187], v26 offset:33024
    v_exp_f32 v68, v68
    v_add_f32 v118, v118, v66
    v_exp_f32 v69, v69
    s_waitcnt lgkmcnt(3)
    v_mfma_f32_32x32x16_bf16 v[80:95], a[204:207], a[28:31], v[80:95]
    ds_read_b128 a[188:191], v27 offset:33024
    v_add_f32 v126, v126, v67
    v_cvt_pk_bf16_f32 v241, v66, v67
    v_exp_f32 v70, v70
    v_add_f32 v118, v118, v68
    s_waitcnt lgkmcnt(3)
    v_mfma_f32_32x32x16_bf16 v[80:95], a[176:179], a[32:35], v[80:95]
    ds_read_b128 a[192:195], v28 offset:33024
    v_exp_f32 v71, v71
    v_add_f32 v126, v126, v69
    v_cvt_pk_bf16_f32 v242, v68, v69
    s_waitcnt lgkmcnt(3)
    v_mfma_f32_32x32x16_bf16 v[80:95], a[180:183], a[36:39], v[80:95]
    ds_read_b128 a[196:199], v29 offset:33024
    buffer_load_dwordx4 v13, s[28:31], s43 offen offset:2048 nt lds
    v_exp_f32 v72, v72
    v_add_f32 v118, v118, v70
    s_waitcnt lgkmcnt(3)
    v_mfma_f32_32x32x16_bf16 v[80:95], a[184:187], a[40:43], v[80:95]
    ds_read_b128 a[200:203], v30 offset:33024
    v_exp_f32 v73, v73
    v_add_f32 v126, v126, v71
    v_cvt_pk_bf16_f32 v243, v70, v71
    s_waitcnt lgkmcnt(3)
    v_mfma_f32_32x32x16_bf16 v[80:95], a[188:191], a[44:47], v[80:95]
    ds_read_b128 a[204:207], v31 offset:33024
    v_exp_f32 v74, v74
    v_add_f32 v118, v118, v72
    v_exp_f32 v75, v75
    s_waitcnt lgkmcnt(3)
    v_mfma_f32_32x32x16_bf16 v[80:95], a[192:195], a[48:51], v[80:95]
    s_waitcnt vmcnt(27)
    s_barrier
    v_add_u32 v116, 0x10000, v116
    ds_read_b64_tr_b16 a[176:177], v116 offset:49152
    ds_read_b64_tr_b16 a[178:179], v116 offset:50176
    s_waitcnt lgkmcnt(4)
    v_mfma_f32_32x32x16_bf16 v[80:95], a[196:199], a[52:55], v[80:95]
    v_add_u32 v117, 0x10000, v117
    ds_read_b64_tr_b16 a[180:181], v117 offset:49152
    ds_read_b64_tr_b16 a[182:183], v117 offset:50176
    buffer_load_dwordx4 v13, s[28:31], s43 offen offset:3072 nt lds
    v_add_f32 v126, v126, v73
    v_cvt_pk_bf16_f32 v244, v72, v73
    s_waitcnt lgkmcnt(5)
    v_mfma_f32_32x32x16_bf16 v[80:95], a[200:203], a[56:59], v[80:95]
    ds_read_b64_tr_b16 a[184:185], v116 offset:51200
    ds_read_b64_tr_b16 a[186:187], v116 offset:52224
    v_exp_f32 v76, v76
    v_add_f32 v118, v118, v74
    s_waitcnt lgkmcnt(6)
    v_mfma_f32_32x32x16_bf16 v[80:95], a[204:207], a[60:63], v[80:95]
    ds_read_b64_tr_b16 a[188:189], v117 offset:51200
    ds_read_b64_tr_b16 a[190:191], v117 offset:52224
    v_exp_f32 v77, v77
    v_add_f32 v126, v126, v75
    v_cvt_pk_bf16_f32 v245, v74, v75
    s_waitcnt lgkmcnt(6)
    v_mfma_f32_32x32x16_bf16 v[32:47], a[176:179], v[128:131], 0
    ds_read_b64_tr_b16 a[192:193], v116 offset:53248
    ds_read_b64_tr_b16 a[194:195], v116 offset:54272
    v_exp_f32 v78, v78
    v_add_f32 v118, v118, v76
    s_waitcnt lgkmcnt(6)
    v_mfma_f32_32x32x16_bf16 v[48:63], a[180:183], v[128:131], 0
    ds_read_b64_tr_b16 a[196:197], v117 offset:53248
    ds_read_b64_tr_b16 a[198:199], v117 offset:54272
    s_add_u32 m0, s42, 81920
    s_mov_b32 s43, 256
    buffer_load_dwordx4 v13, s[28:31], s43 offen offset:0 nt lds
    s_waitcnt lgkmcnt(6)
    v_mfma_f32_32x32x16_bf16 v[32:47], a[184:187], v[132:135], v[32:47]
    ds_read_b64_tr_b16 a[200:201], v116 offset:55296
    ds_read_b64_tr_b16 a[202:203], v116 offset:56320
    v_exp_f32 v79, v79
    v_add_f32 v126, v126, v77
    v_cvt_pk_bf16_f32 v246, v76, v77
    s_waitcnt lgkmcnt(6)
    v_mfma_f32_32x32x16_bf16 v[48:63], a[188:191], v[132:135], v[48:63]
    ds_read_b64_tr_b16 a[204:205], v117 offset:55296
    ds_read_b64_tr_b16 a[206:207], v117 offset:56320
    v_add_f32 v118, v118, v78
    v_add_f32 v126, v126, v79
    v_cvt_pk_bf16_f32 v247, v78, v79
    v_max3_f32 v119, v80, v81, v82
    s_waitcnt lgkmcnt(6)
    v_mfma_f32_32x32x16_bf16 v[32:47], a[192:195], v[136:139], v[32:47]
    ds_read_b64_tr_b16 a[176:177], v116 offset:57344
    ds_read_b64_tr_b16 a[178:179], v116 offset:58368
    v_max3_f32 v123, v83, v84, v85
    v_max3_f32 v124, v86, v87, v88
    v_max3_f32 v119, v119, v89, v90
    v_max3_f32 v123, v123, v91, v92
    s_waitcnt lgkmcnt(6)
    v_mfma_f32_32x32x16_bf16 v[48:63], a[196:199], v[136:139], v[48:63]
    ds_read_b64_tr_b16 a[180:181], v117 offset:57344
    ds_read_b64_tr_b16 a[182:183], v117 offset:58368
    buffer_load_dwordx4 v13, s[28:31], s43 offen offset:1024 nt lds
    v_max3_f32 v124, v124, v93, v94
    v_max_f32 v119, v119, v95
    v_max3_f32 v119, v119, v123, v124
    s_waitcnt lgkmcnt(6)
    v_mfma_f32_32x32x16_bf16 v[32:47], a[200:203], v[140:143], v[32:47]
    ds_read_b64_tr_b16 a[184:185], v116 offset:59392
    ds_read_b64_tr_b16 a[186:187], v116 offset:60416
    v_cmp_lt_f32 vcc, s45, v119
    s_cbranch_vccnz LF_stub15
LF_ret15:
    v_exp_f32 v80, v80
    s_waitcnt lgkmcnt(6)
    v_mfma_f32_32x32x16_bf16 v[48:63], a[204:207], v[140:143], v[48:63]
    ds_read_b64_tr_b16 a[188:189], v117 offset:59392
    ds_read_b64_tr_b16 a[190:191], v117 offset:60416
    v_exp_f32 v81, v81
    v_exp_f32 v82, v82
    s_waitcnt lgkmcnt(6)
    v_mfma_f32_32x32x16_bf16 v[32:47], a[176:179], v[144:147], v[32:47]
    ds_read_b64_tr_b16 a[192:193], v116 offset:61440
    ds_read_b64_tr_b16 a[194:195], v116 offset:62464
    v_add_f32 v118, v118, v80
    v_exp_f32 v83, v83
    v_add_f32 v126, v126, v81
    s_waitcnt lgkmcnt(6)
    v_mfma_f32_32x32x16_bf16 v[48:63], a[180:183], v[144:147], v[48:63]
    ds_read_b64_tr_b16 a[196:197], v117 offset:61440
    ds_read_b64_tr_b16 a[198:199], v117 offset:62464
    buffer_load_dwordx4 v13, s[28:31], s43 offen offset:2048 nt lds
    v_cvt_pk_bf16_f32 v248, v80, v81
    v_exp_f32 v84, v84
    s_waitcnt lgkmcnt(6)
    v_mfma_f32_32x32x16_bf16 v[32:47], a[184:187], v[148:151], v[32:47]
    ds_read_b64_tr_b16 a[200:201], v116 offset:63488
    ds_read_b64_tr_b16 a[202:203], v116 offset:64512
    v_add_f32 v118, v118, v82
    v_exp_f32 v85, v85
    v_add_f32 v126, v126, v83
    s_waitcnt lgkmcnt(6)
    v_mfma_f32_32x32x16_bf16 v[48:63], a[188:191], v[148:151], v[48:63]
    ds_read_b64_tr_b16 a[204:205], v117 offset:63488
    ds_read_b64_tr_b16 a[206:207], v117 offset:64512
    v_cvt_pk_bf16_f32 v249, v82, v83
    v_exp_f32 v86, v86
    v_add_f32 v118, v118, v84
    s_waitcnt lgkmcnt(6)
    v_mfma_f32_32x32x16_bf16 v[32:47], a[192:195], v[152:155], v[32:47]
    s_waitcnt vmcnt(27)
    s_barrier
    v_add_u32 v116, 0x10000, v116
    ds_read_b64_tr_b16 a[176:177], v116 offset:0
    ds_read_b64_tr_b16 a[178:179], v116 offset:1024
    s_waitcnt lgkmcnt(6)
    v_mfma_f32_32x32x16_bf16 v[48:63], a[196:199], v[152:155], v[48:63]
    v_add_u32 v117, 0x10000, v117
    ds_read_b64_tr_b16 a[180:181], v117 offset:0
    ds_read_b64_tr_b16 a[182:183], v117 offset:1024
    buffer_load_dwordx4 v13, s[28:31], s43 offen offset:3072 nt lds
    v_exp_f32 v87, v87
    s_waitcnt lgkmcnt(6)
    v_mfma_f32_32x32x16_bf16 v[32:47], a[200:203], v[156:159], v[32:47]
    ds_read_b64_tr_b16 a[184:185], v116 offset:2048
    ds_read_b64_tr_b16 a[186:187], v116 offset:3072
    v_add_f32 v126, v126, v85
    v_cvt_pk_bf16_f32 v250, v84, v85
    v_exp_f32 v88, v88
    s_waitcnt lgkmcnt(6)
    v_mfma_f32_32x32x16_bf16 v[48:63], a[204:207], v[156:159], v[48:63]
    ds_read_b64_tr_b16 a[188:189], v117 offset:2048
    ds_read_b64_tr_b16 a[190:191], v117 offset:3072
    v_add_f32 v118, v118, v86
    v_exp_f32 v89, v89
    v_add_f32 v126, v126, v87
    s_waitcnt lgkmcnt(6)
    v_mfma_f32_32x32x16_bf16 v[32:47], a[176:179], v[160:163], v[32:47]
    ds_read_b64_tr_b16 a[192:193], v116 offset:4096
    ds_read_b64_tr_b16 a[194:195], v116 offset:5120
    v_cvt_pk_bf16_f32 v251, v86, v87
    v_exp_f32 v90, v90
    v_add_f32 v118, v118, v88
    s_waitcnt lgkmcnt(6)
    v_mfma_f32_32x32x16_bf16 v[48:63], a[180:183], v[160:163], v[48:63]
    ds_read_b64_tr_b16 a[196:197], v117 offset:4096
    ds_read_b64_tr_b16 a[198:199], v117 offset:5120
    s_add_u32 m0, s42, 98304
    s_mov_b32 s43, 65792
    buffer_load_dwordx4 v13, s[28:31], s43 offen offset:0 nt lds
    s_waitcnt lgkmcnt(6)
    v_mfma_f32_32x32x16_bf16 v[32:47], a[184:187], v[164:167], v[32:47]
    ds_read_b64_tr_b16 a[200:201], v116 offset:6144
    ds_read_b64_tr_b16 a[202:203], v116 offset:7168
    v_exp_f32 v91, v91
    v_add_f32 v126, v126, v89
    v_cvt_pk_bf16_f32 v252, v88, v89
    s_waitcnt lgkmcnt(6)
    v_mfma_f32_32x32x16_bf16 v[48:63], a[188:191], v[164:167], v[48:63]
    ds_read_b64_tr_b16 a[204:205], v117 offset:6144
    ds_read_b64_tr_b16 a[206:207], v117 offset:7168
    v_exp_f32 v92, v92
    v_add_f32 v118, v118, v90
    s_waitcnt lgkmcnt(6)
    v_mfma_f32_32x32x16_bf16 v[32:47], a[192:195], v[168:171], v[32:47]
    ds_read_b64_tr_b16 a[176:177], v116 offset:8192
    ds_read_b64_tr_b16 a[178:179], v116 offset:9216
    v_exp_f32 v93, v93
    v_add_f32 v126, v126, v91
    v_cvt_pk_bf16_f32 v253, v90, v91
    s_waitcnt lgkmcnt(6)
    v_mfma_f32_32x32x16_bf16 v[48:63], a[196:199], v[168:171], v[48:63]
    ds_read_b64_tr_b16 a[180:181], v117 offset:8192
    ds_read_b64_tr_b16 a[182:183], v117 offset:9216
    buffer_load_dwordx4 v13, s[28:31], s43 offen offset:1024 nt lds
    v_exp_f32 v94, v94
    v_add_f32 v118, v118, v92
    s_waitcnt lgkmcnt(6)
    v_mfma_f32_32x32x16_bf16 v[32:47], a[200:203], v[172:175], v[32:47]
    ds_read_b64_tr_b16 a[184:185], v116 offset:10240
    ds_read_b64_tr_b16 a[186:187], v116 offset:11264
    v_exp_f32 v95, v95
    v_add_f32 v126, v126, v93
    v_cvt_pk_bf16_f32 v254, v92, v93
    s_waitcnt lgkmcnt(6)
    v_mfma_f32_32x32x16_bf16 v[48:63], a[204:207], v[172:175], v[48:63]
    ds_read_b64_tr_b16 a[188:189], v117 offset:10240
    ds_read_b64_tr_b16 a[190:191], v117 offset:11264
    v_add_f32 v118, v118, v94
    v_add_f32 v126, v126, v95
    v_cvt_pk_bf16_f32 v255, v94, v95
    v_add_f32 v118, v118, v126
    s_waitcnt lgkmcnt(6)
    v_mfma_f32_32x32x16_bf16 v[32:47], a[176:179], v[176:179], v[32:47]
    ds_read_b64_tr_b16 a[192:193], v116 offset:12288
    ds_read_b64_tr_b16 a[194:195], v116 offset:13312
    v_mov_b32 v120, v118
    s_waitcnt lgkmcnt(6)
    v_mfma_f32_32x32x16_bf16 v[48:63], a[180:183], v[176:179], v[48:63]
    ds_read_b64_tr_b16 a[196:197], v117 offset:12288
    ds_read_b64_tr_b16 a[198:199], v117 offset:13312
    buffer_load_dwordx4 v13, s[28:31], s43 offen offset:2048 nt lds
    v_permlane32_swap_b32 v118, v120
    v_add_f32 v118, v118, v120
    s_waitcnt lgkmcnt(6)
    v_mfma_f32_32x32x16_bf16 v[32:47], a[184:187], v[180:183], v[32:47]
    ds_read_b64_tr_b16 a[200:201], v116 offset:14336
    ds_read_b64_tr_b16 a[202:203], v116 offset:15360
    v_rcp_f32 v122, v118
    s_waitcnt lgkmcnt(6)
    v_mfma_f32_32x32x16_bf16 v[48:63], a[188:191], v[180:183], v[48:63]
    ds_read_b64_tr_b16 a[204:205], v117 offset:14336
    ds_read_b64_tr_b16 a[206:207], v117 offset:15360
    s_waitcnt lgkmcnt(6)
    v_mfma_f32_32x32x16_bf16 v[32:47], a[192:195], v[184:187], v[32:47]
    s_waitcnt vmcnt(27)
    s_barrier
    ds_read_b64_tr_b16 a[176:177], v116 offset:16384
    ds_read_b64_tr_b16 a[178:179], v116 offset:17408
    s_waitcnt lgkmcnt(6)
    v_mfma_f32_32x32x16_bf16 v[48:63], a[196:199], v[184:187], v[48:63]
    ds_read_b64_tr_b16 a[180:181], v117 offset:16384
    ds_read_b64_tr_b16 a[182:183], v117 offset:17408
    buffer_load_dwordx4 v13, s[28:31], s43 offen offset:3072 nt lds
    s_waitcnt lgkmcnt(6)
    v_mfma_f32_32x32x16_bf16 v[32:47], a[200:203], v[188:191], v[32:47]
    ds_read_b64_tr_b16 a[184:185], v116 offset:18432
    ds_read_b64_tr_b16 a[186:187], v116 offset:19456
    s_waitcnt lgkmcnt(6)
    v_mfma_f32_32x32x16_bf16 v[48:63], a[204:207], v[188:191], v[48:63]
    ds_read_b64_tr_b16 a[188:189], v117 offset:18432
    ds_read_b64_tr_b16 a[190:191], v117 offset:19456
    s_waitcnt lgkmcnt(6)
    v_mfma_f32_32x32x16_bf16 v[32:47], a[176:179], v[192:195], v[32:47]
    ds_read_b64_tr_b16 a[192:193], v116 offset:20480
    ds_read_b64_tr_b16 a[194:195], v116 offset:21504
    s_waitcnt lgkmcnt(6)
    v_mfma_f32_32x32x16_bf16 v[48:63], a[180:183], v[192:195], v[48:63]
    ds_read_b64_tr_b16 a[196:197], v117 offset:20480
    ds_read_b64_tr_b16 a[198:199], v117 offset:21504
    s_add_u32 m0, s42, 114688
    s_mov_b32 s43, 131328
    buffer_load_dwordx4 v13, s[28:31], s43 offen offset:0 nt lds
    s_waitcnt lgkmcnt(6)
    v_mfma_f32_32x32x16_bf16 v[32:47], a[184:187], v[196:199], v[32:47]
    ds_read_b64_tr_b16 a[200:201], v116 offset:22528
    ds_read_b64_tr_b16 a[202:203], v116 offset:23552
    s_waitcnt lgkmcnt(6)
    v_mfma_f32_32x32x16_bf16 v[48:63], a[188:191], v[196:199], v[48:63]
    ds_read_b64_tr_b16 a[204:205], v117 offset:22528
    ds_read_b64_tr_b16 a[206:207], v117 offset:23552
    s_waitcnt lgkmcnt(6)
    v_mfma_f32_32x32x16_bf16 v[32:47], a[192:195], v[200:203], v[32:47]
    ds_read_b64_tr_b16 a[176:177], v116 offset:24576
    ds_read_b64_tr_b16 a[178:179], v116 offset:25600
    s_waitcnt lgkmcnt(6)
    v_mfma_f32_32x32x16_bf16 v[48:63], a[196:199], v[200:203], v[48:63]
    ds_read_b64_tr_b16 a[180:181], v117 offset:24576
    ds_read_b64_tr_b16 a[182:183], v117 offset:25600
    buffer_load_dwordx4 v13, s[28:31], s43 offen offset:1024 nt lds
    s_waitcnt lgkmcnt(6)
    v_mfma_f32_32x32x16_bf16 v[32:47], a[200:203], v[204:207], v[32:47]
    ds_read_b64_tr_b16 a[184:185], v116 offset:26624
    ds_read_b64_tr_b16 a[186:187], v116 offset:27648
    s_waitcnt lgkmcnt(6)
    v_mfma_f32_32x32x16_bf16 v[48:63], a[204:207], v[204:207], v[48:63]
    ds_read_b64_tr_b16 a[188:189], v117 offset:26624
    ds_read_b64_tr_b16 a[190:191], v117 offset:27648
    s_waitcnt lgkmcnt(6)
    v_mfma_f32_32x32x16_bf16 v[32:47], a[176:179], v[208:211], v[32:47]
    ds_read_b64_tr_b16 a[192:193], v116 offset:28672
    ds_read_b64_tr_b16 a[194:195], v116 offset:29696
    s_waitcnt lgkmcnt(6)
    v_mfma_f32_32x32x16_bf16 v[48:63], a[180:183], v[208:211], v[48:63]
    ds_read_b64_tr_b16 a[196:197], v117 offset:28672
    ds_read_b64_tr_b16 a[198:199], v117 offset:29696
    buffer_load_dwordx4 v13, s[28:31], s43 offen offset:2048 nt lds
    s_waitcnt lgkmcnt(6)
    v_mfma_f32_32x32x16_bf16 v[32:47], a[184:187], v[212:215], v[32:47]
    ds_read_b64_tr_b16 a[200:201], v116 offset:30720
    ds_read_b64_tr_b16 a[202:203], v116 offset:31744
    s_waitcnt lgkmcnt(6)
    v_mfma_f32_32x32x16_bf16 v[48:63], a[188:191], v[212:215], v[48:63]
    ds_read_b64_tr_b16 a[204:205], v117 offset:30720
    ds_read_b64_tr_b16 a[206:207], v117 offset:31744
    s_waitcnt lgkmcnt(6)
    v_mfma_f32_32x32x16_bf16 v[32:47], a[192:195], v[216:219], v[32:47]
    s_waitcnt vmcnt(27)
    s_barrier
    v_add_u32 v116, 0xfffe0000, v116
    ds_read_b64_tr_b16 a[176:177], v116 offset:0
    ds_read_b64_tr_b16 a[178:179], v116 offset:1024
    s_waitcnt lgkmcnt(6)
    v_mfma_f32_32x32x16_bf16 v[48:63], a[196:199], v[216:219], v[48:63]
    v_add_u32 v117, 0xfffe0000, v117
    ds_read_b64_tr_b16 a[180:181], v117 offset:0
    ds_read_b64_tr_b16 a[182:183], v117 offset:1024
    buffer_load_dwordx4 v13, s[28:31], s43 offen offset:3072 nt lds
    s_waitcnt lgkmcnt(6)
    v_mfma_f32_32x32x16_bf16 v[32:47], a[200:203], v[220:223], v[32:47]
    ds_read_b64_tr_b16 a[184:185], v116 offset:2048
    ds_read_b64_tr_b16 a[186:187], v116 offset:3072
    s_waitcnt lgkmcnt(6)
    v_mfma_f32_32x32x16_bf16 v[48:63], a[204:207], v[220:223], v[48:63]
    ds_read_b64_tr_b16 a[188:189], v117 offset:2048
    ds_read_b64_tr_b16 a[190:191], v117 offset:3072
    s_waitcnt lgkmcnt(6)
    v_mfma_f32_32x32x16_bf16 v[32:47], a[176:179], v[224:227], v[32:47]
    ds_read_b64_tr_b16 a[192:193], v116 offset:4096
    ds_read_b64_tr_b16 a[194:195], v116 offset:5120
    s_waitcnt lgkmcnt(6)
    v_mfma_f32_32x32x16_bf16 v[48:63], a[180:183], v[224:227], v[48:63]
    ds_read_b64_tr_b16 a[196:197], v117 offset:4096
    ds_read_b64_tr_b16 a[198:199], v117 offset:5120
    s_add_u32 m0, s42, 131072
    s_mov_b32 s43, 196864
    buffer_load_dwordx4 v13, s[28:31], s43 offen offset:0 nt lds
    s_waitcnt lgkmcnt(6)
    v_mfma_f32_32x32x16_bf16 v[32:47], a[184:187], v[228:231], v[32:47]
    ds_read_b64_tr_b16 a[200:201], v116 offset:6144
    ds_read_b64_tr_b16 a[202:203], v116 offset:7168
    s_waitcnt lgkmcnt(6)
    v_mfma_f32_32x32x16_bf16 v[48:63], a[188:191], v[228:231], v[48:63]
    ds_read_b64_tr_b16 a[204:205], v117 offset:6144
    ds_read_b64_tr_b16 a[206:207], v117 offset:7168
    s_waitcnt lgkmcnt(6)
    v_mfma_f32_32x32x16_bf16 v[32:47], a[192:195], v[232:235], v[32:47]
    ds_read_b64_tr_b16 a[176:177], v116 offset:8192
    ds_read_b64_tr_b16 a[178:179], v116 offset:9216
    s_waitcnt lgkmcnt(6)
    v_mfma_f32_32x32x16_bf16 v[48:63], a[196:199], v[232:235], v[48:63]
    ds_read_b64_tr_b16 a[180:181], v117 offset:8192
    ds_read_b64_tr_b16 a[182:183], v117 offset:9216
    buffer_load_dwordx4 v13, s[28:31], s43 offen offset:1024 nt lds
    s_waitcnt lgkmcnt(6)
    v_mfma_f32_32x32x16_bf16 v[32:47], a[200:203], v[236:239], v[32:47]
    ds_read_b64_tr_b16 a[184:185], v116 offset:10240
    ds_read_b64_tr_b16 a[186:187], v116 offset:11264
    s_waitcnt lgkmcnt(6)
    v_mfma_f32_32x32x16_bf16 v[48:63], a[204:207], v[236:239], v[48:63]
    ds_read_b64_tr_b16 a[188:189], v117 offset:10240
    ds_read_b64_tr_b16 a[190:191], v117 offset:11264
    s_waitcnt lgkmcnt(6)
    v_mfma_f32_32x32x16_bf16 v[32:47], a[176:179], v[240:243], v[32:47]
    ds_read_b64_tr_b16 a[192:193], v116 offset:12288
    ds_read_b64_tr_b16 a[194:195], v116 offset:13312
    s_waitcnt lgkmcnt(6)
    v_mfma_f32_32x32x16_bf16 v[48:63], a[180:183], v[240:243], v[48:63]
    ds_read_b64_tr_b16 a[196:197], v117 offset:12288
    ds_read_b64_tr_b16 a[198:199], v117 offset:13312
    buffer_load_dwordx4 v13, s[28:31], s43 offen offset:2048 nt lds
    s_waitcnt lgkmcnt(6)
    v_mfma_f32_32x32x16_bf16 v[32:47], a[184:187], v[244:247], v[32:47]
    ds_read_b64_tr_b16 a[200:201], v116 offset:14336
    ds_read_b64_tr_b16 a[202:203], v116 offset:15360
    s_waitcnt lgkmcnt(6)
    v_mfma_f32_32x32x16_bf16 v[48:63], a[188:191], v[244:247], v[48:63]
    ds_read_b64_tr_b16 a[204:205], v117 offset:14336
    ds_read_b64_tr_b16 a[206:207], v117 offset:15360
    s_waitcnt lgkmcnt(6)
    v_mfma_f32_32x32x16_bf16 v[32:47], a[192:195], v[248:251], v[32:47]
    s_waitcnt vmcnt(27)
    s_barrier
    ds_read_b64_tr_b16 a[176:177], v116 offset:16384
    ds_read_b64_tr_b16 a[178:179], v116 offset:17408
    s_waitcnt lgkmcnt(6)
    v_mfma_f32_32x32x16_bf16 v[48:63], a[196:199], v[248:251], v[48:63]
    ds_read_b64_tr_b16 a[180:181], v117 offset:16384
    ds_read_b64_tr_b16 a[182:183], v117 offset:17408
    buffer_load_dwordx4 v13, s[28:31], s43 offen offset:3072 nt lds
    s_waitcnt lgkmcnt(6)
    v_mfma_f32_32x32x16_bf16 v[32:47], a[200:203], v[252:255], v[32:47]
    ds_read_b64_tr_b16 a[184:185], v116 offset:18432
    ds_read_b64_tr_b16 a[186:187], v116 offset:19456
    s_waitcnt lgkmcnt(6)
    v_mfma_f32_32x32x16_bf16 v[48:63], a[204:207], v[252:255], v[48:63]
    ds_read_b64_tr_b16 a[188:189], v117 offset:18432
    ds_read_b64_tr_b16 a[190:191], v117 offset:19456
    s_waitcnt lgkmcnt(6)
    v_mfma_f32_32x32x16_bf16 v[64:79], a[176:179], v[128:131], 0
    ds_read_b64_tr_b16 a[192:193], v116 offset:20480
    ds_read_b64_tr_b16 a[194:195], v116 offset:21504
    s_waitcnt lgkmcnt(6)
    v_mfma_f32_32x32x16_bf16 v[80:95], a[180:183], v[128:131], 0
    ds_read_b64_tr_b16 a[196:197], v117 offset:20480
    ds_read_b64_tr_b16 a[198:199], v117 offset:21504
    s_add_u32 m0, s42, 147456
    s_mov_b32 s43, 384
    buffer_load_dwordx4 v13, s[28:31], s43 offen offset:0 nt lds
    v_mul_f32 v32, v122, v32
    s_waitcnt lgkmcnt(6)
    v_mfma_f32_32x32x16_bf16 v[64:79], a[184:187], v[132:135], v[64:79]
    ds_read_b64_tr_b16 a[200:201], v116 offset:22528
    ds_read_b64_tr_b16 a[202:203], v116 offset:23552
    v_mul_f32 v33, v122, v33
    v_mul_f32 v34, v122, v34
    v_mul_f32 v35, v122, v35
    v_mul_f32 v36, v122, v36
    s_waitcnt lgkmcnt(6)
    v_mfma_f32_32x32x16_bf16 v[80:95], a[188:191], v[132:135], v[80:95]
    ds_read_b64_tr_b16 a[204:205], v117 offset:22528
    ds_read_b64_tr_b16 a[206:207], v117 offset:23552
    v_mul_f32 v37, v122, v37
    v_mul_f32 v38, v122, v38
    v_mul_f32 v39, v122, v39
    v_cvt_pk_bf16_f32 v32, v32, v33
    s_waitcnt lgkmcnt(6)
    v_mfma_f32_32x32x16_bf16 v[64:79], a[192:195], v[136:139], v[64:79]
    ds_read_b64_tr_b16 a[176:177], v116 offset:24576
    ds_read_b64_tr_b16 a[178:179], v116 offset:25600
    v_cvt_pk_bf16_f32 v34, v34, v35
    v_cvt_pk_bf16_f32 v36, v36, v37
    v_cvt_pk_bf16_f32 v38, v38, v39
    v_accvgpr_write_b32 a64, v32
    s_waitcnt lgkmcnt(6)
    v_mfma_f32_32x32x16_bf16 v[80:95], a[196:199], v[136:139], v[80:95]
    ds_read_b64_tr_b16 a[180:181], v117 offset:24576
    ds_read_b64_tr_b16 a[182:183], v117 offset:25600
    buffer_load_dwordx4 v13, s[28:31], s43 offen offset:1024 nt lds
    v_accvgpr_write_b32 a65, v34
    v_accvgpr_write_b32 a66, v36
    v_accvgpr_write_b32 a67, v38
    s_waitcnt lgkmcnt(6)
    v_mfma_f32_32x32x16_bf16 v[64:79], a[200:203], v[140:143], v[64:79]
    ds_read_b64_tr_b16 a[184:185], v116 offset:26624
    ds_read_b64_tr_b16 a[186:187], v116 offset:27648
    v_mul_f32 v40, v122, v40
    v_mul_f32 v41, v122, v41
    v_mul_f32 v42, v122, v42
    v_mul_f32 v43, v122, v43
    s_waitcnt lgkmcnt(6)
    v_mfma_f32_32x32x16_bf16 v[80:95], a[204:207], v[140:143], v[80:95]
    ds_read_b64_tr_b16 a[188:189], v117 offset:26624
    ds_read_b64_tr_b16 a[190:191], v117 offset:27648
    v_mul_f32 v44, v122, v44
    v_mul_f32 v45, v122, v45
    v_mul_f32 v46, v122, v46
    v_mul_f32 v47, v122, v47
    s_waitcnt lgkmcnt(6)
    v_mfma_f32_32x32x16_bf16 v[64:79], a[176:179], v[144:147], v[64:79]
    ds_read_b64_tr_b16 a[192:193], v116 offset:28672
    ds_read_b64_tr_b16 a[194:195], v116 offset:29696
    v_cvt_pk_bf16_f32 v40, v40, v41
    v_cvt_pk_bf16_f32 v42, v42, v43
    v_cvt_pk_bf16_f32 v44, v44, v45
    v_cvt_pk_bf16_f32 v46, v46, v47
    s_waitcnt lgkmcnt(6)
    v_mfma_f32_32x32x16_bf16 v[80:95], a[180:183], v[144:147], v[80:95]
    ds_read_b64_tr_b16 a[196:197], v117 offset:28672
    ds_read_b64_tr_b16 a[198:199], v117 offset:29696
    buffer_load_dwordx4 v13, s[28:31], s43 offen offset:2048 nt lds
    v_accvgpr_write_b32 a68, v40
    v_accvgpr_write_b32 a69, v42
    v_accvgpr_write_b32 a70, v44
    s_waitcnt lgkmcnt(6)
    v_mfma_f32_32x32x16_bf16 v[64:79], a[184:187], v[148:151], v[64:79]
    ds_read_b64_tr_b16 a[200:201], v116 offset:30720
    ds_read_b64_tr_b16 a[202:203], v116 offset:31744
    v_accvgpr_write_b32 a71, v46
    v_mul_f32 v48, v122, v48
    v_mul_f32 v49, v122, v49
    v_mul_f32 v50, v122, v50
    s_waitcnt lgkmcnt(6)
    v_mfma_f32_32x32x16_bf16 v[80:95], a[188:191], v[148:151], v[80:95]
    ds_read_b64_tr_b16 a[204:205], v117 offset:30720
    ds_read_b64_tr_b16 a[206:207], v117 offset:31744
    v_mul_f32 v51, v122, v51
    v_mul_f32 v52, v122, v52
    v_mul_f32 v53, v122, v53
    v_mul_f32 v54, v122, v54
    s_waitcnt lgkmcnt(6)
    v_mfma_f32_32x32x16_bf16 v[64:79], a[192:195], v[152:155], v[64:79]
    s_waitcnt vmcnt(27)
    s_barrier
    ds_read_b64_tr_b16 a[176:177], v116 offset:32768
    ds_read_b64_tr_b16 a[178:179], v116 offset:33792
    s_waitcnt lgkmcnt(6)
    v_mfma_f32_32x32x16_bf16 v[80:95], a[196:199], v[152:155], v[80:95]
    ds_read_b64_tr_b16 a[180:181], v117 offset:32768
    ds_read_b64_tr_b16 a[182:183], v117 offset:33792
    buffer_load_dwordx4 v13, s[28:31], s43 offen offset:3072 nt lds
    v_mul_f32 v55, v122, v55
    v_cvt_pk_bf16_f32 v48, v48, v49
    v_cvt_pk_bf16_f32 v50, v50, v51
    s_waitcnt lgkmcnt(6)
    v_mfma_f32_32x32x16_bf16 v[64:79], a[200:203], v[156:159], v[64:79]
    ds_read_b64_tr_b16 a[184:185], v116 offset:34816
    ds_read_b64_tr_b16 a[186:187], v116 offset:35840
    v_cvt_pk_bf16_f32 v52, v52, v53
    v_cvt_pk_bf16_f32 v54, v54, v55
    v_accvgpr_write_b32 a72, v48
    v_accvgpr_write_b32 a73, v50
    s_waitcnt lgkmcnt(6)
    v_mfma_f32_32x32x16_bf16 v[80:95], a[204:207], v[156:159], v[80:95]
    ds_read_b64_tr_b16 a[188:189], v117 offset:34816
    ds_read_b64_tr_b16 a[190:191], v117 offset:35840
    v_accvgpr_write_b32 a74, v52
    v_accvgpr_write_b32 a75, v54
    v_mul_f32 v56, v122, v56
    v_mul_f32 v57, v122, v57
    s_waitcnt lgkmcnt(6)
    v_mfma_f32_32x32x16_bf16 v[64:79], a[176:179], v[160:163], v[64:79]
    ds_read_b64_tr_b16 a[192:193], v116 offset:36864
    ds_read_b64_tr_b16 a[194:195], v116 offset:37888
    v_mul_f32 v58, v122, v58
    v_mul_f32 v59, v122, v59
    v_mul_f32 v60, v122, v60
    v_mul_f32 v61, v122, v61
    s_waitcnt lgkmcnt(6)
    v_mfma_f32_32x32x16_bf16 v[80:95], a[180:183], v[160:163], v[80:95]
    ds_read_b64_tr_b16 a[196:197], v117 offset:36864
    ds_read_b64_tr_b16 a[198:199], v117 offset:37888
    s_add_u32 m0, s42, 0
    s_mov_b32 s43, 65920
    buffer_load_dwordx4 v13, s[28:31], s43 offen offset:0 nt lds
    v_mul_f32 v62, v122, v62
    s_waitcnt lgkmcnt(6)
    v_mfma_f32_32x32x16_bf16 v[64:79], a[184:187], v[164:167], v[64:79]
    ds_read_b64_tr_b16 a[200:201], v116 offset:38912
    ds_read_b64_tr_b16 a[202:203], v116 offset:39936
    v_mul_f32 v63, v122, v63
    v_cvt_pk_bf16_f32 v56, v56, v57
    v_cvt_pk_bf16_f32 v58, v58, v59
    v_cvt_pk_bf16_f32 v60, v60, v61
    s_waitcnt lgkmcnt(6)
    v_mfma_f32_32x32x16_bf16 v[80:95], a[188:191], v[164:167], v[80:95]
    ds_read_b64_tr_b16 a[204:205], v117 offset:38912
    ds_read_b64_tr_b16 a[206:207], v117 offset:39936
    v_cvt_pk_bf16_f32 v62, v62, v63
    v_accvgpr_write_b32 a76, v56
    v_accvgpr_write_b32 a77, v58
    v_accvgpr_write_b32 a78, v60
    s_waitcnt lgkmcnt(6)
    v_mfma_f32_32x32x16_bf16 v[64:79], a[192:195], v[168:171], v[64:79]
    ds_read_b64_tr_b16 a[176:177], v116 offset:40960
    ds_read_b64_tr_b16 a[178:179], v116 offset:41984
    v_accvgpr_write_b32 a79, v62
    s_waitcnt lgkmcnt(6)
    v_mfma_f32_32x32x16_bf16 v[80:95], a[196:199], v[168:171], v[80:95]
    ds_read_b64_tr_b16 a[180:181], v117 offset:40960
    ds_read_b64_tr_b16 a[182:183], v117 offset:41984
    buffer_load_dwordx4 v13, s[28:31], s43 offen offset:1024 nt lds
    s_waitcnt lgkmcnt(6)
    v_mfma_f32_32x32x16_bf16 v[64:79], a[200:203], v[172:175], v[64:79]
    ds_read_b64_tr_b16 a[184:185], v116 offset:43008
    ds_read_b64_tr_b16 a[186:187], v116 offset:44032
    s_waitcnt lgkmcnt(6)
    v_mfma_f32_32x32x16_bf16 v[80:95], a[204:207], v[172:175], v[80:95]
    ds_read_b64_tr_b16 a[188:189], v117 offset:43008
    ds_read_b64_tr_b16 a[190:191], v117 offset:44032
    s_waitcnt lgkmcnt(6)
    v_mfma_f32_32x32x16_bf16 v[64:79], a[176:179], v[176:179], v[64:79]
    ds_read_b64_tr_b16 a[192:193], v116 offset:45056
    ds_read_b64_tr_b16 a[194:195], v116 offset:46080
    s_waitcnt lgkmcnt(6)
    v_mfma_f32_32x32x16_bf16 v[80:95], a[180:183], v[176:179], v[80:95]
    ds_read_b64_tr_b16 a[196:197], v117 offset:45056
    ds_read_b64_tr_b16 a[198:199], v117 offset:46080
    buffer_load_dwordx4 v13, s[28:31], s43 offen offset:2048 nt lds
    s_waitcnt lgkmcnt(6)
    v_mfma_f32_32x32x16_bf16 v[64:79], a[184:187], v[180:183], v[64:79]
    ds_read_b64_tr_b16 a[200:201], v116 offset:47104
    ds_read_b64_tr_b16 a[202:203], v116 offset:48128
    s_waitcnt lgkmcnt(6)
    v_mfma_f32_32x32x16_bf16 v[80:95], a[188:191], v[180:183], v[80:95]
    ds_read_b64_tr_b16 a[204:205], v117 offset:47104
    ds_read_b64_tr_b16 a[206:207], v117 offset:48128
    s_waitcnt lgkmcnt(6)
    v_mfma_f32_32x32x16_bf16 v[64:79], a[192:195], v[184:187], v[64:79]
    s_waitcnt vmcnt(27)
    s_barrier
    ds_read_b64_tr_b16 a[176:177], v116 offset:49152
    ds_read_b64_tr_b16 a[178:179], v116 offset:50176
    s_waitcnt lgkmcnt(6)
    v_mfma_f32_32x32x16_bf16 v[80:95], a[196:199], v[184:187], v[80:95]
    ds_read_b64_tr_b16 a[180:181], v117 offset:49152
    ds_read_b64_tr_b16 a[182:183], v117 offset:50176
    buffer_load_dwordx4 v13, s[28:31], s43 offen offset:3072 nt lds
    s_waitcnt lgkmcnt(6)
    v_mfma_f32_32x32x16_bf16 v[64:79], a[200:203], v[188:191], v[64:79]
    ds_read_b64_tr_b16 a[184:185], v116 offset:51200
    ds_read_b64_tr_b16 a[186:187], v116 offset:52224
    s_waitcnt lgkmcnt(6)
    v_mfma_f32_32x32x16_bf16 v[80:95], a[204:207], v[188:191], v[80:95]
    ds_read_b64_tr_b16 a[188:189], v117 offset:51200
    ds_read_b64_tr_b16 a[190:191], v117 offset:52224
    s_waitcnt lgkmcnt(6)
    v_mfma_f32_32x32x16_bf16 v[64:79], a[176:179], v[192:195], v[64:79]
    ds_read_b64_tr_b16 a[192:193], v116 offset:53248
    ds_read_b64_tr_b16 a[194:195], v116 offset:54272
    s_waitcnt lgkmcnt(6)
    v_mfma_f32_32x32x16_bf16 v[80:95], a[180:183], v[192:195], v[80:95]
    ds_read_b64_tr_b16 a[196:197], v117 offset:53248
    ds_read_b64_tr_b16 a[198:199], v117 offset:54272
    s_add_u32 m0, s42, 16384
    s_mov_b32 s43, 131456
    buffer_load_dwordx4 v13, s[28:31], s43 offen offset:0 nt lds
    s_waitcnt lgkmcnt(6)
    v_mfma_f32_32x32x16_bf16 v[64:79], a[184:187], v[196:199], v[64:79]
    ds_read_b64_tr_b16 a[200:201], v116 offset:55296
    ds_read_b64_tr_b16 a[202:203], v116 offset:56320
    s_waitcnt lgkmcnt(6)
    v_mfma_f32_32x32x16_bf16 v[80:95], a[188:191], v[196:199], v[80:95]
    ds_read_b64_tr_b16 a[204:205], v117 offset:55296
    ds_read_b64_tr_b16 a[206:207], v117 offset:56320
    s_waitcnt lgkmcnt(6)
    v_mfma_f32_32x32x16_bf16 v[64:79], a[192:195], v[200:203], v[64:79]
    ds_read_b64_tr_b16 a[176:177], v116 offset:57344
    ds_read_b64_tr_b16 a[178:179], v116 offset:58368
    s_waitcnt lgkmcnt(6)
    v_mfma_f32_32x32x16_bf16 v[80:95], a[196:199], v[200:203], v[80:95]
    ds_read_b64_tr_b16 a[180:181], v117 offset:57344
    ds_read_b64_tr_b16 a[182:183], v117 offset:58368
    buffer_load_dwordx4 v13, s[28:31], s43 offen offset:1024 nt lds
    s_waitcnt lgkmcnt(6)
    v_mfma_f32_32x32x16_bf16 v[64:79], a[200:203], v[204:207], v[64:79]
    ds_read_b64_tr_b16 a[184:185], v116 offset:59392
    ds_read_b64_tr_b16 a[186:187], v116 offset:60416
    s_waitcnt lgkmcnt(6)
    v_mfma_f32_32x32x16_bf16 v[80:95], a[204:207], v[204:207], v[80:95]
    ds_read_b64_tr_b16 a[188:189], v117 offset:59392
    ds_read_b64_tr_b16 a[190:191], v117 offset:60416
    s_waitcnt lgkmcnt(6)
    v_mfma_f32_32x32x16_bf16 v[64:79], a[176:179], v[208:211], v[64:79]
    ds_read_b64_tr_b16 a[192:193], v116 offset:61440
    ds_read_b64_tr_b16 a[194:195], v116 offset:62464
    s_waitcnt lgkmcnt(6)
    v_mfma_f32_32x32x16_bf16 v[80:95], a[180:183], v[208:211], v[80:95]
    ds_read_b64_tr_b16 a[196:197], v117 offset:61440
    ds_read_b64_tr_b16 a[198:199], v117 offset:62464
    buffer_load_dwordx4 v13, s[28:31], s43 offen offset:2048 nt lds
    s_waitcnt lgkmcnt(6)
    v_mfma_f32_32x32x16_bf16 v[64:79], a[184:187], v[212:215], v[64:79]
    ds_read_b64_tr_b16 a[200:201], v116 offset:63488
    ds_read_b64_tr_b16 a[202:203], v116 offset:64512
    s_waitcnt lgkmcnt(6)
    v_mfma_f32_32x32x16_bf16 v[80:95], a[188:191], v[212:215], v[80:95]
    ds_read_b64_tr_b16 a[204:205], v117 offset:63488
    ds_read_b64_tr_b16 a[206:207], v117 offset:64512
    s_waitcnt lgkmcnt(6)
    v_mfma_f32_32x32x16_bf16 v[64:79], a[192:195], v[216:219], v[64:79]
    s_waitcnt vmcnt(27)
    s_barrier
    v_add_u32 v116, 0x10000, v116
    ds_read_b64_tr_b16 a[176:177], v116 offset:0
    ds_read_b64_tr_b16 a[178:179], v116 offset:1024
    s_waitcnt lgkmcnt(6)
    v_mfma_f32_32x32x16_bf16 v[80:95], a[196:199], v[216:219], v[80:95]
    v_add_u32 v117, 0x10000, v117
    ds_read_b64_tr_b16 a[180:181], v117 offset:0
    ds_read_b64_tr_b16 a[182:183], v117 offset:1024
    buffer_load_dwordx4 v13, s[28:31], s43 offen offset:3072 nt lds
    s_waitcnt lgkmcnt(6)
    v_mfma_f32_32x32x16_bf16 v[64:79], a[200:203], v[220:223], v[64:79]
    ds_read_b64_tr_b16 a[184:185], v116 offset:2048
    ds_read_b64_tr_b16 a[186:187], v116 offset:3072
    s_waitcnt lgkmcnt(6)
    v_mfma_f32_32x32x16_bf16 v[80:95], a[204:207], v[220:223], v[80:95]
    ds_read_b64_tr_b16 a[188:189], v117 offset:2048
    ds_read_b64_tr_b16 a[190:191], v117 offset:3072
    s_waitcnt lgkmcnt(6)
    v_mfma_f32_32x32x16_bf16 v[64:79], a[176:179], v[224:227], v[64:79]
    ds_read_b64_tr_b16 a[192:193], v116 offset:4096
    ds_read_b64_tr_b16 a[194:195], v116 offset:5120
    s_waitcnt lgkmcnt(6)
    v_mfma_f32_32x32x16_bf16 v[80:95], a[180:183], v[224:227], v[80:95]
    ds_read_b64_tr_b16 a[196:197], v117 offset:4096
    ds_read_b64_tr_b16 a[198:199], v117 offset:5120
    s_add_u32 m0, s42, 32768
    s_mov_b32 s43, 196992
    buffer_load_dwordx4 v13, s[28:31], s43 offen offset:0 nt lds
    s_waitcnt lgkmcnt(6)
    v_mfma_f32_32x32x16_bf16 v[64:79], a[184:187], v[228:231], v[64:79]
    ds_read_b64_tr_b16 a[200:201], v116 offset:6144
    ds_read_b64_tr_b16 a[202:203], v116 offset:7168
    s_waitcnt lgkmcnt(6)
    v_mfma_f32_32x32x16_bf16 v[80:95], a[188:191], v[228:231], v[80:95]
    ds_read_b64_tr_b16 a[204:205], v117 offset:6144
    ds_read_b64_tr_b16 a[206:207], v117 offset:7168
    s_waitcnt lgkmcnt(6)
    v_mfma_f32_32x32x16_bf16 v[64:79], a[192:195], v[232:235], v[64:79]
    ds_read_b64_tr_b16 a[176:177], v116 offset:8192
    ds_read_b64_tr_b16 a[178:179], v116 offset:9216
    s_waitcnt lgkmcnt(6)
    v_mfma_f32_32x32x16_bf16 v[80:95], a[196:199], v[232:235], v[80:95]
    ds_read_b64_tr_b16 a[180:181], v117 offset:8192
    ds_read_b64_tr_b16 a[182:183], v117 offset:9216
    buffer_load_dwordx4 v13, s[28:31], s43 offen offset:1024 nt lds
    s_waitcnt lgkmcnt(6)
    v_mfma_f32_32x32x16_bf16 v[64:79], a[200:203], v[236:239], v[64:79]
    ds_read_b64_tr_b16 a[184:185], v116 offset:10240
    ds_read_b64_tr_b16 a[186:187], v116 offset:11264
    s_waitcnt lgkmcnt(6)
    v_mfma_f32_32x32x16_bf16 v[80:95], a[204:207], v[236:239], v[80:95]
    ds_read_b64_tr_b16 a[188:189], v117 offset:10240
    ds_read_b64_tr_b16 a[190:191], v117 offset:11264
    s_waitcnt lgkmcnt(6)
    v_mfma_f32_32x32x16_bf16 v[64:79], a[176:179], v[240:243], v[64:79]
    ds_read_b64_tr_b16 a[192:193], v116 offset:12288
    ds_read_b64_tr_b16 a[194:195], v116 offset:13312
    s_waitcnt lgkmcnt(6)
    v_mfma_f32_32x32x16_bf16 v[80:95], a[180:183], v[240:243], v[80:95]
    ds_read_b64_tr_b16 a[196:197], v117 offset:12288
    ds_read_b64_tr_b16 a[198:199], v117 offset:13312
    buffer_load_dwordx4 v13, s[28:31], s43 offen offset:2048 nt lds
    s_waitcnt lgkmcnt(6)
    v_mfma_f32_32x32x16_bf16 v[64:79], a[184:187], v[244:247], v[64:79]
    ds_read_b64_tr_b16 a[200:201], v116 offset:14336
    ds_read_b64_tr_b16 a[202:203], v116 offset:15360
    s_waitcnt lgkmcnt(6)
    v_mfma_f32_32x32x16_bf16 v[80:95], a[188:191], v[244:247], v[80:95]
    ds_read_b64_tr_b16 a[204:205], v117 offset:14336
    ds_read_b64_tr_b16 a[206:207], v117 offset:15360
    s_waitcnt lgkmcnt(6)
    v_mfma_f32_32x32x16_bf16 v[64:79], a[192:195], v[248:251], v[64:79]
    s_waitcnt vmcnt(27)
    s_barrier
    ds_read_b64_tr_b16 a[176:177], v116 offset:16384
    ds_read_b64_tr_b16 a[178:179], v116 offset:17408
    s_waitcnt lgkmcnt(6)
    v_mfma_f32_32x32x16_bf16 v[80:95], a[196:199], v[248:251], v[80:95]
    ds_read_b64_tr_b16 a[180:181], v117 offset:16384
    ds_read_b64_tr_b16 a[182:183], v117 offset:17408
    buffer_load_dwordx4 v13, s[28:31], s43 offen offset:3072 nt lds
    s_waitcnt lgkmcnt(6)
    v_mfma_f32_32x32x16_bf16 v[64:79], a[200:203], v[252:255], v[64:79]
    ds_read_b64_tr_b16 a[184:185], v116 offset:18432
    ds_read_b64_tr_b16 a[186:187], v116 offset:19456
    s_waitcnt lgkmcnt(6)
    v_mfma_f32_32x32x16_bf16 v[80:95], a[204:207], v[252:255], v[80:95]
    ds_read_b64_tr_b16 a[188:189], v117 offset:18432
    ds_read_b64_tr_b16 a[190:191], v117 offset:19456
    s_waitcnt lgkmcnt(6)
    v_mfma_f32_32x32x16_bf16 v[32:47], a[176:179], v[128:131], 0
    ds_read_b64_tr_b16 a[192:193], v116 offset:20480
    ds_read_b64_tr_b16 a[194:195], v116 offset:21504
    s_waitcnt lgkmcnt(6)
    v_mfma_f32_32x32x16_bf16 v[48:63], a[180:183], v[128:131], 0
    ds_read_b64_tr_b16 a[196:197], v117 offset:20480
    ds_read_b64_tr_b16 a[198:199], v117 offset:21504
    s_add_u32 m0, s42, 49152
    s_mov_b32 s43, 0
    buffer_load_dwordx4 v14, s[32:35], s43 offen offset:0 lds
    v_mul_f32 v64, v122, v64
    s_waitcnt lgkmcnt(6)
    v_mfma_f32_32x32x16_bf16 v[32:47], a[184:187], v[132:135], v[32:47]
    ds_read_b64_tr_b16 a[200:201], v116 offset:22528
    ds_read_b64_tr_b16 a[202:203], v116 offset:23552
    v_mul_f32 v65, v122, v65
    v_mul_f32 v66, v122, v66
    v_mul_f32 v67, v122, v67
    v_mul_f32 v68, v122, v68
    s_waitcnt lgkmcnt(6)
    v_mfma_f32_32x32x16_bf16 v[48:63], a[188:191], v[132:135], v[48:63]
    ds_read_b64_tr_b16 a[204:205], v117 offset:22528
    ds_read_b64_tr_b16 a[206:207], v117 offset:23552
    v_mul_f32 v69, v122, v69
    v_mul_f32 v70, v122, v70
    v_mul_f32 v71, v122, v71
    v_cvt_pk_bf16_f32 v64, v64, v65
    s_waitcnt lgkmcnt(6)
    v_mfma_f32_32x32x16_bf16 v[32:47], a[192:195], v[136:139], v[32:47]
    ds_read_b64_tr_b16 a[176:177], v116 offset:24576
    ds_read_b64_tr_b16 a[178:179], v116 offset:25600
    v_cvt_pk_bf16_f32 v66, v66, v67
    v_cvt_pk_bf16_f32 v68, v68, v69
    v_cvt_pk_bf16_f32 v70, v70, v71
    v_accvgpr_write_b32 a80, v64
    s_waitcnt lgkmcnt(6)
    v_mfma_f32_32x32x16_bf16 v[48:63], a[196:199], v[136:139], v[48:63]
    ds_read_b64_tr_b16 a[180:181], v117 offset:24576
    ds_read_b64_tr_b16 a[182:183], v117 offset:25600
    s_mov_b32 s43, 6144
    buffer_load_dwordx4 v14, s[32:35], s43 offen offset:1024 lds
    v_accvgpr_write_b32 a81, v66
    v_accvgpr_write_b32 a82, v68
    s_waitcnt lgkmcnt(6)
    v_mfma_f32_32x32x16_bf16 v[32:47], a[200:203], v[140:143], v[32:47]
    ds_read_b64_tr_b16 a[184:185], v116 offset:26624
    ds_read_b64_tr_b16 a[186:187], v116 offset:27648
    v_accvgpr_write_b32 a83, v70
    v_mul_f32 v72, v122, v72
    v_mul_f32 v73, v122, v73
    v_mul_f32 v74, v122, v74
    s_waitcnt lgkmcnt(6)
    v_mfma_f32_32x32x16_bf16 v[48:63], a[204:207], v[140:143], v[48:63]
    ds_read_b64_tr_b16 a[188:189], v117 offset:26624
    ds_read_b64_tr_b16 a[190:191], v117 offset:27648
    v_mul_f32 v75, v122, v75
    v_mul_f32 v76, v122, v76
    v_mul_f32 v77, v122, v77
    v_mul_f32 v78, v122, v78
    s_waitcnt lgkmcnt(6)
    v_mfma_f32_32x32x16_bf16 v[32:47], a[176:179], v[144:147], v[32:47]
    ds_read_b64_tr_b16 a[192:193], v116 offset:28672
    ds_read_b64_tr_b16 a[194:195], v116 offset:29696
    v_mul_f32 v79, v122, v79
    v_cvt_pk_bf16_f32 v72, v72, v73
    v_cvt_pk_bf16_f32 v74, v74, v75
    v_cvt_pk_bf16_f32 v76, v76, v77
    s_waitcnt lgkmcnt(6)
    v_mfma_f32_32x32x16_bf16 v[48:63], a[180:183], v[144:147], v[48:63]
    ds_read_b64_tr_b16 a[196:197], v117 offset:28672
    ds_read_b64_tr_b16 a[198:199], v117 offset:29696
    s_mov_b32 s43, 12288
    buffer_load_dwordx4 v14, s[32:35], s43 offen offset:2048 lds
    v_cvt_pk_bf16_f32 v78, v78, v79
    v_accvgpr_write_b32 a84, v72
    s_waitcnt lgkmcnt(6)
    v_mfma_f32_32x32x16_bf16 v[32:47], a[184:187], v[148:151], v[32:47]
    ds_read_b64_tr_b16 a[200:201], v116 offset:30720
    ds_read_b64_tr_b16 a[202:203], v116 offset:31744
    v_accvgpr_write_b32 a85, v74
    v_accvgpr_write_b32 a86, v76
    v_accvgpr_write_b32 a87, v78
    v_mul_f32 v80, v122, v80
    s_waitcnt lgkmcnt(6)
    v_mfma_f32_32x32x16_bf16 v[48:63], a[188:191], v[148:151], v[48:63]
    ds_read_b64_tr_b16 a[204:205], v117 offset:30720
    ds_read_b64_tr_b16 a[206:207], v117 offset:31744
    v_mul_f32 v81, v122, v81
    v_mul_f32 v82, v122, v82
    v_mul_f32 v83, v122, v83
    v_mul_f32 v84, v122, v84
    s_waitcnt lgkmcnt(6)
    v_mfma_f32_32x32x16_bf16 v[32:47], a[192:195], v[152:155], v[32:47]
    s_waitcnt vmcnt(27)
    s_barrier
    ds_read_b64_tr_b16 a[176:177], v116 offset:32768
    ds_read_b64_tr_b16 a[178:179], v116 offset:33792
    s_waitcnt lgkmcnt(6)
    v_mfma_f32_32x32x16_bf16 v[48:63], a[196:199], v[152:155], v[48:63]
    ds_read_b64_tr_b16 a[180:181], v117 offset:32768
    ds_read_b64_tr_b16 a[182:183], v117 offset:33792
    s_mov_b32 s43, 18432
    buffer_load_dwordx4 v14, s[32:35], s43 offen offset:3072 lds
    v_mul_f32 v85, v122, v85
    v_mul_f32 v86, v122, v86
    s_waitcnt lgkmcnt(6)
    v_mfma_f32_32x32x16_bf16 v[32:47], a[200:203], v[156:159], v[32:47]
    ds_read_b64_tr_b16 a[184:185], v116 offset:34816
    ds_read_b64_tr_b16 a[186:187], v116 offset:35840
    v_mul_f32 v87, v122, v87
    v_cvt_pk_bf16_f32 v80, v80, v81
    v_cvt_pk_bf16_f32 v82, v82, v83
    v_cvt_pk_bf16_f32 v84, v84, v85
    s_waitcnt lgkmcnt(6)
    v_mfma_f32_32x32x16_bf16 v[48:63], a[204:207], v[156:159], v[48:63]
    ds_read_b64_tr_b16 a[188:189], v117 offset:34816
    ds_read_b64_tr_b16 a[190:191], v117 offset:35840
    v_cvt_pk_bf16_f32 v86, v86, v87
    v_accvgpr_write_b32 a88, v80
    v_accvgpr_write_b32 a89, v82
    v_accvgpr_write_b32 a90, v84
    s_waitcnt lgkmcnt(6)
    v_mfma_f32_32x32x16_bf16 v[32:47], a[176:179], v[160:163], v[32:47]
    ds_read_b64_tr_b16 a[192:193], v116 offset:36864
    ds_read_b64_tr_b16 a[194:195], v116 offset:37888
    v_accvgpr_write_b32 a91, v86
    v_mul_f32 v88, v122, v88
    v_mul_f32 v89, v122, v89
    v_mul_f32 v90, v122, v90
    s_waitcnt lgkmcnt(6)
    v_mfma_f32_32x32x16_bf16 v[48:63], a[180:183], v[160:163], v[48:63]
    ds_read_b64_tr_b16 a[196:197], v117 offset:36864
    ds_read_b64_tr_b16 a[198:199], v117 offset:37888
    s_add_u32 m0, s42, 65536
    s_mov_b32 s43, 114688
    buffer_load_dwordx4 v14, s[32:35], s43 offen offset:0 lds
    v_mul_f32 v91, v122, v91
    s_waitcnt lgkmcnt(6)
    v_mfma_f32_32x32x16_bf16 v[32:47], a[184:187], v[164:167], v[32:47]
    ds_read_b64_tr_b16 a[200:201], v116 offset:38912
    ds_read_b64_tr_b16 a[202:203], v116 offset:39936
    v_mul_f32 v92, v122, v92
    v_mul_f32 v93, v122, v93
    v_mul_f32 v94, v122, v94
    v_mul_f32 v95, v122, v95
    s_waitcnt lgkmcnt(6)
    v_mfma_f32_32x32x16_bf16 v[48:63], a[188:191], v[164:167], v[48:63]
    ds_read_b64_tr_b16 a[204:205], v117 offset:38912
    ds_read_b64_tr_b16 a[206:207], v117 offset:39936
    v_cvt_pk_bf16_f32 v88, v88, v89
    v_cvt_pk_bf16_f32 v90, v90, v91
    v_cvt_pk_bf16_f32 v92, v92, v93
    v_cvt_pk_bf16_f32 v94, v94, v95
    s_waitcnt lgkmcnt(6)
    v_mfma_f32_32x32x16_bf16 v[32:47], a[192:195], v[168:171], v[32:47]
    ds_read_b64_tr_b16 a[176:177], v116 offset:40960
    ds_read_b64_tr_b16 a[178:179], v116 offset:41984
    v_accvgpr_write_b32 a92, v88
    v_accvgpr_write_b32 a93, v90
    v_accvgpr_write_b32 a94, v92
    v_accvgpr_write_b32 a95, v94
    s_waitcnt lgkmcnt(6)
    v_mfma_f32_32x32x16_bf16 v[48:63], a[196:199], v[168:171], v[48:63]
    ds_read_b64_tr_b16 a[180:181], v117 offset:40960
    ds_read_b64_tr_b16 a[182:183], v117 offset:41984
    s_mov_b32 s43, 120832
    buffer_load_dwordx4 v14, s[32:35], s43 offen offset:1024 lds
    s_waitcnt lgkmcnt(6)
    v_mfma_f32_32x32x16_bf16 v[32:47], a[200:203], v[172:175], v[32:47]
    ds_read_b64_tr_b16 a[184:185], v116 offset:43008
    ds_read_b64_tr_b16 a[186:187], v116 offset:44032
    s_waitcnt lgkmcnt(6)
    v_mfma_f32_32x32x16_bf16 v[48:63], a[204:207], v[172:175], v[48:63]
    ds_read_b64_tr_b16 a[188:189], v117 offset:43008
    ds_read_b64_tr_b16 a[190:191], v117 offset:44032
    s_waitcnt lgkmcnt(6)
    v_mfma_f32_32x32x16_bf16 v[32:47], a[176:179], v[176:179], v[32:47]
    ds_read_b64_tr_b16 a[192:193], v116 offset:45056
    ds_read_b64_tr_b16 a[194:195], v116 offset:46080
    s_waitcnt lgkmcnt(6)
    v_mfma_f32_32x32x16_bf16 v[48:63], a[180:183], v[176:179], v[48:63]
    ds_read_b64_tr_b16 a[196:197], v117 offset:45056
    ds_read_b64_tr_b16 a[198:199], v117 offset:46080
    s_mov_b32 s43, 126976
    buffer_load_dwordx4 v14, s[32:35], s43 offen offset:2048 lds
    s_waitcnt lgkmcnt(6)
    v_mfma_f32_32x32x16_bf16 v[32:47], a[184:187], v[180:183], v[32:47]
    ds_read_b64_tr_b16 a[200:201], v116 offset:47104
    ds_read_b64_tr_b16 a[202:203], v116 offset:48128
    s_waitcnt lgkmcnt(6)
    v_mfma_f32_32x32x16_bf16 v[48:63], a[188:191], v[180:183], v[48:63]
    ds_read_b64_tr_b16 a[204:205], v117 offset:47104
    ds_read_b64_tr_b16 a[206:207], v117 offset:48128
    s_waitcnt lgkmcnt(6)
    v_mfma_f32_32x32x16_bf16 v[32:47], a[192:195], v[184:187], v[32:47]
    s_waitcnt vmcnt(27)
    s_barrier
    ds_read_b64_tr_b16 a[176:177], v116 offset:49152
    ds_read_b64_tr_b16 a[178:179], v116 offset:50176
    s_waitcnt lgkmcnt(6)
    v_mfma_f32_32x32x16_bf16 v[48:63], a[196:199], v[184:187], v[48:63]
    ds_read_b64_tr_b16 a[180:181], v117 offset:49152
    ds_read_b64_tr_b16 a[182:183], v117 offset:50176
    s_mov_b32 s43, 133120
    buffer_load_dwordx4 v14, s[32:35], s43 offen offset:3072 lds
    s_waitcnt lgkmcnt(6)
    v_mfma_f32_32x32x16_bf16 v[32:47], a[200:203], v[188:191], v[32:47]
    ds_read_b64_tr_b16 a[184:185], v116 offset:51200
    ds_read_b64_tr_b16 a[186:187], v116 offset:52224
    s_waitcnt lgkmcnt(6)
    v_mfma_f32_32x32x16_bf16 v[48:63], a[204:207], v[188:191], v[48:63]
    ds_read_b64_tr_b16 a[188:189], v117 offset:51200
    ds_read_b64_tr_b16 a[190:191], v117 offset:52224
    s_waitcnt lgkmcnt(6)
    v_mfma_f32_32x32x16_bf16 v[32:47], a[176:179], v[192:195], v[32:47]
    ds_read_b64_tr_b16 a[192:193], v116 offset:53248
    ds_read_b64_tr_b16 a[194:195], v116 offset:54272
    s_waitcnt lgkmcnt(6)
    v_mfma_f32_32x32x16_bf16 v[48:63], a[180:183], v[192:195], v[48:63]
    ds_read_b64_tr_b16 a[196:197], v117 offset:53248
    ds_read_b64_tr_b16 a[198:199], v117 offset:54272
    s_add_u32 m0, s42, 81920
    s_mov_b32 s43, 128
    buffer_load_dwordx4 v14, s[32:35], s43 offen offset:0 lds
    s_waitcnt lgkmcnt(6)
    v_mfma_f32_32x32x16_bf16 v[32:47], a[184:187], v[196:199], v[32:47]
    ds_read_b64_tr_b16 a[200:201], v116 offset:55296
    ds_read_b64_tr_b16 a[202:203], v116 offset:56320
    s_waitcnt lgkmcnt(6)
    v_mfma_f32_32x32x16_bf16 v[48:63], a[188:191], v[196:199], v[48:63]
    ds_read_b64_tr_b16 a[204:205], v117 offset:55296
    ds_read_b64_tr_b16 a[206:207], v117 offset:56320
    s_waitcnt lgkmcnt(6)
    v_mfma_f32_32x32x16_bf16 v[32:47], a[192:195], v[200:203], v[32:47]
    ds_read_b64_tr_b16 a[176:177], v116 offset:57344
    ds_read_b64_tr_b16 a[178:179], v116 offset:58368
    s_waitcnt lgkmcnt(6)
    v_mfma_f32_32x32x16_bf16 v[48:63], a[196:199], v[200:203], v[48:63]
    ds_read_b64_tr_b16 a[180:181], v117 offset:57344
    ds_read_b64_tr_b16 a[182:183], v117 offset:58368
    s_mov_b32 s43, 6272
    buffer_load_dwordx4 v14, s[32:35], s43 offen offset:1024 lds
    s_waitcnt lgkmcnt(6)
    v_mfma_f32_32x32x16_bf16 v[32:47], a[200:203], v[204:207], v[32:47]
    ds_read_b64_tr_b16 a[184:185], v116 offset:59392
    ds_read_b64_tr_b16 a[186:187], v116 offset:60416
    s_waitcnt lgkmcnt(6)
    v_mfma_f32_32x32x16_bf16 v[48:63], a[204:207], v[204:207], v[48:63]
    ds_read_b64_tr_b16 a[188:189], v117 offset:59392
    ds_read_b64_tr_b16 a[190:191], v117 offset:60416
    s_waitcnt lgkmcnt(6)
    v_mfma_f32_32x32x16_bf16 v[32:47], a[176:179], v[208:211], v[32:47]
    ds_read_b64_tr_b16 a[192:193], v116 offset:61440
    ds_read_b64_tr_b16 a[194:195], v116 offset:62464
    s_waitcnt lgkmcnt(6)
    v_mfma_f32_32x32x16_bf16 v[48:63], a[180:183], v[208:211], v[48:63]
    ds_read_b64_tr_b16 a[196:197], v117 offset:61440
    ds_read_b64_tr_b16 a[198:199], v117 offset:62464
    s_mov_b32 s43, 12416
    buffer_load_dwordx4 v14, s[32:35], s43 offen offset:2048 lds
    s_waitcnt lgkmcnt(6)
    v_mfma_f32_32x32x16_bf16 v[32:47], a[184:187], v[212:215], v[32:47]
    ds_read_b64_tr_b16 a[200:201], v116 offset:63488
    ds_read_b64_tr_b16 a[202:203], v116 offset:64512
    s_waitcnt lgkmcnt(6)
    v_mfma_f32_32x32x16_bf16 v[48:63], a[188:191], v[212:215], v[48:63]
    ds_read_b64_tr_b16 a[204:205], v117 offset:63488
    ds_read_b64_tr_b16 a[206:207], v117 offset:64512
    s_waitcnt lgkmcnt(6)
    v_mfma_f32_32x32x16_bf16 v[32:47], a[192:195], v[216:219], v[32:47]
    s_waitcnt vmcnt(27)
    s_barrier
    v_add_u32 v116, 0x10000, v116
    ds_read_b64_tr_b16 a[176:177], v116 offset:0
    ds_read_b64_tr_b16 a[178:179], v116 offset:1024
    s_waitcnt lgkmcnt(6)
    v_mfma_f32_32x32x16_bf16 v[48:63], a[196:199], v[216:219], v[48:63]
    v_add_u32 v117, 0x10000, v117
    ds_read_b64_tr_b16 a[180:181], v117 offset:0
    ds_read_b64_tr_b16 a[182:183], v117 offset:1024
    s_mov_b32 s43, 18560
    buffer_load_dwordx4 v14, s[32:35], s43 offen offset:3072 lds
    s_waitcnt lgkmcnt(6)
    v_mfma_f32_32x32x16_bf16 v[32:47], a[200:203], v[220:223], v[32:47]
    ds_read_b64_tr_b16 a[184:185], v116 offset:2048
    ds_read_b64_tr_b16 a[186:187], v116 offset:3072
    s_waitcnt lgkmcnt(6)
    v_mfma_f32_32x32x16_bf16 v[48:63], a[204:207], v[220:223], v[48:63]
    ds_read_b64_tr_b16 a[188:189], v117 offset:2048
    ds_read_b64_tr_b16 a[190:191], v117 offset:3072
    s_waitcnt lgkmcnt(6)
    v_mfma_f32_32x32x16_bf16 v[32:47], a[176:179], v[224:227], v[32:47]
    ds_read_b64_tr_b16 a[192:193], v116 offset:4096
    ds_read_b64_tr_b16 a[194:195], v116 offset:5120
    s_waitcnt lgkmcnt(6)
    v_mfma_f32_32x32x16_bf16 v[48:63], a[180:183], v[224:227], v[48:63]
    ds_read_b64_tr_b16 a[196:197], v117 offset:4096
    ds_read_b64_tr_b16 a[198:199], v117 offset:5120
    s_add_u32 m0, s42, 98304
    s_mov_b32 s43, 114816
    buffer_load_dwordx4 v14, s[32:35], s43 offen offset:0 lds
    s_waitcnt lgkmcnt(6)
    v_mfma_f32_32x32x16_bf16 v[32:47], a[184:187], v[228:231], v[32:47]
    ds_read_b64_tr_b16 a[200:201], v116 offset:6144
    ds_read_b64_tr_b16 a[202:203], v116 offset:7168
    s_waitcnt lgkmcnt(6)
    v_mfma_f32_32x32x16_bf16 v[48:63], a[188:191], v[228:231], v[48:63]
    ds_read_b64_tr_b16 a[204:205], v117 offset:6144
    ds_read_b64_tr_b16 a[206:207], v117 offset:7168
    s_waitcnt lgkmcnt(6)
    v_mfma_f32_32x32x16_bf16 v[32:47], a[192:195], v[232:235], v[32:47]
    ds_read_b64_tr_b16 a[176:177], v116 offset:8192
    ds_read_b64_tr_b16 a[178:179], v116 offset:9216
    s_waitcnt lgkmcnt(6)
    v_mfma_f32_32x32x16_bf16 v[48:63], a[196:199], v[232:235], v[48:63]
    ds_read_b64_tr_b16 a[180:181], v117 offset:8192
    ds_read_b64_tr_b16 a[182:183], v117 offset:9216
    s_mov_b32 s43, 120960
    buffer_load_dwordx4 v14, s[32:35], s43 offen offset:1024 lds
    s_waitcnt lgkmcnt(6)
    v_mfma_f32_32x32x16_bf16 v[32:47], a[200:203], v[236:239], v[32:47]
    ds_read_b64_tr_b16 a[184:185], v116 offset:10240
    ds_read_b64_tr_b16 a[186:187], v116 offset:11264
    s_waitcnt lgkmcnt(6)
    v_mfma_f32_32x32x16_bf16 v[48:63], a[204:207], v[236:239], v[48:63]
    ds_read_b64_tr_b16 a[188:189], v117 offset:10240
    ds_read_b64_tr_b16 a[190:191], v117 offset:11264
    s_waitcnt lgkmcnt(6)
    v_mfma_f32_32x32x16_bf16 v[32:47], a[176:179], v[240:243], v[32:47]
    ds_read_b64_tr_b16 a[192:193], v116 offset:12288
    ds_read_b64_tr_b16 a[194:195], v116 offset:13312
    s_waitcnt lgkmcnt(6)
    v_mfma_f32_32x32x16_bf16 v[48:63], a[180:183], v[240:243], v[48:63]
    ds_read_b64_tr_b16 a[196:197], v117 offset:12288
    ds_read_b64_tr_b16 a[198:199], v117 offset:13312
    s_mov_b32 s43, 127104
    buffer_load_dwordx4 v14, s[32:35], s43 offen offset:2048 lds
    s_waitcnt lgkmcnt(6)
    v_mfma_f32_32x32x16_bf16 v[32:47], a[184:187], v[244:247], v[32:47]
    ds_read_b64_tr_b16 a[200:201], v116 offset:14336
    ds_read_b64_tr_b16 a[202:203], v116 offset:15360
    s_waitcnt lgkmcnt(6)
    v_mfma_f32_32x32x16_bf16 v[48:63], a[188:191], v[244:247], v[48:63]
    ds_read_b64_tr_b16 a[204:205], v117 offset:14336
    ds_read_b64_tr_b16 a[206:207], v117 offset:15360
    s_waitcnt lgkmcnt(6)
    v_mfma_f32_32x32x16_bf16 v[32:47], a[192:195], v[248:251], v[32:47]
    s_waitcnt vmcnt(27)
    s_barrier
    ds_read_b64_tr_b16 a[176:177], v116 offset:16384
    ds_read_b64_tr_b16 a[178:179], v116 offset:17408
    s_waitcnt lgkmcnt(6)
    v_mfma_f32_32x32x16_bf16 v[48:63], a[196:199], v[248:251], v[48:63]
    ds_read_b64_tr_b16 a[180:181], v117 offset:16384
    ds_read_b64_tr_b16 a[182:183], v117 offset:17408
    s_mov_b32 s43, 133248
    buffer_load_dwordx4 v14, s[32:35], s43 offen offset:3072 lds
    s_waitcnt lgkmcnt(6)
    v_mfma_f32_32x32x16_bf16 v[32:47], a[200:203], v[252:255], v[32:47]
    ds_read_b64_tr_b16 a[184:185], v116 offset:18432
    ds_read_b64_tr_b16 a[186:187], v116 offset:19456
    s_waitcnt lgkmcnt(6)
    v_mfma_f32_32x32x16_bf16 v[48:63], a[204:207], v[252:255], v[48:63]
    ds_read_b64_tr_b16 a[188:189], v117 offset:18432
    ds_read_b64_tr_b16 a[190:191], v117 offset:19456
    s_waitcnt lgkmcnt(6)
    v_mfma_f32_32x32x16_bf16 v[64:79], a[176:179], v[128:131], 0
    ds_read_b64_tr_b16 a[192:193], v116 offset:20480
    ds_read_b64_tr_b16 a[194:195], v116 offset:21504
    s_waitcnt lgkmcnt(6)
    v_mfma_f32_32x32x16_bf16 v[80:95], a[180:183], v[128:131], 0
    ds_read_b64_tr_b16 a[196:197], v117 offset:20480
    ds_read_b64_tr_b16 a[198:199], v117 offset:21504
    s_add_u32 m0, s42, 114688
    s_mov_b32 s43, 256
    buffer_load_dwordx4 v14, s[32:35], s43 offen offset:0 lds
    v_mul_f32 v32, v122, v32
    s_waitcnt lgkmcnt(6)
    v_mfma_f32_32x32x16_bf16 v[64:79], a[184:187], v[132:135], v[64:79]
    ds_read_b64_tr_b16 a[200:201], v116 offset:22528
    ds_read_b64_tr_b16 a[202:203], v116 offset:23552
    v_mul_f32 v33, v122, v33
    v_mul_f32 v34, v122, v34
    v_mul_f32 v35, v122, v35
    v_mul_f32 v36, v122, v36
    s_waitcnt lgkmcnt(6)
    v_mfma_f32_32x32x16_bf16 v[80:95], a[188:191], v[132:135], v[80:95]
    ds_read_b64_tr_b16 a[204:205], v117 offset:22528
    ds_read_b64_tr_b16 a[206:207], v117 offset:23552
    v_mul_f32 v37, v122, v37
    v_mul_f32 v38, v122, v38
    v_mul_f32 v39, v122, v39
    v_cvt_pk_bf16_f32 v32, v32, v33
    s_waitcnt lgkmcnt(6)
    v_mfma_f32_32x32x16_bf16 v[64:79], a[192:195], v[136:139], v[64:79]
    ds_read_b64_tr_b16 a[176:177], v116 offset:24576
    ds_read_b64_tr_b16 a[178:179], v116 offset:25600
    v_cvt_pk_bf16_f32 v34, v34, v35
    v_cvt_pk_bf16_f32 v36, v36, v37
    v_cvt_pk_bf16_f32 v38, v38, v39
    v_accvgpr_write_b32 a96, v32
    s_waitcnt lgkmcnt(6)
    v_mfma_f32_32x32x16_bf16 v[80:95], a[196:199], v[136:139], v[80:95]
    ds_read_b64_tr_b16 a[180:181], v117 offset:24576
    ds_read_b64_tr_b16 a[182:183], v117 offset:25600
    s_mov_b32 s43, 6400
    buffer_load_dwordx4 v14, s[32:35], s43 offen offset:1024 lds
    v_accvgpr_write_b32 a97, v34
    v_accvgpr_write_b32 a98, v36
    s_waitcnt lgkmcnt(6)
    v_mfma_f32_32x32x16_bf16 v[64:79], a[200:203], v[140:143], v[64:79]
    ds_read_b64_tr_b16 a[184:185], v116 offset:26624
    ds_read_b64_tr_b16 a[186:187], v116 offset:27648
    v_accvgpr_write_b32 a99, v38
    v_mul_f32 v40, v122, v40
    v_mul_f32 v41, v122, v41
    v_mul_f32 v42, v122, v42
    s_waitcnt lgkmcnt(6)
    v_mfma_f32_32x32x16_bf16 v[80:95], a[204:207], v[140:143], v[80:95]
    ds_read_b64_tr_b16 a[188:189], v117 offset:26624
    ds_read_b64_tr_b16 a[190:191], v117 offset:27648
    v_mul_f32 v43, v122, v43
    v_mul_f32 v44, v122, v44
    v_mul_f32 v45, v122, v45
    v_mul_f32 v46, v122, v46
    s_waitcnt lgkmcnt(6)
    v_mfma_f32_32x32x16_bf16 v[64:79], a[176:179], v[144:147], v[64:79]
    ds_read_b64_tr_b16 a[192:193], v116 offset:28672
    ds_read_b64_tr_b16 a[194:195], v116 offset:29696
    v_mul_f32 v47, v122, v47
    v_cvt_pk_bf16_f32 v40, v40, v41
    v_cvt_pk_bf16_f32 v42, v42, v43
    v_cvt_pk_bf16_f32 v44, v44, v45
    s_waitcnt lgkmcnt(6)
    v_mfma_f32_32x32x16_bf16 v[80:95], a[180:183], v[144:147], v[80:95]
    ds_read_b64_tr_b16 a[196:197], v117 offset:28672
    ds_read_b64_tr_b16 a[198:199], v117 offset:29696
    s_mov_b32 s43, 12544
    buffer_load_dwordx4 v14, s[32:35], s43 offen offset:2048 lds
    v_cvt_pk_bf16_f32 v46, v46, v47
    v_accvgpr_write_b32 a100, v40
    s_waitcnt lgkmcnt(6)
    v_mfma_f32_32x32x16_bf16 v[64:79], a[184:187], v[148:151], v[64:79]
    ds_read_b64_tr_b16 a[200:201], v116 offset:30720
    ds_read_b64_tr_b16 a[202:203], v116 offset:31744
    v_accvgpr_write_b32 a101, v42
    v_accvgpr_write_b32 a102, v44
    v_accvgpr_write_b32 a103, v46
    v_mul_f32 v48, v122, v48
    s_waitcnt lgkmcnt(6)
    v_mfma_f32_32x32x16_bf16 v[80:95], a[188:191], v[148:151], v[80:95]
    ds_read_b64_tr_b16 a[204:205], v117 offset:30720
    ds_read_b64_tr_b16 a[206:207], v117 offset:31744
    v_mul_f32 v49, v122, v49
    v_mul_f32 v50, v122, v50
    v_mul_f32 v51, v122, v51
    v_mul_f32 v52, v122, v52
    s_waitcnt lgkmcnt(6)
    v_mfma_f32_32x32x16_bf16 v[64:79], a[192:195], v[152:155], v[64:79]
    s_waitcnt vmcnt(27)
    s_barrier
    v_add_u32 v116, 0xfffe0000, v116
    ds_read_b64_tr_b16 a[176:177], v116 offset:0
    ds_read_b64_tr_b16 a[178:179], v116 offset:1024
    s_waitcnt lgkmcnt(6)
    v_mfma_f32_32x32x16_bf16 v[80:95], a[196:199], v[152:155], v[80:95]
    v_add_u32 v117, 0xfffe0000, v117
    ds_read_b64_tr_b16 a[180:181], v117 offset:0
    ds_read_b64_tr_b16 a[182:183], v117 offset:1024
    s_mov_b32 s43, 18688
    buffer_load_dwordx4 v14, s[32:35], s43 offen offset:3072 lds
    v_mul_f32 v53, v122, v53
    s_waitcnt lgkmcnt(6)
    v_mfma_f32_32x32x16_bf16 v[64:79], a[200:203], v[156:159], v[64:79]
    ds_read_b64_tr_b16 a[184:185], v116 offset:2048
    ds_read_b64_tr_b16 a[186:187], v116 offset:3072
    v_mul_f32 v54, v122, v54
    v_mul_f32 v55, v122, v55
    v_cvt_pk_bf16_f32 v48, v48, v49
    v_cvt_pk_bf16_f32 v50, v50, v51
    s_waitcnt lgkmcnt(6)
    v_mfma_f32_32x32x16_bf16 v[80:95], a[204:207], v[156:159], v[80:95]
    ds_read_b64_tr_b16 a[188:189], v117 offset:2048
    ds_read_b64_tr_b16 a[190:191], v117 offset:3072
    v_cvt_pk_bf16_f32 v52, v52, v53
    v_cvt_pk_bf16_f32 v54, v54, v55
    v_accvgpr_write_b32 a104, v48
    v_accvgpr_write_b32 a105, v50
    s_waitcnt lgkmcnt(6)
    v_mfma_f32_32x32x16_bf16 v[64:79], a[176:179], v[160:163], v[64:79]
    ds_read_b64_tr_b16 a[192:193], v116 offset:4096
    ds_read_b64_tr_b16 a[194:195], v116 offset:5120
    v_accvgpr_write_b32 a106, v52
    v_accvgpr_write_b32 a107, v54
    v_mul_f32 v56, v122, v56
    v_mul_f32 v57, v122, v57
    s_waitcnt lgkmcnt(6)
    v_mfma_f32_32x32x16_bf16 v[80:95], a[180:183], v[160:163], v[80:95]
    ds_read_b64_tr_b16 a[196:197], v117 offset:4096
    ds_read_b64_tr_b16 a[198:199], v117 offset:5120
    s_add_u32 m0, s42, 131072
    s_mov_b32 s43, 114944
    buffer_load_dwordx4 v14, s[32:35], s43 offen offset:0 lds
    v_mul_f32 v58, v122, v58
    s_waitcnt lgkmcnt(6)
    v_mfma_f32_32x32x16_bf16 v[64:79], a[184:187], v[164:167], v[64:79]
    ds_read_b64_tr_b16 a[200:201], v116 offset:6144
    ds_read_b64_tr_b16 a[202:203], v116 offset:7168
    v_mul_f32 v59, v122, v59
    v_mul_f32 v60, v122, v60
    v_mul_f32 v61, v122, v61
    v_mul_f32 v62, v122, v62
    s_waitcnt lgkmcnt(6)
    v_mfma_f32_32x32x16_bf16 v[80:95], a[188:191], v[164:167], v[80:95]
    ds_read_b64_tr_b16 a[204:205], v117 offset:6144
    ds_read_b64_tr_b16 a[206:207], v117 offset:7168
    v_mul_f32 v63, v122, v63
    v_cvt_pk_bf16_f32 v56, v56, v57
    v_cvt_pk_bf16_f32 v58, v58, v59
    v_cvt_pk_bf16_f32 v60, v60, v61
    s_waitcnt lgkmcnt(6)
    v_mfma_f32_32x32x16_bf16 v[64:79], a[192:195], v[168:171], v[64:79]
    ds_read_b64_tr_b16 a[176:177], v116 offset:8192
    ds_read_b64_tr_b16 a[178:179], v116 offset:9216
    v_cvt_pk_bf16_f32 v62, v62, v63
    v_accvgpr_write_b32 a108, v56
    v_accvgpr_write_b32 a109, v58
    v_accvgpr_write_b32 a110, v60
    s_waitcnt lgkmcnt(6)
    v_mfma_f32_32x32x16_bf16 v[80:95], a[196:199], v[168:171], v[80:95]
    ds_read_b64_tr_b16 a[180:181], v117 offset:8192
    ds_read_b64_tr_b16 a[182:183], v117 offset:9216
    s_mov_b32 s43, 121088
    buffer_load_dwordx4 v14, s[32:35], s43 offen offset:1024 lds
    v_accvgpr_write_b32 a111, v62
    s_waitcnt lgkmcnt(6)
    v_mfma_f32_32x32x16_bf16 v[64:79], a[200:203], v[172:175], v[64:79]
    ds_read_b64_tr_b16 a[184:185], v116 offset:10240
    ds_read_b64_tr_b16 a[186:187], v116 offset:11264
    s_waitcnt lgkmcnt(6)
    v_mfma_f32_32x32x16_bf16 v[80:95], a[204:207], v[172:175], v[80:95]
    ds_read_b64_tr_b16 a[188:189], v117 offset:10240
    ds_read_b64_tr_b16 a[190:191], v117 offset:11264
    s_waitcnt lgkmcnt(6)
    v_mfma_f32_32x32x16_bf16 v[64:79], a[176:179], v[176:179], v[64:79]
    ds_read_b64_tr_b16 a[192:193], v116 offset:12288
    ds_read_b64_tr_b16 a[194:195], v116 offset:13312
    s_waitcnt lgkmcnt(6)
    v_mfma_f32_32x32x16_bf16 v[80:95], a[180:183], v[176:179], v[80:95]
    ds_read_b64_tr_b16 a[196:197], v117 offset:12288
    ds_read_b64_tr_b16 a[198:199], v117 offset:13312
    s_mov_b32 s43, 127232
    buffer_load_dwordx4 v14, s[32:35], s43 offen offset:2048 lds
    s_waitcnt lgkmcnt(6)
    v_mfma_f32_32x32x16_bf16 v[64:79], a[184:187], v[180:183], v[64:79]
    ds_read_b64_tr_b16 a[200:201], v116 offset:14336
    ds_read_b64_tr_b16 a[202:203], v116 offset:15360
    s_waitcnt lgkmcnt(6)
    v_mfma_f32_32x32x16_bf16 v[80:95], a[188:191], v[180:183], v[80:95]
    ds_read_b64_tr_b16 a[204:205], v117 offset:14336
    ds_read_b64_tr_b16 a[206:207], v117 offset:15360
    s_waitcnt lgkmcnt(6)
    v_mfma_f32_32x32x16_bf16 v[64:79], a[192:195], v[184:187], v[64:79]
    s_waitcnt vmcnt(27)
    s_barrier
    ds_read_b64_tr_b16 a[176:177], v116 offset:16384
    ds_read_b64_tr_b16 a[178:179], v116 offset:17408
    s_waitcnt lgkmcnt(6)
    v_mfma_f32_32x32x16_bf16 v[80:95], a[196:199], v[184:187], v[80:95]
    ds_read_b64_tr_b16 a[180:181], v117 offset:16384
    ds_read_b64_tr_b16 a[182:183], v117 offset:17408
    s_mov_b32 s43, 133376
    buffer_load_dwordx4 v14, s[32:35], s43 offen offset:3072 lds
    s_waitcnt lgkmcnt(6)
    v_mfma_f32_32x32x16_bf16 v[64:79], a[200:203], v[188:191], v[64:79]
    ds_read_b64_tr_b16 a[184:185], v116 offset:18432
    ds_read_b64_tr_b16 a[186:187], v116 offset:19456
    s_waitcnt lgkmcnt(6)
    v_mfma_f32_32x32x16_bf16 v[80:95], a[204:207], v[188:191], v[80:95]
    ds_read_b64_tr_b16 a[188:189], v117 offset:18432
    ds_read_b64_tr_b16 a[190:191], v117 offset:19456
    s_waitcnt lgkmcnt(6)
    v_mfma_f32_32x32x16_bf16 v[64:79], a[176:179], v[192:195], v[64:79]
    ds_read_b64_tr_b16 a[192:193], v116 offset:20480
    ds_read_b64_tr_b16 a[194:195], v116 offset:21504
    s_waitcnt lgkmcnt(6)
    v_mfma_f32_32x32x16_bf16 v[80:95], a[180:183], v[192:195], v[80:95]
    ds_read_b64_tr_b16 a[196:197], v117 offset:20480
    ds_read_b64_tr_b16 a[198:199], v117 offset:21504
    s_add_u32 m0, s42, 147456
    s_mov_b32 s43, 384
    buffer_load_dwordx4 v14, s[32:35], s43 offen offset:0 lds
    s_waitcnt lgkmcnt(6)
    v_mfma_f32_32x32x16_bf16 v[64:79], a[184:187], v[196:199], v[64:79]
    ds_read_b64_tr_b16 a[200:201], v116 offset:22528
    ds_read_b64_tr_b16 a[202:203], v116 offset:23552
    s_waitcnt lgkmcnt(6)
    v_mfma_f32_32x32x16_bf16 v[80:95], a[188:191], v[196:199], v[80:95]
    ds_read_b64_tr_b16 a[204:205], v117 offset:22528
    ds_read_b64_tr_b16 a[206:207], v117 offset:23552
    s_waitcnt lgkmcnt(6)
    v_mfma_f32_32x32x16_bf16 v[64:79], a[192:195], v[200:203], v[64:79]
    ds_read_b64_tr_b16 a[176:177], v116 offset:24576
    ds_read_b64_tr_b16 a[178:179], v116 offset:25600
    s_waitcnt lgkmcnt(6)
    v_mfma_f32_32x32x16_bf16 v[80:95], a[196:199], v[200:203], v[80:95]
    ds_read_b64_tr_b16 a[180:181], v117 offset:24576
    ds_read_b64_tr_b16 a[182:183], v117 offset:25600
    s_mov_b32 s43, 6528
    buffer_load_dwordx4 v14, s[32:35], s43 offen offset:1024 lds
    s_waitcnt lgkmcnt(6)
    v_mfma_f32_32x32x16_bf16 v[64:79], a[200:203], v[204:207], v[64:79]
    ds_read_b64_tr_b16 a[184:185], v116 offset:26624
    ds_read_b64_tr_b16 a[186:187], v116 offset:27648
    s_waitcnt lgkmcnt(6)
    v_mfma_f32_32x32x16_bf16 v[80:95], a[204:207], v[204:207], v[80:95]
    ds_read_b64_tr_b16 a[188:189], v117 offset:26624
    ds_read_b64_tr_b16 a[190:191], v117 offset:27648
    s_waitcnt lgkmcnt(6)
    v_mfma_f32_32x32x16_bf16 v[64:79], a[176:179], v[208:211], v[64:79]
    ds_read_b64_tr_b16 a[192:193], v116 offset:28672
    ds_read_b64_tr_b16 a[194:195], v116 offset:29696
    s_waitcnt lgkmcnt(6)
    v_mfma_f32_32x32x16_bf16 v[80:95], a[180:183], v[208:211], v[80:95]
    ds_read_b64_tr_b16 a[196:197], v117 offset:28672
    ds_read_b64_tr_b16 a[198:199], v117 offset:29696
    s_mov_b32 s43, 12672
    buffer_load_dwordx4 v14, s[32:35], s43 offen offset:2048 lds
    s_waitcnt lgkmcnt(6)
    v_mfma_f32_32x32x16_bf16 v[64:79], a[184:187], v[212:215], v[64:79]
    ds_read_b64_tr_b16 a[200:201], v116 offset:30720
    ds_read_b64_tr_b16 a[202:203], v116 offset:31744
    s_waitcnt lgkmcnt(6)
    v_mfma_f32_32x32x16_bf16 v[80:95], a[188:191], v[212:215], v[80:95]
    ds_read_b64_tr_b16 a[204:205], v117 offset:30720
    ds_read_b64_tr_b16 a[206:207], v117 offset:31744
    s_waitcnt lgkmcnt(6)
    v_mfma_f32_32x32x16_bf16 v[64:79], a[192:195], v[216:219], v[64:79]
    s_waitcnt vmcnt(27)
    s_barrier
    ds_read_b64_tr_b16 a[176:177], v116 offset:32768
    ds_read_b64_tr_b16 a[178:179], v116 offset:33792
    s_waitcnt lgkmcnt(6)
    v_mfma_f32_32x32x16_bf16 v[80:95], a[196:199], v[216:219], v[80:95]
    ds_read_b64_tr_b16 a[180:181], v117 offset:32768
    ds_read_b64_tr_b16 a[182:183], v117 offset:33792
    s_mov_b32 s43, 18816
    buffer_load_dwordx4 v14, s[32:35], s43 offen offset:3072 lds
    s_waitcnt lgkmcnt(6)
    v_mfma_f32_32x32x16_bf16 v[64:79], a[200:203], v[220:223], v[64:79]
    ds_read_b64_tr_b16 a[184:185], v116 offset:34816
    ds_read_b64_tr_b16 a[186:187], v116 offset:35840
    s_waitcnt lgkmcnt(6)
    v_mfma_f32_32x32x16_bf16 v[80:95], a[204:207], v[220:223], v[80:95]
    ds_read_b64_tr_b16 a[188:189], v117 offset:34816
    ds_read_b64_tr_b16 a[190:191], v117 offset:35840
    s_waitcnt lgkmcnt(6)
    v_mfma_f32_32x32x16_bf16 v[64:79], a[176:179], v[224:227], v[64:79]
    ds_read_b64_tr_b16 a[192:193], v116 offset:36864
    ds_read_b64_tr_b16 a[194:195], v116 offset:37888
    s_waitcnt lgkmcnt(6)
    v_mfma_f32_32x32x16_bf16 v[80:95], a[180:183], v[224:227], v[80:95]
    ds_read_b64_tr_b16 a[196:197], v117 offset:36864
    ds_read_b64_tr_b16 a[198:199], v117 offset:37888
    s_add_u32 m0, s42, 0
    s_mov_b32 s43, 115072
    buffer_load_dwordx4 v14, s[32:35], s43 offen offset:0 lds
    s_waitcnt lgkmcnt(6)
    v_mfma_f32_32x32x16_bf16 v[64:79], a[184:187], v[228:231], v[64:79]
    ds_read_b64_tr_b16 a[200:201], v116 offset:38912
    ds_read_b64_tr_b16 a[202:203], v116 offset:39936
    s_waitcnt lgkmcnt(6)
    v_mfma_f32_32x32x16_bf16 v[80:95], a[188:191], v[228:231], v[80:95]
    ds_read_b64_tr_b16 a[204:205], v117 offset:38912
    ds_read_b64_tr_b16 a[206:207], v117 offset:39936
    s_waitcnt lgkmcnt(6)
    v_mfma_f32_32x32x16_bf16 v[64:79], a[192:195], v[232:235], v[64:79]
    ds_read_b64_tr_b16 a[176:177], v116 offset:40960
    ds_read_b64_tr_b16 a[178:179], v116 offset:41984
    s_waitcnt lgkmcnt(6)
    v_mfma_f32_32x32x16_bf16 v[80:95], a[196:199], v[232:235], v[80:95]
    ds_read_b64_tr_b16 a[180:181], v117 offset:40960
    ds_read_b64_tr_b16 a[182:183], v117 offset:41984
    s_mov_b32 s43, 121216
    buffer_load_dwordx4 v14, s[32:35], s43 offen offset:1024 lds
    s_waitcnt lgkmcnt(6)
    v_mfma_f32_32x32x16_bf16 v[64:79], a[200:203], v[236:239], v[64:79]
    ds_read_b64_tr_b16 a[184:185], v116 offset:43008
    ds_read_b64_tr_b16 a[186:187], v116 offset:44032
    s_waitcnt lgkmcnt(6)
    v_mfma_f32_32x32x16_bf16 v[80:95], a[204:207], v[236:239], v[80:95]
    ds_read_b64_tr_b16 a[188:189], v117 offset:43008
    ds_read_b64_tr_b16 a[190:191], v117 offset:44032
    s_waitcnt lgkmcnt(6)
    v_mfma_f32_32x32x16_bf16 v[64:79], a[176:179], v[240:243], v[64:79]
    ds_read_b64_tr_b16 a[192:193], v116 offset:45056
    ds_read_b64_tr_b16 a[194:195], v116 offset:46080
    s_waitcnt lgkmcnt(6)
    v_mfma_f32_32x32x16_bf16 v[80:95], a[180:183], v[240:243], v[80:95]
    ds_read_b64_tr_b16 a[196:197], v117 offset:45056
    ds_read_b64_tr_b16 a[198:199], v117 offset:46080
    s_mov_b32 s43, 127360
    buffer_load_dwordx4 v14, s[32:35], s43 offen offset:2048 lds
    s_waitcnt lgkmcnt(6)
    v_mfma_f32_32x32x16_bf16 v[64:79], a[184:187], v[244:247], v[64:79]
    ds_read_b64_tr_b16 a[200:201], v116 offset:47104
    ds_read_b64_tr_b16 a[202:203], v116 offset:48128
    s_waitcnt lgkmcnt(6)
    v_mfma_f32_32x32x16_bf16 v[80:95], a[188:191], v[244:247], v[80:95]
    ds_read_b64_tr_b16 a[204:205], v117 offset:47104
    ds_read_b64_tr_b16 a[206:207], v117 offset:48128
    s_waitcnt lgkmcnt(6)
    v_mfma_f32_32x32x16_bf16 v[64:79], a[192:195], v[248:251], v[64:79]
    s_waitcnt vmcnt(27)
    s_barrier
    ds_read_b64_tr_b16 a[176:177], v112 offset:49152
    ds_read_b64_tr_b16 a[178:179], v112 offset:50176
    s_waitcnt lgkmcnt(6)
    v_mfma_f32_32x32x16_bf16 v[80:95], a[196:199], v[248:251], v[80:95]
    ds_read_b64_tr_b16 a[180:181], v113 offset:49152
    ds_read_b64_tr_b16 a[182:183], v113 offset:50176
    s_mov_b32 s43, 133504
    buffer_load_dwordx4 v14, s[32:35], s43 offen offset:3072 lds
    s_waitcnt lgkmcnt(6)
    v_mfma_f32_32x32x16_bf16 v[64:79], a[200:203], v[252:255], v[64:79]
    ds_read_b64_tr_b16 a[184:185], v112 offset:51200
    ds_read_b64_tr_b16 a[186:187], v112 offset:52224
    s_waitcnt lgkmcnt(6)
    v_mfma_f32_32x32x16_bf16 v[80:95], a[204:207], v[252:255], v[80:95]
    ds_read_b64_tr_b16 a[188:189], v113 offset:51200
    ds_read_b64_tr_b16 a[190:191], v113 offset:52224
    s_waitcnt lgkmcnt(6)
    v_mfma_f32_32x32x16_bf16 v[128:143], a[176:179], a[64:67], 0
    ds_read_b64_tr_b16 a[192:193], v112 offset:53248
    ds_read_b64_tr_b16 a[194:195], v112 offset:54272
    s_waitcnt lgkmcnt(6)
    v_mfma_f32_32x32x16_bf16 v[144:159], a[180:183], a[64:67], 0
    ds_read_b64_tr_b16 a[196:197], v113 offset:53248
    ds_read_b64_tr_b16 a[198:199], v113 offset:54272
    s_add_u32 m0, s42, 16384
    s_mov_b32 s43, 512
    buffer_load_dwordx4 v14, s[32:35], s43 offen offset:0 lds
    v_mul_f32 v64, v122, v64
    s_waitcnt lgkmcnt(6)
    v_mfma_f32_32x32x16_bf16 v[128:143], a[184:187], a[68:71], v[128:143]
    ds_read_b64_tr_b16 a[200:201], v112 offset:55296
    ds_read_b64_tr_b16 a[202:203], v112 offset:56320
    v_mul_f32 v65, v122, v65
    v_mul_f32 v66, v122, v66
    v_mul_f32 v67, v122, v67
    v_mul_f32 v68, v122, v68
    s_waitcnt lgkmcnt(6)
    v_mfma_f32_32x32x16_bf16 v[144:159], a[188:191], a[68:71], v[144:159]
    ds_read_b64_tr_b16 a[204:205], v113 offset:55296
    ds_read_b64_tr_b16 a[206:207], v113 offset:56320
    v_mul_f32 v69, v122, v69
    v_mul_f32 v70, v122, v70
    v_mul_f32 v71, v122, v71
    v_cvt_pk_bf16_f32 v64, v64, v65
    s_waitcnt lgkmcnt(6)
    v_mfma_f32_32x32x16_bf16 v[128:143], a[192:195], a[72:75], v[128:143]
    ds_read_b64_tr_b16 a[176:177], v112 offset:57344
    ds_read_b64_tr_b16 a[178:179], v112 offset:58368
    v_cvt_pk_bf16_f32 v66, v66, v67
    v_cvt_pk_bf16_f32 v68, v68, v69
    v_cvt_pk_bf16_f32 v70, v70, v71
    v_accvgpr_write_b32 a112, v64
    s_waitcnt lgkmcnt(6)
    v_mfma_f32_32x32x16_bf16 v[144:159], a[196:199], a[72:75], v[144:159]
    ds_read_b64_tr_b16 a[180:181], v113 offset:57344
    ds_read_b64_tr_b16 a[182:183], v113 offset:58368
    s_mov_b32 s43, 6656
    buffer_load_dwordx4 v14, s[32:35], s43 offen offset:1024 lds
    v_accvgpr_write_b32 a113, v66
    v_accvgpr_write_b32 a114, v68
    s_waitcnt lgkmcnt(6)
    v_mfma_f32_32x32x16_bf16 v[128:143], a[200:203], a[76:79], v[128:143]
    ds_read_b64_tr_b16 a[184:185], v112 offset:59392
    ds_read_b64_tr_b16 a[186:187], v112 offset:60416
    v_accvgpr_write_b32 a115, v70
    v_mul_f32 v72, v122, v72
    v_mul_f32 v73, v122, v73
    v_mul_f32 v74, v122, v74
    s_waitcnt lgkmcnt(6)
    v_mfma_f32_32x32x16_bf16 v[144:159], a[204:207], a[76:79], v[144:159]
    ds_read_b64_tr_b16 a[188:189], v113 offset:59392
    ds_read_b64_tr_b16 a[190:191], v113 offset:60416
    v_mul_f32 v75, v122, v75
    v_mul_f32 v76, v122, v76
    v_mul_f32 v77, v122, v77
    v_mul_f32 v78, v122, v78
    s_waitcnt lgkmcnt(6)
    v_mfma_f32_32x32x16_bf16 v[128:143], a[176:179], a[80:83], v[128:143]
    ds_read_b64_tr_b16 a[192:193], v112 offset:61440
    ds_read_b64_tr_b16 a[194:195], v112 offset:62464
    v_mul_f32 v79, v122, v79
    v_cvt_pk_bf16_f32 v72, v72, v73
    v_cvt_pk_bf16_f32 v74, v74, v75
    v_cvt_pk_bf16_f32 v76, v76, v77
    s_waitcnt lgkmcnt(6)
    v_mfma_f32_32x32x16_bf16 v[144:159], a[180:183], a[80:83], v[144:159]
    ds_read_b64_tr_b16 a[196:197], v113 offset:61440
    ds_read_b64_tr_b16 a[198:199], v113 offset:62464
    s_mov_b32 s43, 12800
    buffer_load_dwordx4 v14, s[32:35], s43 offen offset:2048 lds
    v_cvt_pk_bf16_f32 v78, v78, v79
    v_accvgpr_write_b32 a116, v72
    s_waitcnt lgkmcnt(6)
    v_mfma_f32_32x32x16_bf16 v[128:143], a[184:187], a[84:87], v[128:143]
    ds_read_b64_tr_b16 a[200:201], v112 offset:63488
    ds_read_b64_tr_b16 a[202:203], v112 offset:64512
    v_accvgpr_write_b32 a117, v74
    v_accvgpr_write_b32 a118, v76
    v_accvgpr_write_b32 a119, v78
    v_mul_f32 v80, v122, v80
    s_waitcnt lgkmcnt(6)
    v_mfma_f32_32x32x16_bf16 v[144:159], a[188:191], a[84:87], v[144:159]
    ds_read_b64_tr_b16 a[204:205], v113 offset:63488
    ds_read_b64_tr_b16 a[206:207], v113 offset:64512
    v_mul_f32 v81, v122, v81
    v_mul_f32 v82, v122, v82
    v_mul_f32 v83, v122, v83
    v_mul_f32 v84, v122, v84
    s_waitcnt lgkmcnt(6)
    v_mfma_f32_32x32x16_bf16 v[128:143], a[192:195], a[88:91], v[128:143]
    s_waitcnt vmcnt(27)
    s_barrier
    v_add_u32 v112, 0x10000, v112
    ds_read_b64_tr_b16 a[176:177], v112 offset:0
    ds_read_b64_tr_b16 a[178:179], v112 offset:1024
    s_waitcnt lgkmcnt(6)
    v_mfma_f32_32x32x16_bf16 v[144:159], a[196:199], a[88:91], v[144:159]
    v_add_u32 v113, 0x10000, v113
    ds_read_b64_tr_b16 a[180:181], v113 offset:0
    ds_read_b64_tr_b16 a[182:183], v113 offset:1024
    s_mov_b32 s43, 18944
    buffer_load_dwordx4 v14, s[32:35], s43 offen offset:3072 lds
    v_mul_f32 v85, v122, v85
    s_waitcnt lgkmcnt(6)
    v_mfma_f32_32x32x16_bf16 v[128:143], a[200:203], a[92:95], v[128:143]
    ds_read_b64_tr_b16 a[184:185], v112 offset:2048
    ds_read_b64_tr_b16 a[186:187], v112 offset:3072
    v_mul_f32 v86, v122, v86
    v_mul_f32 v87, v122, v87
    v_cvt_pk_bf16_f32 v80, v80, v81
    v_cvt_pk_bf16_f32 v82, v82, v83
    s_waitcnt lgkmcnt(6)
    v_mfma_f32_32x32x16_bf16 v[144:159], a[204:207], a[92:95], v[144:159]
    ds_read_b64_tr_b16 a[188:189], v113 offset:2048
    ds_read_b64_tr_b16 a[190:191], v113 offset:3072
    v_cvt_pk_bf16_f32 v84, v84, v85
    v_cvt_pk_bf16_f32 v86, v86, v87
    v_accvgpr_write_b32 a120, v80
    v_accvgpr_write_b32 a121, v82
    s_waitcnt lgkmcnt(6)
    v_mfma_f32_32x32x16_bf16 v[128:143], a[176:179], a[96:99], v[128:143]
    ds_read_b64_tr_b16 a[192:193], v112 offset:4096
    ds_read_b64_tr_b16 a[194:195], v112 offset:5120
    v_accvgpr_write_b32 a122, v84
    v_accvgpr_write_b32 a123, v86
    v_mul_f32 v88, v122, v88
    v_mul_f32 v89, v122, v89
    s_waitcnt lgkmcnt(6)
    v_mfma_f32_32x32x16_bf16 v[144:159], a[180:183], a[96:99], v[144:159]
    ds_read_b64_tr_b16 a[196:197], v113 offset:4096
    ds_read_b64_tr_b16 a[198:199], v113 offset:5120
    s_add_u32 m0, s42, 32768
    s_mov_b32 s43, 115200
    buffer_load_dwordx4 v14, s[32:35], s43 offen offset:0 lds
    v_mul_f32 v90, v122, v90
    s_waitcnt lgkmcnt(6)
    v_mfma_f32_32x32x16_bf16 v[128:143], a[184:187], a[100:103], v[128:143]
    ds_read_b64_tr_b16 a[200:201], v112 offset:6144
    ds_read_b64_tr_b16 a[202:203], v112 offset:7168
    v_mul_f32 v91, v122, v91
    v_mul_f32 v92, v122, v92
    v_mul_f32 v93, v122, v93
    v_mul_f32 v94, v122, v94
    s_waitcnt lgkmcnt(6)
    v_mfma_f32_32x32x16_bf16 v[144:159], a[188:191], a[100:103], v[144:159]
    ds_read_b64_tr_b16 a[204:205], v113 offset:6144
    ds_read_b64_tr_b16 a[206:207], v113 offset:7168
    v_mul_f32 v95, v122, v95
    v_cvt_pk_bf16_f32 v88, v88, v89
    v_cvt_pk_bf16_f32 v90, v90, v91
    v_cvt_pk_bf16_f32 v92, v92, v93
    s_waitcnt lgkmcnt(6)
    v_mfma_f32_32x32x16_bf16 v[128:143], a[192:195], a[104:107], v[128:143]
    ds_read_b64_tr_b16 a[176:177], v112 offset:8192
    ds_read_b64_tr_b16 a[178:179], v112 offset:9216
    v_cvt_pk_bf16_f32 v94, v94, v95
    v_accvgpr_write_b32 a124, v88
    v_accvgpr_write_b32 a125, v90
    v_accvgpr_write_b32 a126, v92
    s_waitcnt lgkmcnt(6)
    v_mfma_f32_32x32x16_bf16 v[144:159], a[196:199], a[104:107], v[144:159]
    ds_read_b64_tr_b16 a[180:181], v113 offset:8192
    ds_read_b64_tr_b16 a[182:183], v113 offset:9216
    s_mov_b32 s43, 121344
    buffer_load_dwordx4 v14, s[32:35], s43 offen offset:1024 lds
    v_accvgpr_write_b32 a127, v94
    s_waitcnt lgkmcnt(6)
    v_mfma_f32_32x32x16_bf16 v[128:143], a[200:203], a[108:111], v[128:143]
    ds_read_b64_tr_b16 a[184:185], v112 offset:10240
    ds_read_b64_tr_b16 a[186:187], v112 offset:11264
    s_waitcnt lgkmcnt(6)
    v_mfma_f32_32x32x16_bf16 v[144:159], a[204:207], a[108:111], v[144:159]
    ds_read_b64_tr_b16 a[188:189], v113 offset:10240
    ds_read_b64_tr_b16 a[190:191], v113 offset:11264
    s_waitcnt lgkmcnt(6)
    v_mfma_f32_32x32x16_bf16 v[128:143], a[176:179], a[112:115], v[128:143]
    ds_read_b64_tr_b16 a[192:193], v112 offset:12288
    ds_read_b64_tr_b16 a[194:195], v112 offset:13312
    s_waitcnt lgkmcnt(6)
    v_mfma_f32_32x32x16_bf16 v[144:159], a[180:183], a[112:115], v[144:159]
    ds_read_b64_tr_b16 a[196:197], v113 offset:12288
    ds_read_b64_tr_b16 a[198:199], v113 offset:13312
    s_mov_b32 s43, 127488
    buffer_load_dwordx4 v14, s[32:35], s43 offen offset:2048 lds
    s_waitcnt lgkmcnt(6)
    v_mfma_f32_32x32x16_bf16 v[128:143], a[184:187], a[116:119], v[128:143]
    ds_read_b64_tr_b16 a[200:201], v112 offset:14336
    ds_read_b64_tr_b16 a[202:203], v112 offset:15360
    s_waitcnt lgkmcnt(6)
    v_mfma_f32_32x32x16_bf16 v[144:159], a[188:191], a[116:119], v[144:159]
    ds_read_b64_tr_b16 a[204:205], v113 offset:14336
    ds_read_b64_tr_b16 a[206:207], v113 offset:15360
    s_waitcnt lgkmcnt(6)
    v_mfma_f32_32x32x16_bf16 v[128:143], a[192:195], a[120:123], v[128:143]
    s_waitcnt vmcnt(27)
    s_barrier
    ds_read_b64_tr_b16 a[176:177], v112 offset:16384
    ds_read_b64_tr_b16 a[178:179], v112 offset:17408
    s_waitcnt lgkmcnt(6)
    v_mfma_f32_32x32x16_bf16 v[144:159], a[196:199], a[120:123], v[144:159]
    ds_read_b64_tr_b16 a[180:181], v113 offset:16384
    ds_read_b64_tr_b16 a[182:183], v113 offset:17408
    s_mov_b32 s43, 133632
    buffer_load_dwordx4 v14, s[32:35], s43 offen offset:3072 lds
    s_waitcnt lgkmcnt(6)
    v_mfma_f32_32x32x16_bf16 v[128:143], a[200:203], a[124:127], v[128:143]
    ds_read_b64_tr_b16 a[184:185], v112 offset:18432
    ds_read_b64_tr_b16 a[186:187], v112 offset:19456
    s_waitcnt lgkmcnt(6)
    v_mfma_f32_32x32x16_bf16 v[144:159], a[204:207], a[124:127], v[144:159]
    ds_read_b64_tr_b16 a[188:189], v113 offset:18432
    ds_read_b64_tr_b16 a[190:191], v113 offset:19456
    s_mov_b32 s47, 0
    s_waitcnt lgkmcnt(6)
    v_mfma_f32_32x32x16_bf16 v[160:175], a[176:179], a[64:67], 0
    ds_read_b64_tr_b16 a[192:193], v112 offset:20480
    ds_read_b64_tr_b16 a[194:195], v112 offset:21504
    s_waitcnt lgkmcnt(6)
    v_mfma_f32_32x32x16_bf16 v[176:191], a[180:183], a[64:67], 0
    ds_read_b64_tr_b16 a[196:197], v113 offset:20480
    ds_read_b64_tr_b16 a[198:199], v113 offset:21504
    s_add_u32 m0, s42, 49152
    s_mov_b32 s43, 640
    buffer_load_dwordx4 v14, s[32:35], s43 offen offset:0 lds
    v_cvt_pk_bf16_f32 v128, v128, v129
    s_waitcnt lgkmcnt(6)
    v_mfma_f32_32x32x16_bf16 v[160:175], a[184:187], a[68:71], v[160:175]
    ds_read_b64_tr_b16 a[200:201], v112 offset:22528
    ds_read_b64_tr_b16 a[202:203], v112 offset:23552
    v_cvt_pk_bf16_f32 v129, v130, v131
    v_cvt_pk_bf16_f32 v130, v132, v133
    v_cvt_pk_bf16_f32 v131, v134, v135
    s_waitcnt lgkmcnt(6)
    v_mfma_f32_32x32x16_bf16 v[176:191], a[188:191], a[68:71], v[176:191]
    ds_read_b64_tr_b16 a[204:205], v113 offset:22528
    ds_read_b64_tr_b16 a[206:207], v113 offset:23552
    buffer_store_dwordx2 v[128:129], v15, s[36:39], s47 offen sc1
    buffer_store_dwordx2 v[130:131], v125, s[36:39], s47 offen sc1
    s_waitcnt lgkmcnt(6)
    v_mfma_f32_32x32x16_bf16 v[160:175], a[192:195], a[72:75], v[160:175]
    ds_read_b64_tr_b16 a[176:177], v112 offset:24576
    ds_read_b64_tr_b16 a[178:179], v112 offset:25600
    v_cvt_pk_bf16_f32 v136, v136, v137
    v_cvt_pk_bf16_f32 v137, v138, v139
    v_cvt_pk_bf16_f32 v138, v140, v141
    v_cvt_pk_bf16_f32 v139, v142, v143
    s_waitcnt lgkmcnt(6)
    v_mfma_f32_32x32x16_bf16 v[176:191], a[196:199], a[72:75], v[176:191]
    ds_read_b64_tr_b16 a[180:181], v113 offset:24576
    ds_read_b64_tr_b16 a[182:183], v113 offset:25600
    s_mov_b32 s43, 6784
    buffer_load_dwordx4 v14, s[32:35], s43 offen offset:1024 lds
    buffer_store_dwordx2 v[136:137], v127, s[36:39], s47 offen sc1
    s_waitcnt lgkmcnt(6)
    v_mfma_f32_32x32x16_bf16 v[160:175], a[200:203], a[76:79], v[160:175]
    ds_read_b64_tr_b16 a[184:185], v112 offset:26624
    ds_read_b64_tr_b16 a[186:187], v112 offset:27648
    buffer_store_dwordx2 v[138:139], v0, s[36:39], s47 offen sc1
    s_mov_b32 s47, 50176
    v_cvt_pk_bf16_f32 v144, v144, v145
    s_waitcnt lgkmcnt(6)
    v_mfma_f32_32x32x16_bf16 v[176:191], a[204:207], a[76:79], v[176:191]
    ds_read_b64_tr_b16 a[188:189], v113 offset:26624
    ds_read_b64_tr_b16 a[190:191], v113 offset:27648
    v_cvt_pk_bf16_f32 v145, v146, v147
    v_cvt_pk_bf16_f32 v146, v148, v149
    v_cvt_pk_bf16_f32 v147, v150, v151
    s_waitcnt lgkmcnt(6)
    v_mfma_f32_32x32x16_bf16 v[160:175], a[176:179], a[80:83], v[160:175]
    ds_read_b64_tr_b16 a[192:193], v112 offset:28672
    ds_read_b64_tr_b16 a[194:195], v112 offset:29696
    buffer_store_dwordx2 v[144:145], v15, s[36:39], s47 offen sc1
    buffer_store_dwordx2 v[146:147], v125, s[36:39], s47 offen sc1
    s_waitcnt lgkmcnt(6)
    v_mfma_f32_32x32x16_bf16 v[176:191], a[180:183], a[80:83], v[176:191]
    ds_read_b64_tr_b16 a[196:197], v113 offset:28672
    ds_read_b64_tr_b16 a[198:199], v113 offset:29696
    s_mov_b32 s43, 12928
    buffer_load_dwordx4 v14, s[32:35], s43 offen offset:2048 lds
    v_cvt_pk_bf16_f32 v152, v152, v153
    v_cvt_pk_bf16_f32 v153, v154, v155
    s_waitcnt lgkmcnt(6)
    v_mfma_f32_32x32x16_bf16 v[160:175], a[184:187], a[84:87], v[160:175]
    ds_read_b64_tr_b16 a[200:201], v112 offset:30720
    ds_read_b64_tr_b16 a[202:203], v112 offset:31744
    v_cvt_pk_bf16_f32 v154, v156, v157
    v_cvt_pk_bf16_f32 v155, v158, v159
    buffer_store_dwordx2 v[152:153], v127, s[36:39], s47 offen sc1
    s_waitcnt lgkmcnt(6)
    v_mfma_f32_32x32x16_bf16 v[176:191], a[188:191], a[84:87], v[176:191]
    ds_read_b64_tr_b16 a[204:205], v113 offset:30720
    ds_read_b64_tr_b16 a[206:207], v113 offset:31744
    buffer_store_dwordx2 v[154:155], v0, s[36:39], s47 offen sc1
    s_waitcnt lgkmcnt(6)
    v_mfma_f32_32x32x16_bf16 v[160:175], a[192:195], a[88:91], v[160:175]
    s_waitcnt vmcnt(35)
    s_barrier
    ds_read_b64_tr_b16 a[176:177], v112 offset:32768
    ds_read_b64_tr_b16 a[178:179], v112 offset:33792
    s_waitcnt lgkmcnt(6)
    v_mfma_f32_32x32x16_bf16 v[176:191], a[196:199], a[88:91], v[176:191]
    ds_read_b64_tr_b16 a[180:181], v113 offset:32768
    ds_read_b64_tr_b16 a[182:183], v113 offset:33792
    s_mov_b32 s43, 19072
    buffer_load_dwordx4 v14, s[32:35], s43 offen offset:3072 lds
    s_waitcnt lgkmcnt(6)
    v_mfma_f32_32x32x16_bf16 v[160:175], a[200:203], a[92:95], v[160:175]
    ds_read_b64_tr_b16 a[184:185], v112 offset:34816
    ds_read_b64_tr_b16 a[186:187], v112 offset:35840
    s_waitcnt lgkmcnt(6)
    v_mfma_f32_32x32x16_bf16 v[176:191], a[204:207], a[92:95], v[176:191]
    ds_read_b64_tr_b16 a[188:189], v113 offset:34816
    ds_read_b64_tr_b16 a[190:191], v113 offset:35840
    s_waitcnt lgkmcnt(6)
    v_mfma_f32_32x32x16_bf16 v[160:175], a[176:179], a[96:99], v[160:175]
    ds_read_b64_tr_b16 a[192:193], v112 offset:36864
    ds_read_b64_tr_b16 a[194:195], v112 offset:37888
    s_waitcnt lgkmcnt(6)
    v_mfma_f32_32x32x16_bf16 v[176:191], a[180:183], a[96:99], v[176:191]
    ds_read_b64_tr_b16 a[196:197], v113 offset:36864
    ds_read_b64_tr_b16 a[198:199], v113 offset:37888
    s_add_u32 m0, s42, 65536
    s_mov_b32 s43, 115328
    buffer_load_dwordx4 v14, s[32:35], s43 offen offset:0 lds
    s_waitcnt lgkmcnt(6)
    v_mfma_f32_32x32x16_bf16 v[160:175], a[184:187], a[100:103], v[160:175]
    ds_read_b64_tr_b16 a[200:201], v112 offset:38912
    ds_read_b64_tr_b16 a[202:203], v112 offset:39936
    s_waitcnt lgkmcnt(6)
    v_mfma_f32_32x32x16_bf16 v[176:191], a[188:191], a[100:103], v[176:191]
    ds_read_b64_tr_b16 a[204:205], v113 offset:38912
    ds_read_b64_tr_b16 a[206:207], v113 offset:39936
    s_waitcnt lgkmcnt(6)
    v_mfma_f32_32x32x16_bf16 v[160:175], a[192:195], a[104:107], v[160:175]
    ds_read_b64_tr_b16 a[176:177], v112 offset:40960
    ds_read_b64_tr_b16 a[178:179], v112 offset:41984
    s_waitcnt lgkmcnt(6)
    v_mfma_f32_32x32x16_bf16 v[176:191], a[196:199], a[104:107], v[176:191]
    ds_read_b64_tr_b16 a[180:181], v113 offset:40960
    ds_read_b64_tr_b16 a[182:183], v113 offset:41984
    s_mov_b32 s43, 121472
    buffer_load_dwordx4 v14, s[32:35], s43 offen offset:1024 lds
    s_waitcnt lgkmcnt(6)
    v_mfma_f32_32x32x16_bf16 v[160:175], a[200:203], a[108:111], v[160:175]
    ds_read_b64_tr_b16 a[184:185], v112 offset:43008
    ds_read_b64_tr_b16 a[186:187], v112 offset:44032
    s_waitcnt lgkmcnt(6)
    v_mfma_f32_32x32x16_bf16 v[176:191], a[204:207], a[108:111], v[176:191]
    ds_read_b64_tr_b16 a[188:189], v113 offset:43008
    ds_read_b64_tr_b16 a[190:191], v113 offset:44032
    s_waitcnt lgkmcnt(6)
    v_mfma_f32_32x32x16_bf16 v[160:175], a[176:179], a[112:115], v[160:175]
    ds_read_b64_tr_b16 a[192:193], v112 offset:45056
    ds_read_b64_tr_b16 a[194:195], v112 offset:46080
    s_waitcnt lgkmcnt(6)
    v_mfma_f32_32x32x16_bf16 v[176:191], a[180:183], a[112:115], v[176:191]
    ds_read_b64_tr_b16 a[196:197], v113 offset:45056
    ds_read_b64_tr_b16 a[198:199], v113 offset:46080
    s_mov_b32 s43, 127616
    buffer_load_dwordx4 v14, s[32:35], s43 offen offset:2048 lds
    s_waitcnt lgkmcnt(6)
    v_mfma_f32_32x32x16_bf16 v[160:175], a[184:187], a[116:119], v[160:175]
    ds_read_b64_tr_b16 a[200:201], v112 offset:47104
    ds_read_b64_tr_b16 a[202:203], v112 offset:48128
    s_waitcnt lgkmcnt(6)
    v_mfma_f32_32x32x16_bf16 v[176:191], a[188:191], a[116:119], v[176:191]
    ds_read_b64_tr_b16 a[204:205], v113 offset:47104
    ds_read_b64_tr_b16 a[206:207], v113 offset:48128
    s_waitcnt lgkmcnt(6)
    v_mfma_f32_32x32x16_bf16 v[160:175], a[192:195], a[120:123], v[160:175]
    s_waitcnt vmcnt(35)
    s_barrier
    ds_read_b64_tr_b16 a[176:177], v112 offset:49152
    ds_read_b64_tr_b16 a[178:179], v112 offset:50176
    s_waitcnt lgkmcnt(6)
    v_mfma_f32_32x32x16_bf16 v[176:191], a[196:199], a[120:123], v[176:191]
    ds_read_b64_tr_b16 a[180:181], v113 offset:49152
    ds_read_b64_tr_b16 a[182:183], v113 offset:50176
    s_mov_b32 s43, 133760
    buffer_load_dwordx4 v14, s[32:35], s43 offen offset:3072 lds
    s_waitcnt lgkmcnt(6)
    v_mfma_f32_32x32x16_bf16 v[160:175], a[200:203], a[124:127], v[160:175]
    ds_read_b64_tr_b16 a[184:185], v112 offset:51200
    ds_read_b64_tr_b16 a[186:187], v112 offset:52224
    s_waitcnt lgkmcnt(6)
    v_mfma_f32_32x32x16_bf16 v[176:191], a[204:207], a[124:127], v[176:191]
    ds_read_b64_tr_b16 a[188:189], v113 offset:51200
    ds_read_b64_tr_b16 a[190:191], v113 offset:52224
    s_mov_b32 s47, 3584
    s_waitcnt lgkmcnt(6)
    v_mfma_f32_32x32x16_bf16 v[128:143], a[176:179], a[64:67], 0
    ds_read_b64_tr_b16 a[192:193], v112 offset:53248
    ds_read_b64_tr_b16 a[194:195], v112 offset:54272
    s_waitcnt lgkmcnt(6)
    v_mfma_f32_32x32x16_bf16 v[144:159], a[180:183], a[64:67], 0
    ds_read_b64_tr_b16 a[196:197], v113 offset:53248
    ds_read_b64_tr_b16 a[198:199], v113 offset:54272
    s_add_u32 m0, s42, 81920
    s_mov_b32 s43, 768
    buffer_load_dwordx4 v14, s[32:35], s43 offen offset:0 lds
    v_cvt_pk_bf16_f32 v160, v160, v161
    s_waitcnt lgkmcnt(6)
    v_mfma_f32_32x32x16_bf16 v[128:143], a[184:187], a[68:71], v[128:143]
    ds_read_b64_tr_b16 a[200:201], v112 offset:55296
    ds_read_b64_tr_b16 a[202:203], v112 offset:56320
    v_cvt_pk_bf16_f32 v161, v162, v163
    v_cvt_pk_bf16_f32 v162, v164, v165
    v_cvt_pk_bf16_f32 v163, v166, v167
    s_waitcnt lgkmcnt(6)
    v_mfma_f32_32x32x16_bf16 v[144:159], a[188:191], a[68:71], v[144:159]
    ds_read_b64_tr_b16 a[204:205], v113 offset:55296
    ds_read_b64_tr_b16 a[206:207], v113 offset:56320
    buffer_store_dwordx2 v[160:161], v15, s[36:39], s47 offen sc1
    buffer_store_dwordx2 v[162:163], v125, s[36:39], s47 offen sc1
    s_waitcnt lgkmcnt(6)
    v_mfma_f32_32x32x16_bf16 v[128:143], a[192:195], a[72:75], v[128:143]
    ds_read_b64_tr_b16 a[176:177], v112 offset:57344
    ds_read_b64_tr_b16 a[178:179], v112 offset:58368
    v_cvt_pk_bf16_f32 v168, v168, v169
    v_cvt_pk_bf16_f32 v169, v170, v171
    v_cvt_pk_bf16_f32 v170, v172, v173
    v_cvt_pk_bf16_f32 v171, v174, v175
    s_waitcnt lgkmcnt(6)
    v_mfma_f32_32x32x16_bf16 v[144:159], a[196:199], a[72:75], v[144:159]
    ds_read_b64_tr_b16 a[180:181], v113 offset:57344
    ds_read_b64_tr_b16 a[182:183], v113 offset:58368
    s_mov_b32 s43, 6912
    buffer_load_dwordx4 v14, s[32:35], s43 offen offset:1024 lds
    buffer_store_dwordx2 v[168:169], v127, s[36:39], s47 offen sc1
    s_waitcnt lgkmcnt(6)
    v_mfma_f32_32x32x16_bf16 v[128:143], a[200:203], a[76:79], v[128:143]
    ds_read_b64_tr_b16 a[184:185], v112 offset:59392
    ds_read_b64_tr_b16 a[186:187], v112 offset:60416
    buffer_store_dwordx2 v[170:171], v0, s[36:39], s47 offen sc1
    s_mov_b32 s47, 53760
    v_cvt_pk_bf16_f32 v176, v176, v177
    s_waitcnt lgkmcnt(6)
    v_mfma_f32_32x32x16_bf16 v[144:159], a[204:207], a[76:79], v[144:159]
    ds_read_b64_tr_b16 a[188:189], v113 offset:59392
    ds_read_b64_tr_b16 a[190:191], v113 offset:60416
    v_cvt_pk_bf16_f32 v177, v178, v179
    v_cvt_pk_bf16_f32 v178, v180, v181
    v_cvt_pk_bf16_f32 v179, v182, v183
    s_waitcnt lgkmcnt(6)
    v_mfma_f32_32x32x16_bf16 v[128:143], a[176:179], a[80:83], v[128:143]
    ds_read_b64_tr_b16 a[192:193], v112 offset:61440
    ds_read_b64_tr_b16 a[194:195], v112 offset:62464
    buffer_store_dwordx2 v[176:177], v15, s[36:39], s47 offen sc1
    buffer_store_dwordx2 v[178:179], v125, s[36:39], s47 offen sc1
    s_waitcnt lgkmcnt(6)
    v_mfma_f32_32x32x16_bf16 v[144:159], a[180:183], a[80:83], v[144:159]
    ds_read_b64_tr_b16 a[196:197], v113 offset:61440
    ds_read_b64_tr_b16 a[198:199], v113 offset:62464
    s_mov_b32 s43, 13056
    buffer_load_dwordx4 v14, s[32:35], s43 offen offset:2048 lds
    v_cvt_pk_bf16_f32 v184, v184, v185
    v_cvt_pk_bf16_f32 v185, v186, v187
    s_waitcnt lgkmcnt(6)
    v_mfma_f32_32x32x16_bf16 v[128:143], a[184:187], a[84:87], v[128:143]
    ds_read_b64_tr_b16 a[200:201], v112 offset:63488
    ds_read_b64_tr_b16 a[202:203], v112 offset:64512
    v_cvt_pk_bf16_f32 v186, v188, v189
    v_cvt_pk_bf16_f32 v187, v190, v191
    buffer_store_dwordx2 v[184:185], v127, s[36:39], s47 offen sc1
    s_waitcnt lgkmcnt(6)
    v_mfma_f32_32x32x16_bf16 v[144:159], a[188:191], a[84:87], v[144:159]
    ds_read_b64_tr_b16 a[204:205], v113 offset:63488
    ds_read_b64_tr_b16 a[206:207], v113 offset:64512
    buffer_store_dwordx2 v[186:187], v0, s[36:39], s47 offen sc1
    s_waitcnt lgkmcnt(6)
    v_mfma_f32_32x32x16_bf16 v[128:143], a[192:195], a[88:91], v[128:143]
    s_waitcnt vmcnt(43)
    s_barrier
    v_add_u32 v112, 0x10000, v112
    ds_read_b64_tr_b16 a[176:177], v112 offset:0
    ds_read_b64_tr_b16 a[178:179], v112 offset:1024
    s_waitcnt lgkmcnt(6)
    v_mfma_f32_32x32x16_bf16 v[144:159], a[196:199], a[88:91], v[144:159]
    v_add_u32 v113, 0x10000, v113
    ds_read_b64_tr_b16 a[180:181], v113 offset:0
    ds_read_b64_tr_b16 a[182:183], v113 offset:1024
    s_mov_b32 s43, 19200
    buffer_load_dwordx4 v14, s[32:35], s43 offen offset:3072 lds
    s_waitcnt lgkmcnt(6)
    v_mfma_f32_32x32x16_bf16 v[128:143], a[200:203], a[92:95], v[128:143]
    ds_read_b64_tr_b16 a[184:185], v112 offset:2048
    ds_read_b64_tr_b16 a[186:187], v112 offset:3072
    s_waitcnt lgkmcnt(6)
    v_mfma_f32_32x32x16_bf16 v[144:159], a[204:207], a[92:95], v[144:159]
    ds_read_b64_tr_b16 a[188:189], v113 offset:2048
    ds_read_b64_tr_b16 a[190:191], v113 offset:3072
    s_waitcnt lgkmcnt(6)
    v_mfma_f32_32x32x16_bf16 v[128:143], a[176:179], a[96:99], v[128:143]
    ds_read_b64_tr_b16 a[192:193], v112 offset:4096
    ds_read_b64_tr_b16 a[194:195], v112 offset:5120
    s_waitcnt lgkmcnt(6)
    v_mfma_f32_32x32x16_bf16 v[144:159], a[180:183], a[96:99], v[144:159]
    ds_read_b64_tr_b16 a[196:197], v113 offset:4096
    ds_read_b64_tr_b16 a[198:199], v113 offset:5120
    s_add_u32 m0, s42, 98304
    s_mov_b32 s43, 115456
    buffer_load_dwordx4 v14, s[32:35], s43 offen offset:0 lds
    s_waitcnt lgkmcnt(6)
    v_mfma_f32_32x32x16_bf16 v[128:143], a[184:187], a[100:103], v[128:143]
    ds_read_b64_tr_b16 a[200:201], v112 offset:6144
    ds_read_b64_tr_b16 a[202:203], v112 offset:7168
    s_waitcnt lgkmcnt(6)
    v_mfma_f32_32x32x16_bf16 v[144:159], a[188:191], a[100:103], v[144:159]
    ds_read_b64_tr_b16 a[204:205], v113 offset:6144
    ds_read_b64_tr_b16 a[206:207], v113 offset:7168
    s_waitcnt lgkmcnt(6)
    v_mfma_f32_32x32x16_bf16 v[128:143], a[192:195], a[104:107], v[128:143]
    ds_read_b64_tr_b16 a[176:177], v112 offset:8192
    ds_read_b64_tr_b16 a[178:179], v112 offset:9216
    s_waitcnt lgkmcnt(6)
    v_mfma_f32_32x32x16_bf16 v[144:159], a[196:199], a[104:107], v[144:159]
    ds_read_b64_tr_b16 a[180:181], v113 offset:8192
    ds_read_b64_tr_b16 a[182:183], v113 offset:9216
    s_mov_b32 s43, 121600
    buffer_load_dwordx4 v14, s[32:35], s43 offen offset:1024 lds
    s_waitcnt lgkmcnt(6)
    v_mfma_f32_32x32x16_bf16 v[128:143], a[200:203], a[108:111], v[128:143]
    ds_read_b64_tr_b16 a[184:185], v112 offset:10240
    ds_read_b64_tr_b16 a[186:187], v112 offset:11264
    s_waitcnt lgkmcnt(6)
    v_mfma_f32_32x32x16_bf16 v[144:159], a[204:207], a[108:111], v[144:159]
    ds_read_b64_tr_b16 a[188:189], v113 offset:10240
    ds_read_b64_tr_b16 a[190:191], v113 offset:11264
    s_waitcnt lgkmcnt(6)
    v_mfma_f32_32x32x16_bf16 v[128:143], a[176:179], a[112:115], v[128:143]
    ds_read_b64_tr_b16 a[192:193], v112 offset:12288
    ds_read_b64_tr_b16 a[194:195], v112 offset:13312
    s_waitcnt lgkmcnt(6)
    v_mfma_f32_32x32x16_bf16 v[144:159], a[180:183], a[112:115], v[144:159]
    ds_read_b64_tr_b16 a[196:197], v113 offset:12288
    ds_read_b64_tr_b16 a[198:199], v113 offset:13312
    s_mov_b32 s43, 127744
    buffer_load_dwordx4 v14, s[32:35], s43 offen offset:2048 lds
    s_waitcnt lgkmcnt(6)
    v_mfma_f32_32x32x16_bf16 v[128:143], a[184:187], a[116:119], v[128:143]
    ds_read_b64_tr_b16 a[200:201], v112 offset:14336
    ds_read_b64_tr_b16 a[202:203], v112 offset:15360
    s_waitcnt lgkmcnt(6)
    v_mfma_f32_32x32x16_bf16 v[144:159], a[188:191], a[116:119], v[144:159]
    ds_read_b64_tr_b16 a[204:205], v113 offset:14336
    ds_read_b64_tr_b16 a[206:207], v113 offset:15360
    s_waitcnt lgkmcnt(6)
    v_mfma_f32_32x32x16_bf16 v[128:143], a[192:195], a[120:123], v[128:143]
    s_waitcnt vmcnt(43)
    s_barrier
    ds_read_b64_tr_b16 a[176:177], v112 offset:16384
    ds_read_b64_tr_b16 a[178:179], v112 offset:17408
    s_waitcnt lgkmcnt(6)
    v_mfma_f32_32x32x16_bf16 v[144:159], a[196:199], a[120:123], v[144:159]
    ds_read_b64_tr_b16 a[180:181], v113 offset:16384
    ds_read_b64_tr_b16 a[182:183], v113 offset:17408
    s_mov_b32 s43, 133888
    buffer_load_dwordx4 v14, s[32:35], s43 offen offset:3072 lds
    s_waitcnt lgkmcnt(6)
    v_mfma_f32_32x32x16_bf16 v[128:143], a[200:203], a[124:127], v[128:143]
    ds_read_b64_tr_b16 a[184:185], v112 offset:18432
    ds_read_b64_tr_b16 a[186:187], v112 offset:19456
    s_waitcnt lgkmcnt(6)
    v_mfma_f32_32x32x16_bf16 v[144:159], a[204:207], a[124:127], v[144:159]
    ds_read_b64_tr_b16 a[188:189], v113 offset:18432
    ds_read_b64_tr_b16 a[190:191], v113 offset:19456
    s_mov_b32 s47, 7168
    s_waitcnt lgkmcnt(6)
    v_mfma_f32_32x32x16_bf16 v[160:175], a[176:179], a[64:67], 0
    ds_read_b64_tr_b16 a[192:193], v112 offset:20480
    ds_read_b64_tr_b16 a[194:195], v112 offset:21504
    s_waitcnt lgkmcnt(6)
    v_mfma_f32_32x32x16_bf16 v[176:191], a[180:183], a[64:67], 0
    ds_read_b64_tr_b16 a[196:197], v113 offset:20480
    ds_read_b64_tr_b16 a[198:199], v113 offset:21504
    v_cvt_pk_bf16_f32 v128, v128, v129
    v_cvt_pk_bf16_f32 v129, v130, v131
    v_cvt_pk_bf16_f32 v130, v132, v133
    v_cvt_pk_bf16_f32 v131, v134, v135
    s_waitcnt lgkmcnt(6)
    v_mfma_f32_32x32x16_bf16 v[160:175], a[184:187], a[68:71], v[160:175]
    ds_read_b64_tr_b16 a[200:201], v112 offset:22528
    ds_read_b64_tr_b16 a[202:203], v112 offset:23552
    buffer_store_dwordx2 v[128:129], v15, s[36:39], s47 offen sc1
    buffer_store_dwordx2 v[130:131], v125, s[36:39], s47 offen sc1
    s_waitcnt lgkmcnt(6)
    v_mfma_f32_32x32x16_bf16 v[176:191], a[188:191], a[68:71], v[176:191]
    ds_read_b64_tr_b16 a[204:205], v113 offset:22528
    ds_read_b64_tr_b16 a[206:207], v113 offset:23552
    v_cvt_pk_bf16_f32 v136, v136, v137
    v_cvt_pk_bf16_f32 v137, v138, v139
    v_cvt_pk_bf16_f32 v138, v140, v141
    v_cvt_pk_bf16_f32 v139, v142, v143
    s_waitcnt lgkmcnt(6)
    v_mfma_f32_32x32x16_bf16 v[160:175], a[192:195], a[72:75], v[160:175]
    ds_read_b64_tr_b16 a[176:177], v112 offset:24576
    ds_read_b64_tr_b16 a[178:179], v112 offset:25600
    buffer_store_dwordx2 v[136:137], v127, s[36:39], s47 offen sc1
    buffer_store_dwordx2 v[138:139], v0, s[36:39], s47 offen sc1
    s_waitcnt lgkmcnt(6)
    v_mfma_f32_32x32x16_bf16 v[176:191], a[196:199], a[72:75], v[176:191]
    ds_read_b64_tr_b16 a[180:181], v113 offset:24576
    ds_read_b64_tr_b16 a[182:183], v113 offset:25600
    s_mov_b32 s47, 57344
    v_cvt_pk_bf16_f32 v144, v144, v145
    v_cvt_pk_bf16_f32 v145, v146, v147
    v_cvt_pk_bf16_f32 v146, v148, v149
    s_waitcnt lgkmcnt(6)
    v_mfma_f32_32x32x16_bf16 v[160:175], a[200:203], a[76:79], v[160:175]
    ds_read_b64_tr_b16 a[184:185], v112 offset:26624
    ds_read_b64_tr_b16 a[186:187], v112 offset:27648
    v_cvt_pk_bf16_f32 v147, v150, v151
    buffer_store_dwordx2 v[144:145], v15, s[36:39], s47 offen sc1
    s_waitcnt lgkmcnt(6)
    v_mfma_f32_32x32x16_bf16 v[176:191], a[204:207], a[76:79], v[176:191]
    ds_read_b64_tr_b16 a[188:189], v113 offset:26624
    ds_read_b64_tr_b16 a[190:191], v113 offset:27648
    buffer_store_dwordx2 v[146:147], v125, s[36:39], s47 offen sc1
    v_cvt_pk_bf16_f32 v152, v152, v153
    v_cvt_pk_bf16_f32 v153, v154, v155
    s_waitcnt lgkmcnt(6)
    v_mfma_f32_32x32x16_bf16 v[160:175], a[176:179], a[80:83], v[160:175]
    ds_read_b64_tr_b16 a[192:193], v112 offset:28672
    ds_read_b64_tr_b16 a[194:195], v112 offset:29696
    v_cvt_pk_bf16_f32 v154, v156, v157
    v_cvt_pk_bf16_f32 v155, v158, v159
    buffer_store_dwordx2 v[152:153], v127, s[36:39], s47 offen sc1
    s_waitcnt lgkmcnt(6)
    v_mfma_f32_32x32x16_bf16 v[176:191], a[180:183], a[80:83], v[176:191]
    ds_read_b64_tr_b16 a[196:197], v113 offset:28672
    ds_read_b64_tr_b16 a[198:199], v113 offset:29696
    buffer_store_dwordx2 v[154:155], v0, s[36:39], s47 offen sc1
    s_waitcnt lgkmcnt(6)
    v_mfma_f32_32x32x16_bf16 v[160:175], a[184:187], a[84:87], v[160:175]
    ds_read_b64_tr_b16 a[200:201], v112 offset:30720
    ds_read_b64_tr_b16 a[202:203], v112 offset:31744
    s_waitcnt lgkmcnt(6)
    v_mfma_f32_32x32x16_bf16 v[176:191], a[188:191], a[84:87], v[176:191]
    ds_read_b64_tr_b16 a[204:205], v113 offset:30720
    ds_read_b64_tr_b16 a[206:207], v113 offset:31744
    s_waitcnt lgkmcnt(6)
    v_mfma_f32_32x32x16_bf16 v[160:175], a[192:195], a[88:91], v[160:175]
    s_waitcnt vmcnt(48)
    s_barrier
    v_add_u32 v112, 0xfffe0000, v112
    ds_read_b64_tr_b16 a[176:177], v112 offset:0
    ds_read_b64_tr_b16 a[178:179], v112 offset:1024
    s_waitcnt lgkmcnt(6)
    v_mfma_f32_32x32x16_bf16 v[176:191], a[196:199], a[88:91], v[176:191]
    v_add_u32 v113, 0xfffe0000, v113
    ds_read_b64_tr_b16 a[180:181], v113 offset:0
    ds_read_b64_tr_b16 a[182:183], v113 offset:1024
    s_waitcnt lgkmcnt(6)
    v_mfma_f32_32x32x16_bf16 v[160:175], a[200:203], a[92:95], v[160:175]
    ds_read_b64_tr_b16 a[184:185], v112 offset:2048
    ds_read_b64_tr_b16 a[186:187], v112 offset:3072
    s_waitcnt lgkmcnt(6)
    v_mfma_f32_32x32x16_bf16 v[176:191], a[204:207], a[92:95], v[176:191]
    ds_read_b64_tr_b16 a[188:189], v113 offset:2048
    ds_read_b64_tr_b16 a[190:191], v113 offset:3072
    s_waitcnt lgkmcnt(6)
    v_mfma_f32_32x32x16_bf16 v[160:175], a[176:179], a[96:99], v[160:175]
    ds_read_b64_tr_b16 a[192:193], v112 offset:4096
    ds_read_b64_tr_b16 a[194:195], v112 offset:5120
    s_waitcnt lgkmcnt(6)
    v_mfma_f32_32x32x16_bf16 v[176:191], a[180:183], a[96:99], v[176:191]
    ds_read_b64_tr_b16 a[196:197], v113 offset:4096
    ds_read_b64_tr_b16 a[198:199], v113 offset:5120
    s_waitcnt lgkmcnt(6)
    v_mfma_f32_32x32x16_bf16 v[160:175], a[184:187], a[100:103], v[160:175]
    ds_read_b64_tr_b16 a[200:201], v112 offset:6144
    ds_read_b64_tr_b16 a[202:203], v112 offset:7168
    s_waitcnt lgkmcnt(6)
    v_mfma_f32_32x32x16_bf16 v[176:191], a[188:191], a[100:103], v[176:191]
    ds_read_b64_tr_b16 a[204:205], v113 offset:6144
    ds_read_b64_tr_b16 a[206:207], v113 offset:7168
    s_waitcnt lgkmcnt(6)
    v_mfma_f32_32x32x16_bf16 v[160:175], a[192:195], a[104:107], v[160:175]
    ds_read_b64_tr_b16 a[176:177], v112 offset:8192
    ds_read_b64_tr_b16 a[178:179], v112 offset:9216
    s_waitcnt lgkmcnt(6)
    v_mfma_f32_32x32x16_bf16 v[176:191], a[196:199], a[104:107], v[176:191]
    ds_read_b64_tr_b16 a[180:181], v113 offset:8192
    ds_read_b64_tr_b16 a[182:183], v113 offset:9216
    s_waitcnt lgkmcnt(6)
    v_mfma_f32_32x32x16_bf16 v[160:175], a[200:203], a[108:111], v[160:175]
    ds_read_b64_tr_b16 a[184:185], v112 offset:10240
    ds_read_b64_tr_b16 a[186:187], v112 offset:11264
    s_waitcnt lgkmcnt(6)
    v_mfma_f32_32x32x16_bf16 v[176:191], a[204:207], a[108:111], v[176:191]
    ds_read_b64_tr_b16 a[188:189], v113 offset:10240
    ds_read_b64_tr_b16 a[190:191], v113 offset:11264
    s_waitcnt lgkmcnt(6)
    v_mfma_f32_32x32x16_bf16 v[160:175], a[176:179], a[112:115], v[160:175]
    ds_read_b64_tr_b16 a[192:193], v112 offset:12288
    ds_read_b64_tr_b16 a[194:195], v112 offset:13312
    s_waitcnt lgkmcnt(6)
    v_mfma_f32_32x32x16_bf16 v[176:191], a[180:183], a[112:115], v[176:191]
    ds_read_b64_tr_b16 a[196:197], v113 offset:12288
    ds_read_b64_tr_b16 a[198:199], v113 offset:13312
    s_waitcnt lgkmcnt(6)
    v_mfma_f32_32x32x16_bf16 v[160:175], a[184:187], a[116:119], v[160:175]
    ds_read_b64_tr_b16 a[200:201], v112 offset:14336
    ds_read_b64_tr_b16 a[202:203], v112 offset:15360
    s_waitcnt lgkmcnt(6)
    v_mfma_f32_32x32x16_bf16 v[176:191], a[188:191], a[116:119], v[176:191]
    ds_read_b64_tr_b16 a[204:205], v113 offset:14336
    ds_read_b64_tr_b16 a[206:207], v113 offset:15360
    s_waitcnt lgkmcnt(6)
    v_mfma_f32_32x32x16_bf16 v[160:175], a[192:195], a[120:123], v[160:175]
    s_waitcnt vmcnt(44)
    s_barrier
    ds_read_b64_tr_b16 a[176:177], v112 offset:16384
    ds_read_b64_tr_b16 a[178:179], v112 offset:17408
    s_waitcnt lgkmcnt(6)
    v_mfma_f32_32x32x16_bf16 v[176:191], a[196:199], a[120:123], v[176:191]
    ds_read_b64_tr_b16 a[180:181], v113 offset:16384
    ds_read_b64_tr_b16 a[182:183], v113 offset:17408
    s_waitcnt lgkmcnt(6)
    v_mfma_f32_32x32x16_bf16 v[160:175], a[200:203], a[124:127], v[160:175]
    ds_read_b64_tr_b16 a[184:185], v112 offset:18432
    ds_read_b64_tr_b16 a[186:187], v112 offset:19456
    s_waitcnt lgkmcnt(6)
    v_mfma_f32_32x32x16_bf16 v[176:191], a[204:207], a[124:127], v[176:191]
    ds_read_b64_tr_b16 a[188:189], v113 offset:18432
    ds_read_b64_tr_b16 a[190:191], v113 offset:19456
    s_mov_b32 s47, 10752
    s_waitcnt lgkmcnt(6)
    v_mfma_f32_32x32x16_bf16 v[128:143], a[176:179], a[64:67], 0
    ds_read_b64_tr_b16 a[192:193], v112 offset:20480
    ds_read_b64_tr_b16 a[194:195], v112 offset:21504
    s_waitcnt lgkmcnt(6)
    v_mfma_f32_32x32x16_bf16 v[144:159], a[180:183], a[64:67], 0
    ds_read_b64_tr_b16 a[196:197], v113 offset:20480
    ds_read_b64_tr_b16 a[198:199], v113 offset:21504
    v_cvt_pk_bf16_f32 v160, v160, v161
    v_cvt_pk_bf16_f32 v161, v162, v163
    v_cvt_pk_bf16_f32 v162, v164, v165
    v_cvt_pk_bf16_f32 v163, v166, v167
    s_waitcnt lgkmcnt(6)
    v_mfma_f32_32x32x16_bf16 v[128:143], a[184:187], a[68:71], v[128:143]
    ds_read_b64_tr_b16 a[200:201], v112 offset:22528
    ds_read_b64_tr_b16 a[202:203], v112 offset:23552
    buffer_store_dwordx2 v[160:161], v15, s[36:39], s47 offen sc1
    buffer_store_dwordx2 v[162:163], v125, s[36:39], s47 offen sc1
    s_waitcnt lgkmcnt(6)
    v_mfma_f32_32x32x16_bf16 v[144:159], a[188:191], a[68:71], v[144:159]
    ds_read_b64_tr_b16 a[204:205], v113 offset:22528
    ds_read_b64_tr_b16 a[206:207], v113 offset:23552
    v_cvt_pk_bf16_f32 v168, v168, v169
    v_cvt_pk_bf16_f32 v169, v170, v171
    v_cvt_pk_bf16_f32 v170, v172, v173
    v_cvt_pk_bf16_f32 v171, v174, v175
    s_waitcnt lgkmcnt(6)
    v_mfma_f32_32x32x16_bf16 v[128:143], a[192:195], a[72:75], v[128:143]
    ds_read_b64_tr_b16 a[176:177], v112 offset:24576
    ds_read_b64_tr_b16 a[178:179], v112 offset:25600
    buffer_store_dwordx2 v[168:169], v127, s[36:39], s47 offen sc1
    buffer_store_dwordx2 v[170:171], v0, s[36:39], s47 offen sc1
    s_waitcnt lgkmcnt(6)
    v_mfma_f32_32x32x16_bf16 v[144:159], a[196:199], a[72:75], v[144:159]
    ds_read_b64_tr_b16 a[180:181], v113 offset:24576
    ds_read_b64_tr_b16 a[182:183], v113 offset:25600
    s_mov_b32 s47, 60928
    v_cvt_pk_bf16_f32 v176, v176, v177
    v_cvt_pk_bf16_f32 v177, v178, v179
    v_cvt_pk_bf16_f32 v178, v180, v181
    s_waitcnt lgkmcnt(6)
    v_mfma_f32_32x32x16_bf16 v[128:143], a[200:203], a[76:79], v[128:143]
    ds_read_b64_tr_b16 a[184:185], v112 offset:26624
    ds_read_b64_tr_b16 a[186:187], v112 offset:27648
    v_cvt_pk_bf16_f32 v179, v182, v183
    buffer_store_dwordx2 v[176:177], v15, s[36:39], s47 offen sc1
    s_waitcnt lgkmcnt(6)
    v_mfma_f32_32x32x16_bf16 v[144:159], a[204:207], a[76:79], v[144:159]
    ds_read_b64_tr_b16 a[188:189], v113 offset:26624
    ds_read_b64_tr_b16 a[190:191], v113 offset:27648
    buffer_store_dwordx2 v[178:179], v125, s[36:39], s47 offen sc1
    v_cvt_pk_bf16_f32 v184, v184, v185
    v_cvt_pk_bf16_f32 v185, v186, v187
    s_waitcnt lgkmcnt(6)
    v_mfma_f32_32x32x16_bf16 v[128:143], a[176:179], a[80:83], v[128:143]
    ds_read_b64_tr_b16 a[192:193], v112 offset:28672
    ds_read_b64_tr_b16 a[194:195], v112 offset:29696
    v_cvt_pk_bf16_f32 v186, v188, v189
    v_cvt_pk_bf16_f32 v187, v190, v191
    buffer_store_dwordx2 v[184:185], v127, s[36:39], s47 offen sc1
    s_waitcnt lgkmcnt(6)
    v_mfma_f32_32x32x16_bf16 v[144:159], a[180:183], a[80:83], v[144:159]
    ds_read_b64_tr_b16 a[196:197], v113 offset:28672
    ds_read_b64_tr_b16 a[198:199], v113 offset:29696
    buffer_store_dwordx2 v[186:187], v0, s[36:39], s47 offen sc1
    s_waitcnt lgkmcnt(6)
    v_mfma_f32_32x32x16_bf16 v[128:143], a[184:187], a[84:87], v[128:143]
    ds_read_b64_tr_b16 a[200:201], v112 offset:30720
    ds_read_b64_tr_b16 a[202:203], v112 offset:31744
    s_waitcnt lgkmcnt(6)
    v_mfma_f32_32x32x16_bf16 v[144:159], a[188:191], a[84:87], v[144:159]
    ds_read_b64_tr_b16 a[204:205], v113 offset:30720
    ds_read_b64_tr_b16 a[206:207], v113 offset:31744
    s_waitcnt lgkmcnt(6)
    v_mfma_f32_32x32x16_bf16 v[128:143], a[192:195], a[88:91], v[128:143]
    s_waitcnt vmcnt(48)
    s_barrier
    ds_read_b64_tr_b16 a[176:177], v112 offset:32768
    ds_read_b64_tr_b16 a[178:179], v112 offset:33792
    s_waitcnt lgkmcnt(6)
    v_mfma_f32_32x32x16_bf16 v[144:159], a[196:199], a[88:91], v[144:159]
    ds_read_b64_tr_b16 a[180:181], v113 offset:32768
    ds_read_b64_tr_b16 a[182:183], v113 offset:33792
    s_waitcnt lgkmcnt(6)
    v_mfma_f32_32x32x16_bf16 v[128:143], a[200:203], a[92:95], v[128:143]
    ds_read_b64_tr_b16 a[184:185], v112 offset:34816
    ds_read_b64_tr_b16 a[186:187], v112 offset:35840
    s_waitcnt lgkmcnt(6)
    v_mfma_f32_32x32x16_bf16 v[144:159], a[204:207], a[92:95], v[144:159]
    ds_read_b64_tr_b16 a[188:189], v113 offset:34816
    ds_read_b64_tr_b16 a[190:191], v113 offset:35840
    s_waitcnt lgkmcnt(6)
    v_mfma_f32_32x32x16_bf16 v[128:143], a[176:179], a[96:99], v[128:143]
    ds_read_b64_tr_b16 a[192:193], v112 offset:36864
    ds_read_b64_tr_b16 a[194:195], v112 offset:37888
    s_waitcnt lgkmcnt(6)
    v_mfma_f32_32x32x16_bf16 v[144:159], a[180:183], a[96:99], v[144:159]
    ds_read_b64_tr_b16 a[196:197], v113 offset:36864
    ds_read_b64_tr_b16 a[198:199], v113 offset:37888
    s_waitcnt lgkmcnt(6)
    v_mfma_f32_32x32x16_bf16 v[128:143], a[184:187], a[100:103], v[128:143]
    ds_read_b64_tr_b16 a[200:201], v112 offset:38912
    ds_read_b64_tr_b16 a[202:203], v112 offset:39936
    s_waitcnt lgkmcnt(6)
    v_mfma_f32_32x32x16_bf16 v[144:159], a[188:191], a[100:103], v[144:159]
    ds_read_b64_tr_b16 a[204:205], v113 offset:38912
    ds_read_b64_tr_b16 a[206:207], v113 offset:39936
    s_waitcnt lgkmcnt(6)
    v_mfma_f32_32x32x16_bf16 v[128:143], a[192:195], a[104:107], v[128:143]
    ds_read_b64_tr_b16 a[176:177], v112 offset:40960
    ds_read_b64_tr_b16 a[178:179], v112 offset:41984
    s_waitcnt lgkmcnt(6)
    v_mfma_f32_32x32x16_bf16 v[144:159], a[196:199], a[104:107], v[144:159]
    ds_read_b64_tr_b16 a[180:181], v113 offset:40960
    ds_read_b64_tr_b16 a[182:183], v113 offset:41984
    s_waitcnt lgkmcnt(6)
    v_mfma_f32_32x32x16_bf16 v[128:143], a[200:203], a[108:111], v[128:143]
    ds_read_b64_tr_b16 a[184:185], v112 offset:43008
    ds_read_b64_tr_b16 a[186:187], v112 offset:44032
    s_waitcnt lgkmcnt(6)
    v_mfma_f32_32x32x16_bf16 v[144:159], a[204:207], a[108:111], v[144:159]
    ds_read_b64_tr_b16 a[188:189], v113 offset:43008
    ds_read_b64_tr_b16 a[190:191], v113 offset:44032
    s_waitcnt lgkmcnt(6)
    v_mfma_f32_32x32x16_bf16 v[128:143], a[176:179], a[112:115], v[128:143]
    ds_read_b64_tr_b16 a[192:193], v112 offset:45056
    ds_read_b64_tr_b16 a[194:195], v112 offset:46080
    s_waitcnt lgkmcnt(6)
    v_mfma_f32_32x32x16_bf16 v[144:159], a[180:183], a[112:115], v[144:159]
    ds_read_b64_tr_b16 a[196:197], v113 offset:45056
    ds_read_b64_tr_b16 a[198:199], v113 offset:46080
    s_waitcnt lgkmcnt(6)
    v_mfma_f32_32x32x16_bf16 v[128:143], a[184:187], a[116:119], v[128:143]
    ds_read_b64_tr_b16 a[200:201], v112 offset:47104
    ds_read_b64_tr_b16 a[202:203], v112 offset:48128
    s_waitcnt lgkmcnt(6)
    v_mfma_f32_32x32x16_bf16 v[144:159], a[188:191], a[116:119], v[144:159]
    ds_read_b64_tr_b16 a[204:205], v113 offset:47104
    ds_read_b64_tr_b16 a[206:207], v113 offset:48128
    s_waitcnt lgkmcnt(6)
    v_mfma_f32_32x32x16_bf16 v[128:143], a[192:195], a[120:123], v[128:143]
    s_waitcnt vmcnt(36)
    s_barrier
    ds_read_b64_tr_b16 a[176:177], v112 offset:49152
    ds_read_b64_tr_b16 a[178:179], v112 offset:50176
    s_waitcnt lgkmcnt(6)
    v_mfma_f32_32x32x16_bf16 v[144:159], a[196:199], a[120:123], v[144:159]
    ds_read_b64_tr_b16 a[180:181], v113 offset:49152
    ds_read_b64_tr_b16 a[182:183], v113 offset:50176
    s_waitcnt lgkmcnt(6)
    v_mfma_f32_32x32x16_bf16 v[128:143], a[200:203], a[124:127], v[128:143]
    ds_read_b64_tr_b16 a[184:185], v112 offset:51200
    ds_read_b64_tr_b16 a[186:187], v112 offset:52224
    s_waitcnt lgkmcnt(6)
    v_mfma_f32_32x32x16_bf16 v[144:159], a[204:207], a[124:127], v[144:159]
    ds_read_b64_tr_b16 a[188:189], v113 offset:51200
    ds_read_b64_tr_b16 a[190:191], v113 offset:52224
    s_mov_b32 s47, 14336
    s_waitcnt lgkmcnt(6)
    v_mfma_f32_32x32x16_bf16 v[160:175], a[176:179], a[64:67], 0
    ds_read_b64_tr_b16 a[192:193], v112 offset:53248
    ds_read_b64_tr_b16 a[194:195], v112 offset:54272
    s_waitcnt lgkmcnt(6)
    v_mfma_f32_32x32x16_bf16 v[176:191], a[180:183], a[64:67], 0
    ds_read_b64_tr_b16 a[196:197], v113 offset:53248
    ds_read_b64_tr_b16 a[198:199], v113 offset:54272
    v_cvt_pk_bf16_f32 v128, v128, v129
    v_cvt_pk_bf16_f32 v129, v130, v131
    v_cvt_pk_bf16_f32 v130, v132, v133
    v_cvt_pk_bf16_f32 v131, v134, v135
    s_waitcnt lgkmcnt(6)
    v_mfma_f32_32x32x16_bf16 v[160:175], a[184:187], a[68:71], v[160:175]
    ds_read_b64_tr_b16 a[200:201], v112 offset:55296
    ds_read_b64_tr_b16 a[202:203], v112 offset:56320
    buffer_store_dwordx2 v[128:129], v15, s[36:39], s47 offen sc1
    buffer_store_dwordx2 v[130:131], v125, s[36:39], s47 offen sc1
    s_waitcnt lgkmcnt(6)
    v_mfma_f32_32x32x16_bf16 v[176:191], a[188:191], a[68:71], v[176:191]
    ds_read_b64_tr_b16 a[204:205], v113 offset:55296
    ds_read_b64_tr_b16 a[206:207], v113 offset:56320
    v_cvt_pk_bf16_f32 v136, v136, v137
    v_cvt_pk_bf16_f32 v137, v138, v139
    v_cvt_pk_bf16_f32 v138, v140, v141
    v_cvt_pk_bf16_f32 v139, v142, v143
    s_waitcnt lgkmcnt(6)
    v_mfma_f32_32x32x16_bf16 v[160:175], a[192:195], a[72:75], v[160:175]
    ds_read_b64_tr_b16 a[176:177], v112 offset:57344
    ds_read_b64_tr_b16 a[178:179], v112 offset:58368
    buffer_store_dwordx2 v[136:137], v127, s[36:39], s47 offen sc1
    buffer_store_dwordx2 v[138:139], v0, s[36:39], s47 offen sc1
    s_waitcnt lgkmcnt(6)
    v_mfma_f32_32x32x16_bf16 v[176:191], a[196:199], a[72:75], v[176:191]
    ds_read_b64_tr_b16 a[180:181], v113 offset:57344
    ds_read_b64_tr_b16 a[182:183], v113 offset:58368
    s_mov_b32 s47, 64512
    v_cvt_pk_bf16_f32 v144, v144, v145
    v_cvt_pk_bf16_f32 v145, v146, v147
    v_cvt_pk_bf16_f32 v146, v148, v149
    s_waitcnt lgkmcnt(6)
    v_mfma_f32_32x32x16_bf16 v[160:175], a[200:203], a[76:79], v[160:175]
    ds_read_b64_tr_b16 a[184:185], v112 offset:59392
    ds_read_b64_tr_b16 a[186:187], v112 offset:60416
    v_cvt_pk_bf16_f32 v147, v150, v151
    buffer_store_dwordx2 v[144:145], v15, s[36:39], s47 offen sc1
    s_waitcnt lgkmcnt(6)
    v_mfma_f32_32x32x16_bf16 v[176:191], a[204:207], a[76:79], v[176:191]
    ds_read_b64_tr_b16 a[188:189], v113 offset:59392
    ds_read_b64_tr_b16 a[190:191], v113 offset:60416
    buffer_store_dwordx2 v[146:147], v125, s[36:39], s47 offen sc1
    v_cvt_pk_bf16_f32 v152, v152, v153
    v_cvt_pk_bf16_f32 v153, v154, v155
    s_waitcnt lgkmcnt(6)
    v_mfma_f32_32x32x16_bf16 v[160:175], a[176:179], a[80:83], v[160:175]
    ds_read_b64_tr_b16 a[192:193], v112 offset:61440
    ds_read_b64_tr_b16 a[194:195], v112 offset:62464
    v_cvt_pk_bf16_f32 v154, v156, v157
    v_cvt_pk_bf16_f32 v155, v158, v159
    buffer_store_dwordx2 v[152:153], v127, s[36:39], s47 offen sc1
    s_waitcnt lgkmcnt(6)
    v_mfma_f32_32x32x16_bf16 v[176:191], a[180:183], a[80:83], v[176:191]
    ds_read_b64_tr_b16 a[196:197], v113 offset:61440
    ds_read_b64_tr_b16 a[198:199], v113 offset:62464
    buffer_store_dwordx2 v[154:155], v0, s[36:39], s47 offen sc1
    s_waitcnt lgkmcnt(6)
    v_mfma_f32_32x32x16_bf16 v[160:175], a[184:187], a[84:87], v[160:175]
    ds_read_b64_tr_b16 a[200:201], v112 offset:63488
    ds_read_b64_tr_b16 a[202:203], v112 offset:64512
    s_waitcnt lgkmcnt(6)
    v_mfma_f32_32x32x16_bf16 v[176:191], a[188:191], a[84:87], v[176:191]
    ds_read_b64_tr_b16 a[204:205], v113 offset:63488
    ds_read_b64_tr_b16 a[206:207], v113 offset:64512
    s_waitcnt lgkmcnt(6)
    v_mfma_f32_32x32x16_bf16 v[160:175], a[192:195], a[88:91], v[160:175]
    s_waitcnt vmcnt(40)
    s_barrier
    v_add_u32 v112, 0x10000, v112
    ds_read_b64_tr_b16 a[176:177], v112 offset:0
    ds_read_b64_tr_b16 a[178:179], v112 offset:1024
    s_waitcnt lgkmcnt(6)
    v_mfma_f32_32x32x16_bf16 v[176:191], a[196:199], a[88:91], v[176:191]
    v_add_u32 v113, 0x10000, v113
    ds_read_b64_tr_b16 a[180:181], v113 offset:0
    ds_read_b64_tr_b16 a[182:183], v113 offset:1024
    s_waitcnt lgkmcnt(6)
    v_mfma_f32_32x32x16_bf16 v[160:175], a[200:203], a[92:95], v[160:175]
    ds_read_b64_tr_b16 a[184:185], v112 offset:2048
    ds_read_b64_tr_b16 a[186:187], v112 offset:3072
    s_waitcnt lgkmcnt(6)
    v_mfma_f32_32x32x16_bf16 v[176:191], a[204:207], a[92:95], v[176:191]
    ds_read_b64_tr_b16 a[188:189], v113 offset:2048
    ds_read_b64_tr_b16 a[190:191], v113 offset:3072
    s_waitcnt lgkmcnt(6)
    v_mfma_f32_32x32x16_bf16 v[160:175], a[176:179], a[96:99], v[160:175]
    ds_read_b64_tr_b16 a[192:193], v112 offset:4096
    ds_read_b64_tr_b16 a[194:195], v112 offset:5120
    s_waitcnt lgkmcnt(6)
    v_mfma_f32_32x32x16_bf16 v[176:191], a[180:183], a[96:99], v[176:191]
    ds_read_b64_tr_b16 a[196:197], v113 offset:4096
    ds_read_b64_tr_b16 a[198:199], v113 offset:5120
    s_waitcnt lgkmcnt(6)
    v_mfma_f32_32x32x16_bf16 v[160:175], a[184:187], a[100:103], v[160:175]
    ds_read_b64_tr_b16 a[200:201], v112 offset:6144
    ds_read_b64_tr_b16 a[202:203], v112 offset:7168
    s_waitcnt lgkmcnt(6)
    v_mfma_f32_32x32x16_bf16 v[176:191], a[188:191], a[100:103], v[176:191]
    ds_read_b64_tr_b16 a[204:205], v113 offset:6144
    ds_read_b64_tr_b16 a[206:207], v113 offset:7168
    s_waitcnt lgkmcnt(6)
    v_mfma_f32_32x32x16_bf16 v[160:175], a[192:195], a[104:107], v[160:175]
    ds_read_b64_tr_b16 a[176:177], v112 offset:8192
    ds_read_b64_tr_b16 a[178:179], v112 offset:9216
    s_waitcnt lgkmcnt(6)
    v_mfma_f32_32x32x16_bf16 v[176:191], a[196:199], a[104:107], v[176:191]
    ds_read_b64_tr_b16 a[180:181], v113 offset:8192
    ds_read_b64_tr_b16 a[182:183], v113 offset:9216
    s_waitcnt lgkmcnt(6)
    v_mfma_f32_32x32x16_bf16 v[160:175], a[200:203], a[108:111], v[160:175]
    ds_read_b64_tr_b16 a[184:185], v112 offset:10240
    ds_read_b64_tr_b16 a[186:187], v112 offset:11264
    s_waitcnt lgkmcnt(6)
    v_mfma_f32_32x32x16_bf16 v[176:191], a[204:207], a[108:111], v[176:191]
    ds_read_b64_tr_b16 a[188:189], v113 offset:10240
    ds_read_b64_tr_b16 a[190:191], v113 offset:11264
    s_waitcnt lgkmcnt(6)
    v_mfma_f32_32x32x16_bf16 v[160:175], a[176:179], a[112:115], v[160:175]
    ds_read_b64_tr_b16 a[192:193], v112 offset:12288
    ds_read_b64_tr_b16 a[194:195], v112 offset:13312
    s_waitcnt lgkmcnt(6)
    v_mfma_f32_32x32x16_bf16 v[176:191], a[180:183], a[112:115], v[176:191]
    ds_read_b64_tr_b16 a[196:197], v113 offset:12288
    ds_read_b64_tr_b16 a[198:199], v113 offset:13312
    s_waitcnt lgkmcnt(6)
    v_mfma_f32_32x32x16_bf16 v[160:175], a[184:187], a[116:119], v[160:175]
    ds_read_b64_tr_b16 a[200:201], v112 offset:14336
    ds_read_b64_tr_b16 a[202:203], v112 offset:15360
    s_waitcnt lgkmcnt(6)
    v_mfma_f32_32x32x16_bf16 v[176:191], a[188:191], a[116:119], v[176:191]
    ds_read_b64_tr_b16 a[204:205], v113 offset:14336
    ds_read_b64_tr_b16 a[206:207], v113 offset:15360
    s_waitcnt lgkmcnt(6)
    v_mfma_f32_32x32x16_bf16 v[160:175], a[192:195], a[120:123], v[160:175]
    s_waitcnt vmcnt(28)
    s_barrier
    ds_read_b64_tr_b16 a[176:177], v112 offset:16384
    ds_read_b64_tr_b16 a[178:179], v112 offset:17408
    s_waitcnt lgkmcnt(6)
    v_mfma_f32_32x32x16_bf16 v[176:191], a[196:199], a[120:123], v[176:191]
    ds_read_b64_tr_b16 a[180:181], v113 offset:16384
    ds_read_b64_tr_b16 a[182:183], v113 offset:17408
    s_waitcnt lgkmcnt(6)
    v_mfma_f32_32x32x16_bf16 v[160:175], a[200:203], a[124:127], v[160:175]
    ds_read_b64_tr_b16 a[184:185], v112 offset:18432
    ds_read_b64_tr_b16 a[186:187], v112 offset:19456
    s_waitcnt lgkmcnt(6)
    v_mfma_f32_32x32x16_bf16 v[176:191], a[204:207], a[124:127], v[176:191]
    ds_read_b64_tr_b16 a[188:189], v113 offset:18432
    ds_read_b64_tr_b16 a[190:191], v113 offset:19456
    s_mov_b32 s47, 17920
    s_waitcnt lgkmcnt(6)
    v_mfma_f32_32x32x16_bf16 v[128:143], a[176:179], a[64:67], 0
    ds_read_b64_tr_b16 a[192:193], v112 offset:20480
    ds_read_b64_tr_b16 a[194:195], v112 offset:21504
    s_waitcnt lgkmcnt(6)
    v_mfma_f32_32x32x16_bf16 v[144:159], a[180:183], a[64:67], 0
    ds_read_b64_tr_b16 a[196:197], v113 offset:20480
    ds_read_b64_tr_b16 a[198:199], v113 offset:21504
    v_cvt_pk_bf16_f32 v160, v160, v161
    v_cvt_pk_bf16_f32 v161, v162, v163
    v_cvt_pk_bf16_f32 v162, v164, v165
    v_cvt_pk_bf16_f32 v163, v166, v167
    s_waitcnt lgkmcnt(6)
    v_mfma_f32_32x32x16_bf16 v[128:143], a[184:187], a[68:71], v[128:143]
    ds_read_b64_tr_b16 a[200:201], v112 offset:22528
    ds_read_b64_tr_b16 a[202:203], v112 offset:23552
    buffer_store_dwordx2 v[160:161], v15, s[36:39], s47 offen sc1
    buffer_store_dwordx2 v[162:163], v125, s[36:39], s47 offen sc1
    s_waitcnt lgkmcnt(6)
    v_mfma_f32_32x32x16_bf16 v[144:159], a[188:191], a[68:71], v[144:159]
    ds_read_b64_tr_b16 a[204:205], v113 offset:22528
    ds_read_b64_tr_b16 a[206:207], v113 offset:23552
    v_cvt_pk_bf16_f32 v168, v168, v169
    v_cvt_pk_bf16_f32 v169, v170, v171
    v_cvt_pk_bf16_f32 v170, v172, v173
    v_cvt_pk_bf16_f32 v171, v174, v175
    s_waitcnt lgkmcnt(6)
    v_mfma_f32_32x32x16_bf16 v[128:143], a[192:195], a[72:75], v[128:143]
    ds_read_b64_tr_b16 a[176:177], v112 offset:24576
    ds_read_b64_tr_b16 a[178:179], v112 offset:25600
    buffer_store_dwordx2 v[168:169], v127, s[36:39], s47 offen sc1
    buffer_store_dwordx2 v[170:171], v0, s[36:39], s47 offen sc1
    s_waitcnt lgkmcnt(6)
    v_mfma_f32_32x32x16_bf16 v[144:159], a[196:199], a[72:75], v[144:159]
    ds_read_b64_tr_b16 a[180:181], v113 offset:24576
    ds_read_b64_tr_b16 a[182:183], v113 offset:25600
    s_mov_b32 s47, 68096
    v_cvt_pk_bf16_f32 v176, v176, v177
    v_cvt_pk_bf16_f32 v177, v178, v179
    v_cvt_pk_bf16_f32 v178, v180, v181
    s_waitcnt lgkmcnt(6)
    v_mfma_f32_32x32x16_bf16 v[128:143], a[200:203], a[76:79], v[128:143]
    ds_read_b64_tr_b16 a[184:185], v112 offset:26624
    ds_read_b64_tr_b16 a[186:187], v112 offset:27648
    v_cvt_pk_bf16_f32 v179, v182, v183
    buffer_store_dwordx2 v[176:177], v15, s[36:39], s47 offen sc1
    s_waitcnt lgkmcnt(6)
    v_mfma_f32_32x32x16_bf16 v[144:159], a[204:207], a[76:79], v[144:159]
    ds_read_b64_tr_b16 a[188:189], v113 offset:26624
    ds_read_b64_tr_b16 a[190:191], v113 offset:27648
    buffer_store_dwordx2 v[178:179], v125, s[36:39], s47 offen sc1
    v_cvt_pk_bf16_f32 v184, v184, v185
    v_cvt_pk_bf16_f32 v185, v186, v187
    s_waitcnt lgkmcnt(6)
    v_mfma_f32_32x32x16_bf16 v[128:143], a[176:179], a[80:83], v[128:143]
    ds_read_b64_tr_b16 a[192:193], v112 offset:28672
    ds_read_b64_tr_b16 a[194:195], v112 offset:29696
    v_cvt_pk_bf16_f32 v186, v188, v189
    v_cvt_pk_bf16_f32 v187, v190, v191
    buffer_store_dwordx2 v[184:185], v127, s[36:39], s47 offen sc1
    s_waitcnt lgkmcnt(6)
    v_mfma_f32_32x32x16_bf16 v[144:159], a[180:183], a[80:83], v[144:159]
    ds_read_b64_tr_b16 a[196:197], v113 offset:28672
    ds_read_b64_tr_b16 a[198:199], v113 offset:29696
    buffer_store_dwordx2 v[186:187], v0, s[36:39], s47 offen sc1
    s_waitcnt lgkmcnt(6)
    v_mfma_f32_32x32x16_bf16 v[128:143], a[184:187], a[84:87], v[128:143]
    ds_read_b64_tr_b16 a[200:201], v112 offset:30720
    ds_read_b64_tr_b16 a[202:203], v112 offset:31744
    s_waitcnt lgkmcnt(6)
    v_mfma_f32_32x32x16_bf16 v[144:159], a[188:191], a[84:87], v[144:159]
    ds_read_b64_tr_b16 a[204:205], v113 offset:30720
    ds_read_b64_tr_b16 a[206:207], v113 offset:31744
    s_waitcnt lgkmcnt(6)
    v_mfma_f32_32x32x16_bf16 v[128:143], a[192:195], a[88:91], v[128:143]
    s_waitcnt vmcnt(32)
    s_barrier
    ds_read_b64_tr_b16 a[176:177], v112 offset:32768
    ds_read_b64_tr_b16 a[178:179], v112 offset:33792
    s_waitcnt lgkmcnt(6)
    v_mfma_f32_32x32x16_bf16 v[144:159], a[196:199], a[88:91], v[144:159]
    ds_read_b64_tr_b16 a[180:181], v113 offset:32768
    ds_read_b64_tr_b16 a[182:183], v113 offset:33792
    s_waitcnt lgkmcnt(6)
    v_mfma_f32_32x32x16_bf16 v[128:143], a[200:203], a[92:95], v[128:143]
    ds_read_b64_tr_b16 a[184:185], v112 offset:34816
    ds_read_b64_tr_b16 a[186:187], v112 offset:35840
    s_waitcnt lgkmcnt(6)
    v_mfma_f32_32x32x16_bf16 v[144:159], a[204:207], a[92:95], v[144:159]
    ds_read_b64_tr_b16 a[188:189], v113 offset:34816
    ds_read_b64_tr_b16 a[190:191], v113 offset:35840
    s_waitcnt lgkmcnt(6)
    v_mfma_f32_32x32x16_bf16 v[128:143], a[176:179], a[96:99], v[128:143]
    ds_read_b64_tr_b16 a[192:193], v112 offset:36864
    ds_read_b64_tr_b16 a[194:195], v112 offset:37888
    s_waitcnt lgkmcnt(6)
    v_mfma_f32_32x32x16_bf16 v[144:159], a[180:183], a[96:99], v[144:159]
    ds_read_b64_tr_b16 a[196:197], v113 offset:36864
    ds_read_b64_tr_b16 a[198:199], v113 offset:37888
    s_waitcnt lgkmcnt(6)
    v_mfma_f32_32x32x16_bf16 v[128:143], a[184:187], a[100:103], v[128:143]
    ds_read_b64_tr_b16 a[200:201], v112 offset:38912
    ds_read_b64_tr_b16 a[202:203], v112 offset:39936
    s_waitcnt lgkmcnt(6)
    v_mfma_f32_32x32x16_bf16 v[144:159], a[188:191], a[100:103], v[144:159]
    ds_read_b64_tr_b16 a[204:205], v113 offset:38912
    ds_read_b64_tr_b16 a[206:207], v113 offset:39936
    s_waitcnt lgkmcnt(6)
    v_mfma_f32_32x32x16_bf16 v[128:143], a[192:195], a[104:107], v[128:143]
    ds_read_b64_tr_b16 a[176:177], v112 offset:40960
    ds_read_b64_tr_b16 a[178:179], v112 offset:41984
    s_waitcnt lgkmcnt(6)
    v_mfma_f32_32x32x16_bf16 v[144:159], a[196:199], a[104:107], v[144:159]
    ds_read_b64_tr_b16 a[180:181], v113 offset:40960
    ds_read_b64_tr_b16 a[182:183], v113 offset:41984
    s_waitcnt lgkmcnt(6)
    v_mfma_f32_32x32x16_bf16 v[128:143], a[200:203], a[108:111], v[128:143]
    ds_read_b64_tr_b16 a[184:185], v112 offset:43008
    ds_read_b64_tr_b16 a[186:187], v112 offset:44032
    s_waitcnt lgkmcnt(6)
    v_mfma_f32_32x32x16_bf16 v[144:159], a[204:207], a[108:111], v[144:159]
    ds_read_b64_tr_b16 a[188:189], v113 offset:43008
    ds_read_b64_tr_b16 a[190:191], v113 offset:44032
    s_waitcnt lgkmcnt(6)
    v_mfma_f32_32x32x16_bf16 v[128:143], a[176:179], a[112:115], v[128:143]
    ds_read_b64_tr_b16 a[192:193], v112 offset:45056
    ds_read_b64_tr_b16 a[194:195], v112 offset:46080
    s_waitcnt lgkmcnt(6)
    v_mfma_f32_32x32x16_bf16 v[144:159], a[180:183], a[112:115], v[144:159]
    ds_read_b64_tr_b16 a[196:197], v113 offset:45056
    ds_read_b64_tr_b16 a[198:199], v113 offset:46080
    s_waitcnt lgkmcnt(6)
    v_mfma_f32_32x32x16_bf16 v[128:143], a[184:187], a[116:119], v[128:143]
    ds_read_b64_tr_b16 a[200:201], v112 offset:47104
    ds_read_b64_tr_b16 a[202:203], v112 offset:48128
    s_waitcnt lgkmcnt(6)
    v_mfma_f32_32x32x16_bf16 v[144:159], a[188:191], a[116:119], v[144:159]
    ds_read_b64_tr_b16 a[204:205], v113 offset:47104
    ds_read_b64_tr_b16 a[206:207], v113 offset:48128
    s_waitcnt lgkmcnt(6)
    v_mfma_f32_32x32x16_bf16 v[128:143], a[192:195], a[120:123], v[128:143]
    s_waitcnt lgkmcnt(4)
    v_mfma_f32_32x32x16_bf16 v[144:159], a[196:199], a[120:123], v[144:159]
    s_waitcnt lgkmcnt(2)
    v_mfma_f32_32x32x16_bf16 v[128:143], a[200:203], a[124:127], v[128:143]
    s_waitcnt lgkmcnt(0)
    v_mfma_f32_32x32x16_bf16 v[144:159], a[204:207], a[124:127], v[144:159]
    s_mov_b32 s47, 21504
    s_nop 8
    v_cvt_pk_bf16_f32 v128, v128, v129
    v_cvt_pk_bf16_f32 v129, v130, v131
    v_cvt_pk_bf16_f32 v130, v132, v133
    v_cvt_pk_bf16_f32 v131, v134, v135
    buffer_store_dwordx2 v[128:129], v15, s[36:39], s47 offen sc1
    buffer_store_dwordx2 v[130:131], v125, s[36:39], s47 offen sc1
    v_cvt_pk_bf16_f32 v136, v136, v137
    v_cvt_pk_bf16_f32 v137, v138, v139
    v_cvt_pk_bf16_f32 v138, v140, v141
    v_cvt_pk_bf16_f32 v139, v142, v143
    buffer_store_dwordx2 v[136:137], v127, s[36:39], s47 offen sc1
    buffer_store_dwordx2 v[138:139], v0, s[36:39], s47 offen sc1
    s_mov_b32 s47, 71680
    v_cvt_pk_bf16_f32 v144, v144, v145
    v_cvt_pk_bf16_f32 v145, v146, v147
    v_cvt_pk_bf16_f32 v146, v148, v149
    v_cvt_pk_bf16_f32 v147, v150, v151
    buffer_store_dwordx2 v[144:145], v15, s[36:39], s47 offen sc1
    buffer_store_dwordx2 v[146:147], v125, s[36:39], s47 offen sc1
    v_cvt_pk_bf16_f32 v152, v152, v153
    v_cvt_pk_bf16_f32 v153, v154, v155
    v_cvt_pk_bf16_f32 v154, v156, v157
    v_cvt_pk_bf16_f32 v155, v158, v159
    buffer_store_dwordx2 v[152:153], v127, s[36:39], s47 offen sc1
    buffer_store_dwordx2 v[154:155], v0, s[36:39], s47 offen sc1
    s_branch L_ftail
LF_stub1:
    s_call_b64 s[40:41], LF_fix
    s_branch LF_ret1
LF_stub2:
    s_call_b64 s[40:41], LF_fix
    s_branch LF_ret2
LF_stub3:
    s_call_b64 s[40:41], LF_fix
    s_branch LF_ret3
LF_stub4:
    s_call_b64 s[40:41], LF_fix
    s_branch LF_ret4
LF_stub5:
    s_call_b64 s[40:41], LF_fix
    s_branch LF_ret5
LF_stub6:
    s_call_b64 s[40:41], LF_fix
    s_branch LF_ret6
LF_stub7:
    s_call_b64 s[40:41], LF_fix
    s_branch LF_ret7
LF_stub8:
    s_call_b64 s[40:41], LF_fix
    s_branch LF_ret8
LF_stub9:
    s_call_b64 s[40:41], LF_fix
    s_branch LF_ret9
LF_stub10:
    s_call_b64 s[40:41], LF_fix
    s_branch LF_ret10
LF_stub11:
    s_call_b64 s[40:41], LF_fix
    s_branch LF_ret11
LF_stub12:
    s_call_b64 s[40:41], LF_fix
    s_branch LF_ret12
LF_stub13:
    s_call_b64 s[40:41], LF_fix
    s_branch LF_ret13
LF_stub14:
    s_call_b64 s[40:41], LF_fix
    s_branch LF_ret14
LF_stub15:
    s_call_b64 s[40:41], LF_fix
    s_branch LF_ret15
LF_fix:
    s_nop 15
    s_nop 15
    v_mov_b32 v120, v119
    s_nop 1
    v_permlane32_swap_b32 v119, v120
    v_max3_f32 v119, v119, v120, 0
    v_ceil_f32 v119, v119
    v_sub_f32 v121, 0, v119
    v_exp_f32 v121, v121
    v_sub_f32 v64, v64, v119
    v_sub_f32 v65, v65, v119
    v_sub_f32 v66, v66, v119
    v_sub_f32 v67, v67, v119
    v_sub_f32 v68, v68, v119
    v_sub_f32 v69, v69, v119
    v_sub_f32 v70, v70, v119
    v_sub_f32 v71, v71, v119
    v_sub_f32 v72, v72, v119
    v_sub_f32 v73, v73, v119
    v_sub_f32 v74, v74, v119
    v_sub_f32 v75, v75, v119
    v_sub_f32 v76, v76, v119
    v_sub_f32 v77, v77, v119
    v_sub_f32 v78, v78, v119
    v_sub_f32 v79, v79, v119
    v_sub_f32 v80, v80, v119
    v_sub_f32 v81, v81, v119
    v_sub_f32 v82, v82, v119
    v_sub_f32 v83, v83, v119
    v_sub_f32 v84, v84, v119
    v_sub_f32 v85, v85, v119
    v_sub_f32 v86, v86, v119
    v_sub_f32 v87, v87, v119
    v_sub_f32 v88, v88, v119
    v_sub_f32 v89, v89, v119
    v_sub_f32 v90, v90, v119
    v_sub_f32 v91, v91, v119
    v_sub_f32 v92, v92, v119
    v_sub_f32 v93, v93, v119
    v_sub_f32 v94, v94, v119
    v_sub_f32 v95, v95, v119
    v_sub_f32 v96, v96, v119
    v_sub_f32 v97, v97, v119
    v_sub_f32 v98, v98, v119
    v_sub_f32 v99, v99, v119
    v_sub_f32 v100, v100, v119
    v_sub_f32 v101, v101, v119
    v_sub_f32 v102, v102, v119
    v_sub_f32 v103, v103, v119
    v_sub_f32 v104, v104, v119
    v_sub_f32 v105, v105, v119
    v_sub_f32 v106, v106, v119
    v_sub_f32 v107, v107, v119
    v_sub_f32 v108, v108, v119
    v_sub_f32 v109, v109, v119
    v_sub_f32 v110, v110, v119
    v_sub_f32 v111, v111, v119
    v_mul_f32 v118, v118, v121
    v_mul_f32 v126, v126, v121
    v_mul_f32 v32, v32, v121
    v_mul_f32 v33, v33, v121
    v_mul_f32 v34, v34, v121
    v_mul_f32 v35, v35, v121
    v_mul_f32 v36, v36, v121
    v_mul_f32 v37, v37, v121
    v_mul_f32 v38, v38, v121
    v_mul_f32 v39, v39, v121
    v_mul_f32 v40, v40, v121
    v_mul_f32 v41, v41, v121
    v_mul_f32 v42, v42, v121
    v_mul_f32 v43, v43, v121
    v_mul_f32 v44, v44, v121
    v_mul_f32 v45, v45, v121
    v_mul_f32 v46, v46, v121
    v_mul_f32 v47, v47, v121
    v_mul_f32 v48, v48, v121
    v_mul_f32 v49, v49, v121
    v_mul_f32 v50, v50, v121
    v_mul_f32 v51, v51, v121
    v_mul_f32 v52, v52, v121
    v_mul_f32 v53, v53, v121
    v_mul_f32 v54, v54, v121
    v_mul_f32 v55, v55, v121
    v_mul_f32 v56, v56, v121
    v_mul_f32 v57, v57, v121
    v_mul_f32 v58, v58, v121
    v_mul_f32 v59, v59, v121
    v_mul_f32 v60, v60, v121
    v_mul_f32 v61, v61, v121
    v_mul_f32 v62, v62, v121
    v_mul_f32 v63, v63, v121
    v_lshlrev_b32 v123, 16, v128
    v_and_b32 v124, 0xffff0000, v128
    v_mul_f32 v123, v123, v121
    v_mul_f32 v124, v124, v121
    v_cvt_pk_bf16_f32 v128, v123, v124
    v_lshlrev_b32 v123, 16, v129
    v_and_b32 v124, 0xffff0000, v129
    v_mul_f32 v123, v123, v121
    v_mul_f32 v124, v124, v121
    v_cvt_pk_bf16_f32 v129, v123, v124
    v_lshlrev_b32 v123, 16, v130
    v_and_b32 v124, 0xffff0000, v130
    v_mul_f32 v123, v123, v121
    v_mul_f32 v124, v124, v121
    v_cvt_pk_bf16_f32 v130, v123, v124
    v_lshlrev_b32 v123, 16, v131
    v_and_b32 v124, 0xffff0000, v131
    v_mul_f32 v123, v123, v121
    v_mul_f32 v124, v124, v121
    v_cvt_pk_bf16_f32 v131, v123, v124
    v_lshlrev_b32 v123, 16, v132
    v_and_b32 v124, 0xffff0000, v132
    v_mul_f32 v123, v123, v121
    v_mul_f32 v124, v124, v121
    v_cvt_pk_bf16_f32 v132, v123, v124
    v_lshlrev_b32 v123, 16, v133
    v_and_b32 v124, 0xffff0000, v133
    v_mul_f32 v123, v123, v121
    v_mul_f32 v124, v124, v121
    v_cvt_pk_bf16_f32 v133, v123, v124
    v_lshlrev_b32 v123, 16, v134
    v_and_b32 v124, 0xffff0000, v134
    v_mul_f32 v123, v123, v121
    v_mul_f32 v124, v124, v121
    v_cvt_pk_bf16_f32 v134, v123, v124
    v_lshlrev_b32 v123, 16, v135
    v_and_b32 v124, 0xffff0000, v135
    v_mul_f32 v123, v123, v121
    v_mul_f32 v124, v124, v121
    v_cvt_pk_bf16_f32 v135, v123, v124
    v_lshlrev_b32 v123, 16, v136
    v_and_b32 v124, 0xffff0000, v136
    v_mul_f32 v123, v123, v121
    v_mul_f32 v124, v124, v121
    v_cvt_pk_bf16_f32 v136, v123, v124
    v_lshlrev_b32 v123, 16, v137
    v_and_b32 v124, 0xffff0000, v137
    v_mul_f32 v123, v123, v121
    v_mul_f32 v124, v124, v121
    v_cvt_pk_bf16_f32 v137, v123, v124
    v_lshlrev_b32 v123, 16, v138
    v_and_b32 v124, 0xffff0000, v138
    v_mul_f32 v123, v123, v121
    v_mul_f32 v124, v124, v121
    v_cvt_pk_bf16_f32 v138, v123, v124
    v_lshlrev_b32 v123, 16, v139
    v_and_b32 v124, 0xffff0000, v139
    v_mul_f32 v123, v123, v121
    v_mul_f32 v124, v124, v121
    v_cvt_pk_bf16_f32 v139, v123, v124
    v_lshlrev_b32 v123, 16, v140
    v_and_b32 v124, 0xffff0000, v140
    v_mul_f32 v123, v123, v121
    v_mul_f32 v124, v124, v121
    v_cvt_pk_bf16_f32 v140, v123, v124
    v_lshlrev_b32 v123, 16, v141
    v_and_b32 v124, 0xffff0000, v141
    v_mul_f32 v123, v123, v121
    v_mul_f32 v124, v124, v121
    v_cvt_pk_bf16_f32 v141, v123, v124
    v_lshlrev_b32 v123, 16, v142
    v_and_b32 v124, 0xffff0000, v142
    v_mul_f32 v123, v123, v121
    v_mul_f32 v124, v124, v121
    v_cvt_pk_bf16_f32 v142, v123, v124
    v_lshlrev_b32 v123, 16, v143
    v_and_b32 v124, 0xffff0000, v143
    v_mul_f32 v123, v123, v121
    v_mul_f32 v124, v124, v121
    v_cvt_pk_bf16_f32 v143, v123, v124
    v_lshlrev_b32 v123, 16, v144
    v_and_b32 v124, 0xffff0000, v144
    v_mul_f32 v123, v123, v121
    v_mul_f32 v124, v124, v121
    v_cvt_pk_bf16_f32 v144, v123, v124
    v_lshlrev_b32 v123, 16, v145
    v_and_b32 v124, 0xffff0000, v145
    v_mul_f32 v123, v123, v121
    v_mul_f32 v124, v124, v121
    v_cvt_pk_bf16_f32 v145, v123, v124
    v_lshlrev_b32 v123, 16, v146
    v_and_b32 v124, 0xffff0000, v146
    v_mul_f32 v123, v123, v121
    v_mul_f32 v124, v124, v121
    v_cvt_pk_bf16_f32 v146, v123, v124
    v_lshlrev_b32 v123, 16, v147
    v_and_b32 v124, 0xffff0000, v147
    v_mul_f32 v123, v123, v121
    v_mul_f32 v124, v124, v121
    v_cvt_pk_bf16_f32 v147, v123, v124
    v_lshlrev_b32 v123, 16, v148
    v_and_b32 v124, 0xffff0000, v148
    v_mul_f32 v123, v123, v121
    v_mul_f32 v124, v124, v121
    v_cvt_pk_bf16_f32 v148, v123, v124
    v_lshlrev_b32 v123, 16, v149
    v_and_b32 v124, 0xffff0000, v149
    v_mul_f32 v123, v123, v121
    v_mul_f32 v124, v124, v121
    v_cvt_pk_bf16_f32 v149, v123, v124
    v_lshlrev_b32 v123, 16, v150
    v_and_b32 v124, 0xffff0000, v150
    v_mul_f32 v123, v123, v121
    v_mul_f32 v124, v124, v121
    v_cvt_pk_bf16_f32 v150, v123, v124
    v_lshlrev_b32 v123, 16, v151
    v_and_b32 v124, 0xffff0000, v151
    v_mul_f32 v123, v123, v121
    v_mul_f32 v124, v124, v121
    v_cvt_pk_bf16_f32 v151, v123, v124
    v_lshlrev_b32 v123, 16, v152
    v_and_b32 v124, 0xffff0000, v152
    v_mul_f32 v123, v123, v121
    v_mul_f32 v124, v124, v121
    v_cvt_pk_bf16_f32 v152, v123, v124
    v_lshlrev_b32 v123, 16, v153
    v_and_b32 v124, 0xffff0000, v153
    v_mul_f32 v123, v123, v121
    v_mul_f32 v124, v124, v121
    v_cvt_pk_bf16_f32 v153, v123, v124
    v_lshlrev_b32 v123, 16, v154
    v_and_b32 v124, 0xffff0000, v154
    v_mul_f32 v123, v123, v121
    v_mul_f32 v124, v124, v121
    v_cvt_pk_bf16_f32 v154, v123, v124
    v_lshlrev_b32 v123, 16, v155
    v_and_b32 v124, 0xffff0000, v155
    v_mul_f32 v123, v123, v121
    v_mul_f32 v124, v124, v121
    v_cvt_pk_bf16_f32 v155, v123, v124
    v_lshlrev_b32 v123, 16, v156
    v_and_b32 v124, 0xffff0000, v156
    v_mul_f32 v123, v123, v121
    v_mul_f32 v124, v124, v121
    v_cvt_pk_bf16_f32 v156, v123, v124
    v_lshlrev_b32 v123, 16, v157
    v_and_b32 v124, 0xffff0000, v157
    v_mul_f32 v123, v123, v121
    v_mul_f32 v124, v124, v121
    v_cvt_pk_bf16_f32 v157, v123, v124
    v_lshlrev_b32 v123, 16, v158
    v_and_b32 v124, 0xffff0000, v158
    v_mul_f32 v123, v123, v121
    v_mul_f32 v124, v124, v121
    v_cvt_pk_bf16_f32 v158, v123, v124
    v_lshlrev_b32 v123, 16, v159
    v_and_b32 v124, 0xffff0000, v159
    v_mul_f32 v123, v123, v121
    v_mul_f32 v124, v124, v121
    v_cvt_pk_bf16_f32 v159, v123, v124
    v_lshlrev_b32 v123, 16, v160
    v_and_b32 v124, 0xffff0000, v160
    v_mul_f32 v123, v123, v121
    v_mul_f32 v124, v124, v121
    v_cvt_pk_bf16_f32 v160, v123, v124
    v_lshlrev_b32 v123, 16, v161
    v_and_b32 v124, 0xffff0000, v161
    v_mul_f32 v123, v123, v121
    v_mul_f32 v124, v124, v121
    v_cvt_pk_bf16_f32 v161, v123, v124
    v_lshlrev_b32 v123, 16, v162
    v_and_b32 v124, 0xffff0000, v162
    v_mul_f32 v123, v123, v121
    v_mul_f32 v124, v124, v121
    v_cvt_pk_bf16_f32 v162, v123, v124
    v_lshlrev_b32 v123, 16, v163
    v_and_b32 v124, 0xffff0000, v163
    v_mul_f32 v123, v123, v121
    v_mul_f32 v124, v124, v121
    v_cvt_pk_bf16_f32 v163, v123, v124
    v_lshlrev_b32 v123, 16, v164
    v_and_b32 v124, 0xffff0000, v164
    v_mul_f32 v123, v123, v121
    v_mul_f32 v124, v124, v121
    v_cvt_pk_bf16_f32 v164, v123, v124
    v_lshlrev_b32 v123, 16, v165
    v_and_b32 v124, 0xffff0000, v165
    v_mul_f32 v123, v123, v121
    v_mul_f32 v124, v124, v121
    v_cvt_pk_bf16_f32 v165, v123, v124
    v_lshlrev_b32 v123, 16, v166
    v_and_b32 v124, 0xffff0000, v166
    v_mul_f32 v123, v123, v121
    v_mul_f32 v124, v124, v121
    v_cvt_pk_bf16_f32 v166, v123, v124
    v_lshlrev_b32 v123, 16, v167
    v_and_b32 v124, 0xffff0000, v167
    v_mul_f32 v123, v123, v121
    v_mul_f32 v124, v124, v121
    v_cvt_pk_bf16_f32 v167, v123, v124
    v_lshlrev_b32 v123, 16, v168
    v_and_b32 v124, 0xffff0000, v168
    v_mul_f32 v123, v123, v121
    v_mul_f32 v124, v124, v121
    v_cvt_pk_bf16_f32 v168, v123, v124
    v_lshlrev_b32 v123, 16, v169
    v_and_b32 v124, 0xffff0000, v169
    v_mul_f32 v123, v123, v121
    v_mul_f32 v124, v124, v121
    v_cvt_pk_bf16_f32 v169, v123, v124
    v_lshlrev_b32 v123, 16, v170
    v_and_b32 v124, 0xffff0000, v170
    v_mul_f32 v123, v123, v121
    v_mul_f32 v124, v124, v121
    v_cvt_pk_bf16_f32 v170, v123, v124
    v_lshlrev_b32 v123, 16, v171
    v_and_b32 v124, 0xffff0000, v171
    v_mul_f32 v123, v123, v121
    v_mul_f32 v124, v124, v121
    v_cvt_pk_bf16_f32 v171, v123, v124
    v_lshlrev_b32 v123, 16, v172
    v_and_b32 v124, 0xffff0000, v172
    v_mul_f32 v123, v123, v121
    v_mul_f32 v124, v124, v121
    v_cvt_pk_bf16_f32 v172, v123, v124
    v_lshlrev_b32 v123, 16, v173
    v_and_b32 v124, 0xffff0000, v173
    v_mul_f32 v123, v123, v121
    v_mul_f32 v124, v124, v121
    v_cvt_pk_bf16_f32 v173, v123, v124
    v_lshlrev_b32 v123, 16, v174
    v_and_b32 v124, 0xffff0000, v174
    v_mul_f32 v123, v123, v121
    v_mul_f32 v124, v124, v121
    v_cvt_pk_bf16_f32 v174, v123, v124
    v_lshlrev_b32 v123, 16, v175
    v_and_b32 v124, 0xffff0000, v175
    v_mul_f32 v123, v123, v121
    v_mul_f32 v124, v124, v121
    v_cvt_pk_bf16_f32 v175, v123, v124
    v_lshlrev_b32 v123, 16, v176
    v_and_b32 v124, 0xffff0000, v176
    v_mul_f32 v123, v123, v121
    v_mul_f32 v124, v124, v121
    v_cvt_pk_bf16_f32 v176, v123, v124
    v_lshlrev_b32 v123, 16, v177
    v_and_b32 v124, 0xffff0000, v177
    v_mul_f32 v123, v123, v121
    v_mul_f32 v124, v124, v121
    v_cvt_pk_bf16_f32 v177, v123, v124
    v_lshlrev_b32 v123, 16, v178
    v_and_b32 v124, 0xffff0000, v178
    v_mul_f32 v123, v123, v121
    v_mul_f32 v124, v124, v121
    v_cvt_pk_bf16_f32 v178, v123, v124
    v_lshlrev_b32 v123, 16, v179
    v_and_b32 v124, 0xffff0000, v179
    v_mul_f32 v123, v123, v121
    v_mul_f32 v124, v124, v121
    v_cvt_pk_bf16_f32 v179, v123, v124
    v_lshlrev_b32 v123, 16, v180
    v_and_b32 v124, 0xffff0000, v180
    v_mul_f32 v123, v123, v121
    v_mul_f32 v124, v124, v121
    v_cvt_pk_bf16_f32 v180, v123, v124
    v_lshlrev_b32 v123, 16, v181
    v_and_b32 v124, 0xffff0000, v181
    v_mul_f32 v123, v123, v121
    v_mul_f32 v124, v124, v121
    v_cvt_pk_bf16_f32 v181, v123, v124
    v_lshlrev_b32 v123, 16, v182
    v_and_b32 v124, 0xffff0000, v182
    v_mul_f32 v123, v123, v121
    v_mul_f32 v124, v124, v121
    v_cvt_pk_bf16_f32 v182, v123, v124
    v_lshlrev_b32 v123, 16, v183
    v_and_b32 v124, 0xffff0000, v183
    v_mul_f32 v123, v123, v121
    v_mul_f32 v124, v124, v121
    v_cvt_pk_bf16_f32 v183, v123, v124
    v_lshlrev_b32 v123, 16, v184
    v_and_b32 v124, 0xffff0000, v184
    v_mul_f32 v123, v123, v121
    v_mul_f32 v124, v124, v121
    v_cvt_pk_bf16_f32 v184, v123, v124
    v_lshlrev_b32 v123, 16, v185
    v_and_b32 v124, 0xffff0000, v185
    v_mul_f32 v123, v123, v121
    v_mul_f32 v124, v124, v121
    v_cvt_pk_bf16_f32 v185, v123, v124
    v_lshlrev_b32 v123, 16, v186
    v_and_b32 v124, 0xffff0000, v186
    v_mul_f32 v123, v123, v121
    v_mul_f32 v124, v124, v121
    v_cvt_pk_bf16_f32 v186, v123, v124
    v_lshlrev_b32 v123, 16, v187
    v_and_b32 v124, 0xffff0000, v187
    v_mul_f32 v123, v123, v121
    v_mul_f32 v124, v124, v121
    v_cvt_pk_bf16_f32 v187, v123, v124
    v_lshlrev_b32 v123, 16, v188
    v_and_b32 v124, 0xffff0000, v188
    v_mul_f32 v123, v123, v121
    v_mul_f32 v124, v124, v121
    v_cvt_pk_bf16_f32 v188, v123, v124
    v_lshlrev_b32 v123, 16, v189
    v_and_b32 v124, 0xffff0000, v189
    v_mul_f32 v123, v123, v121
    v_mul_f32 v124, v124, v121
    v_cvt_pk_bf16_f32 v189, v123, v124
    v_lshlrev_b32 v123, 16, v190
    v_and_b32 v124, 0xffff0000, v190
    v_mul_f32 v123, v123, v121
    v_mul_f32 v124, v124, v121
    v_cvt_pk_bf16_f32 v190, v123, v124
    v_lshlrev_b32 v123, 16, v191
    v_and_b32 v124, 0xffff0000, v191
    v_mul_f32 v123, v123, v121
    v_mul_f32 v124, v124, v121
    v_cvt_pk_bf16_f32 v191, v123, v124
    v_lshlrev_b32 v123, 16, v192
    v_and_b32 v124, 0xffff0000, v192
    v_mul_f32 v123, v123, v121
    v_mul_f32 v124, v124, v121
    v_cvt_pk_bf16_f32 v192, v123, v124
    v_lshlrev_b32 v123, 16, v193
    v_and_b32 v124, 0xffff0000, v193
    v_mul_f32 v123, v123, v121
    v_mul_f32 v124, v124, v121
    v_cvt_pk_bf16_f32 v193, v123, v124
    v_lshlrev_b32 v123, 16, v194
    v_and_b32 v124, 0xffff0000, v194
    v_mul_f32 v123, v123, v121
    v_mul_f32 v124, v124, v121
    v_cvt_pk_bf16_f32 v194, v123, v124
    v_lshlrev_b32 v123, 16, v195
    v_and_b32 v124, 0xffff0000, v195
    v_mul_f32 v123, v123, v121
    v_mul_f32 v124, v124, v121
    v_cvt_pk_bf16_f32 v195, v123, v124
    v_lshlrev_b32 v123, 16, v196
    v_and_b32 v124, 0xffff0000, v196
    v_mul_f32 v123, v123, v121
    v_mul_f32 v124, v124, v121
    v_cvt_pk_bf16_f32 v196, v123, v124
    v_lshlrev_b32 v123, 16, v197
    v_and_b32 v124, 0xffff0000, v197
    v_mul_f32 v123, v123, v121
    v_mul_f32 v124, v124, v121
    v_cvt_pk_bf16_f32 v197, v123, v124
    v_lshlrev_b32 v123, 16, v198
    v_and_b32 v124, 0xffff0000, v198
    v_mul_f32 v123, v123, v121
    v_mul_f32 v124, v124, v121
    v_cvt_pk_bf16_f32 v198, v123, v124
    v_lshlrev_b32 v123, 16, v199
    v_and_b32 v124, 0xffff0000, v199
    v_mul_f32 v123, v123, v121
    v_mul_f32 v124, v124, v121
    v_cvt_pk_bf16_f32 v199, v123, v124
    v_lshlrev_b32 v123, 16, v200
    v_and_b32 v124, 0xffff0000, v200
    v_mul_f32 v123, v123, v121
    v_mul_f32 v124, v124, v121
    v_cvt_pk_bf16_f32 v200, v123, v124
    v_lshlrev_b32 v123, 16, v201
    v_and_b32 v124, 0xffff0000, v201
    v_mul_f32 v123, v123, v121
    v_mul_f32 v124, v124, v121
    v_cvt_pk_bf16_f32 v201, v123, v124
    v_lshlrev_b32 v123, 16, v202
    v_and_b32 v124, 0xffff0000, v202
    v_mul_f32 v123, v123, v121
    v_mul_f32 v124, v124, v121
    v_cvt_pk_bf16_f32 v202, v123, v124
    v_lshlrev_b32 v123, 16, v203
    v_and_b32 v124, 0xffff0000, v203
    v_mul_f32 v123, v123, v121
    v_mul_f32 v124, v124, v121
    v_cvt_pk_bf16_f32 v203, v123, v124
    v_lshlrev_b32 v123, 16, v204
    v_and_b32 v124, 0xffff0000, v204
    v_mul_f32 v123, v123, v121
    v_mul_f32 v124, v124, v121
    v_cvt_pk_bf16_f32 v204, v123, v124
    v_lshlrev_b32 v123, 16, v205
    v_and_b32 v124, 0xffff0000, v205
    v_mul_f32 v123, v123, v121
    v_mul_f32 v124, v124, v121
    v_cvt_pk_bf16_f32 v205, v123, v124
    v_lshlrev_b32 v123, 16, v206
    v_and_b32 v124, 0xffff0000, v206
    v_mul_f32 v123, v123, v121
    v_mul_f32 v124, v124, v121
    v_cvt_pk_bf16_f32 v206, v123, v124
    v_lshlrev_b32 v123, 16, v207
    v_and_b32 v124, 0xffff0000, v207
    v_mul_f32 v123, v123, v121
    v_mul_f32 v124, v124, v121
    v_cvt_pk_bf16_f32 v207, v123, v124
    v_lshlrev_b32 v123, 16, v208
    v_and_b32 v124, 0xffff0000, v208
    v_mul_f32 v123, v123, v121
    v_mul_f32 v124, v124, v121
    v_cvt_pk_bf16_f32 v208, v123, v124
    v_lshlrev_b32 v123, 16, v209
    v_and_b32 v124, 0xffff0000, v209
    v_mul_f32 v123, v123, v121
    v_mul_f32 v124, v124, v121
    v_cvt_pk_bf16_f32 v209, v123, v124
    v_lshlrev_b32 v123, 16, v210
    v_and_b32 v124, 0xffff0000, v210
    v_mul_f32 v123, v123, v121
    v_mul_f32 v124, v124, v121
    v_cvt_pk_bf16_f32 v210, v123, v124
    v_lshlrev_b32 v123, 16, v211
    v_and_b32 v124, 0xffff0000, v211
    v_mul_f32 v123, v123, v121
    v_mul_f32 v124, v124, v121
    v_cvt_pk_bf16_f32 v211, v123, v124
    v_lshlrev_b32 v123, 16, v212
    v_and_b32 v124, 0xffff0000, v212
    v_mul_f32 v123, v123, v121
    v_mul_f32 v124, v124, v121
    v_cvt_pk_bf16_f32 v212, v123, v124
    v_lshlrev_b32 v123, 16, v213
    v_and_b32 v124, 0xffff0000, v213
    v_mul_f32 v123, v123, v121
    v_mul_f32 v124, v124, v121
    v_cvt_pk_bf16_f32 v213, v123, v124
    v_lshlrev_b32 v123, 16, v214
    v_and_b32 v124, 0xffff0000, v214
    v_mul_f32 v123, v123, v121
    v_mul_f32 v124, v124, v121
    v_cvt_pk_bf16_f32 v214, v123, v124
    v_lshlrev_b32 v123, 16, v215
    v_and_b32 v124, 0xffff0000, v215
    v_mul_f32 v123, v123, v121
    v_mul_f32 v124, v124, v121
    v_cvt_pk_bf16_f32 v215, v123, v124
    v_lshlrev_b32 v123, 16, v216
    v_and_b32 v124, 0xffff0000, v216
    v_mul_f32 v123, v123, v121
    v_mul_f32 v124, v124, v121
    v_cvt_pk_bf16_f32 v216, v123, v124
    v_lshlrev_b32 v123, 16, v217
    v_and_b32 v124, 0xffff0000, v217
    v_mul_f32 v123, v123, v121
    v_mul_f32 v124, v124, v121
    v_cvt_pk_bf16_f32 v217, v123, v124
    v_lshlrev_b32 v123, 16, v218
    v_and_b32 v124, 0xffff0000, v218
    v_mul_f32 v123, v123, v121
    v_mul_f32 v124, v124, v121
    v_cvt_pk_bf16_f32 v218, v123, v124
    v_lshlrev_b32 v123, 16, v219
    v_and_b32 v124, 0xffff0000, v219
    v_mul_f32 v123, v123, v121
    v_mul_f32 v124, v124, v121
    v_cvt_pk_bf16_f32 v219, v123, v124
    v_lshlrev_b32 v123, 16, v220
    v_and_b32 v124, 0xffff0000, v220
    v_mul_f32 v123, v123, v121
    v_mul_f32 v124, v124, v121
    v_cvt_pk_bf16_f32 v220, v123, v124
    v_lshlrev_b32 v123, 16, v221
    v_and_b32 v124, 0xffff0000, v221
    v_mul_f32 v123, v123, v121
    v_mul_f32 v124, v124, v121
    v_cvt_pk_bf16_f32 v221, v123, v124
    v_lshlrev_b32 v123, 16, v222
    v_and_b32 v124, 0xffff0000, v222
    v_mul_f32 v123, v123, v121
    v_mul_f32 v124, v124, v121
    v_cvt_pk_bf16_f32 v222, v123, v124
    v_lshlrev_b32 v123, 16, v223
    v_and_b32 v124, 0xffff0000, v223
    v_mul_f32 v123, v123, v121
    v_mul_f32 v124, v124, v121
    v_cvt_pk_bf16_f32 v223, v123, v124
    v_lshlrev_b32 v123, 16, v224
    v_and_b32 v124, 0xffff0000, v224
    v_mul_f32 v123, v123, v121
    v_mul_f32 v124, v124, v121
    v_cvt_pk_bf16_f32 v224, v123, v124
    v_lshlrev_b32 v123, 16, v225
    v_and_b32 v124, 0xffff0000, v225
    v_mul_f32 v123, v123, v121
    v_mul_f32 v124, v124, v121
    v_cvt_pk_bf16_f32 v225, v123, v124
    v_lshlrev_b32 v123, 16, v226
    v_and_b32 v124, 0xffff0000, v226
    v_mul_f32 v123, v123, v121
    v_mul_f32 v124, v124, v121
    v_cvt_pk_bf16_f32 v226, v123, v124
    v_lshlrev_b32 v123, 16, v227
    v_and_b32 v124, 0xffff0000, v227
    v_mul_f32 v123, v123, v121
    v_mul_f32 v124, v124, v121
    v_cvt_pk_bf16_f32 v227, v123, v124
    v_lshlrev_b32 v123, 16, v228
    v_and_b32 v124, 0xffff0000, v228
    v_mul_f32 v123, v123, v121
    v_mul_f32 v124, v124, v121
    v_cvt_pk_bf16_f32 v228, v123, v124
    v_lshlrev_b32 v123, 16, v229
    v_and_b32 v124, 0xffff0000, v229
    v_mul_f32 v123, v123, v121
    v_mul_f32 v124, v124, v121
    v_cvt_pk_bf16_f32 v229, v123, v124
    v_lshlrev_b32 v123, 16, v230
    v_and_b32 v124, 0xffff0000, v230
    v_mul_f32 v123, v123, v121
    v_mul_f32 v124, v124, v121
    v_cvt_pk_bf16_f32 v230, v123, v124
    v_lshlrev_b32 v123, 16, v231
    v_and_b32 v124, 0xffff0000, v231
    v_mul_f32 v123, v123, v121
    v_mul_f32 v124, v124, v121
    v_cvt_pk_bf16_f32 v231, v123, v124
    v_lshlrev_b32 v123, 16, v232
    v_and_b32 v124, 0xffff0000, v232
    v_mul_f32 v123, v123, v121
    v_mul_f32 v124, v124, v121
    v_cvt_pk_bf16_f32 v232, v123, v124
    v_lshlrev_b32 v123, 16, v233
    v_and_b32 v124, 0xffff0000, v233
    v_mul_f32 v123, v123, v121
    v_mul_f32 v124, v124, v121
    v_cvt_pk_bf16_f32 v233, v123, v124
    v_lshlrev_b32 v123, 16, v234
    v_and_b32 v124, 0xffff0000, v234
    v_mul_f32 v123, v123, v121
    v_mul_f32 v124, v124, v121
    v_cvt_pk_bf16_f32 v234, v123, v124
    v_lshlrev_b32 v123, 16, v235
    v_and_b32 v124, 0xffff0000, v235
    v_mul_f32 v123, v123, v121
    v_mul_f32 v124, v124, v121
    v_cvt_pk_bf16_f32 v235, v123, v124
    v_lshlrev_b32 v123, 16, v236
    v_and_b32 v124, 0xffff0000, v236
    v_mul_f32 v123, v123, v121
    v_mul_f32 v124, v124, v121
    v_cvt_pk_bf16_f32 v236, v123, v124
    v_lshlrev_b32 v123, 16, v237
    v_and_b32 v124, 0xffff0000, v237
    v_mul_f32 v123, v123, v121
    v_mul_f32 v124, v124, v121
    v_cvt_pk_bf16_f32 v237, v123, v124
    v_lshlrev_b32 v123, 16, v238
    v_and_b32 v124, 0xffff0000, v238
    v_mul_f32 v123, v123, v121
    v_mul_f32 v124, v124, v121
    v_cvt_pk_bf16_f32 v238, v123, v124
    v_lshlrev_b32 v123, 16, v239
    v_and_b32 v124, 0xffff0000, v239
    v_mul_f32 v123, v123, v121
    v_mul_f32 v124, v124, v121
    v_cvt_pk_bf16_f32 v239, v123, v124
    v_lshlrev_b32 v123, 16, v240
    v_and_b32 v124, 0xffff0000, v240
    v_mul_f32 v123, v123, v121
    v_mul_f32 v124, v124, v121
    v_cvt_pk_bf16_f32 v240, v123, v124
    v_lshlrev_b32 v123, 16, v241
    v_and_b32 v124, 0xffff0000, v241
    v_mul_f32 v123, v123, v121
    v_mul_f32 v124, v124, v121
    v_cvt_pk_bf16_f32 v241, v123, v124
    v_lshlrev_b32 v123, 16, v242
    v_and_b32 v124, 0xffff0000, v242
    v_mul_f32 v123, v123, v121
    v_mul_f32 v124, v124, v121
    v_cvt_pk_bf16_f32 v242, v123, v124
    v_lshlrev_b32 v123, 16, v243
    v_and_b32 v124, 0xffff0000, v243
    v_mul_f32 v123, v123, v121
    v_mul_f32 v124, v124, v121
    v_cvt_pk_bf16_f32 v243, v123, v124
    v_lshlrev_b32 v123, 16, v244
    v_and_b32 v124, 0xffff0000, v244
    v_mul_f32 v123, v123, v121
    v_mul_f32 v124, v124, v121
    v_cvt_pk_bf16_f32 v244, v123, v124
    v_lshlrev_b32 v123, 16, v245
    v_and_b32 v124, 0xffff0000, v245
    v_mul_f32 v123, v123, v121
    v_mul_f32 v124, v124, v121
    v_cvt_pk_bf16_f32 v245, v123, v124
    v_lshlrev_b32 v123, 16, v246
    v_and_b32 v124, 0xffff0000, v246
    v_mul_f32 v123, v123, v121
    v_mul_f32 v124, v124, v121
    v_cvt_pk_bf16_f32 v246, v123, v124
    v_lshlrev_b32 v123, 16, v247
    v_and_b32 v124, 0xffff0000, v247
    v_mul_f32 v123, v123, v121
    v_mul_f32 v124, v124, v121
    v_cvt_pk_bf16_f32 v247, v123, v124
    v_lshlrev_b32 v123, 16, v248
    v_and_b32 v124, 0xffff0000, v248
    v_mul_f32 v123, v123, v121
    v_mul_f32 v124, v124, v121
    v_cvt_pk_bf16_f32 v248, v123, v124
    v_lshlrev_b32 v123, 16, v249
    v_and_b32 v124, 0xffff0000, v249
    v_mul_f32 v123, v123, v121
    v_mul_f32 v124, v124, v121
    v_cvt_pk_bf16_f32 v249, v123, v124
    v_lshlrev_b32 v123, 16, v250
    v_and_b32 v124, 0xffff0000, v250
    v_mul_f32 v123, v123, v121
    v_mul_f32 v124, v124, v121
    v_cvt_pk_bf16_f32 v250, v123, v124
    v_lshlrev_b32 v123, 16, v251
    v_and_b32 v124, 0xffff0000, v251
    v_mul_f32 v123, v123, v121
    v_mul_f32 v124, v124, v121
    v_cvt_pk_bf16_f32 v251, v123, v124
    v_lshlrev_b32 v123, 16, v252
    v_and_b32 v124, 0xffff0000, v252
    v_mul_f32 v123, v123, v121
    v_mul_f32 v124, v124, v121
    v_cvt_pk_bf16_f32 v252, v123, v124
    v_lshlrev_b32 v123, 16, v253
    v_and_b32 v124, 0xffff0000, v253
    v_mul_f32 v123, v123, v121
    v_mul_f32 v124, v124, v121
    v_cvt_pk_bf16_f32 v253, v123, v124
    v_lshlrev_b32 v123, 16, v254
    v_and_b32 v124, 0xffff0000, v254
    v_mul_f32 v123, v123, v121
    v_mul_f32 v124, v124, v121
    v_cvt_pk_bf16_f32 v254, v123, v124
    v_lshlrev_b32 v123, 16, v255
    v_and_b32 v124, 0xffff0000, v255
    v_mul_f32 v123, v123, v121
    v_mul_f32 v124, v124, v121
    v_cvt_pk_bf16_f32 v255, v123, v124
    s_nop 1
    s_setpc_b64 s[40:41]
L_ftail:
    s_waitcnt vmcnt(0) lgkmcnt(0)
    s_nop 15
    s_barrier
    v_lshlrev_b32 v10, 4, v1
    v_accvgpr_read_b32 v2, a250
    v_accvgpr_read_b32 v4, a251
    v_and_b32 v1, 496, v10
    v_lshlrev_b32 v1, 3, v1
    v_lshrrev_b32 v128, 4, v10
    v_and_b32 v129, 15, v128
    v_lshrrev_b32 v130, 4, v128
    v_lshlrev_b32 v0, 24, v128
    v_and_b32 v131, 16, v10
    v_mov_b32 v132, 0x3f80
    v_lshlrev_b32 v131, v131, v132
    v_bfe_u32 v132, v128, 1, 3
    v_cmp_eq_u32 vcc, 0, v132
    v_cmp_eq_u32 s[24:25], 1, v132
    s_nop 0
    v_cndmask_b32 v120, 0, v131, vcc
    v_cndmask_b32 v121, 0, v131, s[24:25]
    v_cmp_eq_u32 vcc, 2, v132
    v_cmp_eq_u32 s[24:25], 3, v132
    s_nop 0
    v_cndmask_b32 v122, 0, v131, vcc
    v_cndmask_b32 v123, 0, v131, s[24:25]
    v_cmp_eq_u32 vcc, 4, v132
    v_cmp_eq_u32 s[24:25], 5, v132
    s_nop 0
    v_cndmask_b32 v124, 0, v131, vcc
    v_cndmask_b32 v125, 0, v131, s[24:25]
    v_cmp_eq_u32 vcc, 6, v132
    v_cmp_eq_u32 s[24:25], 7, v132
    s_nop 0
    v_cndmask_b32 v126, 0, v131, vcc
    v_cndmask_b32 v127, 0, v131, s[24:25]
    v_and_b32 v131, 7, v128
    v_bfe_u32 v132, v128, 3, 1
    v_mul_u32_u24 v6, 100352, v130
    v_mul_u32_u24 v133, 25088, v132
    v_lshl_add_u32 v6, v131, 4, v6
    v_add_u32 v6, v6, v133
    v_lshl_add_u32 v133, v130, 3, v131
    v_lshlrev_b32 v133, 6, v133
    v_lshl_add_u32 v133, v132, 5, v133
    s_lshl_b32 s40, s3, 3
    s_add_u32 s40, s40, 98304
    v_add_u32 v8, s40, v133
    s_lshl_b32 s40, s3, 10
    s_add_u32 s40, s40, 98304
    v_add_u32 v9, s40, v10
    s_lshr_b32 s24, s55, 1
    s_cmp_eq_u32 s24, 6
    s_cselect_b32 s25, 2, 1
    s_cselect_b32 s26, 1, 16
    v_bfe_u32 v131, v128, 2, 3
    v_lshrrev_b32 v132, 5, v128
    v_mul_u32_u24 v131, s25, v131
    v_mul_u32_u24 v132, s26, v132
    v_add_u32 v131, v131, v132
    v_mul_u32_u24 v131, 896, v131
    v_and_b32 v132, 48, v10
    v_add_u32 v7, v131, v132
    s_lshr_b32 s25, s24, 1
    s_lshl_b32 s25, s25, 5
    s_and_b32 s24, s24, 1
    s_lshl_b32 s24, s24, 3
    s_add_u32 s24, s24, s25
    s_mul_i32 s24, s24, 896
    s_and_b32 s25, s55, 1
    s_lshl_b32 s25, s25, 6
    s_add_u32 s24, s24, s25
    s_lshl_b32 s25, s3, 7
    s_add_u32 s30, s24, s25
    s_cmp_eq_u32 s3, 3
    s_cselect_b32 s31, 0x1000000, s30
    v_and_b32 v4, -16, v4
    v_add_u32 v4, 23, v4
    buffer_store_dword v4, v0, s[12:15], 0 offen sc1
    buffer_load_dword v19, v1, s[8:11], 0 offen sc1
    s_waitcnt vmcnt(0)
    v_cmp_ne_u32 vcc, v19, v2
    v_and_b32 v3, 15, v19
    v_cmp_le_u32 s[26:27], 7, v3
    s_and_b64 vcc, vcc, s[26:27]
    s_cmp_eq_u64 vcc, -1
    s_cbranch_scc0 L_spin2
L_spun2:
    s_add_u32 s43, s57, 0
    buffer_load_dwordx4 v[144:147], v6, s[60:63], s43 offen sc1
    s_add_u32 s43, s57, 401408
    buffer_load_dwordx4 v[148:151], v6, s[60:63], s43 offen sc1
    s_add_u32 s43, s57, 802816
    buffer_load_dwordx4 v[152:155], v6, s[60:63], s43 offen sc1
    s_add_u32 s43, s57, 1204224
    buffer_load_dwordx4 v[156:159], v6, s[60:63], s43 offen sc1
    s_add_u32 s43, s57, 3584
    buffer_load_dwordx4 v[160:163], v6, s[60:63], s43 offen sc1
    s_add_u32 s43, s57, 404992
    buffer_load_dwordx4 v[164:167], v6, s[60:63], s43 offen sc1
    s_add_u32 s43, s57, 806400
    buffer_load_dwordx4 v[168:171], v6, s[60:63], s43 offen sc1
    s_add_u32 s43, s57, 1207808
    buffer_load_dwordx4 v[172:175], v6, s[60:63], s43 offen sc1
    s_add_u32 s43, s57, 7168
    buffer_load_dwordx4 v[176:179], v6, s[60:63], s43 offen sc1
    s_add_u32 s43, s57, 408576
    buffer_load_dwordx4 v[180:183], v6, s[60:63], s43 offen sc1
    s_add_u32 s43, s57, 809984
    buffer_load_dwordx4 v[184:187], v6, s[60:63], s43 offen sc1
    s_add_u32 s43, s57, 1211392
    buffer_load_dwordx4 v[188:191], v6, s[60:63], s43 offen sc1
    s_add_u32 s43, s57, 10752
    buffer_load_dwordx4 v[192:195], v6, s[60:63], s43 offen sc1
    s_add_u32 s43, s57, 412160
    buffer_load_dwordx4 v[196:199], v6, s[60:63], s43 offen sc1
    s_add_u32 s43, s57, 813568
    buffer_load_dwordx4 v[200:203], v6, s[60:63], s43 offen sc1
    s_add_u32 s43, s57, 1214976
    buffer_load_dwordx4 v[204:207], v6, s[60:63], s43 offen sc1
    s_add_u32 s43, s57, 14336
    buffer_load_dwordx4 v[208:211], v6, s[60:63], s43 offen sc1
    s_add_u32 s43, s57, 415744
    buffer_load_dwordx4 v[212:215], v6, s[60:63], s43 offen sc1
    s_add_u32 s43, s57, 817152
    buffer_load_dwordx4 v[216:219], v6, s[60:63], s43 offen sc1
    s_add_u32 s43, s57, 1218560
    buffer_load_dwordx4 v[220:223], v6, s[60:63], s43 offen sc1
    s_add_u32 s43, s57, 17920
    buffer_load_dwordx4 v[224:227], v6, s[60:63], s43 offen sc1
    s_add_u32 s43, s57, 419328
    buffer_load_dwordx4 v[228:231], v6, s[60:63], s43 offen sc1
    s_add_u32 s43, s57, 820736
    buffer_load_dwordx4 v[232:235], v6, s[60:63], s43 offen sc1
    s_add_u32 s43, s57, 1222144
    buffer_load_dwordx4 v[236:239], v6, s[60:63], s43 offen sc1
    s_add_u32 s43, s57, 21504
    buffer_load_dwordx4 v[240:243], v6, s[60:63], s43 offen sc1
    s_add_u32 s43, s57, 422912
    buffer_load_dwordx4 v[244:247], v6, s[60:63], s43 offen sc1
    s_add_u32 s43, s57, 824320
    buffer_load_dwordx4 v[248:251], v6, s[60:63], s43 offen sc1
    s_add_u32 s43, s57, 1225728
    buffer_load_dwordx4 v[252:255], v6, s[60:63], s43 offen sc1
    s_waitcnt vmcnt(27)
    v_mfma_f32_16x16x32_bf16 v[128:131], v[120:123], v[144:147], 0
    s_waitcnt vmcnt(26)
    v_mfma_f32_16x16x32_bf16 v[128:131], v[120:123], v[148:151], v[128:131]
    s_waitcnt vmcnt(25)
    v_mfma_f32_16x16x32_bf16 v[128:131], v[120:123], v[152:155], v[128:131]
    s_waitcnt vmcnt(24)
    v_mfma_f32_16x16x32_bf16 v[128:131], v[120:123], v[156:159], v[128:131]
    s_waitcnt vmcnt(23)
    v_mfma_f32_16x16x32_bf16 v[128:131], v[124:127], v[160:163], v[128:131]
    s_waitcnt vmcnt(22)
    v_mfma_f32_16x16x32_bf16 v[128:131], v[124:127], v[164:167], v[128:131]
    s_waitcnt vmcnt(21)
    v_mfma_f32_16x16x32_bf16 v[128:131], v[124:127], v[168:171], v[128:131]
    s_waitcnt vmcnt(20)
    v_mfma_f32_16x16x32_bf16 v[128:131], v[124:127], v[172:175], v[128:131]
    s_waitcnt vmcnt(19)
    v_mfma_f32_16x16x32_bf16 v[132:135], v[120:123], v[176:179], 0
    s_waitcnt vmcnt(18)
    v_mfma_f32_16x16x32_bf16 v[132:135], v[120:123], v[180:183], v[132:135]
    s_waitcnt vmcnt(17)
    v_mfma_f32_16x16x32_bf16 v[132:135], v[120:123], v[184:187], v[132:135]
    s_waitcnt vmcnt(16)
    v_mfma_f32_16x16x32_bf16 v[132:135], v[120:123], v[188:191], v[132:135]
    s_waitcnt vmcnt(15)
    v_mfma_f32_16x16x32_bf16 v[132:135], v[124:127], v[192:195], v[132:135]
    s_waitcnt vmcnt(14)
    v_mfma_f32_16x16x32_bf16 v[132:135], v[124:127], v[196:199], v[132:135]
    s_waitcnt vmcnt(13)
    v_mfma_f32_16x16x32_bf16 v[132:135], v[124:127], v[200:203], v[132:135]
    s_waitcnt vmcnt(12)
    v_mfma_f32_16x16x32_bf16 v[132:135], v[124:127], v[204:207], v[132:135]
    s_waitcnt vmcnt(11)
    v_mfma_f32_16x16x32_bf16 v[136:139], v[120:123], v[208:211], 0
    s_waitcnt vmcnt(10)
    v_mfma_f32_16x16x32_bf16 v[136:139], v[120:123], v[212:215], v[136:139]
    s_waitcnt vmcnt(9)
    v_mfma_f32_16x16x32_bf16 v[136:139], v[120:123], v[216:219], v[136:139]
    s_waitcnt vmcnt(8)
    v_mfma_f32_16x16x32_bf16 v[136:139], v[120:123], v[220:223], v[136:139]
    s_waitcnt vmcnt(7)
    v_mfma_f32_16x16x32_bf16 v[136:139], v[124:127], v[224:227], v[136:139]
    s_waitcnt vmcnt(6)
    v_mfma_f32_16x16x32_bf16 v[136:139], v[124:127], v[228:231], v[136:139]
    s_waitcnt vmcnt(5)
    v_mfma_f32_16x16x32_bf16 v[136:139], v[124:127], v[232:235], v[136:139]
    s_waitcnt vmcnt(4)
    v_mfma_f32_16x16x32_bf16 v[136:139], v[124:127], v[236:239], v[136:139]
    s_waitcnt vmcnt(3)
    v_mfma_f32_16x16x32_bf16 v[140:143], v[120:123], v[240:243], 0
    s_waitcnt vmcnt(2)
    v_mfma_f32_16x16x32_bf16 v[140:143], v[120:123], v[244:247], v[140:143]
    s_waitcnt vmcnt(1)
    v_mfma_f32_16x16x32_bf16 v[140:143], v[120:123], v[248:251], v[140:143]
    s_waitcnt vmcnt(0)
    v_mfma_f32_16x16x32_bf16 v[140:143], v[120:123], v[252:255], v[140:143]
    v_cvt_pk_bf16_f32 v128, v128, v129
    v_cvt_pk_bf16_f32 v129, v130, v131
    ds_write_b64 v8, v[128:129] offset:0
    v_cvt_pk_bf16_f32 v132, v132, v133
    v_cvt_pk_bf16_f32 v133, v134, v135
    ds_write_b64 v8, v[132:133] offset:2048
    v_cvt_pk_bf16_f32 v136, v136, v137
    v_cvt_pk_bf16_f32 v137, v138, v139
    ds_write_b64 v8, v[136:137] offset:4096
    v_cvt_pk_bf16_f32 v140, v140, v141
    v_cvt_pk_bf16_f32 v141, v142, v143
    ds_write_b64 v8, v[140:141] offset:6144
    s_waitcnt lgkmcnt(0)
    s_barrier
    ds_read_b128 v[128:131], v9
    ds_read_b128 v[132:135], v9 offset:4096
    s_waitcnt lgkmcnt(1)
    buffer_store_dwordx4 v[128:131], v7, s[64:67], s30 offen
    s_waitcnt lgkmcnt(0)
    buffer_store_dwordx4 v[132:135], v7, s[64:67], s31 offen offset:512
    s_waitcnt vmcnt(0)
    s_endpgm
.section .rodata,"a"
.p2align 6
.amdhsa_kernel standalone__gqa_block_cached__near_ridge_kernel
  .amdhsa_next_free_vgpr 512
  .amdhsa_next_free_sgpr 102
  .amdhsa_accum_offset 256
  .amdhsa_group_segment_fixed_size 0
  .amdhsa_kernarg_size 64
  .amdhsa_user_sgpr_count 2
  .amdhsa_user_sgpr_kernarg_segment_ptr 1
  .amdhsa_system_sgpr_workgroup_id_x 1
.end_amdhsa_kernel
```
